```python
import torch

def _softmax(x, axis=-1):
    return torch.softmax(x, dim=axis)

def _gelu(x):
    return torch.nn.functional.gelu(x, approximate='tanh')

def _silu(x):
    return torch.nn.functional.silu(x)

def _sigmoid(x):
    return torch.sigmoid(x)

def _layernorm(x, axis=-1, eps=1e-05):
    m = x.mean(dim=axis, keepdim=True)
    v = x.var(dim=axis, keepdim=True, unbiased=False)
    return (x - m) / torch.sqrt(v + eps)

def _scatter_add(tgt, idx, src, axis=0):
    return tgt.clone().index_add_(axis, idx, src)

def _segment_sum(src, seg, n):
    out = torch.zeros((n,) + src.shape[1:], dtype=src.dtype)
    return out.index_add_(0, seg, src)

def _pad(x, pw):
    flat = tuple((v for pair in reversed(pw) for v in pair))
    return torch.nn.functional.pad(x, flat)
kernel_name = 'adaLN_cond__compressed_kv_cla__moe_arch_mod__prompt'

def setup_inputs():

    _w = lambda a: (lambda t: t.to(torch.bfloat16) if t.is_floating_point() else t)(torch.as_tensor(a))

    def _A_setup():
        B, H, Sq, Sk, D, M = (1, 32, 2048, 2048, 128, 640)
        Dc = 4 * D
        return {'x': _w((lambda *s: torch.randn(*s, dtype=torch.bfloat16) * 0.1)(B, Sq, M)), 'c_kv': _w((lambda *s: torch.randn(*s, dtype=torch.bfloat16) * 1.6)(B, Sk, Dc)), 'w_q': _w((lambda *s: torch.randn(*s, dtype=torch.bfloat16) * 0.8)(M, H, D) * M ** (-0.5)), 'w_uk': _w((lambda *s: torch.randn(*s, dtype=torch.bfloat16) * 0.8)(Dc, H, D) * Dc ** (-0.5)), 'w_uv': _w((lambda *s: torch.randn(*s, dtype=torch.bfloat16) * 1.6)(Dc, H, D) * Dc ** (-0.5)), 'w_o': _w((lambda *s: torch.randn(*s, dtype=torch.bfloat16) * 1.6)(H, D, M) * (H * D) ** (-0.5))}
    _A_in = _A_setup()

    def _B_setup():
        B, S, D, F, C = (1, 2048, 640, 1728, 8)
        return {'x': _w((lambda *s: torch.randn(*s, dtype=torch.bfloat16) * 0.1)(B, S, D)), 'w_r': _w((lambda *s: torch.randn(*s, dtype=torch.bfloat16) * 0.1)(D)), 'w_gate': _w((lambda *s: torch.randn(*s, dtype=torch.bfloat16) * 0.1)(D, F)), 'w_up': _w((lambda *s: torch.randn(*s, dtype=torch.bfloat16) * 0.1)(D, F)), 'w_down': _w((lambda *s: torch.randn(*s, dtype=torch.bfloat16) * 0.1)(F, D))}
    _B_in = _B_setup()
    return {'A_x': _A_in['x'], 'A_c_kv': _A_in['c_kv'], 'A_w_q': _A_in['w_q'], 'A_w_uk': _A_in['w_uk'], 'A_w_uv': _A_in['w_uv'], 'A_w_o': _A_in['w_o'], 'B_x': _B_in['x'], 'B_w_r': _B_in['w_r'], 'B_w_gate': _B_in['w_gate'], 'B_w_up': _B_in['w_up'], 'B_w_down': _B_in['w_down'], 'c': _w((lambda *s: torch.randn(*s, dtype=torch.bfloat16) * 0.2)(1, 640) * 8.0), 'w_mod': _w((lambda *s: torch.randn(*s, dtype=torch.bfloat16) * 0.2)(640, 6 * 640) * 640 ** (-0.5) * 8.0)}

def reference(A_x, A_c_kv, A_w_q, A_w_uk, A_w_uv, A_w_o, B_x, B_w_r, B_w_gate, B_w_up, B_w_down, c, w_mod):

    def _A_ref(x, c_kv, w_q, w_uk, w_uv, w_o):
        B, Sq, M = (x.shape[0], x.shape[1], x.shape[2])
        Sk = c_kv.shape[1]
        H, D = (w_q.shape[1], w_q.shape[2])
        q = torch.einsum('bqm,mhd->bhqd', x, w_q)
        k = torch.einsum('bkc,chd->bhkd', c_kv, w_uk)
        v = torch.einsum('bkc,chd->bhkd', c_kv, w_uv)
        scores = torch.einsum('bhqd,bhkd->bhqk', q, k) * D ** (-0.5)
        off = Sk - Sq
        qi = torch.arange(Sq)[:, None]
        kj = torch.arange(Sk)[None, :]
        cmask = kj <= qi + off
        scores = torch.where(cmask[None, None], scores, -1000000000.0)
        p = _softmax(scores, axis=-1)
        ctx = torch.einsum('bhqk,bhkd->bhqd', p, v)
        return torch.einsum('bhqd,hdm->bqm', ctx, w_o)

    def _B_ref(x, w_r, w_gate, w_up, w_down):
        B, S, D = x.shape
        C = 8
        r = x @ w_r
        idx = torch.argsort(-r, axis=-1)[:, :C]
        idx_e = (lambda x, n, axis: torch.repeat_interleave(x, n, dim=axis))(idx.reshape(B, C, 1), D, axis=2)
        x_sel = (lambda x, i, axis: torch.take_along_dim(x, i, dim=axis))(x, idx_e, axis=1)
        g = _silu(x_sel @ w_gate)
        u = x_sel @ w_up
        y = g * u @ w_down
        r_sel = _sigmoid((lambda x, i, axis: torch.take_along_dim(x, i, dim=axis))(r, idx, axis=1))
        y = y * r_sel.reshape(B, C, 1)
        b_off = (torch.arange(B) * S).reshape(B, 1)
        flat_idx = (idx + b_off).reshape(B * C)
        zero = (x * 0.0).reshape(B * S, D)
        upd = _scatter_add(zero, flat_idx, y.reshape(B * C, D), axis=0)
        return x + upd.reshape(B, S, D)
    x = A_x
    mod = (_silu(c) @ w_mod).reshape(c.shape[0], 6, 1, -1)
    sa, ca, ga, sb, cb, gb = (mod[:, 0].clone(), mod[:, 1].clone(), mod[:, 2].clone(), mod[:, 3].clone(), mod[:, 4].clone(), mod[:, 5].clone())
    h = _layernorm(x, axis=-1) * (1 + ca) + sa
    x = x + ga * _A_ref(h, A_c_kv, A_w_q, A_w_uk, A_w_uv, A_w_o)
    h = _layernorm(x, axis=-1) * (1 + cb) + sb
    x = x + gb * _B_ref(h, B_w_r, B_w_gate, B_w_up, B_w_down)
    return x
```

```asm
; @launch kernel=k1_kernel grid=(256,1,1) block=(512,1,1) lds=163840
.amdgcn_target "amdgcn-amd-amdhsa--gfx950"
.text
.globl k1_kernel
.p2align 8
.type k1_kernel,@function
k1_kernel:
    s_cmp_ge_u32 s2, 256
    s_cbranch_scc1 k1_end
    s_load_dwordx8 s[76:83], s[0:1], 0
    s_load_dwordx2 s[84:85], s[0:1], 32
    s_load_dwordx8 s[88:95], s[0:1], 88
    s_load_dwordx2 s[96:97], s[0:1], 120
    s_load_dwordx2 s[64:65], s[0:1], 40
    v_lshrrev_b32 v1, 6, v0
    s_nop 0
    v_readfirstlane_b32 s22, v1
    v_lshrrev_b32 v1, 1, v0
    v_and_b32 v2, 1, v0
    v_lshlrev_b32 v184, 1, v1
    v_mul_u32_u24 v185, 7680, v1
    v_lshl_add_u32 v185, v2, 4, v185
    v_lshrrev_b32 v1, 4, v0
    v_lshl_add_u32 v1, v1, 1, v2
    v_lshlrev_b32 v1, 5, v1
    v_add_u32 v163, 49152, v1
    v_and_b32 v0, 63, v0
    s_lshr_b32 s4, s22, 2
    s_and_b32 s5, s22, 3
    s_and_b32 s3, s2, 7
    s_lshr_b32 s15, s2, 3
    s_lshl_b32 s10, s3, 5
    s_add_u32 s10, s10, s15
    s_lshl_b32 s6, s3, 1
    s_and_b32 s3, s15, 1
    s_add_u32 s6, s6, s3
    s_and_b32 s3, s15, 2
    s_lshl_b32 s3, s3, 3
    s_add_u32 s6, s6, s3
    s_lshr_b32 s9, s15, 2
    s_and_b32 s7, s9, 1
    s_lshr_b32 s8, s15, 3
    s_lshl_b32 s12, s22, 11
    s_lshl_b32 s13, s8, 17
    s_lshl_b32 s3, s22, 14
    s_add_u32 s13, s13, s3
    s_lshl_b32 s14, s22, 15
    s_lshl_b32 s3, s6, 8
    s_add_u32 s14, s14, s3
    v_lshrrev_b32 v1, 3, v0
    v_lshlrev_b32 v1, 10, v1
    v_and_b32 v2, 7, v0
    v_lshrrev_b32 v3, 4, v0
    v_xor_b32 v2, v2, v3
    v_lshl_or_b32 v4, v2, 4, v1
    v_xor_b32 v5, 64, v4
    v_add_u32 v5, 7168, v5
    v_and_b32 v2, 15, v0
    v_lshlrev_b32 v1, 1, v3
    v_xor_b32 v2, v2, v1
    s_lshl_b32 s3, s22, 2
    s_and_b32 s3, s3, 8
    v_xor_b32 v2, s3, v2
    v_lshlrev_b32 v1, 13, v3
    v_lshl_or_b32 v6, v2, 4, v1
    v_add_u32 v7, 261120, v6
    v_lshlrev_b32 v20, 4, v0
    v_lshlrev_b32 v21, 2, v0
    s_lshl_b32 s17, s2, 3
    s_add_u32 s17, s17, s22
    s_mul_i32 s17, s17, 1280
    s_lshl_b32 s11, s10, 5
    s_waitcnt lgkmcnt(0)
    s_mov_b32 s24, s78
    s_mov_b32 s25, s79
    s_mov_b32 s26, 2097152
    s_mov_b32 s27, 0x00020000
    s_cmp_eq_u32 s7, 0
    s_cselect_b32 s28, s82, s84
    s_cselect_b32 s29, s83, s85
    s_mov_b32 s30, 4194304
    s_mov_b32 s31, 0x00020000
    s_mov_b32 s52, s88
    s_mov_b32 s53, s89
    s_mov_b32 s54, 1280
    s_mov_b32 s55, 0x00020000
    s_mov_b32 s56, s90
    s_mov_b32 s57, s91
    s_mov_b32 s58, 4915200
    s_mov_b32 s59, 0x00020000
    s_mov_b32 s48, s76
    s_mov_b32 s49, s77
    s_mov_b32 s50, 2621440
    s_mov_b32 s51, 0x00020000
    buffer_load_ushort v160, v184, s[52:55], 0 offen offset:0
    buffer_load_ushort v161, v184, s[52:55], 0 offen offset:512
    buffer_load_ushort v162, v184, s[52:55], 0 offen offset:1024
    s_add_u32 s15, s11, 0
    buffer_load_dwordx4 v[164:167], v185, s[56:59], s15 offen nt
    s_add_u32 s15, s11, 1966080
    buffer_load_dwordx4 v[168:171], v185, s[56:59], s15 offen nt
    s_add_u32 s15, s11, 3932160
    buffer_load_dwordx4 v[172:175], v185, s[56:59], s15 offen nt
    buffer_load_dwordx4 v[24:27], v20, s[48:51], s17 offen nt
    buffer_load_dword v28, v21, s[48:51], s17 offen offset:1024 nt
    s_add_u32 m0, s12, 114688
    s_add_u32 s15, s13, 0
    buffer_load_dwordx4 v4, s[24:27], s15 offen lds
    buffer_load_dwordx4 v5, s[24:27], s15 offen offset:1024 lds
    s_add_u32 m0, s12, 131072
    s_add_u32 s15, s14, 0
    buffer_load_dwordx4 v6, s[28:31], s15 offen nt lds
    buffer_load_dwordx4 v7, s[28:31], s15 offen offset:1024 nt lds
    s_add_u32 m0, s12, 147456
    s_add_u32 s15, s13, 128
    buffer_load_dwordx4 v4, s[24:27], s15 offen lds
    buffer_load_dwordx4 v5, s[24:27], s15 offen offset:1024 lds
    s_add_u32 m0, s12, 0
    s_add_u32 s15, s14, 524288
    buffer_load_dwordx4 v6, s[28:31], s15 offen nt lds
    buffer_load_dwordx4 v7, s[28:31], s15 offen offset:1024 nt lds
    s_mov_b32 s32, s80
    s_mov_b32 s33, s81
    s_mov_b32 s34, 5242880
    s_mov_b32 s35, 0x00020000
    v_lshlrev_b32 v1, 7, v0
    v_cmp_gt_u32 vcc, 32, v0
    v_mov_b32 v2, 1073741824
    s_nop 0
    v_cndmask_b32 v50, v2, v1, vcc
    v_lshrrev_b32 v1, 1, v0
    v_lshlrev_b32 v1, 13, v1
    v_and_b32 v51, 1, v0
    v_lshl_add_u32 v1, v51, 7, v1
    v_cmp_gt_u32 vcc, 20, v0
    s_nop 1
    v_cndmask_b32 v51, v2, v1, vcc
    v_lshrrev_b32 v1, 2, v0
    v_lshlrev_b32 v1, 19, v1
    v_bfe_u32 v52, v0, 1, 1
    v_lshl_add_u32 v1, v52, 13, v1
    v_and_b32 v52, 1, v0
    v_lshl_add_u32 v1, v52, 7, v1
    v_cmp_gt_u32 vcc, 24, v0
    s_nop 1
    v_cndmask_b32 v1, v2, v1, vcc
    s_lshl_b32 s3, s8, 3
    s_add_u32 s3, s3, s22
    s_lshl_b32 s3, s3, 14
    s_lshl_b32 s15, s6, 8
    s_add_u32 s3, s3, s15
    s_add_u32 s3, s3, 1048576
    buffer_load_dword v52, v1, s[28:31], s3 offen nt
    s_lshr_b32 s3, s2, 3
    s_lshl_b32 s3, s3, 3
    s_add_u32 s3, s3, s22
    s_lshl_b32 s3, s3, 12
    buffer_load_dword v53, v50, s[24:27], s3 offen
    s_mov_b32 s36, s96
    s_mov_b32 s37, s97
    s_mov_b32 s38, 268435456
    s_mov_b32 s39, 0x00020000
    s_mov_b32 s40, s96
    s_mov_b32 s41, s97
    s_mov_b32 s42, 268435456
    s_mov_b32 s43, 0x00020000
    s_mov_b32 s44, s94
    s_mov_b32 s45, s95
    s_mov_b32 s46, 256
    s_mov_b32 s47, 0x00020000
    v_and_b32 v1, 15, v0
    v_lshrrev_b32 v2, 1, v1
    v_xor_b32 v2, v2, v3
    s_lshl_b32 s3, s4, 13
    v_lshlrev_b32 v1, 7, v1
    v_add_u32 v1, s3, v1
    v_lshl_or_b32 v8, v2, 4, v1
    v_xor_b32 v9, 64, v8
    v_add_u32 v10, 65536, v8
    v_add_u32 v11, 65536, v9
    v_add_u32 v12, 131072, v8
    v_add_u32 v13, 131072, v9
    v_bfe_u32 v1, v0, 2, 2
    v_lshlrev_b32 v2, 8, v1
    v_lshl_add_u32 v2, v3, 12, v2
    v_and_b32 v47, 1, v3
    v_lshl_add_u32 v1, v47, 2, v1
    v_lshlrev_b32 v1, 1, v1
    v_bfe_u32 v47, v0, 1, 1
    v_xor_b32 v1, v1, v47
    v_lshl_add_u32 v2, v1, 4, v2
    v_and_b32 v1, 1, v0
    v_lshl_add_u32 v47, v1, 3, v2
    s_lshl_b32 s3, s5, 6
    v_xor_b32 v14, s3, v47
    v_xor_b32 v15, 32, v14
    v_add_u32 v16, 65536, v14
    v_add_u32 v17, 65536, v15
    v_add_u32 v18, 131072, v14
    v_add_u32 v19, 131072, v15
    s_mov_b32 s15, 1073741824
    s_cmp_eq_u32 s22, 0
    s_cselect_b32 s3, 0, s15
    s_cselect_b32 s60, 0, 0xffff
    v_mov_b32 v1, s15
    v_cmp_eq_u32 vcc, 0, v0
    v_mov_b32 v2, s3
    s_nop 0
    v_cndmask_b32 v22, v1, v2, vcc
    v_add_u32 v2, s3, v21
    v_cmp_gt_u32 vcc, 16, v0
    s_nop 1
    v_cndmask_b32 v31, v1, v2, vcc
    s_cmp_eq_u32 s5, 0
    s_cselect_b32 s3, 0, s15
    s_cselect_b32 s19, 0, 0xffff
    v_add_u32 v2, s3, v21
    v_cndmask_b32 v23, v1, v2, vcc
    v_mov_b32 v30, 1
    v_mov_b32 v35, 0
    s_lshl_b32 s3, s10, 8
    s_add_u32 s3, s3, 83951616
    s_cmp_lt_u32 s10, 48
    s_cselect_b32 s3, s3, s15
    buffer_store_dword v35, v31, s[36:39], s3 offen sc1
    s_lshl_b32 s3, s10, 10
    s_add_u32 s3, s3, 83968000
    s_lshl_b32 s61, s22, 6
    s_add_u32 s61, s61, s10
    s_cmp_lt_u32 s61, 52
    s_cselect_b32 s3, s3, s15
    s_cmp_lt_u32 s61, 24
    s_cselect_b32 s61, 0, -1
    v_mov_b32 v36, s61
    v_mov_b32 v37, s61
    v_mov_b32 v38, s61
    v_mov_b32 v39, s61
    buffer_store_dwordx4 v[36:39], v20, s[36:39], s3 offen sc1
    s_cmp_eq_u32 s22, 0
    s_cselect_b32 s3, 0, s15
    s_cmp_lt_u32 s10, 240
    s_cselect_b32 s3, s3, s15
    v_lshlrev_b32 v2, 1, v0
    v_add_u32 v2, s3, v2
    v_and_b32 v33, 0x31, v0
    v_cmp_eq_u32 vcc, 0, v33
    s_nop 1
    v_cndmask_b32 v33, v1, v2, vcc
    v_and_b32 v1, 15, v0
    v_lshlrev_b32 v1, 2, v1
    v_lshl_add_u32 v1, v3, 9, v1
    v_add_u32 v32, 49152, v1
    s_sub_u32 s3, s10, 40
    s_cmp_lt_u32 s3, 40
    s_cselect_b32 s18, 1.0, 0
    s_sub_u32 s3, s10, 160
    s_cmp_lt_u32 s3, 40
    s_cselect_b32 s18, 1.0, s18
    s_lshl_b32 s16, s6, 20
    s_lshl_b32 s3, s8, 16
    s_add_u32 s16, s16, s3
    s_lshl_b32 s3, s4, 15
    s_add_u32 s16, s16, s3
    s_lshl_b32 s3, s5, 10
    s_lshl_b32 s3, s3, s7
    s_add_u32 s16, s16, s3
    s_lshl_b32 s3, s7, 14
    s_add_u32 s16, s16, s3
    s_sub_u32 s3, 15, s9
    s_cmp_eq_u32 s4, 0
    s_cselect_b32 s23, s3, s9
    s_lshl_b32 s3, s23, 2
    s_add_u32 s3, s3, s5
    s_mul_i32 s3, s3, 40960
    s_add_u32 s20, s3, 50331648
    s_lshr_b32 s3, s2, 1
    s_mul_i32 s21, s3, 20480
    s_and_b32 s3, s2, 1
    s_lshl_b32 s3, s3, 7
    s_add_u32 s21, s21, s3
    s_add_u32 s21, s21, 50331648
    s_waitcnt vmcnt(17)
    s_mov_b32 s3, 0xbfb8aa3b
    v_lshlrev_b32 v160, 16, v160
    v_mul_f32 v184, s3, v160
    v_exp_f32 v184, v184
    v_lshlrev_b32 v161, 16, v161
    v_mul_f32 v185, s3, v161
    v_exp_f32 v185, v185
    v_lshlrev_b32 v162, 16, v162
    v_mul_f32 v186, s3, v162
    v_exp_f32 v186, v186
    v_add_f32 v184, 1.0, v184
    v_rcp_f32 v184, v184
    v_add_f32 v185, 1.0, v185
    v_rcp_f32 v185, v185
    v_add_f32 v186, 1.0, v186
    v_rcp_f32 v186, v186
    v_mul_f32 v160, v160, v184
    v_cvt_pk_bf16_f32 v160, v160, v160
    v_lshlrev_b32 v160, 16, v160
    v_mul_f32 v161, v161, v185
    v_cvt_pk_bf16_f32 v161, v161, v161
    v_lshlrev_b32 v161, 16, v161
    v_mul_f32 v162, v162, v186
    v_cvt_pk_bf16_f32 v162, v162, v162
    v_lshlrev_b32 v162, 16, v162
    s_waitcnt vmcnt(16)
    v_lshlrev_b32 v184, 16, v164
    v_and_b32 v185, 0xffff0000, v164
    v_lshlrev_b32 v186, 16, v165
    v_and_b32 v187, 0xffff0000, v165
    v_lshlrev_b32 v188, 16, v166
    v_and_b32 v189, 0xffff0000, v166
    v_lshlrev_b32 v190, 16, v167
    v_and_b32 v191, 0xffff0000, v167
    v_mul_f32 v176, v160, v184
    v_mul_f32 v177, v160, v185
    v_mul_f32 v178, v160, v186
    v_mul_f32 v179, v160, v187
    v_mul_f32 v180, v160, v188
    v_mul_f32 v181, v160, v189
    v_mul_f32 v182, v160, v190
    v_mul_f32 v183, v160, v191
    s_waitcnt vmcnt(15)
    v_lshlrev_b32 v184, 16, v168
    v_and_b32 v185, 0xffff0000, v168
    v_lshlrev_b32 v186, 16, v169
    v_and_b32 v187, 0xffff0000, v169
    v_lshlrev_b32 v188, 16, v170
    v_and_b32 v189, 0xffff0000, v170
    v_lshlrev_b32 v190, 16, v171
    v_and_b32 v191, 0xffff0000, v171
    v_fmac_f32 v176, v161, v184
    v_fmac_f32 v177, v161, v185
    v_fmac_f32 v178, v161, v186
    v_fmac_f32 v179, v161, v187
    v_fmac_f32 v180, v161, v188
    v_fmac_f32 v181, v161, v189
    v_fmac_f32 v182, v161, v190
    v_fmac_f32 v183, v161, v191
    s_waitcnt vmcnt(14)
    v_lshlrev_b32 v184, 16, v172
    v_and_b32 v185, 0xffff0000, v172
    v_lshlrev_b32 v186, 16, v173
    v_and_b32 v187, 0xffff0000, v173
    v_lshlrev_b32 v188, 16, v174
    v_and_b32 v189, 0xffff0000, v174
    v_lshlrev_b32 v190, 16, v175
    v_and_b32 v191, 0xffff0000, v175
    v_fmac_f32 v176, v162, v184
    v_fmac_f32 v177, v162, v185
    v_fmac_f32 v178, v162, v186
    v_fmac_f32 v179, v162, v187
    v_fmac_f32 v180, v162, v188
    v_fmac_f32 v181, v162, v189
    v_fmac_f32 v182, v162, v190
    v_fmac_f32 v183, v162, v191
    v_add_f32_dpp v176, v176, v176 row_ror:2 row_mask:0xf bank_mask:0xf
    v_add_f32_dpp v177, v177, v177 row_ror:2 row_mask:0xf bank_mask:0xf
    v_add_f32_dpp v178, v178, v178 row_ror:2 row_mask:0xf bank_mask:0xf
    v_add_f32_dpp v179, v179, v179 row_ror:2 row_mask:0xf bank_mask:0xf
    v_add_f32_dpp v180, v180, v180 row_ror:2 row_mask:0xf bank_mask:0xf
    v_add_f32_dpp v181, v181, v181 row_ror:2 row_mask:0xf bank_mask:0xf
    v_add_f32_dpp v182, v182, v182 row_ror:2 row_mask:0xf bank_mask:0xf
    v_add_f32_dpp v183, v183, v183 row_ror:2 row_mask:0xf bank_mask:0xf
    v_add_f32_dpp v176, v176, v176 row_ror:4 row_mask:0xf bank_mask:0xf
    v_add_f32_dpp v177, v177, v177 row_ror:4 row_mask:0xf bank_mask:0xf
    v_add_f32_dpp v178, v178, v178 row_ror:4 row_mask:0xf bank_mask:0xf
    v_add_f32_dpp v179, v179, v179 row_ror:4 row_mask:0xf bank_mask:0xf
    v_add_f32_dpp v180, v180, v180 row_ror:4 row_mask:0xf bank_mask:0xf
    v_add_f32_dpp v181, v181, v181 row_ror:4 row_mask:0xf bank_mask:0xf
    v_add_f32_dpp v182, v182, v182 row_ror:4 row_mask:0xf bank_mask:0xf
    v_add_f32_dpp v183, v183, v183 row_ror:4 row_mask:0xf bank_mask:0xf
    v_add_f32_dpp v176, v176, v176 row_ror:8 row_mask:0xf bank_mask:0xf
    v_add_f32_dpp v177, v177, v177 row_ror:8 row_mask:0xf bank_mask:0xf
    v_add_f32_dpp v178, v178, v178 row_ror:8 row_mask:0xf bank_mask:0xf
    v_add_f32_dpp v179, v179, v179 row_ror:8 row_mask:0xf bank_mask:0xf
    v_add_f32_dpp v180, v180, v180 row_ror:8 row_mask:0xf bank_mask:0xf
    v_add_f32_dpp v181, v181, v181 row_ror:8 row_mask:0xf bank_mask:0xf
    v_add_f32_dpp v182, v182, v182 row_ror:8 row_mask:0xf bank_mask:0xf
    v_add_f32_dpp v183, v183, v183 row_ror:8 row_mask:0xf bank_mask:0xf
    ds_write_b128 v163, v[176:179]
    ds_write_b128 v163, v[180:183] offset:16
    s_waitcnt lgkmcnt(0)
    s_barrier
    ds_read2_b32 v[36:37], v32 offset0:0 offset1:16
    ds_read2_b32 v[38:39], v32 offset0:32 offset1:48
    ds_read2_b32 v[40:41], v32 offset0:64 offset1:80
    ds_read2_b32 v[42:43], v32 offset0:96 offset1:112
    s_lshl_b32 s3, s10, 5
    s_add_u32 s3, s3, 83886080
    s_waitcnt lgkmcnt(0)
    v_add_f32 v36, v36, v37
    v_add_f32 v38, v38, v39
    v_add_f32 v40, v40, v41
    v_add_f32 v42, v42, v43
    v_add_f32 v36, v36, v38
    v_add_f32 v40, v40, v42
    v_add_f32 v36, v36, v40
    v_mov_b32 v37, v36
    s_nop 1
    v_permlane16_swap_b32 v36, v37
    v_add_f32 v36, v36, v37
    v_mov_b32 v37, v36
    s_nop 1
    v_permlane32_swap_b32 v36, v37
    v_add_f32 v36, v36, v37
    v_cvt_pk_bf16_f32 v36, v36, v36
    v_lshlrev_b32 v36, 16, v36
    v_add_f32 v36, s18, v36
    s_nop 1
    v_mov_b32_dpp v37, v36 quad_perm:[1,0,3,2] row_mask:0xf bank_mask:0xf
    v_cvt_pk_bf16_f32 v34, v36, v37
    buffer_store_dword v34, v33, s[36:39], s3 offen sc1
    s_waitcnt vmcnt(13)
    v_lshlrev_b32 v36, 16, v24
    v_and_b32 v37, 0xffff0000, v24
    v_lshlrev_b32 v38, 16, v25
    v_and_b32 v39, 0xffff0000, v25
    v_lshlrev_b32 v40, 16, v26
    v_and_b32 v41, 0xffff0000, v26
    v_lshlrev_b32 v42, 16, v27
    v_and_b32 v43, 0xffff0000, v27
    v_lshlrev_b32 v44, 16, v28
    v_and_b32 v45, 0xffff0000, v28
    v_add_f32 v46, v36, v37
    v_add_f32 v1, v38, v39
    v_add_f32 v46, v46, v40
    v_add_f32 v1, v1, v41
    v_add_f32 v46, v46, v42
    v_add_f32 v1, v1, v43
    v_add_f32 v46, v46, v44
    v_add_f32 v1, v1, v45
    v_add_f32 v46, v46, v1
    s_nop 1
    v_add_f32_dpp v46, v46, v46 row_ror:1 row_mask:0xf bank_mask:0xf
    s_nop 1
    v_add_f32_dpp v46, v46, v46 row_ror:2 row_mask:0xf bank_mask:0xf
    s_nop 1
    v_add_f32_dpp v46, v46, v46 row_ror:4 row_mask:0xf bank_mask:0xf
    s_nop 1
    v_add_f32_dpp v46, v46, v46 row_ror:8 row_mask:0xf bank_mask:0xf
    v_mov_b32 v2, v46
    s_nop 1
    v_permlane16_swap_b32 v46, v2
    v_add_f32 v46, v46, v2
    v_mov_b32 v2, v46
    s_nop 1
    v_permlane32_swap_b32 v46, v2
    v_add_f32 v46, v46, v2
    v_mul_f32 v46, 0x3acccccd, v46
    v_sub_f32 v2, v36, v46
    v_mul_f32 v1, v2, v2
    v_sub_f32 v3, v37, v46
    v_fmac_f32 v1, v3, v3
    v_sub_f32 v2, v38, v46
    v_fmac_f32 v1, v2, v2
    v_sub_f32 v3, v39, v46
    v_fmac_f32 v1, v3, v3
    v_sub_f32 v2, v40, v46
    v_fmac_f32 v1, v2, v2
    v_sub_f32 v3, v41, v46
    v_fmac_f32 v1, v3, v3
    v_sub_f32 v2, v42, v46
    v_fmac_f32 v1, v2, v2
    v_sub_f32 v3, v43, v46
    v_fmac_f32 v1, v3, v3
    v_sub_f32 v2, v44, v46
    v_fmac_f32 v1, v2, v2
    v_sub_f32 v3, v45, v46
    v_fmac_f32 v1, v3, v3
    s_nop 1
    v_add_f32_dpp v1, v1, v1 row_ror:1 row_mask:0xf bank_mask:0xf
    s_nop 1
    v_add_f32_dpp v1, v1, v1 row_ror:2 row_mask:0xf bank_mask:0xf
    s_nop 1
    v_add_f32_dpp v1, v1, v1 row_ror:4 row_mask:0xf bank_mask:0xf
    s_nop 1
    v_add_f32_dpp v1, v1, v1 row_ror:8 row_mask:0xf bank_mask:0xf
    v_mov_b32 v2, v1
    s_nop 1
    v_permlane16_swap_b32 v1, v2
    v_add_f32 v1, v1, v2
    v_mov_b32 v2, v1
    s_nop 1
    v_permlane32_swap_b32 v1, v2
    v_add_f32 v1, v1, v2
    v_mul_f32 v1, 0x3acccccd, v1
    v_cvt_pk_bf16_f32 v1, v1, v1
    v_lshlrev_b32 v1, 16, v1
    v_cvt_pk_bf16_f32 v46, v46, v46
    v_lshlrev_b32 v46, 16, v46
    v_add_f32 v1, 0x3727c5ac, v1
    v_cvt_pk_bf16_f32 v1, v1, v1
    v_lshlrev_b32 v1, 16, v1
    v_sqrt_f32 v1, v1
    s_nop 0
    v_cvt_pk_bf16_f32 v1, v1, v1
    v_lshlrev_b32 v1, 16, v1
    v_rcp_f32 v1, v1
    v_sub_f32 v36, v36, v46
    v_sub_f32 v37, v37, v46
    v_cvt_pk_bf16_f32 v2, v36, v37
    v_lshlrev_b32 v36, 16, v2
    v_and_b32 v37, 0xffff0000, v2
    v_mul_f32 v36, v36, v1
    v_mul_f32 v37, v37, v1
    v_cvt_pk_bf16_f32 v24, v36, v37
    v_sub_f32 v38, v38, v46
    v_sub_f32 v39, v39, v46
    v_cvt_pk_bf16_f32 v3, v38, v39
    v_lshlrev_b32 v38, 16, v3
    v_and_b32 v39, 0xffff0000, v3
    v_mul_f32 v38, v38, v1
    v_mul_f32 v39, v39, v1
    v_cvt_pk_bf16_f32 v25, v38, v39
    v_sub_f32 v40, v40, v46
    v_sub_f32 v41, v41, v46
    v_cvt_pk_bf16_f32 v2, v40, v41
    v_lshlrev_b32 v40, 16, v2
    v_and_b32 v41, 0xffff0000, v2
    v_mul_f32 v40, v40, v1
    v_mul_f32 v41, v41, v1
    v_cvt_pk_bf16_f32 v26, v40, v41
    v_sub_f32 v42, v42, v46
    v_sub_f32 v43, v43, v46
    v_cvt_pk_bf16_f32 v3, v42, v43
    v_lshlrev_b32 v42, 16, v3
    v_and_b32 v43, 0xffff0000, v3
    v_mul_f32 v42, v42, v1
    v_mul_f32 v43, v43, v1
    v_cvt_pk_bf16_f32 v27, v42, v43
    v_sub_f32 v44, v44, v46
    v_sub_f32 v45, v45, v46
    v_cvt_pk_bf16_f32 v2, v44, v45
    v_lshlrev_b32 v44, 16, v2
    v_and_b32 v45, 0xffff0000, v2
    v_mul_f32 v44, v44, v1
    v_mul_f32 v45, v45, v1
    v_cvt_pk_bf16_f32 v28, v44, v45
    s_waitcnt lgkmcnt(0)
    s_cmp_lg_u32 s7, 0
    s_cbranch_scc1 k1_vpath
    s_waitcnt vmcnt(9)
    s_barrier
    ds_read_b128 v[64:67], v10 offset:49152
    ds_read_b64_tr_b16 v[192:193], v18 offset:0
    ds_read_b64_tr_b16 v[194:195], v18 offset:2048
    ds_read_b64_tr_b16 v[196:197], v19 offset:0
    ds_read_b64_tr_b16 v[198:199], v19 offset:2048
    ds_read_b128 v[68:71], v10 offset:51200
    ds_read_b128 v[72:75], v10 offset:53248
    ds_read_b128 v[76:79], v10 offset:55296
    s_waitcnt lgkmcnt(0)
    ds_read_b128 v[80:83], v11 offset:49152
    ds_read_b64_tr_b16 v[200:201], v18 offset:1024
    v_mfma_f32_16x16x32_bf16 v[96:99], v[192:195], v[64:67], 0
    v_and_b32 v1, 7, v0
    v_xor_b32 v1, s22, v1
    ds_read_b64_tr_b16 v[202:203], v18 offset:3072
    ds_read_b64_tr_b16 v[204:205], v19 offset:1024
    v_mfma_f32_16x16x32_bf16 v[100:103], v[196:199], v[64:67], 0
    s_add_u32 m0, s12, 16384
    s_add_u32 s15, s13, 256
    buffer_load_dwordx4 v4, s[24:27], s15 offen lds
    ds_read_b64_tr_b16 v[206:207], v19 offset:3072
    ds_read_b128 v[84:87], v11 offset:51200
    v_mfma_f32_16x16x32_bf16 v[104:107], v[192:195], v[68:71], 0
    v_lshlrev_b32 v1, 4, v1
    v_lshl_add_u32 v1, v0, 7, v1
    ds_read_b128 v[88:91], v11 offset:53248
    ds_read_b128 v[92:95], v11 offset:55296
    v_mfma_f32_16x16x32_bf16 v[108:111], v[196:199], v[68:71], 0
    buffer_load_dwordx4 v5, s[24:27], s15 offen offset:1024 lds
    v_mfma_f32_16x16x32_bf16 v[112:115], v[192:195], v[72:75], 0
    v_add_u32 v1, 49152, v1
    v_bfe_u32 v2, v0, 2, 3
    v_mfma_f32_16x16x32_bf16 v[116:119], v[196:199], v[72:75], 0
    s_add_u32 m0, s12, 32768
    s_add_u32 s15, s14, 1048576
    buffer_load_dwordx4 v6, s[28:31], s15 offen nt lds
    v_mfma_f32_16x16x32_bf16 v[120:123], v[192:195], v[76:79], 0
    v_xor_b32 v2, s22, v2
    v_lshlrev_b32 v2, 4, v2
    v_mfma_f32_16x16x32_bf16 v[124:127], v[196:199], v[76:79], 0
    buffer_load_dwordx4 v7, s[28:31], s15 offen offset:1024 nt lds
    s_waitcnt lgkmcnt(0)
    s_waitcnt vmcnt(9)
    s_barrier
    ds_read_b128 v[64:67], v12 offset:16384
    ds_read_b64_tr_b16 v[208:209], v14 offset:0
    v_mfma_f32_16x16x32_bf16 v[96:99], v[200:203], v[80:83], v[96:99]
    v_lshrrev_b32 v3, 2, v0
    v_lshl_add_u32 v2, v3, 7, v2
    ds_read_b64_tr_b16 v[210:211], v14 offset:2048
    ds_read_b64_tr_b16 v[212:213], v15 offset:0
    v_mfma_f32_16x16x32_bf16 v[100:103], v[204:207], v[80:83], v[100:103]
    s_add_u32 m0, s12, 65536
    s_add_u32 s15, s13, 384
    buffer_load_dwordx4 v4, s[24:27], s15 offen lds
    ds_read_b64_tr_b16 v[214:215], v15 offset:2048
    ds_read_b128 v[68:71], v12 offset:18432
    v_mfma_f32_16x16x32_bf16 v[104:107], v[200:203], v[84:87], v[104:107]
    v_and_b32 v3, 3, v0
    v_lshl_add_u32 v2, v3, 2, v2
    ds_read_b128 v[72:75], v12 offset:20480
    ds_read_b128 v[76:79], v12 offset:22528
    v_mfma_f32_16x16x32_bf16 v[108:111], v[204:207], v[84:87], v[108:111]
    buffer_load_dwordx4 v5, s[24:27], s15 offen offset:1024 lds
    v_mfma_f32_16x16x32_bf16 v[112:115], v[200:203], v[88:91], v[112:115]
    v_add_u32 v2, 57344, v2
    s_waitcnt vmcnt(6)
    v_mfma_f32_16x16x32_bf16 v[116:119], v[204:207], v[88:91], v[116:119]
    s_add_u32 m0, s12, 81920
    s_add_u32 s15, s14, 1572864
    buffer_load_dwordx4 v6, s[28:31], s15 offen nt lds
    v_mfma_f32_16x16x32_bf16 v[120:123], v[200:203], v[92:95], v[120:123]
    s_cmp_lt_u32 s10, 240
    s_cselect_b32 s3, 2, 64
    s_lshl_b32 s3, s3, 6
    s_cmp_lt_u32 s10, 80
    s_cselect_b32 s3, 0, s3
    v_mfma_f32_16x16x32_bf16 v[124:127], v[204:207], v[92:95], v[124:127]
    buffer_load_dwordx4 v7, s[28:31], s15 offen offset:1024 nt lds
    s_waitcnt lgkmcnt(0)
    ds_read_b128 v[80:83], v13 offset:16384
    ds_read_b64_tr_b16 v[216:217], v14 offset:1024
    v_mfma_f32_16x16x32_bf16 v[96:99], v[208:211], v[64:67], v[96:99]
    buffer_atomic_add v30, v22, s[44:47], s3 offen sc1
    ds_read_b64_tr_b16 v[218:219], v14 offset:3072
    ds_read_b64_tr_b16 v[220:221], v15 offset:1024
    v_mfma_f32_16x16x32_bf16 v[100:103], v[212:215], v[64:67], v[100:103]
    s_add_u32 m0, s12, 98304
    s_add_u32 s15, s13, 512
    buffer_load_dwordx4 v4, s[24:27], s15 offen lds
    ds_read_b64_tr_b16 v[222:223], v15 offset:3072
    ds_read_b128 v[84:87], v13 offset:18432
    v_mfma_f32_16x16x32_bf16 v[104:107], v[208:211], v[68:71], v[104:107]
    ds_read_b128 v[88:91], v13 offset:20480
    ds_read_b128 v[92:95], v13 offset:22528
    v_mfma_f32_16x16x32_bf16 v[108:111], v[212:215], v[68:71], v[108:111]
    buffer_load_dwordx4 v5, s[24:27], s15 offen offset:1024 lds
    v_mfma_f32_16x16x32_bf16 v[112:115], v[208:211], v[72:75], v[112:115]
    v_mfma_f32_16x16x32_bf16 v[116:119], v[212:215], v[72:75], v[116:119]
    s_add_u32 m0, s12, 114688
    s_add_u32 s15, s14, 2097152
    buffer_load_dwordx4 v6, s[28:31], s15 offen nt lds
    v_mfma_f32_16x16x32_bf16 v[120:123], v[208:211], v[76:79], v[120:123]
    v_mfma_f32_16x16x32_bf16 v[124:127], v[212:215], v[76:79], v[124:127]
    buffer_load_dwordx4 v7, s[28:31], s15 offen offset:1024 nt lds
    s_waitcnt lgkmcnt(0)
    s_waitcnt vmcnt(9)
    s_barrier
    ds_read_b128 v[64:67], v8 offset:16384
    ds_read_b64_tr_b16 v[224:225], v14 offset:32768
    v_mfma_f32_16x16x32_bf16 v[96:99], v[216:219], v[80:83], v[96:99]
    ds_read_b64_tr_b16 v[226:227], v14 offset:34816
    ds_read_b64_tr_b16 v[228:229], v15 offset:32768
    v_mfma_f32_16x16x32_bf16 v[100:103], v[220:223], v[80:83], v[100:103]
    s_add_u32 m0, s12, 131072
    s_add_u32 s15, s13, 640
    buffer_load_dwordx4 v4, s[24:27], s15 offen lds
    ds_read_b64_tr_b16 v[230:231], v15 offset:34816
    ds_read_b128 v[68:71], v8 offset:18432
    v_mfma_f32_16x16x32_bf16 v[104:107], v[216:219], v[84:87], v[104:107]
    ds_read_b128 v[72:75], v8 offset:20480
    ds_read_b128 v[76:79], v8 offset:22528
    v_mfma_f32_16x16x32_bf16 v[108:111], v[220:223], v[84:87], v[108:111]
    buffer_load_dwordx4 v5, s[24:27], s15 offen offset:1024 lds
    v_mfma_f32_16x16x32_bf16 v[112:115], v[216:219], v[88:91], v[112:115]
    v_mfma_f32_16x16x32_bf16 v[116:119], v[220:223], v[88:91], v[116:119]
    s_add_u32 m0, s12, 147456
    s_add_u32 s15, s14, 2621440
    buffer_load_dwordx4 v6, s[28:31], s15 offen nt lds
    v_mfma_f32_16x16x32_bf16 v[120:123], v[216:219], v[92:95], v[120:123]
    v_mfma_f32_16x16x32_bf16 v[124:127], v[220:223], v[92:95], v[124:127]
    buffer_load_dwordx4 v7, s[28:31], s15 offen offset:1024 nt lds
    s_waitcnt lgkmcnt(0)
    ds_read_b128 v[80:83], v9 offset:16384
    ds_read_b64_tr_b16 v[232:233], v14 offset:33792
    v_mfma_f32_16x16x32_bf16 v[96:99], v[224:227], v[64:67], v[96:99]
    ds_read_b64_tr_b16 v[234:235], v14 offset:35840
    ds_read_b64_tr_b16 v[236:237], v15 offset:33792
    v_mfma_f32_16x16x32_bf16 v[100:103], v[228:231], v[64:67], v[100:103]
    s_add_u32 m0, s12, 0
    s_add_u32 s15, s13, 768
    buffer_load_dwordx4 v4, s[24:27], s15 offen lds
    ds_read_b64_tr_b16 v[238:239], v15 offset:35840
    ds_read_b128 v[84:87], v9 offset:18432
    v_mfma_f32_16x16x32_bf16 v[104:107], v[224:227], v[68:71], v[104:107]
    ds_read_b128 v[88:91], v9 offset:20480
    ds_read_b128 v[92:95], v9 offset:22528
    v_mfma_f32_16x16x32_bf16 v[108:111], v[228:231], v[68:71], v[108:111]
    buffer_load_dwordx4 v5, s[24:27], s15 offen offset:1024 lds
    v_mfma_f32_16x16x32_bf16 v[112:115], v[224:227], v[72:75], v[112:115]
    v_mfma_f32_16x16x32_bf16 v[116:119], v[228:231], v[72:75], v[116:119]
    v_mfma_f32_16x16x32_bf16 v[120:123], v[224:227], v[76:79], v[120:123]
    v_mfma_f32_16x16x32_bf16 v[124:127], v[228:231], v[76:79], v[124:127]
    s_waitcnt lgkmcnt(0)
    s_waitcnt vmcnt(11)
    s_barrier
    ds_read_b128 v[64:67], v10 offset:0
    ds_read_b64_tr_b16 v[240:241], v16 offset:16384
    v_mfma_f32_16x16x32_bf16 v[96:99], v[232:235], v[80:83], v[96:99]
    ds_read_b64_tr_b16 v[242:243], v16 offset:18432
    ds_read_b64_tr_b16 v[244:245], v17 offset:16384
    v_mfma_f32_16x16x32_bf16 v[100:103], v[236:239], v[80:83], v[100:103]
    s_add_u32 m0, s12, 16384
    s_add_u32 s15, s14, 3145728
    buffer_load_dwordx4 v6, s[28:31], s15 offen nt lds
    ds_read_b64_tr_b16 v[246:247], v17 offset:18432
    ds_read_b128 v[68:71], v10 offset:2048
    v_mfma_f32_16x16x32_bf16 v[104:107], v[232:235], v[84:87], v[104:107]
    ds_read_b128 v[72:75], v10 offset:4096
    ds_read_b128 v[76:79], v10 offset:6144
    v_mfma_f32_16x16x32_bf16 v[108:111], v[236:239], v[84:87], v[108:111]
    buffer_load_dwordx4 v7, s[28:31], s15 offen offset:1024 nt lds
    v_mfma_f32_16x16x32_bf16 v[112:115], v[232:235], v[88:91], v[112:115]
    v_mfma_f32_16x16x32_bf16 v[116:119], v[236:239], v[88:91], v[116:119]
    s_add_u32 m0, s12, 32768
    s_add_u32 s15, s13, 896
    buffer_load_dwordx4 v4, s[24:27], s15 offen lds
    v_mfma_f32_16x16x32_bf16 v[120:123], v[232:235], v[92:95], v[120:123]
    v_mfma_f32_16x16x32_bf16 v[124:127], v[236:239], v[92:95], v[124:127]
    buffer_load_dwordx4 v5, s[24:27], s15 offen offset:1024 lds
    s_waitcnt lgkmcnt(0)
    ds_read_b128 v[80:83], v11 offset:0
    ds_read_b64_tr_b16 v[248:249], v16 offset:17408
    v_mfma_f32_16x16x32_bf16 v[96:99], v[240:243], v[64:67], v[96:99]
    buffer_load_dword v29, v22, s[44:47], 0 offen offset:0 sc1
    ds_read_b64_tr_b16 v[250:251], v16 offset:19456
    ds_read_b64_tr_b16 v[252:253], v17 offset:17408
    v_mfma_f32_16x16x32_bf16 v[100:103], v[244:247], v[64:67], v[100:103]
    ds_read_b64_tr_b16 v[254:255], v17 offset:19456
    ds_read_b128 v[84:87], v11 offset:2048
    v_mfma_f32_16x16x32_bf16 v[104:107], v[240:243], v[68:71], v[104:107]
    ds_read_b128 v[88:91], v11 offset:4096
    ds_read_b128 v[92:95], v11 offset:6144
    v_mfma_f32_16x16x32_bf16 v[108:111], v[244:247], v[68:71], v[108:111]
    v_mfma_f32_16x16x32_bf16 v[112:115], v[240:243], v[72:75], v[112:115]
    v_mfma_f32_16x16x32_bf16 v[116:119], v[244:247], v[72:75], v[116:119]
    v_mfma_f32_16x16x32_bf16 v[120:123], v[240:243], v[76:79], v[120:123]
    v_mfma_f32_16x16x32_bf16 v[124:127], v[244:247], v[76:79], v[124:127]
    s_waitcnt lgkmcnt(0)
    s_waitcnt vmcnt(11)
    s_barrier
    ds_read_b128 v[64:67], v10 offset:32768
    ds_read_b64_tr_b16 v[128:129], v16 offset:49152
    v_mfma_f32_16x16x32_bf16 v[96:99], v[248:251], v[80:83], v[96:99]
    s_lshr_b32 s3, s2, 3
    s_lshl_b32 s3, s3, 3
    s_add_u32 s3, s3, s22
    s_mul_i32 s3, s3, 4096
    s_add_u32 s3, s3, 1048576
    ds_read_b64_tr_b16 v[130:131], v16 offset:51200
    ds_read_b64_tr_b16 v[132:133], v17 offset:49152
    v_mfma_f32_16x16x32_bf16 v[100:103], v[252:255], v[80:83], v[100:103]
    s_add_u32 m0, s12, 65536
    s_add_u32 s15, s14, 3670016
    buffer_load_dwordx4 v6, s[28:31], s15 offen nt lds
    ds_read_b64_tr_b16 v[134:135], v17 offset:51200
    ds_read_b128 v[68:71], v10 offset:34816
    v_mfma_f32_16x16x32_bf16 v[104:107], v[248:251], v[84:87], v[104:107]
    buffer_load_dword v48, v50, s[24:27], s3 offen
    ds_read_b128 v[72:75], v10 offset:36864
    ds_read_b128 v[76:79], v10 offset:38912
    v_mfma_f32_16x16x32_bf16 v[108:111], v[252:255], v[84:87], v[108:111]
    buffer_load_dwordx4 v7, s[28:31], s15 offen offset:1024 nt lds
    v_mfma_f32_16x16x32_bf16 v[112:115], v[248:251], v[88:91], v[112:115]
    v_mfma_f32_16x16x32_bf16 v[116:119], v[252:255], v[88:91], v[116:119]
    s_add_u32 m0, s12, 81920
    s_add_u32 s15, s13, 524288
    buffer_load_dwordx4 v4, s[24:27], s15 offen lds
    v_mfma_f32_16x16x32_bf16 v[120:123], v[248:251], v[92:95], v[120:123]
    v_mfma_f32_16x16x32_bf16 v[124:127], v[252:255], v[92:95], v[124:127]
    buffer_load_dwordx4 v5, s[24:27], s15 offen offset:1024 lds
    s_waitcnt lgkmcnt(0)
    ds_read_b128 v[80:83], v11 offset:32768
    ds_read_b64_tr_b16 v[136:137], v16 offset:50176
    v_mfma_f32_16x16x32_bf16 v[96:99], v[128:131], v[64:67], v[96:99]
    s_mul_i32 s3, s9, 80
    s_mul_i32 s61, s22, 10
    s_add_u32 s3, s3, s61
    s_lshl_b32 s3, s3, 13
    s_lshl_b32 s61, s6, 8
    s_add_u32 s3, s3, s61
    ds_read_b64_tr_b16 v[138:139], v16 offset:52224
    ds_read_b64_tr_b16 v[140:141], v17 offset:50176
    v_mfma_f32_16x16x32_bf16 v[100:103], v[132:135], v[64:67], v[100:103]
    buffer_load_dword v49, v51, s[32:35], s3 offen
    ds_read_b64_tr_b16 v[142:143], v17 offset:52224
    ds_read_b128 v[84:87], v11 offset:34816
    v_mfma_f32_16x16x32_bf16 v[104:107], v[128:131], v[68:71], v[104:107]
    ds_read_b128 v[88:91], v11 offset:36864
    ds_read_b128 v[92:95], v11 offset:38912
    v_mfma_f32_16x16x32_bf16 v[108:111], v[132:135], v[68:71], v[108:111]
    v_mfma_f32_16x16x32_bf16 v[112:115], v[128:131], v[72:75], v[112:115]
    v_mfma_f32_16x16x32_bf16 v[116:119], v[132:135], v[72:75], v[116:119]
    v_mfma_f32_16x16x32_bf16 v[120:123], v[128:131], v[76:79], v[120:123]
    v_mfma_f32_16x16x32_bf16 v[124:127], v[132:135], v[76:79], v[124:127]
    s_waitcnt lgkmcnt(0)
    s_waitcnt vmcnt(13)
    s_barrier
    ds_read_b128 v[64:67], v12 offset:0
    ds_read_b64_tr_b16 v[144:145], v18 offset:16384
    v_mfma_f32_16x16x32_bf16 v[96:99], v[136:139], v[80:83], v[96:99]
    ds_read_b64_tr_b16 v[146:147], v18 offset:18432
    ds_read_b64_tr_b16 v[148:149], v19 offset:16384
    v_mfma_f32_16x16x32_bf16 v[100:103], v[140:143], v[80:83], v[100:103]
    s_add_u32 m0, s12, 98304
    s_add_u32 s15, s13, 524416
    buffer_load_dwordx4 v4, s[24:27], s15 offen lds
    ds_read_b64_tr_b16 v[150:151], v19 offset:18432
    ds_read_b128 v[68:71], v12 offset:2048
    v_mfma_f32_16x16x32_bf16 v[104:107], v[136:139], v[84:87], v[104:107]
    ds_read_b128 v[72:75], v12 offset:4096
    ds_read_b128 v[76:79], v12 offset:6144
    v_mfma_f32_16x16x32_bf16 v[108:111], v[140:143], v[84:87], v[108:111]
    buffer_load_dwordx4 v5, s[24:27], s15 offen offset:1024 lds
    v_mfma_f32_16x16x32_bf16 v[112:115], v[136:139], v[88:91], v[112:115]
    v_mfma_f32_16x16x32_bf16 v[116:119], v[140:143], v[88:91], v[116:119]
    s_add_u32 m0, s12, 114688
    s_add_u32 s15, s13, 524544
    buffer_load_dwordx4 v4, s[24:27], s15 offen lds
    v_mfma_f32_16x16x32_bf16 v[120:123], v[136:139], v[92:95], v[120:123]
    v_mfma_f32_16x16x32_bf16 v[124:127], v[140:143], v[92:95], v[124:127]
    buffer_load_dwordx4 v5, s[24:27], s15 offen offset:1024 lds
    s_waitcnt lgkmcnt(0)
    ds_read_b128 v[80:83], v13 offset:0
    ds_read_b64_tr_b16 v[152:153], v18 offset:17408
    v_mfma_f32_16x16x32_bf16 v[96:99], v[144:147], v[64:67], v[96:99]
    ds_read_b64_tr_b16 v[154:155], v18 offset:19456
    ds_read_b64_tr_b16 v[156:157], v19 offset:17408
    v_mfma_f32_16x16x32_bf16 v[100:103], v[148:151], v[64:67], v[100:103]
    ds_read_b64_tr_b16 v[158:159], v19 offset:19456
    ds_read_b128 v[84:87], v13 offset:2048
    v_mfma_f32_16x16x32_bf16 v[104:107], v[144:147], v[68:71], v[104:107]
    ds_read_b128 v[88:91], v13 offset:4096
    ds_read_b128 v[92:95], v13 offset:6144
    v_mfma_f32_16x16x32_bf16 v[108:111], v[148:151], v[68:71], v[108:111]
    v_mfma_f32_16x16x32_bf16 v[112:115], v[144:147], v[72:75], v[112:115]
    v_mfma_f32_16x16x32_bf16 v[116:119], v[148:151], v[72:75], v[116:119]
    s_waitcnt vmcnt(10)
    v_readfirstlane_b32 s3, v29
    s_nop 0
    s_or_b32 s3, s3, s60
    s_cmp_ge_u32 s3, 80
    s_cbranch_scc0 k1_spin1
k1_back2:
    v_mfma_f32_16x16x32_bf16 v[120:123], v[144:147], v[76:79], v[120:123]
    v_mfma_f32_16x16x32_bf16 v[124:127], v[148:151], v[76:79], v[124:127]
    s_waitcnt lgkmcnt(0)
    s_waitcnt vmcnt(13)
    s_barrier
    ds_read_b128 v[64:67], v8 offset:0
    ds_read_b64_tr_b16 v[160:161], v14 offset:16384
    v_mfma_f32_16x16x32_bf16 v[96:99], v[152:155], v[80:83], v[96:99]
    s_mov_b32 s3, 83886080
    buffer_load_dwordx4 v[32:35], v20, s[36:39], s3 offen sc1
    ds_read_b64_tr_b16 v[162:163], v14 offset:18432
    ds_read_b64_tr_b16 v[164:165], v15 offset:16384
    v_mfma_f32_16x16x32_bf16 v[100:103], v[156:159], v[80:83], v[100:103]
    s_add_u32 m0, s12, 131072
    s_add_u32 s15, s13, 524672
    buffer_load_dwordx4 v4, s[24:27], s15 offen lds
    ds_read_b64_tr_b16 v[166:167], v15 offset:18432
    ds_read_b128 v[68:71], v8 offset:2048
    v_mfma_f32_16x16x32_bf16 v[104:107], v[152:155], v[84:87], v[104:107]
    buffer_load_dwordx4 v[40:43], v20, s[36:39], s3 offen offset:1280 sc1
    buffer_load_dword v36, v21, s[36:39], s3 offen offset:1024 sc1
    ds_read_b128 v[72:75], v8 offset:4096
    ds_read_b128 v[76:79], v8 offset:6144
    v_mfma_f32_16x16x32_bf16 v[108:111], v[156:159], v[84:87], v[108:111]
    buffer_load_dwordx4 v5, s[24:27], s15 offen offset:1024 lds
    v_mfma_f32_16x16x32_bf16 v[112:115], v[152:155], v[88:91], v[112:115]
    buffer_load_dword v37, v21, s[36:39], s3 offen offset:2304 sc1
    v_mfma_f32_16x16x32_bf16 v[116:119], v[156:159], v[88:91], v[116:119]
    s_add_u32 m0, s12, 147456
    s_add_u32 s15, s13, 524800
    buffer_load_dwordx4 v4, s[24:27], s15 offen lds
    v_mfma_f32_16x16x32_bf16 v[120:123], v[152:155], v[92:95], v[120:123]
    v_mfma_f32_16x16x32_bf16 v[124:127], v[156:159], v[92:95], v[124:127]
    buffer_load_dwordx4 v5, s[24:27], s15 offen offset:1024 lds
    s_waitcnt lgkmcnt(0)
    ds_read_b128 v[80:83], v9 offset:0
    ds_read_b64_tr_b16 v[168:169], v14 offset:17408
    v_mfma_f32_16x16x32_bf16 v[96:99], v[160:163], v[64:67], v[96:99]
    ds_read_b64_tr_b16 v[170:171], v14 offset:19456
    ds_read_b64_tr_b16 v[172:173], v15 offset:17408
    v_mfma_f32_16x16x32_bf16 v[100:103], v[164:167], v[64:67], v[100:103]
    ds_read_b64_tr_b16 v[174:175], v15 offset:19456
    ds_read_b128 v[84:87], v9 offset:2048
    v_mfma_f32_16x16x32_bf16 v[104:107], v[160:163], v[68:71], v[104:107]
    ds_read_b128 v[88:91], v9 offset:4096
    ds_read_b128 v[92:95], v9 offset:6144
    v_mfma_f32_16x16x32_bf16 v[108:111], v[164:167], v[68:71], v[108:111]
    v_mfma_f32_16x16x32_bf16 v[112:115], v[160:163], v[72:75], v[112:115]
    v_mfma_f32_16x16x32_bf16 v[116:119], v[164:167], v[72:75], v[116:119]
    v_mfma_f32_16x16x32_bf16 v[120:123], v[160:163], v[76:79], v[120:123]
    v_mfma_f32_16x16x32_bf16 v[124:127], v[164:167], v[76:79], v[124:127]
    s_waitcnt lgkmcnt(0)
    s_waitcnt vmcnt(15)
    s_barrier
    ds_read_b128 v[64:67], v8 offset:32768
    ds_read_b64_tr_b16 v[176:177], v16 offset:0
    v_mfma_f32_16x16x32_bf16 v[96:99], v[168:171], v[80:83], v[96:99]
    ds_read_b64_tr_b16 v[178:179], v16 offset:2048
    ds_read_b64_tr_b16 v[180:181], v17 offset:0
    v_mfma_f32_16x16x32_bf16 v[100:103], v[172:175], v[80:83], v[100:103]
    s_add_u32 m0, s12, 0
    s_add_u32 s15, s13, 524928
    buffer_load_dwordx4 v4, s[24:27], s15 offen lds
    ds_read_b64_tr_b16 v[182:183], v17 offset:2048
    ds_read_b128 v[68:71], v8 offset:34816
    v_mfma_f32_16x16x32_bf16 v[104:107], v[168:171], v[84:87], v[104:107]
    ds_read_b128 v[72:75], v8 offset:36864
    ds_read_b128 v[76:79], v8 offset:38912
    v_mfma_f32_16x16x32_bf16 v[108:111], v[172:175], v[84:87], v[108:111]
    buffer_load_dwordx4 v5, s[24:27], s15 offen offset:1024 lds
    v_mfma_f32_16x16x32_bf16 v[112:115], v[168:171], v[88:91], v[112:115]
    v_mfma_f32_16x16x32_bf16 v[116:119], v[172:175], v[88:91], v[116:119]
    s_add_u32 m0, s12, 16384
    s_add_u32 s15, s13, 525056
    buffer_load_dwordx4 v4, s[24:27], s15 offen lds
    v_mfma_f32_16x16x32_bf16 v[120:123], v[168:171], v[92:95], v[120:123]
    v_mfma_f32_16x16x32_bf16 v[124:127], v[172:175], v[92:95], v[124:127]
    buffer_load_dwordx4 v5, s[24:27], s15 offen offset:1024 lds
    s_waitcnt lgkmcnt(0)
    ds_read_b128 v[80:83], v9 offset:32768
    ds_read_b64_tr_b16 v[184:185], v16 offset:1024
    v_mfma_f32_16x16x32_bf16 v[96:99], v[176:179], v[64:67], v[96:99]
    ds_read_b64_tr_b16 v[186:187], v16 offset:3072
    ds_read_b64_tr_b16 v[188:189], v17 offset:1024
    v_mfma_f32_16x16x32_bf16 v[100:103], v[180:183], v[64:67], v[100:103]
    ds_read_b64_tr_b16 v[190:191], v17 offset:3072
    ds_read_b128 v[84:87], v9 offset:34816
    v_mfma_f32_16x16x32_bf16 v[104:107], v[176:179], v[68:71], v[104:107]
    ds_read_b128 v[88:91], v9 offset:36864
    ds_read_b128 v[92:95], v9 offset:38912
    v_mfma_f32_16x16x32_bf16 v[108:111], v[180:183], v[68:71], v[108:111]
    v_mfma_f32_16x16x32_bf16 v[112:115], v[176:179], v[72:75], v[112:115]
    v_mfma_f32_16x16x32_bf16 v[116:119], v[180:183], v[72:75], v[116:119]
    v_mfma_f32_16x16x32_bf16 v[120:123], v[176:179], v[76:79], v[120:123]
    v_mfma_f32_16x16x32_bf16 v[124:127], v[180:183], v[76:79], v[124:127]
    s_waitcnt lgkmcnt(0)
    s_waitcnt vmcnt(14)
    s_barrier
    ds_read_b128 v[64:67], v10 offset:16384
    ds_read_b128 v[68:71], v10 offset:18432
    v_mfma_f32_16x16x32_bf16 v[96:99], v[184:187], v[80:83], v[96:99]
    s_waitcnt vmcnt(6)
    v_lshlrev_b32 v38, 16, v24
    ds_read_b128 v[72:75], v10 offset:20480
    ds_read_b128 v[76:79], v10 offset:22528
    v_mfma_f32_16x16x32_bf16 v[100:103], v[188:191], v[80:83], v[100:103]
    s_add_u32 m0, s12, 32768
    s_add_u32 s15, s13, 525184
    buffer_load_dwordx4 v4, s[24:27], s15 offen lds
    v_mfma_f32_16x16x32_bf16 v[104:107], v[184:187], v[84:87], v[104:107]
    v_and_b32 v39, 0xffff0000, v24
    v_lshlrev_b32 v44, 16, v40
    v_mfma_f32_16x16x32_bf16 v[108:111], v[188:191], v[84:87], v[108:111]
    buffer_load_dwordx4 v5, s[24:27], s15 offen offset:1024 lds
    v_mfma_f32_16x16x32_bf16 v[112:115], v[184:187], v[88:91], v[112:115]
    v_and_b32 v45, 0xffff0000, v40
    v_mul_f32 v38, v38, v44
    v_mfma_f32_16x16x32_bf16 v[116:119], v[188:191], v[88:91], v[116:119]
    s_add_u32 m0, s12, 65536
    s_add_u32 s15, s13, 1048576
    buffer_load_dwordx4 v4, s[24:27], s15 offen lds
    v_mfma_f32_16x16x32_bf16 v[120:123], v[184:187], v[92:95], v[120:123]
    v_mul_f32 v39, v39, v45
    v_cvt_pk_bf16_f32 v46, v38, v39
    v_mfma_f32_16x16x32_bf16 v[124:127], v[188:191], v[92:95], v[124:127]
    buffer_load_dwordx4 v5, s[24:27], s15 offen offset:1024 lds
    s_waitcnt lgkmcnt(0)
    v_cvt_pk_bf16_f32 v48, v96, v97
    v_cvt_pk_bf16_f32 v49, v98, v99
    v_cvt_pk_bf16_f32 v50, v100, v101
    v_cvt_pk_bf16_f32 v51, v102, v103
    ds_read_b128 v[80:83], v11 offset:16384
    ds_read_b128 v[84:87], v11 offset:18432
    v_mfma_f32_16x16x32_bf16 v[96:99], v[192:195], v[64:67], 0
    ds_read_b128 v[88:91], v11 offset:20480
    ds_read_b128 v[92:95], v11 offset:22528
    v_mfma_f32_16x16x32_bf16 v[100:103], v[196:199], v[64:67], 0
    v_cvt_pk_bf16_f32 v52, v104, v105
    v_cvt_pk_bf16_f32 v53, v106, v107
    v_cvt_pk_bf16_f32 v54, v108, v109
    v_cvt_pk_bf16_f32 v55, v110, v111
    v_mfma_f32_16x16x32_bf16 v[104:107], v[192:195], v[68:71], 0
    v_mfma_f32_16x16x32_bf16 v[108:111], v[196:199], v[68:71], 0
    v_cvt_pk_bf16_f32 v56, v112, v113
    v_cvt_pk_bf16_f32 v57, v114, v115
    v_cvt_pk_bf16_f32 v58, v116, v117
    v_cvt_pk_bf16_f32 v59, v118, v119
    v_mfma_f32_16x16x32_bf16 v[112:115], v[192:195], v[72:75], 0
    v_mfma_f32_16x16x32_bf16 v[116:119], v[196:199], v[72:75], 0
    v_cvt_pk_bf16_f32 v60, v120, v121
    v_cvt_pk_bf16_f32 v61, v122, v123
    v_cvt_pk_bf16_f32 v62, v124, v125
    v_cvt_pk_bf16_f32 v63, v126, v127
    v_mfma_f32_16x16x32_bf16 v[120:123], v[192:195], v[76:79], 0
    v_mfma_f32_16x16x32_bf16 v[124:127], v[196:199], v[76:79], 0
    s_waitcnt lgkmcnt(0)
    ds_read_b128 v[64:67], v10 offset:32768
    ds_read_b128 v[68:71], v10 offset:34816
    v_mfma_f32_16x16x32_bf16 v[96:99], v[200:203], v[80:83], v[96:99]
    v_lshlrev_b32 v38, 16, v46
    v_and_b32 v39, 0xffff0000, v46
    ds_read_b128 v[72:75], v10 offset:36864
    ds_read_b128 v[76:79], v10 offset:38912
    v_mfma_f32_16x16x32_bf16 v[100:103], v[204:207], v[80:83], v[100:103]
    v_lshlrev_b32 v44, 16, v32
    v_and_b32 v45, 0xffff0000, v32
    v_mfma_f32_16x16x32_bf16 v[104:107], v[200:203], v[84:87], v[104:107]
    v_add_f32 v38, v38, v44
    v_add_f32 v39, v39, v45
    v_mfma_f32_16x16x32_bf16 v[108:111], v[204:207], v[84:87], v[108:111]
    v_cvt_pk_bf16_f32 v24, v38, v39
    v_lshlrev_b32 v38, 16, v25
    v_mfma_f32_16x16x32_bf16 v[112:115], v[200:203], v[88:91], v[112:115]
    v_and_b32 v39, 0xffff0000, v25
    v_lshlrev_b32 v44, 16, v41
    v_mfma_f32_16x16x32_bf16 v[116:119], v[204:207], v[88:91], v[116:119]
    v_and_b32 v45, 0xffff0000, v41
    v_mul_f32 v38, v38, v44
    v_mfma_f32_16x16x32_bf16 v[120:123], v[200:203], v[92:95], v[120:123]
    s_add_u32 s11, s16, 0
    buffer_store_dwordx4 v[48:51], v20, s[36:39], s11 offen sc1
    v_mfma_f32_16x16x32_bf16 v[124:127], v[204:207], v[92:95], v[124:127]
    v_mul_f32 v39, v39, v45
    v_cvt_pk_bf16_f32 v46, v38, v39
    s_waitcnt lgkmcnt(0)
    ds_read_b128 v[80:83], v11 offset:32768
    ds_read_b128 v[84:87], v11 offset:34816
    v_mfma_f32_16x16x32_bf16 v[96:99], v[208:211], v[64:67], v[96:99]
    v_lshlrev_b32 v38, 16, v46
    v_and_b32 v39, 0xffff0000, v46
    ds_read_b128 v[88:91], v11 offset:36864
    ds_read_b128 v[92:95], v11 offset:38912
    v_mfma_f32_16x16x32_bf16 v[100:103], v[212:215], v[64:67], v[100:103]
    v_lshlrev_b32 v44, 16, v33
    v_and_b32 v45, 0xffff0000, v33
    v_mfma_f32_16x16x32_bf16 v[104:107], v[208:211], v[68:71], v[104:107]
    v_add_f32 v38, v38, v44
    v_add_f32 v39, v39, v45
    v_mfma_f32_16x16x32_bf16 v[108:111], v[212:215], v[68:71], v[108:111]
    v_cvt_pk_bf16_f32 v25, v38, v39
    v_lshlrev_b32 v38, 16, v26
    v_mfma_f32_16x16x32_bf16 v[112:115], v[208:211], v[72:75], v[112:115]
    v_and_b32 v39, 0xffff0000, v26
    v_lshlrev_b32 v44, 16, v42
    v_mfma_f32_16x16x32_bf16 v[116:119], v[212:215], v[72:75], v[116:119]
    v_and_b32 v45, 0xffff0000, v42
    v_mul_f32 v38, v38, v44
    v_mfma_f32_16x16x32_bf16 v[120:123], v[208:211], v[76:79], v[120:123]
    v_mul_f32 v39, v39, v45
    v_cvt_pk_bf16_f32 v46, v38, v39
    v_mfma_f32_16x16x32_bf16 v[124:127], v[212:215], v[76:79], v[124:127]
    v_lshlrev_b32 v38, 16, v46
    v_and_b32 v39, 0xffff0000, v46
    s_waitcnt lgkmcnt(0)
    s_waitcnt vmcnt(12)
    s_barrier
    ds_read_b128 v[64:67], v10 offset:49152
    ds_read_b128 v[68:71], v10 offset:51200
    v_mfma_f32_16x16x32_bf16 v[96:99], v[216:219], v[80:83], v[96:99]
    v_lshlrev_b32 v44, 16, v34
    v_and_b32 v45, 0xffff0000, v34
    ds_read_b128 v[72:75], v10 offset:53248
    ds_read_b128 v[76:79], v10 offset:55296
    v_mfma_f32_16x16x32_bf16 v[100:103], v[220:223], v[80:83], v[100:103]
    s_add_u32 m0, s12, 81920
    s_add_u32 s15, s13, 1048704
    buffer_load_dwordx4 v4, s[24:27], s15 offen lds
    v_mfma_f32_16x16x32_bf16 v[104:107], v[216:219], v[84:87], v[104:107]
    v_add_f32 v38, v38, v44
    v_add_f32 v39, v39, v45
    v_mfma_f32_16x16x32_bf16 v[108:111], v[220:223], v[84:87], v[108:111]
    buffer_load_dwordx4 v5, s[24:27], s15 offen offset:1024 lds
    v_mfma_f32_16x16x32_bf16 v[112:115], v[216:219], v[88:91], v[112:115]
    v_cvt_pk_bf16_f32 v26, v38, v39
    v_lshlrev_b32 v38, 16, v27
    v_mfma_f32_16x16x32_bf16 v[116:119], v[220:223], v[88:91], v[116:119]
    v_and_b32 v39, 0xffff0000, v27
    v_lshlrev_b32 v44, 16, v43
    v_mfma_f32_16x16x32_bf16 v[120:123], v[216:219], v[92:95], v[120:123]
    v_and_b32 v45, 0xffff0000, v43
    v_mul_f32 v38, v38, v44
    v_mfma_f32_16x16x32_bf16 v[124:127], v[220:223], v[92:95], v[124:127]
    v_mul_f32 v39, v39, v45
    v_cvt_pk_bf16_f32 v46, v38, v39
    s_waitcnt lgkmcnt(0)
    ds_read_b128 v[80:83], v11 offset:49152
    ds_read_b128 v[84:87], v11 offset:51200
    v_mfma_f32_16x16x32_bf16 v[96:99], v[224:227], v[64:67], v[96:99]
    v_lshlrev_b32 v38, 16, v46
    v_and_b32 v39, 0xffff0000, v46
    ds_read_b128 v[88:91], v11 offset:53248
    ds_read_b128 v[92:95], v11 offset:55296
    v_mfma_f32_16x16x32_bf16 v[100:103], v[228:231], v[64:67], v[100:103]
    s_add_u32 m0, s12, 98304
    s_add_u32 s15, s13, 1048832
    buffer_load_dwordx4 v4, s[24:27], s15 offen lds
    v_mfma_f32_16x16x32_bf16 v[104:107], v[224:227], v[68:71], v[104:107]
    v_lshlrev_b32 v44, 16, v35
    v_and_b32 v45, 0xffff0000, v35
    v_mfma_f32_16x16x32_bf16 v[108:111], v[228:231], v[68:71], v[108:111]
    buffer_load_dwordx4 v5, s[24:27], s15 offen offset:1024 lds
    v_mfma_f32_16x16x32_bf16 v[112:115], v[224:227], v[72:75], v[112:115]
    v_add_f32 v38, v38, v44
    v_add_f32 v39, v39, v45
    v_mfma_f32_16x16x32_bf16 v[116:119], v[228:231], v[72:75], v[116:119]
    v_cvt_pk_bf16_f32 v27, v38, v39
    ds_write_b128 v1, v[24:27]
    v_mfma_f32_16x16x32_bf16 v[120:123], v[224:227], v[76:79], v[120:123]
    v_lshlrev_b32 v38, 16, v28
    v_and_b32 v39, 0xffff0000, v28
    v_mfma_f32_16x16x32_bf16 v[124:127], v[228:231], v[76:79], v[124:127]
    v_lshlrev_b32 v44, 16, v37
    v_and_b32 v45, 0xffff0000, v37
    s_waitcnt lgkmcnt(0)
    ds_read_b128 v[64:67], v12 offset:0
    ds_read_b128 v[68:71], v12 offset:2048
    v_mfma_f32_16x16x32_bf16 v[96:99], v[232:235], v[80:83], v[96:99]
    v_mul_f32 v38, v38, v44
    v_mul_f32 v39, v39, v45
    ds_read_b128 v[72:75], v12 offset:4096
    ds_read_b128 v[76:79], v12 offset:6144
    v_mfma_f32_16x16x32_bf16 v[100:103], v[236:239], v[80:83], v[100:103]
    v_cvt_pk_bf16_f32 v46, v38, v39
    v_lshlrev_b32 v38, 16, v46
    v_mfma_f32_16x16x32_bf16 v[104:107], v[232:235], v[84:87], v[104:107]
    v_and_b32 v39, 0xffff0000, v46
    v_lshlrev_b32 v44, 16, v36
    v_mfma_f32_16x16x32_bf16 v[108:111], v[236:239], v[84:87], v[108:111]
    v_and_b32 v45, 0xffff0000, v36
    v_add_f32 v38, v38, v44
    v_mfma_f32_16x16x32_bf16 v[112:115], v[232:235], v[88:91], v[112:115]
    v_add_f32 v39, v39, v45
    v_cvt_pk_bf16_f32 v28, v38, v39
    v_mfma_f32_16x16x32_bf16 v[116:119], v[236:239], v[88:91], v[116:119]
    ds_write_b32 v2, v28
    s_lshl_b32 s3, s22, 10
    s_add_u32 s3, s3, 49152
    v_add_u32 v1, s3, v20
    v_mfma_f32_16x16x32_bf16 v[120:123], v[232:235], v[92:95], v[120:123]
    s_add_u32 s11, s16, 4096
    buffer_store_dwordx4 v[52:55], v20, s[36:39], s11 offen sc1
    v_mfma_f32_16x16x32_bf16 v[124:127], v[236:239], v[92:95], v[124:127]
    s_lshl_b32 s3, s22, 8
    s_add_u32 s3, s3, 57344
    v_add_u32 v2, s3, v20
    s_waitcnt lgkmcnt(0)
    ds_read_b128 v[80:83], v13 offset:0
    ds_read_b128 v[84:87], v13 offset:2048
    v_mfma_f32_16x16x32_bf16 v[96:99], v[240:243], v[64:67], v[96:99]
    v_lshrrev_b32 v39, 3, v0
    v_and_b32 v44, 7, v0
    ds_read_b128 v[88:91], v13 offset:4096
    ds_read_b128 v[92:95], v13 offset:6144
    v_mfma_f32_16x16x32_bf16 v[100:103], v[244:247], v[64:67], v[100:103]
    v_xor_b32 v3, v44, v39
    v_lshlrev_b32 v3, 4, v3
    v_mfma_f32_16x16x32_bf16 v[104:107], v[240:243], v[68:71], v[104:107]
    v_lshl_add_u32 v3, v39, 8, v3
    s_lshl_b32 s3, s22, 11
    v_add_u32 v3, s3, v3
    v_mfma_f32_16x16x32_bf16 v[108:111], v[244:247], v[68:71], v[108:111]
    s_lshl_b32 s3, s22, 1
    v_add_u32 v39, s3, v39
    v_mfma_f32_16x16x32_bf16 v[112:115], v[240:243], v[72:75], v[112:115]
    v_and_b32 v45, 7, v39
    v_xor_b32 v38, v44, v45
    v_mfma_f32_16x16x32_bf16 v[116:119], v[244:247], v[72:75], v[116:119]
    v_lshlrev_b32 v38, 4, v38
    v_lshl_add_u32 v38, v39, 8, v38
    v_mfma_f32_16x16x32_bf16 v[120:123], v[240:243], v[76:79], v[120:123]
    v_add_u32 v38, 0x4000, v38
    v_lshrrev_b32 v45, 4, v0
    v_mfma_f32_16x16x32_bf16 v[124:127], v[244:247], v[76:79], v[124:127]
    v_lshl_or_b32 v38, v45, 28, v38
    s_waitcnt lgkmcnt(0)
    s_waitcnt vmcnt(12)
    s_barrier
    ds_read_b128 v[64:67], v12 offset:16384
    ds_read_b128 v[68:71], v12 offset:18432
    v_mfma_f32_16x16x32_bf16 v[96:99], v[248:251], v[80:83], v[96:99]
    ds_read_b128 v[32:35], v1
    ds_read_b128 v[40:43], v2
    ds_read_b128 v[72:75], v12 offset:20480
    ds_read_b128 v[76:79], v12 offset:22528
    v_mfma_f32_16x16x32_bf16 v[100:103], v[252:255], v[80:83], v[100:103]
    s_add_u32 m0, s12, 114688
    s_add_u32 s15, s13, 1048960
    buffer_load_dwordx4 v4, s[24:27], s15 offen lds
    v_mfma_f32_16x16x32_bf16 v[104:107], v[248:251], v[84:87], v[104:107]
    v_mfma_f32_16x16x32_bf16 v[108:111], v[252:255], v[84:87], v[108:111]
    buffer_load_dwordx4 v5, s[24:27], s15 offen offset:1024 lds
    v_mfma_f32_16x16x32_bf16 v[112:115], v[248:251], v[88:91], v[112:115]
    v_mfma_f32_16x16x32_bf16 v[116:119], v[252:255], v[88:91], v[116:119]
    v_mfma_f32_16x16x32_bf16 v[120:123], v[248:251], v[92:95], v[120:123]
    v_mfma_f32_16x16x32_bf16 v[124:127], v[252:255], v[92:95], v[124:127]
    s_waitcnt lgkmcnt(0)
    ds_read_b128 v[80:83], v13 offset:16384
    ds_read_b128 v[84:87], v13 offset:18432
    v_mfma_f32_16x16x32_bf16 v[96:99], v[128:131], v[64:67], v[96:99]
    buffer_store_dwordx4 v[32:35], v3, s[36:39], s21 offen sc1
    buffer_store_dwordx4 v[40:43], v38, s[36:39], s21 offen sc1
    ds_read_b128 v[88:91], v13 offset:20480
    ds_read_b128 v[92:95], v13 offset:22528
    v_mfma_f32_16x16x32_bf16 v[100:103], v[132:135], v[64:67], v[100:103]
    s_add_u32 m0, s12, 131072
    s_add_u32 s15, s13, 1049088
    buffer_load_dwordx4 v4, s[24:27], s15 offen lds
    v_mfma_f32_16x16x32_bf16 v[104:107], v[128:131], v[68:71], v[104:107]
    v_mfma_f32_16x16x32_bf16 v[108:111], v[132:135], v[68:71], v[108:111]
    buffer_load_dwordx4 v5, s[24:27], s15 offen offset:1024 lds
    v_mfma_f32_16x16x32_bf16 v[112:115], v[128:131], v[72:75], v[112:115]
    v_mfma_f32_16x16x32_bf16 v[116:119], v[132:135], v[72:75], v[116:119]
    v_mfma_f32_16x16x32_bf16 v[120:123], v[128:131], v[76:79], v[120:123]
    v_mfma_f32_16x16x32_bf16 v[124:127], v[132:135], v[76:79], v[124:127]
    s_waitcnt lgkmcnt(0)
    ds_read_b128 v[64:67], v8 offset:0
    ds_read_b128 v[68:71], v8 offset:2048
    v_mfma_f32_16x16x32_bf16 v[96:99], v[136:139], v[80:83], v[96:99]
    ds_read_b128 v[72:75], v8 offset:4096
    ds_read_b128 v[76:79], v8 offset:6144
    v_mfma_f32_16x16x32_bf16 v[100:103], v[140:143], v[80:83], v[100:103]
    v_mfma_f32_16x16x32_bf16 v[104:107], v[136:139], v[84:87], v[104:107]
    v_mfma_f32_16x16x32_bf16 v[108:111], v[140:143], v[84:87], v[108:111]
    v_mfma_f32_16x16x32_bf16 v[112:115], v[136:139], v[88:91], v[112:115]
    v_mfma_f32_16x16x32_bf16 v[116:119], v[140:143], v[88:91], v[116:119]
    v_mfma_f32_16x16x32_bf16 v[120:123], v[136:139], v[92:95], v[120:123]
    s_add_u32 s11, s16, 8192
    buffer_store_dwordx4 v[56:59], v20, s[36:39], s11 offen sc1
    v_mfma_f32_16x16x32_bf16 v[124:127], v[140:143], v[92:95], v[124:127]
    s_waitcnt lgkmcnt(0)
    ds_read_b128 v[80:83], v9 offset:0
    ds_read_b128 v[84:87], v9 offset:2048
    v_mfma_f32_16x16x32_bf16 v[96:99], v[144:147], v[64:67], v[96:99]
    ds_read_b128 v[88:91], v9 offset:4096
    ds_read_b128 v[92:95], v9 offset:6144
    v_mfma_f32_16x16x32_bf16 v[100:103], v[148:151], v[64:67], v[100:103]
    v_mfma_f32_16x16x32_bf16 v[104:107], v[144:147], v[68:71], v[104:107]
    v_mfma_f32_16x16x32_bf16 v[108:111], v[148:151], v[68:71], v[108:111]
    v_mfma_f32_16x16x32_bf16 v[112:115], v[144:147], v[72:75], v[112:115]
    v_mfma_f32_16x16x32_bf16 v[116:119], v[148:151], v[72:75], v[116:119]
    v_mfma_f32_16x16x32_bf16 v[120:123], v[144:147], v[76:79], v[120:123]
    v_mfma_f32_16x16x32_bf16 v[124:127], v[148:151], v[76:79], v[124:127]
    s_waitcnt lgkmcnt(0)
    s_waitcnt vmcnt(15)
    s_barrier
    ds_read_b128 v[64:67], v8 offset:16384
    ds_read_b128 v[68:71], v8 offset:18432
    v_mfma_f32_16x16x32_bf16 v[96:99], v[152:155], v[80:83], v[96:99]
    ds_read_b128 v[72:75], v8 offset:20480
    ds_read_b128 v[76:79], v8 offset:22528
    v_mfma_f32_16x16x32_bf16 v[100:103], v[156:159], v[80:83], v[100:103]
    s_add_u32 m0, s12, 147456
    s_add_u32 s15, s13, 1049216
    buffer_load_dwordx4 v4, s[24:27], s15 offen lds
    v_mfma_f32_16x16x32_bf16 v[104:107], v[152:155], v[84:87], v[104:107]
    v_mfma_f32_16x16x32_bf16 v[108:111], v[156:159], v[84:87], v[108:111]
    buffer_load_dwordx4 v5, s[24:27], s15 offen offset:1024 lds
    v_mfma_f32_16x16x32_bf16 v[112:115], v[152:155], v[88:91], v[112:115]
    v_mfma_f32_16x16x32_bf16 v[116:119], v[156:159], v[88:91], v[116:119]
    v_mfma_f32_16x16x32_bf16 v[120:123], v[152:155], v[92:95], v[120:123]
    v_mfma_f32_16x16x32_bf16 v[124:127], v[156:159], v[92:95], v[124:127]
    s_waitcnt lgkmcnt(0)
    ds_read_b128 v[80:83], v9 offset:16384
    ds_read_b128 v[84:87], v9 offset:18432
    v_mfma_f32_16x16x32_bf16 v[96:99], v[160:163], v[64:67], v[96:99]
    ds_read_b128 v[88:91], v9 offset:20480
    ds_read_b128 v[92:95], v9 offset:22528
    v_mfma_f32_16x16x32_bf16 v[100:103], v[164:167], v[64:67], v[100:103]
    s_add_u32 m0, s12, 0
    s_add_u32 s15, s13, 1049344
    buffer_load_dwordx4 v4, s[24:27], s15 offen lds
    v_mfma_f32_16x16x32_bf16 v[104:107], v[160:163], v[68:71], v[104:107]
    v_mfma_f32_16x16x32_bf16 v[108:111], v[164:167], v[68:71], v[108:111]
    buffer_load_dwordx4 v5, s[24:27], s15 offen offset:1024 lds
    v_mfma_f32_16x16x32_bf16 v[112:115], v[160:163], v[72:75], v[112:115]
    v_mfma_f32_16x16x32_bf16 v[116:119], v[164:167], v[72:75], v[116:119]
    v_mfma_f32_16x16x32_bf16 v[120:123], v[160:163], v[76:79], v[120:123]
    v_mfma_f32_16x16x32_bf16 v[124:127], v[164:167], v[76:79], v[124:127]
    s_waitcnt lgkmcnt(0)
    ds_read_b128 v[64:67], v8 offset:32768
    ds_read_b128 v[68:71], v8 offset:34816
    v_mfma_f32_16x16x32_bf16 v[96:99], v[168:171], v[80:83], v[96:99]
    ds_read_b128 v[72:75], v8 offset:36864
    ds_read_b128 v[76:79], v8 offset:38912
    v_mfma_f32_16x16x32_bf16 v[100:103], v[172:175], v[80:83], v[100:103]
    v_mfma_f32_16x16x32_bf16 v[104:107], v[168:171], v[84:87], v[104:107]
    v_mfma_f32_16x16x32_bf16 v[108:111], v[172:175], v[84:87], v[108:111]
    v_mfma_f32_16x16x32_bf16 v[112:115], v[168:171], v[88:91], v[112:115]
    v_mfma_f32_16x16x32_bf16 v[116:119], v[172:175], v[88:91], v[116:119]
    v_mfma_f32_16x16x32_bf16 v[120:123], v[168:171], v[92:95], v[120:123]
    s_add_u32 s11, s16, 12288
    buffer_store_dwordx4 v[60:63], v20, s[36:39], s11 offen sc1
    v_mfma_f32_16x16x32_bf16 v[124:127], v[172:175], v[92:95], v[124:127]
    s_waitcnt lgkmcnt(0)
    ds_read_b128 v[80:83], v9 offset:32768
    ds_read_b128 v[84:87], v9 offset:34816
    v_mfma_f32_16x16x32_bf16 v[96:99], v[176:179], v[64:67], v[96:99]
    ds_read_b128 v[88:91], v9 offset:36864
    ds_read_b128 v[92:95], v9 offset:38912
    v_mfma_f32_16x16x32_bf16 v[100:103], v[180:183], v[64:67], v[100:103]
    v_mfma_f32_16x16x32_bf16 v[104:107], v[176:179], v[68:71], v[104:107]
    v_mfma_f32_16x16x32_bf16 v[108:111], v[180:183], v[68:71], v[108:111]
    v_mfma_f32_16x16x32_bf16 v[112:115], v[176:179], v[72:75], v[112:115]
    v_mfma_f32_16x16x32_bf16 v[116:119], v[180:183], v[72:75], v[116:119]
    s_waitcnt vmcnt(8)
    v_mfma_f32_16x16x32_bf16 v[120:123], v[176:179], v[76:79], v[120:123]
    v_mfma_f32_16x16x32_bf16 v[124:127], v[180:183], v[76:79], v[124:127]
    s_waitcnt lgkmcnt(0)
    s_waitcnt vmcnt(15)
    s_barrier
    ds_read_b128 v[64:67], v10 offset:0
    ds_read_b128 v[68:71], v10 offset:2048
    v_mfma_f32_16x16x32_bf16 v[96:99], v[184:187], v[80:83], v[96:99]
    s_lshr_b32 s3, s2, 4
    s_lshl_b32 s3, s3, 8
    ds_read_b128 v[72:75], v10 offset:4096
    ds_read_b128 v[76:79], v10 offset:6144
    v_mfma_f32_16x16x32_bf16 v[100:103], v[188:191], v[80:83], v[100:103]
    s_add_u32 m0, s12, 16384
    s_add_u32 s15, s13, 1049472
    buffer_load_dwordx4 v4, s[24:27], s15 offen lds
    v_mfma_f32_16x16x32_bf16 v[104:107], v[184:187], v[84:87], v[104:107]
    s_and_b32 s18, s2, 15
    s_lshl_b32 s18, s18, 2
    v_mfma_f32_16x16x32_bf16 v[108:111], v[188:191], v[84:87], v[108:111]
    buffer_load_dwordx4 v5, s[24:27], s15 offen offset:1024 lds
    v_mfma_f32_16x16x32_bf16 v[112:115], v[184:187], v[88:91], v[112:115]
    s_add_u32 s3, s3, s18
    s_add_u32 s3, s3, 83951616
    v_mfma_f32_16x16x32_bf16 v[116:119], v[188:191], v[88:91], v[116:119]
    buffer_store_dword v30, v22, s[36:39], s3 offen sc1
    v_xor_b32 v32, 0, v47
    v_mfma_f32_16x16x32_bf16 v[120:123], v[184:187], v[92:95], v[120:123]
    v_xor_b32 v33, 32, v47
    v_xor_b32 v34, 64, v47
    v_mfma_f32_16x16x32_bf16 v[124:127], v[188:191], v[92:95], v[124:127]
    v_xor_b32 v35, 96, v47
    v_xor_b32 v36, 128, v47
    s_waitcnt lgkmcnt(0)
    v_cvt_pk_bf16_f32 v48, v96, v97
    v_cvt_pk_bf16_f32 v49, v98, v99
    v_cvt_pk_bf16_f32 v50, v100, v101
    v_cvt_pk_bf16_f32 v51, v102, v103
    ds_read_b128 v[80:83], v11 offset:0
    ds_read_b128 v[84:87], v11 offset:2048
    v_mfma_f32_16x16x32_bf16 v[96:99], v[192:195], v[64:67], 0
    ds_read_b128 v[88:91], v11 offset:4096
    ds_read_b128 v[92:95], v11 offset:6144
    v_mfma_f32_16x16x32_bf16 v[100:103], v[196:199], v[64:67], 0
    s_add_u32 m0, s12, 32768
    s_add_u32 s15, s13, 1572864
    buffer_load_dwordx4 v4, s[24:27], s15 offen lds
    v_cvt_pk_bf16_f32 v52, v104, v105
    v_cvt_pk_bf16_f32 v53, v106, v107
    v_cvt_pk_bf16_f32 v54, v108, v109
    v_cvt_pk_bf16_f32 v55, v110, v111
    v_mfma_f32_16x16x32_bf16 v[104:107], v[192:195], v[68:71], 0
    v_mfma_f32_16x16x32_bf16 v[108:111], v[196:199], v[68:71], 0
    buffer_load_dwordx4 v5, s[24:27], s15 offen offset:1024 lds
    v_cvt_pk_bf16_f32 v56, v112, v113
    v_cvt_pk_bf16_f32 v57, v114, v115
    v_cvt_pk_bf16_f32 v58, v116, v117
    v_cvt_pk_bf16_f32 v59, v118, v119
    v_mfma_f32_16x16x32_bf16 v[112:115], v[192:195], v[72:75], 0
    v_mfma_f32_16x16x32_bf16 v[116:119], v[196:199], v[72:75], 0
    v_cvt_pk_bf16_f32 v60, v120, v121
    v_cvt_pk_bf16_f32 v61, v122, v123
    v_cvt_pk_bf16_f32 v62, v124, v125
    v_cvt_pk_bf16_f32 v63, v126, v127
    v_mfma_f32_16x16x32_bf16 v[120:123], v[192:195], v[76:79], 0
    v_mfma_f32_16x16x32_bf16 v[124:127], v[196:199], v[76:79], 0
    s_waitcnt lgkmcnt(0)
    ds_read_b128 v[64:67], v10 offset:16384
    ds_read_b128 v[68:71], v10 offset:18432
    v_mfma_f32_16x16x32_bf16 v[96:99], v[200:203], v[80:83], v[96:99]
    v_xor_b32 v37, 160, v47
    v_xor_b32 v38, 192, v47
    ds_read_b128 v[72:75], v10 offset:20480
    ds_read_b128 v[76:79], v10 offset:22528
    v_mfma_f32_16x16x32_bf16 v[100:103], v[204:207], v[80:83], v[100:103]
    s_add_u32 m0, s12, 49152
    s_add_u32 s15, s13, 1572992
    buffer_load_dwordx4 v4, s[24:27], s15 offen lds
    v_mfma_f32_16x16x32_bf16 v[104:107], v[200:203], v[84:87], v[104:107]
    v_xor_b32 v39, 224, v47
    buffer_load_dword v29, v22, s[44:47], 0 offen offset:128 sc1
    v_mfma_f32_16x16x32_bf16 v[108:111], v[204:207], v[84:87], v[108:111]
    buffer_load_dwordx4 v5, s[24:27], s15 offen offset:1024 lds
    v_mfma_f32_16x16x32_bf16 v[112:115], v[200:203], v[88:91], v[112:115]
    v_mfma_f32_16x16x32_bf16 v[116:119], v[204:207], v[88:91], v[116:119]
    v_mfma_f32_16x16x32_bf16 v[120:123], v[200:203], v[92:95], v[120:123]
    s_add_u32 s11, s16, 262144
    buffer_store_dwordx4 v[48:51], v20, s[36:39], s11 offen sc1
    v_mfma_f32_16x16x32_bf16 v[124:127], v[204:207], v[92:95], v[124:127]
    s_waitcnt lgkmcnt(0)
    ds_read_b128 v[80:83], v11 offset:16384
    ds_read_b128 v[84:87], v11 offset:18432
    v_mfma_f32_16x16x32_bf16 v[96:99], v[208:211], v[64:67], v[96:99]
    ds_read_b128 v[88:91], v11 offset:20480
    ds_read_b128 v[92:95], v11 offset:22528
    v_mfma_f32_16x16x32_bf16 v[100:103], v[212:215], v[64:67], v[100:103]
    v_mfma_f32_16x16x32_bf16 v[104:107], v[208:211], v[68:71], v[104:107]
    v_mfma_f32_16x16x32_bf16 v[108:111], v[212:215], v[68:71], v[108:111]
    v_mfma_f32_16x16x32_bf16 v[112:115], v[208:211], v[72:75], v[112:115]
    v_mfma_f32_16x16x32_bf16 v[116:119], v[212:215], v[72:75], v[116:119]
    v_mfma_f32_16x16x32_bf16 v[120:123], v[208:211], v[76:79], v[120:123]
    v_mfma_f32_16x16x32_bf16 v[124:127], v[212:215], v[76:79], v[124:127]
    s_waitcnt lgkmcnt(0)
    s_waitcnt vmcnt(19)
    s_barrier
    ds_read_b128 v[64:67], v10 offset:32768
    ds_read_b128 v[68:71], v10 offset:34816
    v_mfma_f32_16x16x32_bf16 v[96:99], v[216:219], v[80:83], v[96:99]
    ds_read_b128 v[72:75], v10 offset:36864
    ds_read_b128 v[76:79], v10 offset:38912
    v_mfma_f32_16x16x32_bf16 v[100:103], v[220:223], v[80:83], v[100:103]
    s_add_u32 m0, s12, 65536
    s_add_u32 s15, s13, 1573120
    buffer_load_dwordx4 v4, s[24:27], s15 offen lds
    v_mfma_f32_16x16x32_bf16 v[104:107], v[216:219], v[84:87], v[104:107]
    v_mfma_f32_16x16x32_bf16 v[108:111], v[220:223], v[84:87], v[108:111]
    buffer_load_dwordx4 v5, s[24:27], s15 offen offset:1024 lds
    v_mfma_f32_16x16x32_bf16 v[112:115], v[216:219], v[88:91], v[112:115]
    v_mfma_f32_16x16x32_bf16 v[116:119], v[220:223], v[88:91], v[116:119]
    v_mfma_f32_16x16x32_bf16 v[120:123], v[216:219], v[92:95], v[120:123]
    v_mfma_f32_16x16x32_bf16 v[124:127], v[220:223], v[92:95], v[124:127]
    s_waitcnt lgkmcnt(0)
    ds_read_b128 v[80:83], v11 offset:32768
    ds_read_b128 v[84:87], v11 offset:34816
    v_mfma_f32_16x16x32_bf16 v[96:99], v[224:227], v[64:67], v[96:99]
    ds_read_b128 v[88:91], v11 offset:36864
    ds_read_b128 v[92:95], v11 offset:38912
    v_mfma_f32_16x16x32_bf16 v[100:103], v[228:231], v[64:67], v[100:103]
    s_add_u32 m0, s12, 81920
    s_add_u32 s15, s13, 1573248
    buffer_load_dwordx4 v4, s[24:27], s15 offen lds
    v_mfma_f32_16x16x32_bf16 v[104:107], v[224:227], v[68:71], v[104:107]
    v_mfma_f32_16x16x32_bf16 v[108:111], v[228:231], v[68:71], v[108:111]
    buffer_load_dwordx4 v5, s[24:27], s15 offen offset:1024 lds
    v_mfma_f32_16x16x32_bf16 v[112:115], v[224:227], v[72:75], v[112:115]
    v_mfma_f32_16x16x32_bf16 v[116:119], v[228:231], v[72:75], v[116:119]
    v_mfma_f32_16x16x32_bf16 v[120:123], v[224:227], v[76:79], v[120:123]
    v_mfma_f32_16x16x32_bf16 v[124:127], v[228:231], v[76:79], v[124:127]
    s_waitcnt lgkmcnt(0)
    ds_read_b128 v[64:67], v10 offset:49152
    ds_read_b128 v[68:71], v10 offset:51200
    v_mfma_f32_16x16x32_bf16 v[96:99], v[232:235], v[80:83], v[96:99]
    ds_read_b128 v[72:75], v10 offset:53248
    ds_read_b128 v[76:79], v10 offset:55296
    v_mfma_f32_16x16x32_bf16 v[100:103], v[236:239], v[80:83], v[100:103]
    v_mfma_f32_16x16x32_bf16 v[104:107], v[232:235], v[84:87], v[104:107]
    v_mfma_f32_16x16x32_bf16 v[108:111], v[236:239], v[84:87], v[108:111]
    v_mfma_f32_16x16x32_bf16 v[112:115], v[232:235], v[88:91], v[112:115]
    v_mfma_f32_16x16x32_bf16 v[116:119], v[236:239], v[88:91], v[116:119]
    v_mfma_f32_16x16x32_bf16 v[120:123], v[232:235], v[92:95], v[120:123]
    s_add_u32 s11, s16, 266240
    buffer_store_dwordx4 v[52:55], v20, s[36:39], s11 offen sc1
    v_mfma_f32_16x16x32_bf16 v[124:127], v[236:239], v[92:95], v[124:127]
    s_waitcnt lgkmcnt(0)
    ds_read_b128 v[80:83], v11 offset:49152
    ds_read_b128 v[84:87], v11 offset:51200
    v_mfma_f32_16x16x32_bf16 v[96:99], v[240:243], v[64:67], v[96:99]
    ds_read_b128 v[88:91], v11 offset:53248
    ds_read_b128 v[92:95], v11 offset:55296
    v_mfma_f32_16x16x32_bf16 v[100:103], v[244:247], v[64:67], v[100:103]
    v_mfma_f32_16x16x32_bf16 v[104:107], v[240:243], v[68:71], v[104:107]
    v_mfma_f32_16x16x32_bf16 v[108:111], v[244:247], v[68:71], v[108:111]
    v_mfma_f32_16x16x32_bf16 v[112:115], v[240:243], v[72:75], v[112:115]
    v_mfma_f32_16x16x32_bf16 v[116:119], v[244:247], v[72:75], v[116:119]
    s_waitcnt vmcnt(7)
    v_readfirstlane_b32 s3, v29
    s_nop 0
    s_or_b32 s3, s3, s60
    s_cmp_ge_u32 s3, 160
    s_cbranch_scc0 k1_spin3
k1_back4:
    v_mfma_f32_16x16x32_bf16 v[120:123], v[240:243], v[76:79], v[120:123]
    v_mfma_f32_16x16x32_bf16 v[124:127], v[244:247], v[76:79], v[124:127]
    s_waitcnt lgkmcnt(0)
    s_waitcnt vmcnt(17)
    s_barrier
    ds_read_b128 v[64:67], v12 offset:0
    ds_read_b128 v[68:71], v12 offset:2048
    v_mfma_f32_16x16x32_bf16 v[96:99], v[248:251], v[80:83], v[96:99]
    ds_read_b128 v[72:75], v12 offset:4096
    ds_read_b128 v[76:79], v12 offset:6144
    v_mfma_f32_16x16x32_bf16 v[100:103], v[252:255], v[80:83], v[100:103]
    s_add_u32 m0, s12, 98304
    s_add_u32 s15, s13, 1573376
    buffer_load_dwordx4 v4, s[24:27], s15 offen lds
    v_mfma_f32_16x16x32_bf16 v[104:107], v[248:251], v[84:87], v[104:107]
    v_mfma_f32_16x16x32_bf16 v[108:111], v[252:255], v[84:87], v[108:111]
    buffer_load_dwordx4 v5, s[24:27], s15 offen offset:1024 lds
    v_mfma_f32_16x16x32_bf16 v[112:115], v[248:251], v[88:91], v[112:115]
    v_mfma_f32_16x16x32_bf16 v[116:119], v[252:255], v[88:91], v[116:119]
    v_mfma_f32_16x16x32_bf16 v[120:123], v[248:251], v[92:95], v[120:123]
    v_mfma_f32_16x16x32_bf16 v[124:127], v[252:255], v[92:95], v[124:127]
    s_waitcnt lgkmcnt(0)
    ds_read_b128 v[80:83], v13 offset:0
    ds_read_b128 v[84:87], v13 offset:2048
    v_mfma_f32_16x16x32_bf16 v[96:99], v[128:131], v[64:67], v[96:99]
    s_lshl_b32 s18, s23, 8
    s_add_u32 s18, s18, 83951616
    ds_read_b128 v[88:91], v13 offset:4096
    ds_read_b128 v[92:95], v13 offset:6144
    v_mfma_f32_16x16x32_bf16 v[100:103], v[132:135], v[64:67], v[100:103]
    s_add_u32 m0, s12, 114688
    s_add_u32 s15, s13, 1573504
    buffer_load_dwordx4 v4, s[24:27], s15 offen lds
    v_mfma_f32_16x16x32_bf16 v[104:107], v[128:131], v[68:71], v[104:107]
    buffer_load_dword v29, v23, s[36:39], s18 offen sc1
    v_mfma_f32_16x16x32_bf16 v[108:111], v[132:135], v[68:71], v[108:111]
    buffer_load_dwordx4 v5, s[24:27], s15 offen offset:1024 lds
    v_mfma_f32_16x16x32_bf16 v[112:115], v[128:131], v[72:75], v[112:115]
    v_mfma_f32_16x16x32_bf16 v[116:119], v[132:135], v[72:75], v[116:119]
    v_mfma_f32_16x16x32_bf16 v[120:123], v[128:131], v[76:79], v[120:123]
    v_mfma_f32_16x16x32_bf16 v[124:127], v[132:135], v[76:79], v[124:127]
    s_waitcnt lgkmcnt(0)
    ds_read_b128 v[64:67], v12 offset:16384
    ds_read_b128 v[68:71], v12 offset:18432
    v_mfma_f32_16x16x32_bf16 v[96:99], v[136:139], v[80:83], v[96:99]
    ds_read_b128 v[72:75], v12 offset:20480
    ds_read_b128 v[76:79], v12 offset:22528
    v_mfma_f32_16x16x32_bf16 v[100:103], v[140:143], v[80:83], v[100:103]
    v_mfma_f32_16x16x32_bf16 v[104:107], v[136:139], v[84:87], v[104:107]
    v_mfma_f32_16x16x32_bf16 v[108:111], v[140:143], v[84:87], v[108:111]
    v_mfma_f32_16x16x32_bf16 v[112:115], v[136:139], v[88:91], v[112:115]
    v_mfma_f32_16x16x32_bf16 v[116:119], v[140:143], v[88:91], v[116:119]
    v_mfma_f32_16x16x32_bf16 v[120:123], v[136:139], v[92:95], v[120:123]
    s_add_u32 s11, s16, 270336
    buffer_store_dwordx4 v[56:59], v20, s[36:39], s11 offen sc1
    v_mfma_f32_16x16x32_bf16 v[124:127], v[140:143], v[92:95], v[124:127]
    s_waitcnt lgkmcnt(0)
    ds_read_b128 v[80:83], v13 offset:16384
    ds_read_b128 v[84:87], v13 offset:18432
    v_mfma_f32_16x16x32_bf16 v[96:99], v[144:147], v[64:67], v[96:99]
    ds_read_b128 v[88:91], v13 offset:20480
    ds_read_b128 v[92:95], v13 offset:22528
    v_mfma_f32_16x16x32_bf16 v[100:103], v[148:151], v[64:67], v[100:103]
    v_mfma_f32_16x16x32_bf16 v[104:107], v[144:147], v[68:71], v[104:107]
    v_mfma_f32_16x16x32_bf16 v[108:111], v[148:151], v[68:71], v[108:111]
    v_mfma_f32_16x16x32_bf16 v[112:115], v[144:147], v[72:75], v[112:115]
    v_mfma_f32_16x16x32_bf16 v[116:119], v[148:151], v[72:75], v[116:119]
    v_mfma_f32_16x16x32_bf16 v[120:123], v[144:147], v[76:79], v[120:123]
    v_mfma_f32_16x16x32_bf16 v[124:127], v[148:151], v[76:79], v[124:127]
    s_waitcnt lgkmcnt(0)
    s_waitcnt vmcnt(18)
    s_barrier
    ds_read_b128 v[64:67], v8 offset:0
    ds_read_b128 v[68:71], v8 offset:2048
    v_mfma_f32_16x16x32_bf16 v[96:99], v[152:155], v[80:83], v[96:99]
    ds_read_b128 v[72:75], v8 offset:4096
    ds_read_b128 v[76:79], v8 offset:6144
    v_mfma_f32_16x16x32_bf16 v[100:103], v[156:159], v[80:83], v[100:103]
    s_add_u32 m0, s12, 131072
    s_add_u32 s15, s13, 1573632
    buffer_load_dwordx4 v4, s[24:27], s15 offen lds
    v_mfma_f32_16x16x32_bf16 v[104:107], v[152:155], v[84:87], v[104:107]
    v_mfma_f32_16x16x32_bf16 v[108:111], v[156:159], v[84:87], v[108:111]
    buffer_load_dwordx4 v5, s[24:27], s15 offen offset:1024 lds
    v_mfma_f32_16x16x32_bf16 v[112:115], v[152:155], v[88:91], v[112:115]
    v_mfma_f32_16x16x32_bf16 v[116:119], v[156:159], v[88:91], v[116:119]
    v_mfma_f32_16x16x32_bf16 v[120:123], v[152:155], v[92:95], v[120:123]
    v_mfma_f32_16x16x32_bf16 v[124:127], v[156:159], v[92:95], v[124:127]
    s_waitcnt lgkmcnt(0)
    ds_read_b128 v[80:83], v9 offset:0
    ds_read_b128 v[84:87], v9 offset:2048
    v_mfma_f32_16x16x32_bf16 v[96:99], v[160:163], v[64:67], v[96:99]
    ds_read_b128 v[88:91], v9 offset:4096
    ds_read_b128 v[92:95], v9 offset:6144
    v_mfma_f32_16x16x32_bf16 v[100:103], v[164:167], v[64:67], v[100:103]
    s_add_u32 m0, s12, 147456
    s_add_u32 s15, s13, 1573760
    buffer_load_dwordx4 v4, s[24:27], s15 offen lds
    v_mfma_f32_16x16x32_bf16 v[104:107], v[160:163], v[68:71], v[104:107]
    v_mfma_f32_16x16x32_bf16 v[108:111], v[164:167], v[68:71], v[108:111]
    buffer_load_dwordx4 v5, s[24:27], s15 offen offset:1024 lds
    v_mfma_f32_16x16x32_bf16 v[112:115], v[160:163], v[72:75], v[112:115]
    v_mfma_f32_16x16x32_bf16 v[116:119], v[164:167], v[72:75], v[116:119]
    v_mfma_f32_16x16x32_bf16 v[120:123], v[160:163], v[76:79], v[120:123]
    v_mfma_f32_16x16x32_bf16 v[124:127], v[164:167], v[76:79], v[124:127]
    s_waitcnt lgkmcnt(0)
    ds_read_b128 v[64:67], v8 offset:16384
    ds_read_b128 v[68:71], v8 offset:18432
    v_mfma_f32_16x16x32_bf16 v[96:99], v[168:171], v[80:83], v[96:99]
    ds_read_b128 v[72:75], v8 offset:20480
    ds_read_b128 v[76:79], v8 offset:22528
    v_mfma_f32_16x16x32_bf16 v[100:103], v[172:175], v[80:83], v[100:103]
    v_mfma_f32_16x16x32_bf16 v[104:107], v[168:171], v[84:87], v[104:107]
    v_mfma_f32_16x16x32_bf16 v[108:111], v[172:175], v[84:87], v[108:111]
    v_mfma_f32_16x16x32_bf16 v[112:115], v[168:171], v[88:91], v[112:115]
    v_mfma_f32_16x16x32_bf16 v[116:119], v[172:175], v[88:91], v[116:119]
    v_mfma_f32_16x16x32_bf16 v[120:123], v[168:171], v[92:95], v[120:123]
    s_add_u32 s11, s16, 274432
    buffer_store_dwordx4 v[60:63], v20, s[36:39], s11 offen sc1
    v_mfma_f32_16x16x32_bf16 v[124:127], v[172:175], v[92:95], v[124:127]
    s_waitcnt lgkmcnt(0)
    ds_read_b128 v[80:83], v9 offset:16384
    ds_read_b128 v[84:87], v9 offset:18432
    v_mfma_f32_16x16x32_bf16 v[96:99], v[176:179], v[64:67], v[96:99]
    ds_read_b128 v[88:91], v9 offset:20480
    ds_read_b128 v[92:95], v9 offset:22528
    v_mfma_f32_16x16x32_bf16 v[100:103], v[180:183], v[64:67], v[100:103]
    v_mfma_f32_16x16x32_bf16 v[104:107], v[176:179], v[68:71], v[104:107]
    v_mfma_f32_16x16x32_bf16 v[108:111], v[180:183], v[68:71], v[108:111]
    v_mfma_f32_16x16x32_bf16 v[112:115], v[176:179], v[72:75], v[112:115]
    v_mfma_f32_16x16x32_bf16 v[116:119], v[180:183], v[72:75], v[116:119]
    s_waitcnt vmcnt(7)
    v_cmp_le_u32 vcc, 1, v29
    s_nop 0
    s_or_b32 s3, vcc_lo, s19
    s_and_b32 s3, s3, 65535
    s_cmp_eq_u32 s3, 65535
    s_cbranch_scc0 k1_spin5
k1_back6:
    v_mfma_f32_16x16x32_bf16 v[120:123], v[176:179], v[76:79], v[120:123]
    v_mfma_f32_16x16x32_bf16 v[124:127], v[180:183], v[76:79], v[124:127]
    s_waitcnt lgkmcnt(0)
    s_waitcnt vmcnt(17)
    s_barrier
    ds_read_b128 v[64:67], v8 offset:32768
    ds_read_b128 v[68:71], v8 offset:34816
    v_mfma_f32_16x16x32_bf16 v[96:99], v[184:187], v[80:83], v[96:99]
    s_lshl_b32 s18, s6, 8
    s_add_u32 s18, s18, 83955712
    ds_read_b128 v[72:75], v8 offset:36864
    ds_read_b128 v[76:79], v8 offset:38912
    v_mfma_f32_16x16x32_bf16 v[100:103], v[188:191], v[80:83], v[100:103]
    s_add_u32 m0, s12, 0
    s_add_u32 s15, s14, 0
    buffer_load_dwordx4 v6, s[32:35], s15 offen lds
    v_mfma_f32_16x16x32_bf16 v[104:107], v[184:187], v[84:87], v[104:107]
    s_lshl_b32 s17, s9, 2
    s_add_u32 s17, s17, s18
    v_mfma_f32_16x16x32_bf16 v[108:111], v[188:191], v[84:87], v[108:111]
    buffer_load_dwordx4 v7, s[32:35], s15 offen offset:1024 lds
    v_mfma_f32_16x16x32_bf16 v[112:115], v[184:187], v[88:91], v[112:115]
    v_mov_b32 v24, 2
    v_mfma_f32_16x16x32_bf16 v[116:119], v[188:191], v[88:91], v[116:119]
    v_mfma_f32_16x16x32_bf16 v[120:123], v[184:187], v[92:95], v[120:123]
    v_mfma_f32_16x16x32_bf16 v[124:127], v[188:191], v[92:95], v[124:127]
    s_waitcnt lgkmcnt(0)
    v_cvt_pk_bf16_f32 v48, v96, v97
    v_cvt_pk_bf16_f32 v49, v98, v99
    v_cvt_pk_bf16_f32 v50, v100, v101
    v_cvt_pk_bf16_f32 v51, v102, v103
    ds_read_b128 v[80:83], v9 offset:32768
    ds_read_b128 v[84:87], v9 offset:34816
    v_mfma_f32_16x16x32_bf16 v[96:99], v[192:195], v[64:67], 0
    ds_read_b128 v[88:91], v9 offset:36864
    ds_read_b128 v[92:95], v9 offset:38912
    v_mfma_f32_16x16x32_bf16 v[100:103], v[196:199], v[64:67], 0
    s_add_u32 m0, s12, 16384
    s_add_u32 s15, s14, 524288
    buffer_load_dwordx4 v6, s[32:35], s15 offen lds
    v_cvt_pk_bf16_f32 v52, v104, v105
    v_cvt_pk_bf16_f32 v53, v106, v107
    v_cvt_pk_bf16_f32 v54, v108, v109
    v_cvt_pk_bf16_f32 v55, v110, v111
    v_mfma_f32_16x16x32_bf16 v[104:107], v[192:195], v[68:71], 0
    v_mfma_f32_16x16x32_bf16 v[108:111], v[196:199], v[68:71], 0
    buffer_load_dwordx4 v7, s[32:35], s15 offen offset:1024 lds
    v_cvt_pk_bf16_f32 v56, v112, v113
    v_cvt_pk_bf16_f32 v57, v114, v115
    v_cvt_pk_bf16_f32 v58, v116, v117
    v_cvt_pk_bf16_f32 v59, v118, v119
    v_mfma_f32_16x16x32_bf16 v[112:115], v[192:195], v[72:75], 0
    v_mfma_f32_16x16x32_bf16 v[116:119], v[196:199], v[72:75], 0
    v_cvt_pk_bf16_f32 v60, v120, v121
    v_cvt_pk_bf16_f32 v61, v122, v123
    v_cvt_pk_bf16_f32 v62, v124, v125
    v_cvt_pk_bf16_f32 v63, v126, v127
    v_mfma_f32_16x16x32_bf16 v[120:123], v[192:195], v[76:79], 0
    v_mfma_f32_16x16x32_bf16 v[124:127], v[196:199], v[76:79], 0
    s_waitcnt lgkmcnt(0)
    ds_read_b128 v[64:67], v8 offset:49152
    ds_read_b128 v[68:71], v8 offset:51200
    v_mfma_f32_16x16x32_bf16 v[96:99], v[200:203], v[80:83], v[96:99]
    s_add_u32 s61, s20, 0
    buffer_load_dwordx4 v[192:195], v20, s[36:39], s61 offen sc1
    s_add_u32 s61, s20, 20480
    buffer_load_dwordx4 v[196:199], v20, s[36:39], s61 offen sc1
    ds_read_b128 v[72:75], v8 offset:53248
    ds_read_b128 v[76:79], v8 offset:55296
    v_mfma_f32_16x16x32_bf16 v[100:103], v[204:207], v[80:83], v[100:103]
    v_mfma_f32_16x16x32_bf16 v[104:107], v[200:203], v[84:87], v[104:107]
    v_mfma_f32_16x16x32_bf16 v[108:111], v[204:207], v[84:87], v[108:111]
    v_mfma_f32_16x16x32_bf16 v[112:115], v[200:203], v[88:91], v[112:115]
    v_mfma_f32_16x16x32_bf16 v[116:119], v[204:207], v[88:91], v[116:119]
    v_mfma_f32_16x16x32_bf16 v[120:123], v[200:203], v[92:95], v[120:123]
    s_add_u32 s11, s16, 524288
    buffer_store_dwordx4 v[48:51], v20, s[36:39], s11 offen sc1
    v_mfma_f32_16x16x32_bf16 v[124:127], v[204:207], v[92:95], v[124:127]
    s_waitcnt lgkmcnt(0)
    ds_read_b128 v[80:83], v9 offset:49152
    ds_read_b128 v[84:87], v9 offset:51200
    v_mfma_f32_16x16x32_bf16 v[96:99], v[208:211], v[64:67], v[96:99]
    s_add_u32 s61, s20, 1024
    buffer_load_dwordx4 v[200:203], v20, s[36:39], s61 offen sc1
    s_add_u32 s61, s20, 21504
    buffer_load_dwordx4 v[204:207], v20, s[36:39], s61 offen sc1
    ds_read_b128 v[88:91], v9 offset:53248
    ds_read_b128 v[92:95], v9 offset:55296
    v_mfma_f32_16x16x32_bf16 v[100:103], v[212:215], v[64:67], v[100:103]
    v_mfma_f32_16x16x32_bf16 v[104:107], v[208:211], v[68:71], v[104:107]
    v_mfma_f32_16x16x32_bf16 v[108:111], v[212:215], v[68:71], v[108:111]
    v_mfma_f32_16x16x32_bf16 v[112:115], v[208:211], v[72:75], v[112:115]
    v_mfma_f32_16x16x32_bf16 v[116:119], v[212:215], v[72:75], v[116:119]
    s_waitcnt vmcnt(9)
    v_mfma_f32_16x16x32_bf16 v[120:123], v[208:211], v[76:79], v[120:123]
    v_mfma_f32_16x16x32_bf16 v[124:127], v[212:215], v[76:79], v[124:127]
    s_waitcnt lgkmcnt(0)
    s_waitcnt vmcnt(21)
    s_barrier
    ds_read_b128 v[64:67], v10 offset:0
    ds_read_b128 v[68:71], v10 offset:2048
    v_mfma_f32_16x16x32_bf16 v[96:99], v[216:219], v[80:83], v[96:99]
    buffer_store_dword v30, v22, s[36:39], s17 offen sc1
    s_add_u32 s61, s20, 2048
    buffer_load_dwordx4 v[208:211], v20, s[36:39], s61 offen sc1
    ds_read_b128 v[72:75], v10 offset:4096
    ds_read_b128 v[76:79], v10 offset:6144
    v_mfma_f32_16x16x32_bf16 v[100:103], v[220:223], v[80:83], v[100:103]
    s_add_u32 m0, s12, 32768
    s_add_u32 s15, s14, 1048576
    buffer_load_dwordx4 v6, s[32:35], s15 offen lds
    v_mfma_f32_16x16x32_bf16 v[104:107], v[216:219], v[84:87], v[104:107]
    s_add_u32 s61, s20, 22528
    buffer_load_dwordx4 v[212:215], v20, s[36:39], s61 offen sc1
    v_mfma_f32_16x16x32_bf16 v[108:111], v[220:223], v[84:87], v[108:111]
    buffer_load_dwordx4 v7, s[32:35], s15 offen offset:1024 lds
    v_mfma_f32_16x16x32_bf16 v[112:115], v[216:219], v[88:91], v[112:115]
    v_mfma_f32_16x16x32_bf16 v[116:119], v[220:223], v[88:91], v[116:119]
    v_mfma_f32_16x16x32_bf16 v[120:123], v[216:219], v[92:95], v[120:123]
    v_mfma_f32_16x16x32_bf16 v[124:127], v[220:223], v[92:95], v[124:127]
    s_waitcnt lgkmcnt(0)
    ds_read_b128 v[80:83], v11 offset:0
    ds_read_b128 v[84:87], v11 offset:2048
    v_mfma_f32_16x16x32_bf16 v[96:99], v[224:227], v[64:67], v[96:99]
    s_add_u32 s61, s20, 3072
    buffer_load_dwordx4 v[216:219], v20, s[36:39], s61 offen sc1
    s_add_u32 s61, s20, 23552
    buffer_load_dwordx4 v[220:223], v20, s[36:39], s61 offen sc1
    ds_read_b128 v[88:91], v11 offset:4096
    ds_read_b128 v[92:95], v11 offset:6144
    v_mfma_f32_16x16x32_bf16 v[100:103], v[228:231], v[64:67], v[100:103]
    s_add_u32 m0, s12, 49152
    s_add_u32 s15, s14, 1572864
    buffer_load_dwordx4 v6, s[32:35], s15 offen lds
    v_mfma_f32_16x16x32_bf16 v[104:107], v[224:227], v[68:71], v[104:107]
    v_mfma_f32_16x16x32_bf16 v[108:111], v[228:231], v[68:71], v[108:111]
    buffer_load_dwordx4 v7, s[32:35], s15 offen offset:1024 lds
    v_mfma_f32_16x16x32_bf16 v[112:115], v[224:227], v[72:75], v[112:115]
    v_mfma_f32_16x16x32_bf16 v[116:119], v[228:231], v[72:75], v[116:119]
    v_mfma_f32_16x16x32_bf16 v[120:123], v[224:227], v[76:79], v[120:123]
    v_mfma_f32_16x16x32_bf16 v[124:127], v[228:231], v[76:79], v[124:127]
    s_waitcnt lgkmcnt(0)
    ds_read_b128 v[64:67], v10 offset:16384
    ds_read_b128 v[68:71], v10 offset:18432
    v_mfma_f32_16x16x32_bf16 v[96:99], v[232:235], v[80:83], v[96:99]
    s_add_u32 s61, s20, 4096
    buffer_load_dwordx4 v[224:227], v20, s[36:39], s61 offen sc1
    s_add_u32 s61, s20, 24576
    buffer_load_dwordx4 v[228:231], v20, s[36:39], s61 offen sc1
    ds_read_b128 v[72:75], v10 offset:20480
    ds_read_b128 v[76:79], v10 offset:22528
    v_mfma_f32_16x16x32_bf16 v[100:103], v[236:239], v[80:83], v[100:103]
    v_mfma_f32_16x16x32_bf16 v[104:107], v[232:235], v[84:87], v[104:107]
    v_mfma_f32_16x16x32_bf16 v[108:111], v[236:239], v[84:87], v[108:111]
    v_mfma_f32_16x16x32_bf16 v[112:115], v[232:235], v[88:91], v[112:115]
    v_mfma_f32_16x16x32_bf16 v[116:119], v[236:239], v[88:91], v[116:119]
    v_mfma_f32_16x16x32_bf16 v[120:123], v[232:235], v[92:95], v[120:123]
    s_add_u32 s11, s16, 528384
    buffer_store_dwordx4 v[52:55], v20, s[36:39], s11 offen sc1
    v_mfma_f32_16x16x32_bf16 v[124:127], v[236:239], v[92:95], v[124:127]
    s_waitcnt lgkmcnt(0)
    ds_read_b128 v[80:83], v11 offset:16384
    ds_read_b128 v[84:87], v11 offset:18432
    v_mfma_f32_16x16x32_bf16 v[96:99], v[240:243], v[64:67], v[96:99]
    s_add_u32 s61, s20, 5120
    buffer_load_dwordx4 v[232:235], v20, s[36:39], s61 offen sc1
    s_add_u32 s61, s20, 25600
    buffer_load_dwordx4 v[236:239], v20, s[36:39], s61 offen sc1
    ds_read_b128 v[88:91], v11 offset:20480
    ds_read_b128 v[92:95], v11 offset:22528
    v_mfma_f32_16x16x32_bf16 v[100:103], v[244:247], v[64:67], v[100:103]
    v_mfma_f32_16x16x32_bf16 v[104:107], v[240:243], v[68:71], v[104:107]
    v_mfma_f32_16x16x32_bf16 v[108:111], v[244:247], v[68:71], v[108:111]
    v_mfma_f32_16x16x32_bf16 v[112:115], v[240:243], v[72:75], v[112:115]
    v_mfma_f32_16x16x32_bf16 v[116:119], v[244:247], v[72:75], v[116:119]
    v_mfma_f32_16x16x32_bf16 v[120:123], v[240:243], v[76:79], v[120:123]
    v_mfma_f32_16x16x32_bf16 v[124:127], v[244:247], v[76:79], v[124:127]
    s_waitcnt lgkmcnt(0)
    s_waitcnt vmcnt(29)
    s_barrier
    ds_read_b128 v[64:67], v10 offset:32768
    ds_read_b128 v[68:71], v10 offset:34816
    v_mfma_f32_16x16x32_bf16 v[96:99], v[248:251], v[80:83], v[96:99]
    s_add_u32 s61, s20, 6144
    buffer_load_dwordx4 v[240:243], v20, s[36:39], s61 offen sc1
    s_add_u32 s61, s20, 26624
    buffer_load_dwordx4 v[244:247], v20, s[36:39], s61 offen sc1
    ds_read_b128 v[72:75], v10 offset:36864
    ds_read_b128 v[76:79], v10 offset:38912
    v_mfma_f32_16x16x32_bf16 v[100:103], v[252:255], v[80:83], v[100:103]
    s_add_u32 m0, s12, 65536
    s_add_u32 s15, s14, 2097152
    buffer_load_dwordx4 v6, s[32:35], s15 offen lds
    v_mfma_f32_16x16x32_bf16 v[104:107], v[248:251], v[84:87], v[104:107]
    v_mfma_f32_16x16x32_bf16 v[108:111], v[252:255], v[84:87], v[108:111]
    buffer_load_dwordx4 v7, s[32:35], s15 offen offset:1024 lds
    v_mfma_f32_16x16x32_bf16 v[112:115], v[248:251], v[88:91], v[112:115]
    v_mfma_f32_16x16x32_bf16 v[116:119], v[252:255], v[88:91], v[116:119]
    v_mfma_f32_16x16x32_bf16 v[120:123], v[248:251], v[92:95], v[120:123]
    v_mfma_f32_16x16x32_bf16 v[124:127], v[252:255], v[92:95], v[124:127]
    s_waitcnt lgkmcnt(0)
    ds_read_b128 v[80:83], v11 offset:32768
    ds_read_b128 v[84:87], v11 offset:34816
    v_mfma_f32_16x16x32_bf16 v[96:99], v[128:131], v[64:67], v[96:99]
    s_add_u32 s61, s20, 7168
    buffer_load_dwordx4 v[248:251], v20, s[36:39], s61 offen sc1
    s_add_u32 s61, s20, 27648
    buffer_load_dwordx4 v[252:255], v20, s[36:39], s61 offen sc1
    ds_read_b128 v[88:91], v11 offset:36864
    ds_read_b128 v[92:95], v11 offset:38912
    v_mfma_f32_16x16x32_bf16 v[100:103], v[132:135], v[64:67], v[100:103]
    s_add_u32 m0, s12, 81920
    s_add_u32 s15, s14, 2621440
    buffer_load_dwordx4 v6, s[32:35], s15 offen lds
    v_mfma_f32_16x16x32_bf16 v[104:107], v[128:131], v[68:71], v[104:107]
    v_mfma_f32_16x16x32_bf16 v[108:111], v[132:135], v[68:71], v[108:111]
    buffer_load_dwordx4 v7, s[32:35], s15 offen offset:1024 lds
    v_mfma_f32_16x16x32_bf16 v[112:115], v[128:131], v[72:75], v[112:115]
    v_mfma_f32_16x16x32_bf16 v[116:119], v[132:135], v[72:75], v[116:119]
    v_mfma_f32_16x16x32_bf16 v[120:123], v[128:131], v[76:79], v[120:123]
    v_mfma_f32_16x16x32_bf16 v[124:127], v[132:135], v[76:79], v[124:127]
    s_waitcnt lgkmcnt(0)
    ds_read_b128 v[64:67], v10 offset:49152
    ds_read_b128 v[68:71], v10 offset:51200
    v_mfma_f32_16x16x32_bf16 v[96:99], v[136:139], v[80:83], v[96:99]
    ds_read_b128 v[72:75], v10 offset:53248
    ds_read_b128 v[76:79], v10 offset:55296
    v_mfma_f32_16x16x32_bf16 v[100:103], v[140:143], v[80:83], v[100:103]
    v_mfma_f32_16x16x32_bf16 v[104:107], v[136:139], v[84:87], v[104:107]
    v_mfma_f32_16x16x32_bf16 v[108:111], v[140:143], v[84:87], v[108:111]
    v_mfma_f32_16x16x32_bf16 v[112:115], v[136:139], v[88:91], v[112:115]
    v_mfma_f32_16x16x32_bf16 v[116:119], v[140:143], v[88:91], v[116:119]
    v_mfma_f32_16x16x32_bf16 v[120:123], v[136:139], v[92:95], v[120:123]
    s_add_u32 s11, s16, 532480
    buffer_store_dwordx4 v[56:59], v20, s[36:39], s11 offen sc1
    v_mfma_f32_16x16x32_bf16 v[124:127], v[140:143], v[92:95], v[124:127]
    s_waitcnt lgkmcnt(0)
    ds_read_b128 v[80:83], v11 offset:49152
    ds_read_b128 v[84:87], v11 offset:51200
    v_mfma_f32_16x16x32_bf16 v[96:99], v[144:147], v[64:67], v[96:99]
    ds_read_b128 v[88:91], v11 offset:53248
    ds_read_b128 v[92:95], v11 offset:55296
    v_mfma_f32_16x16x32_bf16 v[100:103], v[148:151], v[64:67], v[100:103]
    v_mfma_f32_16x16x32_bf16 v[104:107], v[144:147], v[68:71], v[104:107]
    v_mfma_f32_16x16x32_bf16 v[108:111], v[148:151], v[68:71], v[108:111]
    v_mfma_f32_16x16x32_bf16 v[112:115], v[144:147], v[72:75], v[112:115]
    v_mfma_f32_16x16x32_bf16 v[116:119], v[148:151], v[72:75], v[116:119]
    v_mfma_f32_16x16x32_bf16 v[120:123], v[144:147], v[76:79], v[120:123]
    v_mfma_f32_16x16x32_bf16 v[124:127], v[148:151], v[76:79], v[124:127]
    s_waitcnt lgkmcnt(0)
    s_waitcnt vmcnt(33)
    s_barrier
    ds_read_b128 v[64:67], v12 offset:0
    ds_read_b128 v[68:71], v12 offset:2048
    v_mfma_f32_16x16x32_bf16 v[96:99], v[152:155], v[80:83], v[96:99]
    ds_read_b128 v[72:75], v12 offset:4096
    ds_read_b128 v[76:79], v12 offset:6144
    v_mfma_f32_16x16x32_bf16 v[100:103], v[156:159], v[80:83], v[100:103]
    s_add_u32 m0, s12, 98304
    s_add_u32 s15, s14, 3145728
    buffer_load_dwordx4 v6, s[32:35], s15 offen lds
    v_mfma_f32_16x16x32_bf16 v[104:107], v[152:155], v[84:87], v[104:107]
    v_mfma_f32_16x16x32_bf16 v[108:111], v[156:159], v[84:87], v[108:111]
    buffer_load_dwordx4 v7, s[32:35], s15 offen offset:1024 lds
    v_mfma_f32_16x16x32_bf16 v[112:115], v[152:155], v[88:91], v[112:115]
    v_mfma_f32_16x16x32_bf16 v[116:119], v[156:159], v[88:91], v[116:119]
    v_mfma_f32_16x16x32_bf16 v[120:123], v[152:155], v[92:95], v[120:123]
    v_mfma_f32_16x16x32_bf16 v[124:127], v[156:159], v[92:95], v[124:127]
    s_waitcnt lgkmcnt(0)
    ds_read_b128 v[80:83], v13 offset:0
    ds_read_b128 v[84:87], v13 offset:2048
    v_mfma_f32_16x16x32_bf16 v[96:99], v[160:163], v[64:67], v[96:99]
    ds_read_b128 v[88:91], v13 offset:4096
    ds_read_b128 v[92:95], v13 offset:6144
    v_mfma_f32_16x16x32_bf16 v[100:103], v[164:167], v[64:67], v[100:103]
    s_add_u32 m0, s12, 114688
    s_add_u32 s15, s14, 3670016
    buffer_load_dwordx4 v6, s[32:35], s15 offen lds
    v_mfma_f32_16x16x32_bf16 v[104:107], v[160:163], v[68:71], v[104:107]
    v_mfma_f32_16x16x32_bf16 v[108:111], v[164:167], v[68:71], v[108:111]
    buffer_load_dwordx4 v7, s[32:35], s15 offen offset:1024 lds
    v_mfma_f32_16x16x32_bf16 v[112:115], v[160:163], v[72:75], v[112:115]
    v_mfma_f32_16x16x32_bf16 v[116:119], v[164:167], v[72:75], v[116:119]
    v_mfma_f32_16x16x32_bf16 v[120:123], v[160:163], v[76:79], v[120:123]
    v_mfma_f32_16x16x32_bf16 v[124:127], v[164:167], v[76:79], v[124:127]
    s_waitcnt lgkmcnt(0)
    ds_read_b128 v[64:67], v12 offset:16384
    ds_read_b128 v[68:71], v12 offset:18432
    v_mfma_f32_16x16x32_bf16 v[96:99], v[168:171], v[80:83], v[96:99]
    ds_read_b128 v[72:75], v12 offset:20480
    ds_read_b128 v[76:79], v12 offset:22528
    v_mfma_f32_16x16x32_bf16 v[100:103], v[172:175], v[80:83], v[100:103]
    v_mfma_f32_16x16x32_bf16 v[104:107], v[168:171], v[84:87], v[104:107]
    v_mfma_f32_16x16x32_bf16 v[108:111], v[172:175], v[84:87], v[108:111]
    v_mfma_f32_16x16x32_bf16 v[112:115], v[168:171], v[88:91], v[112:115]
    v_mfma_f32_16x16x32_bf16 v[116:119], v[172:175], v[88:91], v[116:119]
    v_mfma_f32_16x16x32_bf16 v[120:123], v[168:171], v[92:95], v[120:123]
    s_add_u32 s11, s16, 536576
    buffer_store_dwordx4 v[60:63], v20, s[36:39], s11 offen sc1
    v_mfma_f32_16x16x32_bf16 v[124:127], v[172:175], v[92:95], v[124:127]
    s_waitcnt lgkmcnt(0)
    ds_read_b128 v[80:83], v13 offset:16384
    ds_read_b128 v[84:87], v13 offset:18432
    v_mfma_f32_16x16x32_bf16 v[96:99], v[176:179], v[64:67], v[96:99]
    ds_read_b128 v[88:91], v13 offset:20480
    ds_read_b128 v[92:95], v13 offset:22528
    v_mfma_f32_16x16x32_bf16 v[100:103], v[180:183], v[64:67], v[100:103]
    v_mfma_f32_16x16x32_bf16 v[104:107], v[176:179], v[68:71], v[104:107]
    v_mfma_f32_16x16x32_bf16 v[108:111], v[180:183], v[68:71], v[108:111]
    v_mfma_f32_16x16x32_bf16 v[112:115], v[176:179], v[72:75], v[112:115]
    v_mfma_f32_16x16x32_bf16 v[116:119], v[180:183], v[72:75], v[116:119]
    v_mfma_f32_16x16x32_bf16 v[120:123], v[176:179], v[76:79], v[120:123]
    v_mfma_f32_16x16x32_bf16 v[124:127], v[180:183], v[76:79], v[124:127]
    s_waitcnt lgkmcnt(0)
    s_waitcnt vmcnt(10)
    s_barrier
    ds_read_b64_tr_b16 v[128:129], v32 offset:0
    ds_read_b64_tr_b16 v[130:131], v32 offset:2048
    v_mfma_f32_16x16x32_bf16 v[96:99], v[184:187], v[80:83], v[96:99]
    ds_read_b64_tr_b16 v[132:133], v33 offset:0
    ds_read_b64_tr_b16 v[134:135], v33 offset:2048
    v_mfma_f32_16x16x32_bf16 v[100:103], v[188:191], v[80:83], v[100:103]
    s_add_u32 m0, s12, 131072
    s_add_u32 s15, s14, 4194304
    buffer_load_dwordx4 v6, s[32:35], s15 offen lds
    ds_read_b64_tr_b16 v[136:137], v34 offset:0
    ds_read_b64_tr_b16 v[138:139], v34 offset:2048
    v_mfma_f32_16x16x32_bf16 v[104:107], v[184:187], v[84:87], v[104:107]
    ds_read_b64_tr_b16 v[140:141], v35 offset:0
    ds_read_b64_tr_b16 v[142:143], v35 offset:2048
    v_mfma_f32_16x16x32_bf16 v[108:111], v[188:191], v[84:87], v[108:111]
    buffer_load_dwordx4 v7, s[32:35], s15 offen offset:1024 lds
    ds_read_b64_tr_b16 v[144:145], v36 offset:0
    ds_read_b64_tr_b16 v[146:147], v36 offset:2048
    v_mfma_f32_16x16x32_bf16 v[112:115], v[184:187], v[88:91], v[112:115]
    ds_read_b64_tr_b16 v[148:149], v37 offset:0
    ds_read_b64_tr_b16 v[150:151], v37 offset:2048
    v_mfma_f32_16x16x32_bf16 v[116:119], v[188:191], v[88:91], v[116:119]
    s_add_u32 m0, s12, 147456
    s_add_u32 s15, s14, 4718592
    buffer_load_dwordx4 v6, s[32:35], s15 offen lds
    ds_read_b64_tr_b16 v[152:153], v38 offset:0
    ds_read_b64_tr_b16 v[154:155], v38 offset:2048
    v_mfma_f32_16x16x32_bf16 v[120:123], v[184:187], v[92:95], v[120:123]
    ds_read_b64_tr_b16 v[156:157], v39 offset:0
    ds_read_b64_tr_b16 v[158:159], v39 offset:2048
    v_mfma_f32_16x16x32_bf16 v[124:127], v[188:191], v[92:95], v[124:127]
    buffer_load_dwordx4 v7, s[32:35], s15 offen offset:1024 lds
    s_waitcnt vmcnt(35)
    s_waitcnt lgkmcnt(0)
    v_cvt_pk_bf16_f32 v48, v96, v97
    v_cvt_pk_bf16_f32 v49, v98, v99
    v_cvt_pk_bf16_f32 v50, v100, v101
    v_cvt_pk_bf16_f32 v51, v102, v103
    ds_read_b64_tr_b16 v[160:161], v32 offset:1024
    ds_read_b64_tr_b16 v[162:163], v32 offset:3072
    v_mfma_f32_16x16x32_bf16 v[64:67], v[128:131], v[192:195], 0
    s_lshl_b32 s52, s6, 20
    ds_read_b64_tr_b16 v[164:165], v33 offset:1024
    ds_read_b64_tr_b16 v[166:167], v33 offset:3072
    v_mfma_f32_16x16x32_bf16 v[68:71], v[128:131], v[196:199], 0
    s_lshl_b32 s3, s5, 12
    v_cvt_pk_bf16_f32 v52, v104, v105
    v_cvt_pk_bf16_f32 v53, v106, v107
    v_cvt_pk_bf16_f32 v54, v108, v109
    v_cvt_pk_bf16_f32 v55, v110, v111
    ds_read_b64_tr_b16 v[168:169], v34 offset:1024
    ds_read_b64_tr_b16 v[170:171], v34 offset:3072
    v_mfma_f32_16x16x32_bf16 v[72:75], v[132:135], v[192:195], 0
    s_add_u32 s52, s52, s3
    ds_read_b64_tr_b16 v[172:173], v35 offset:1024
    ds_read_b64_tr_b16 v[174:175], v35 offset:3072
    v_mfma_f32_16x16x32_bf16 v[76:79], v[132:135], v[196:199], 0
    s_lshl_b32 s53, s4, 15
    v_cvt_pk_bf16_f32 v56, v112, v113
    v_cvt_pk_bf16_f32 v57, v114, v115
    v_cvt_pk_bf16_f32 v58, v116, v117
    v_cvt_pk_bf16_f32 v59, v118, v119
    ds_read_b64_tr_b16 v[176:177], v36 offset:1024
    v_mfma_f32_16x16x32_bf16 v[80:83], v[136:139], v[192:195], 0
    s_add_u32 s53, s53, s3
    ds_read_b64_tr_b16 v[178:179], v36 offset:3072
    v_mfma_f32_16x16x32_bf16 v[84:87], v[136:139], v[196:199], 0
    s_lshl_b32 s7, s9, 1
    v_cvt_pk_bf16_f32 v60, v120, v121
    v_cvt_pk_bf16_f32 v61, v122, v123
    v_cvt_pk_bf16_f32 v62, v124, v125
    v_cvt_pk_bf16_f32 v63, v126, v127
    ds_read_b64_tr_b16 v[180:181], v37 offset:1024
    v_mfma_f32_16x16x32_bf16 v[88:91], v[140:143], v[192:195], 0
    s_add_u32 s7, s7, 2
    ds_read_b64_tr_b16 v[182:183], v37 offset:3072
    v_mfma_f32_16x16x32_bf16 v[92:95], v[140:143], v[196:199], 0
    s_sub_u32 s8, s4, s7
    ds_read_b64_tr_b16 v[184:185], v38 offset:1024
    v_mfma_f32_16x16x32_bf16 v[96:99], v[144:147], v[192:195], 0
    s_cmp_eq_u32 s4, 1
    s_cselect_b32 s13, s7, 99
    ds_read_b64_tr_b16 v[186:187], v38 offset:3072
    v_mfma_f32_16x16x32_bf16 v[100:103], v[144:147], v[196:199], 0
    s_sub_u32 s14, s13, 1
    ds_read_b64_tr_b16 v[188:189], v39 offset:1024
    v_mfma_f32_16x16x32_bf16 v[104:107], v[148:151], v[192:195], 0
    s_add_u32 s11, s16, 786432
    buffer_store_dwordx4 v[48:51], v20, s[36:39], s11 offen sc1
    ds_read_b64_tr_b16 v[190:191], v39 offset:3072
    v_mfma_f32_16x16x32_bf16 v[108:111], v[148:151], v[196:199], 0
    s_sub_u32 s10, s13, 2
    v_mfma_f32_16x16x32_bf16 v[112:115], v[152:155], v[192:195], 0
    s_mov_b32 s48, 0x42700000
    v_mfma_f32_16x16x32_bf16 v[116:119], v[152:155], v[196:199], 0
    s_mov_b32 s49, 0xe0ad78ec
    v_mfma_f32_16x16x32_bf16 v[120:123], v[156:159], v[192:195], 0
    s_mov_b32 s50, 0
    v_mfma_f32_16x16x32_bf16 v[124:127], v[156:159], v[196:199], 0
    s_mov_b32 s51, 1
    s_waitcnt vmcnt(33)
    s_waitcnt lgkmcnt(0)
    ds_read_b64_tr_b16 v[128:129], v32 offset:16384
    ds_read_b64_tr_b16 v[130:131], v32 offset:18432
    v_mfma_f32_16x16x32_bf16 v[64:67], v[160:163], v[200:203], v[64:67]
    s_add_u32 s61, s20, 8192
    buffer_load_dwordx4 v[192:195], v20, s[36:39], s61 offen sc1
    ds_read_b64_tr_b16 v[132:133], v33 offset:16384
    ds_read_b64_tr_b16 v[134:135], v33 offset:18432
    v_mfma_f32_16x16x32_bf16 v[68:71], v[160:163], v[204:207], v[68:71]
    s_add_u32 s61, s20, 28672
    buffer_load_dwordx4 v[196:199], v20, s[36:39], s61 offen sc1
    ds_read_b64_tr_b16 v[136:137], v34 offset:16384
    ds_read_b64_tr_b16 v[138:139], v34 offset:18432
    v_mfma_f32_16x16x32_bf16 v[72:75], v[164:167], v[200:203], v[72:75]
    s_mov_b32 s59, 1
    ds_read_b64_tr_b16 v[140:141], v35 offset:16384
    ds_read_b64_tr_b16 v[142:143], v35 offset:18432
    v_mfma_f32_16x16x32_bf16 v[76:79], v[164:167], v[204:207], v[76:79]
    s_lshl_b32 s3, s4, 15
    ds_read_b64_tr_b16 v[144:145], v36 offset:16384
    v_mfma_f32_16x16x32_bf16 v[80:83], v[168:171], v[200:203], v[80:83]
    v_add_u32 v15, s3, v20
    ds_read_b64_tr_b16 v[146:147], v36 offset:18432
    v_mfma_f32_16x16x32_bf16 v[84:87], v[168:171], v[204:207], v[84:87]
    v_mov_b32 v16, v15
    ds_read_b64_tr_b16 v[148:149], v37 offset:16384
    v_mfma_f32_16x16x32_bf16 v[88:91], v[172:175], v[200:203], v[88:91]
    v_and_b32 v1, 15, v0
    ds_read_b64_tr_b16 v[150:151], v37 offset:18432
    v_mfma_f32_16x16x32_bf16 v[92:95], v[172:175], v[204:207], v[92:95]
    v_lshrrev_b32 v2, 4, v0
    ds_read_b64_tr_b16 v[152:153], v38 offset:16384
    v_mfma_f32_16x16x32_bf16 v[96:99], v[176:179], v[200:203], v[96:99]
    v_lshlrev_b32 v2, 2, v2
    ds_read_b64_tr_b16 v[154:155], v38 offset:18432
    v_mfma_f32_16x16x32_bf16 v[100:103], v[176:179], v[204:207], v[100:103]
    v_sub_u32 v1, v1, v2
    ds_read_b64_tr_b16 v[156:157], v39 offset:16384
    v_mfma_f32_16x16x32_bf16 v[104:107], v[180:183], v[200:203], v[104:107]
    s_add_u32 s11, s16, 790528
    buffer_store_dwordx4 v[52:55], v20, s[36:39], s11 offen sc1
    ds_read_b64_tr_b16 v[158:159], v39 offset:18432
    v_mfma_f32_16x16x32_bf16 v[108:111], v[180:183], v[204:207], v[108:111]
    s_lshl_b32 s3, s5, 5
    v_add_u32 v17, s3, v1
    v_mfma_f32_16x16x32_bf16 v[112:115], v[184:187], v[200:203], v[112:115]
    v_mov_b32 v19, 0xf149f2ca
    v_mfma_f32_16x16x32_bf16 v[116:119], v[184:187], v[204:207], v[116:119]
    s_lshl_b32 s3, s5, 13
    s_add_u32 s3, s3, 131072
    v_add_u32 v27, s3, v20
    v_mfma_f32_16x16x32_bf16 v[120:123], v[188:191], v[200:203], v[120:123]
    v_mov_b32 v40, 0x3f803f80
    v_mfma_f32_16x16x32_bf16 v[124:127], v[188:191], v[204:207], v[124:127]
    v_mov_b32 v41, 0x3f803f80
    s_waitcnt vmcnt(32)
    s_waitcnt lgkmcnt(0)
    ds_read_b64_tr_b16 v[160:161], v32 offset:17408
    ds_read_b64_tr_b16 v[162:163], v32 offset:19456
    v_mfma_f32_16x16x32_bf16 v[64:67], v[128:131], v[208:211], v[64:67]
    s_add_u32 s61, s20, 9216
    buffer_load_dwordx4 v[200:203], v20, s[36:39], s61 offen sc1
    ds_read_b64_tr_b16 v[164:165], v33 offset:17408
    ds_read_b64_tr_b16 v[166:167], v33 offset:19456
    v_mfma_f32_16x16x32_bf16 v[68:71], v[128:131], v[212:215], v[68:71]
    s_add_u32 s61, s20, 29696
    buffer_load_dwordx4 v[204:207], v20, s[36:39], s61 offen sc1
    ds_read_b64_tr_b16 v[168:169], v34 offset:17408
    ds_read_b64_tr_b16 v[170:171], v34 offset:19456
    v_mfma_f32_16x16x32_bf16 v[72:75], v[132:135], v[208:211], v[72:75]
    v_mov_b32 v42, 0x3f803f80
    ds_read_b64_tr_b16 v[172:173], v35 offset:17408
    ds_read_b64_tr_b16 v[174:175], v35 offset:19456
    v_mfma_f32_16x16x32_bf16 v[76:79], v[132:135], v[212:215], v[76:79]
    v_mov_b32 v43, 0x3f803f80
    ds_read_b64_tr_b16 v[176:177], v36 offset:17408
    v_mfma_f32_16x16x32_bf16 v[80:83], v[136:139], v[208:211], v[80:83]
    v_mov_b32 v44, 0
    ds_read_b64_tr_b16 v[178:179], v36 offset:19456
    v_mfma_f32_16x16x32_bf16 v[84:87], v[136:139], v[212:215], v[84:87]
    v_mov_b32 v45, 0
    ds_read_b64_tr_b16 v[180:181], v37 offset:17408
    v_mfma_f32_16x16x32_bf16 v[88:91], v[140:143], v[208:211], v[88:91]
    v_mov_b32 v46, 0
    ds_read_b64_tr_b16 v[182:183], v37 offset:19456
    v_mfma_f32_16x16x32_bf16 v[92:95], v[140:143], v[212:215], v[92:95]
    v_mov_b32 v47, 0
    ds_read_b64_tr_b16 v[184:185], v38 offset:17408
    v_mfma_f32_16x16x32_bf16 v[96:99], v[144:147], v[208:211], v[96:99]
    v_mov_b32 v48, 0
    ds_read_b64_tr_b16 v[186:187], v38 offset:19456
    v_mfma_f32_16x16x32_bf16 v[100:103], v[144:147], v[212:215], v[100:103]
    v_mov_b32 v49, 0
    ds_read_b64_tr_b16 v[188:189], v39 offset:17408
    v_mfma_f32_16x16x32_bf16 v[104:107], v[148:151], v[208:211], v[104:107]
    s_add_u32 s11, s16, 794624
    buffer_store_dwordx4 v[56:59], v20, s[36:39], s11 offen sc1
    ds_read_b64_tr_b16 v[190:191], v39 offset:19456
    v_mfma_f32_16x16x32_bf16 v[108:111], v[148:151], v[212:215], v[108:111]
    v_mov_b32 v50, 0
    v_mfma_f32_16x16x32_bf16 v[112:115], v[152:155], v[208:211], v[112:115]
    v_mov_b32 v51, 0
    v_mfma_f32_16x16x32_bf16 v[116:119], v[152:155], v[212:215], v[116:119]
    v_mfma_f32_16x16x32_bf16 v[120:123], v[156:159], v[208:211], v[120:123]
    v_mfma_f32_16x16x32_bf16 v[124:127], v[156:159], v[212:215], v[124:127]
    s_waitcnt vmcnt(32)
    s_waitcnt lgkmcnt(0)
    ds_read_b64_tr_b16 v[128:129], v32 offset:32768
    ds_read_b64_tr_b16 v[130:131], v32 offset:34816
    v_mfma_f32_16x16x32_bf16 v[64:67], v[160:163], v[216:219], v[64:67]
    s_add_u32 s61, s20, 10240
    buffer_load_dwordx4 v[208:211], v20, s[36:39], s61 offen sc1
    ds_read_b64_tr_b16 v[132:133], v33 offset:32768
    ds_read_b64_tr_b16 v[134:135], v33 offset:34816
    v_mfma_f32_16x16x32_bf16 v[68:71], v[160:163], v[220:223], v[68:71]
    s_add_u32 s61, s20, 30720
    buffer_load_dwordx4 v[212:215], v20, s[36:39], s61 offen sc1
    ds_read_b64_tr_b16 v[136:137], v34 offset:32768
    ds_read_b64_tr_b16 v[138:139], v34 offset:34816
    v_mfma_f32_16x16x32_bf16 v[72:75], v[164:167], v[216:219], v[72:75]
    ds_read_b64_tr_b16 v[140:141], v35 offset:32768
    ds_read_b64_tr_b16 v[142:143], v35 offset:34816
    v_mfma_f32_16x16x32_bf16 v[76:79], v[164:167], v[220:223], v[76:79]
    ds_read_b64_tr_b16 v[144:145], v36 offset:32768
    v_mfma_f32_16x16x32_bf16 v[80:83], v[168:171], v[216:219], v[80:83]
    ds_read_b64_tr_b16 v[146:147], v36 offset:34816
    v_mfma_f32_16x16x32_bf16 v[84:87], v[168:171], v[220:223], v[84:87]
    ds_read_b64_tr_b16 v[148:149], v37 offset:32768
    v_mfma_f32_16x16x32_bf16 v[88:91], v[172:175], v[216:219], v[88:91]
    ds_read_b64_tr_b16 v[150:151], v37 offset:34816
    v_mfma_f32_16x16x32_bf16 v[92:95], v[172:175], v[220:223], v[92:95]
    ds_read_b64_tr_b16 v[152:153], v38 offset:32768
    v_mfma_f32_16x16x32_bf16 v[96:99], v[176:179], v[216:219], v[96:99]
    ds_read_b64_tr_b16 v[154:155], v38 offset:34816
    v_mfma_f32_16x16x32_bf16 v[100:103], v[176:179], v[220:223], v[100:103]
    ds_read_b64_tr_b16 v[156:157], v39 offset:32768
    v_mfma_f32_16x16x32_bf16 v[104:107], v[180:183], v[216:219], v[104:107]
    s_add_u32 s11, s16, 798720
    buffer_store_dwordx4 v[60:63], v20, s[36:39], s11 offen sc1
    ds_read_b64_tr_b16 v[158:159], v39 offset:34816
    v_mfma_f32_16x16x32_bf16 v[108:111], v[180:183], v[220:223], v[108:111]
    v_mfma_f32_16x16x32_bf16 v[112:115], v[184:187], v[216:219], v[112:115]
    v_mfma_f32_16x16x32_bf16 v[116:119], v[184:187], v[220:223], v[116:119]
    v_mfma_f32_16x16x32_bf16 v[120:123], v[188:191], v[216:219], v[120:123]
    v_mfma_f32_16x16x32_bf16 v[124:127], v[188:191], v[220:223], v[124:127]
    s_waitcnt vmcnt(31)
    s_waitcnt lgkmcnt(0)
    ds_read_b64_tr_b16 v[160:161], v32 offset:33792
    ds_read_b64_tr_b16 v[162:163], v32 offset:35840
    v_mfma_f32_16x16x32_bf16 v[64:67], v[128:131], v[224:227], v[64:67]
    s_add_u32 s61, s20, 11264
    buffer_load_dwordx4 v[216:219], v20, s[36:39], s61 offen sc1
    ds_read_b64_tr_b16 v[164:165], v33 offset:33792
    ds_read_b64_tr_b16 v[166:167], v33 offset:35840
    v_mfma_f32_16x16x32_bf16 v[68:71], v[128:131], v[228:231], v[68:71]
    s_add_u32 s61, s20, 31744
    buffer_load_dwordx4 v[220:223], v20, s[36:39], s61 offen sc1
    ds_read_b64_tr_b16 v[168:169], v34 offset:33792
    ds_read_b64_tr_b16 v[170:171], v34 offset:35840
    v_mfma_f32_16x16x32_bf16 v[72:75], v[132:135], v[224:227], v[72:75]
    buffer_load_dword v29, v31, s[36:39], s18 offen sc1
    ds_read_b64_tr_b16 v[172:173], v35 offset:33792
    ds_read_b64_tr_b16 v[174:175], v35 offset:35840
    v_mfma_f32_16x16x32_bf16 v[76:79], v[132:135], v[228:231], v[76:79]
    s_mov_b32 s28, s64
    ds_read_b64_tr_b16 v[176:177], v36 offset:33792
    v_mfma_f32_16x16x32_bf16 v[80:83], v[136:139], v[224:227], v[80:83]
    s_mov_b32 s29, s65
    ds_read_b64_tr_b16 v[178:179], v36 offset:35840
    v_mfma_f32_16x16x32_bf16 v[84:87], v[136:139], v[228:231], v[84:87]
    s_mov_b32 s30, 5242880
    ds_read_b64_tr_b16 v[180:181], v37 offset:33792
    v_mfma_f32_16x16x32_bf16 v[88:91], v[140:143], v[224:227], v[88:91]
    s_mov_b32 s31, 0x00020000
    ds_read_b64_tr_b16 v[182:183], v37 offset:35840
    v_mfma_f32_16x16x32_bf16 v[92:95], v[140:143], v[228:231], v[92:95]
    s_lshl_b32 s3, s23, 2
    s_add_u32 s3, s3, s5
    s_lshl_b32 s3, s3, 7
    s_and_b32 s24, s6, 14
    s_lshl_b32 s24, s24, 3
    s_add_u32 s24, s24, s3
    ds_read_b64_tr_b16 v[184:185], v38 offset:33792
    v_mfma_f32_16x16x32_bf16 v[96:99], v[144:147], v[224:227], v[96:99]
    s_and_b32 s3, s6, 1
    s_lshl_b32 s3, s3, 2
    s_add_u32 s24, s24, s3
    s_lshr_b32 s3, s6, 4
    s_lshl_b32 s3, s3, 3
    s_add_u32 s24, s24, s3
    s_add_u32 s24, s24, 83968000
    ds_read_b64_tr_b16 v[186:187], v38 offset:35840
    v_mfma_f32_16x16x32_bf16 v[100:103], v[144:147], v[228:231], v[100:103]
    s_lshr_b32 s3, s2, 5
    s_xor_b32 s25, s4, 1
    s_lshl_b32 s25, s25, 3
    s_add_u32 s3, s3, s25
    s_lshl_b32 s3, s3, 2
    s_add_u32 s3, s3, s5
    s_lshl_b32 s26, s3, 18
    s_mul_i32 s32, s3, 40960
    s_lshl_b32 s25, s3, 7
    ds_read_b64_tr_b16 v[188:189], v39 offset:33792
    v_mfma_f32_16x16x32_bf16 v[104:107], v[148:151], v[224:227], v[104:107]
    s_and_b32 s3, s2, 7
    s_lshl_b32 s61, s3, 4
    s_add_u32 s25, s25, s61
    s_add_u32 s25, s25, 83968000
    s_lshl_b32 s61, s3, 13
    s_add_u32 s26, s26, s61
    s_add_u32 s26, s26, 33554432
    s_add_u32 s27, s26, 0x20000
    ds_read_b64_tr_b16 v[190:191], v39 offset:35840
    v_mfma_f32_16x16x32_bf16 v[108:111], v[148:151], v[228:231], v[108:111]
    s_mul_i32 s61, s3, 2621440
    s_add_u32 s32, s32, s61
    s_add_u32 s32, s32, 54525952
    s_mul_i32 s35, s3, 327680
    s_bfe_u32 s3, s2, 0x20003
    s_mul_i32 s61, s3, 320
    s_add_u32 s35, s35, s61
    s_lshl_b32 s61, s61, 4
    s_add_u32 s32, s32, s61
    v_mfma_f32_16x16x32_bf16 v[112:115], v[152:155], v[224:227], v[112:115]
    s_xor_b32 s3, s4, 1
    s_mul_i32 s3, s3, 163840
    s_add_u32 s33, s35, s3
    s_add_u32 s35, s35, 2621440
    s_mul_i32 s34, s4, 40960
    s_mul_i32 s3, s5, 10240
    s_add_u32 s34, s34, s3
    s_add_u32 s34, s34, 81920
    s_mul_i32 s45, s5, 640
    v_mfma_f32_16x16x32_bf16 v[116:119], v[152:155], v[228:231], v[116:119]
    v_add_u32 v1, s45, v0
    v_mfma_f32_16x16x32_bf16 v[120:123], v[156:159], v[224:227], v[120:123]
    v_mul_u32_u24 v2, 52429, v1
    v_mfma_f32_16x16x32_bf16 v[124:127], v[156:159], v[228:231], v[124:127]
    v_lshrrev_b32 v2, 20, v2
    s_waitcnt vmcnt(31)
    s_waitcnt lgkmcnt(0)
    ds_read_b64_tr_b16 v[128:129], v32 offset:49152
    ds_read_b64_tr_b16 v[130:131], v32 offset:51200
    v_mfma_f32_16x16x32_bf16 v[64:67], v[160:163], v[232:235], v[64:67]
    s_add_u32 s61, s20, 12288
    buffer_load_dwordx4 v[224:227], v20, s[36:39], s61 offen sc1
    ds_read_b64_tr_b16 v[132:133], v33 offset:49152
    ds_read_b64_tr_b16 v[134:135], v33 offset:51200
    v_mfma_f32_16x16x32_bf16 v[68:71], v[160:163], v[236:239], v[68:71]
    s_add_u32 s61, s20, 32768
    buffer_load_dwordx4 v[228:231], v20, s[36:39], s61 offen sc1
    ds_read_b64_tr_b16 v[136:137], v34 offset:49152
    ds_read_b64_tr_b16 v[138:139], v34 offset:51200
    v_mfma_f32_16x16x32_bf16 v[72:75], v[164:167], v[232:235], v[72:75]
    v_mul_u32_u24 v4, 20, v2
    ds_read_b64_tr_b16 v[140:141], v35 offset:49152
    ds_read_b64_tr_b16 v[142:143], v35 offset:51200
    v_mfma_f32_16x16x32_bf16 v[76:79], v[164:167], v[236:239], v[76:79]
    v_sub_u32 v1, v1, v4
    ds_read_b64_tr_b16 v[144:145], v36 offset:49152
    v_mfma_f32_16x16x32_bf16 v[80:83], v[168:171], v[232:235], v[80:83]
    v_bfe_u32 v4, v2, 2, 1
    ds_read_b64_tr_b16 v[146:147], v36 offset:51200
    v_mfma_f32_16x16x32_bf16 v[84:87], v[168:171], v[236:239], v[84:87]
    v_xor_b32 v1, v1, v4
    ds_read_b64_tr_b16 v[148:149], v37 offset:49152
    v_mfma_f32_16x16x32_bf16 v[88:91], v[172:175], v[232:235], v[88:91]
    v_mul_u32_u24 v2, 1280, v2
    ds_read_b64_tr_b16 v[150:151], v37 offset:51200
    v_mfma_f32_16x16x32_bf16 v[92:95], v[172:175], v[236:239], v[92:95]
    v_lshl_add_u32 v4, v1, 4, v2
    ds_read_b64_tr_b16 v[152:153], v38 offset:49152
    v_mfma_f32_16x16x32_bf16 v[96:99], v[176:179], v[232:235], v[96:99]
    v_add_u32 v1, s45, v0
    ds_read_b64_tr_b16 v[154:155], v38 offset:51200
    v_mfma_f32_16x16x32_bf16 v[100:103], v[176:179], v[236:239], v[100:103]
    v_add_u32 v1, 64, v1
    ds_read_b64_tr_b16 v[156:157], v39 offset:49152
    v_mfma_f32_16x16x32_bf16 v[104:107], v[180:183], v[232:235], v[104:107]
    v_mul_u32_u24 v2, 52429, v1
    ds_read_b64_tr_b16 v[158:159], v39 offset:51200
    v_mfma_f32_16x16x32_bf16 v[108:111], v[180:183], v[236:239], v[108:111]
    v_lshrrev_b32 v2, 20, v2
    v_mfma_f32_16x16x32_bf16 v[112:115], v[184:187], v[232:235], v[112:115]
    v_mul_u32_u24 v5, 20, v2
    v_mfma_f32_16x16x32_bf16 v[116:119], v[184:187], v[236:239], v[116:119]
    v_sub_u32 v1, v1, v5
    v_mfma_f32_16x16x32_bf16 v[120:123], v[188:191], v[232:235], v[120:123]
    v_bfe_u32 v5, v2, 2, 1
    v_mfma_f32_16x16x32_bf16 v[124:127], v[188:191], v[236:239], v[124:127]
    v_xor_b32 v1, v1, v5
    s_waitcnt vmcnt(31)
    s_waitcnt lgkmcnt(0)
    ds_read_b64_tr_b16 v[160:161], v32 offset:50176
    ds_read_b64_tr_b16 v[162:163], v32 offset:52224
    v_mfma_f32_16x16x32_bf16 v[64:67], v[128:131], v[240:243], v[64:67]
    s_add_u32 s61, s20, 13312
    buffer_load_dwordx4 v[232:235], v20, s[36:39], s61 offen sc1
    ds_read_b64_tr_b16 v[164:165], v33 offset:50176
    ds_read_b64_tr_b16 v[166:167], v33 offset:52224
    v_mfma_f32_16x16x32_bf16 v[68:71], v[128:131], v[244:247], v[68:71]
    s_add_u32 s61, s20, 33792
    buffer_load_dwordx4 v[236:239], v20, s[36:39], s61 offen sc1
    ds_read_b64_tr_b16 v[168:169], v34 offset:50176
    ds_read_b64_tr_b16 v[170:171], v34 offset:52224
    v_mfma_f32_16x16x32_bf16 v[72:75], v[132:135], v[240:243], v[72:75]
    v_mul_u32_u24 v2, 1280, v2
    ds_read_b64_tr_b16 v[172:173], v35 offset:50176
    ds_read_b64_tr_b16 v[174:175], v35 offset:52224
    v_mfma_f32_16x16x32_bf16 v[76:79], v[132:135], v[244:247], v[76:79]
    v_lshl_add_u32 v5, v1, 4, v2
    ds_read_b64_tr_b16 v[176:177], v36 offset:50176
    v_mfma_f32_16x16x32_bf16 v[80:83], v[136:139], v[240:243], v[80:83]
    v_add_u32 v1, s45, v0
    ds_read_b64_tr_b16 v[178:179], v36 offset:52224
    v_mfma_f32_16x16x32_bf16 v[84:87], v[136:139], v[244:247], v[84:87]
    v_add_u32 v1, 128, v1
    ds_read_b64_tr_b16 v[180:181], v37 offset:50176
    v_mfma_f32_16x16x32_bf16 v[88:91], v[140:143], v[240:243], v[88:91]
    v_mul_u32_u24 v2, 52429, v1
    ds_read_b64_tr_b16 v[182:183], v37 offset:52224
    v_mfma_f32_16x16x32_bf16 v[92:95], v[140:143], v[244:247], v[92:95]
    v_lshrrev_b32 v2, 20, v2
    ds_read_b64_tr_b16 v[184:185], v38 offset:50176
    v_mfma_f32_16x16x32_bf16 v[96:99], v[144:147], v[240:243], v[96:99]
    v_mul_u32_u24 v6, 20, v2
    ds_read_b64_tr_b16 v[186:187], v38 offset:52224
    v_mfma_f32_16x16x32_bf16 v[100:103], v[144:147], v[244:247], v[100:103]
    v_sub_u32 v1, v1, v6
    ds_read_b64_tr_b16 v[188:189], v39 offset:50176
    v_mfma_f32_16x16x32_bf16 v[104:107], v[148:151], v[240:243], v[104:107]
    v_bfe_u32 v6, v2, 2, 1
    ds_read_b64_tr_b16 v[190:191], v39 offset:52224
    v_mfma_f32_16x16x32_bf16 v[108:111], v[148:151], v[244:247], v[108:111]
    v_xor_b32 v1, v1, v6
    v_mfma_f32_16x16x32_bf16 v[112:115], v[152:155], v[240:243], v[112:115]
    v_mul_u32_u24 v2, 1280, v2
    v_mfma_f32_16x16x32_bf16 v[116:119], v[152:155], v[244:247], v[116:119]
    v_lshl_add_u32 v6, v1, 4, v2
    v_mfma_f32_16x16x32_bf16 v[120:123], v[156:159], v[240:243], v[120:123]
    v_add_u32 v1, s45, v0
    v_mfma_f32_16x16x32_bf16 v[124:127], v[156:159], v[244:247], v[124:127]
    s_waitcnt vmcnt(29)
    s_waitcnt lgkmcnt(0)
    v_add_u32 v32, 0x10000, v32
    v_add_u32 v33, 0x10000, v33
    v_add_u32 v34, 0x10000, v34
    v_add_u32 v35, 0x10000, v35
    v_add_u32 v36, 0x10000, v36
    v_add_u32 v37, 0x10000, v37
    v_add_u32 v38, 0x10000, v38
    v_add_u32 v39, 0x10000, v39
    ds_read_b64_tr_b16 v[128:129], v32 offset:0
    ds_read_b64_tr_b16 v[130:131], v32 offset:2048
    v_mfma_f32_16x16x32_bf16 v[64:67], v[160:163], v[248:251], v[64:67]
    s_add_u32 s61, s20, 14336
    buffer_load_dwordx4 v[240:243], v20, s[36:39], s61 offen sc1
    ds_read_b64_tr_b16 v[132:133], v33 offset:0
    ds_read_b64_tr_b16 v[134:135], v33 offset:2048
    v_mfma_f32_16x16x32_bf16 v[68:71], v[160:163], v[252:255], v[68:71]
    s_add_u32 s61, s20, 34816
    buffer_load_dwordx4 v[244:247], v20, s[36:39], s61 offen sc1
    ds_read_b64_tr_b16 v[136:137], v34 offset:0
    ds_read_b64_tr_b16 v[138:139], v34 offset:2048
    v_mfma_f32_16x16x32_bf16 v[72:75], v[164:167], v[248:251], v[72:75]
    ds_read_b64_tr_b16 v[140:141], v35 offset:0
    ds_read_b64_tr_b16 v[142:143], v35 offset:2048
    v_mfma_f32_16x16x32_bf16 v[76:79], v[164:167], v[252:255], v[76:79]
    ds_read_b64_tr_b16 v[144:145], v36 offset:0
    v_mfma_f32_16x16x32_bf16 v[80:83], v[168:171], v[248:251], v[80:83]
    ds_read_b64_tr_b16 v[146:147], v36 offset:2048
    v_mfma_f32_16x16x32_bf16 v[84:87], v[168:171], v[252:255], v[84:87]
    ds_read_b64_tr_b16 v[148:149], v37 offset:0
    v_mfma_f32_16x16x32_bf16 v[88:91], v[172:175], v[248:251], v[88:91]
    ds_read_b64_tr_b16 v[150:151], v37 offset:2048
    v_mfma_f32_16x16x32_bf16 v[92:95], v[172:175], v[252:255], v[92:95]
    ds_read_b64_tr_b16 v[152:153], v38 offset:0
    v_mfma_f32_16x16x32_bf16 v[96:99], v[176:179], v[248:251], v[96:99]
    ds_read_b64_tr_b16 v[154:155], v38 offset:2048
    v_mfma_f32_16x16x32_bf16 v[100:103], v[176:179], v[252:255], v[100:103]
    ds_read_b64_tr_b16 v[156:157], v39 offset:0
    v_mfma_f32_16x16x32_bf16 v[104:107], v[180:183], v[248:251], v[104:107]
    ds_read_b64_tr_b16 v[158:159], v39 offset:2048
    v_mfma_f32_16x16x32_bf16 v[108:111], v[180:183], v[252:255], v[108:111]
    v_mfma_f32_16x16x32_bf16 v[112:115], v[184:187], v[248:251], v[112:115]
    v_mfma_f32_16x16x32_bf16 v[116:119], v[184:187], v[252:255], v[116:119]
    v_mfma_f32_16x16x32_bf16 v[120:123], v[188:191], v[248:251], v[120:123]
    v_mfma_f32_16x16x32_bf16 v[124:127], v[188:191], v[252:255], v[124:127]
    s_waitcnt vmcnt(16)
    s_waitcnt lgkmcnt(0)
    ds_read_b64_tr_b16 v[160:161], v32 offset:1024
    ds_read_b64_tr_b16 v[162:163], v32 offset:3072
    v_mfma_f32_16x16x32_bf16 v[64:67], v[128:131], v[192:195], v[64:67]
    s_add_u32 s61, s20, 15360
    buffer_load_dwordx4 v[248:251], v20, s[36:39], s61 offen sc1
    ds_read_b64_tr_b16 v[164:165], v33 offset:1024
    ds_read_b64_tr_b16 v[166:167], v33 offset:3072
    v_mfma_f32_16x16x32_bf16 v[68:71], v[128:131], v[196:199], v[68:71]
    s_add_u32 s61, s20, 35840
    buffer_load_dwordx4 v[252:255], v20, s[36:39], s61 offen sc1
    ds_read_b64_tr_b16 v[168:169], v34 offset:1024
    ds_read_b64_tr_b16 v[170:171], v34 offset:3072
    v_mfma_f32_16x16x32_bf16 v[72:75], v[132:135], v[192:195], v[72:75]
    ds_read_b64_tr_b16 v[172:173], v35 offset:1024
    ds_read_b64_tr_b16 v[174:175], v35 offset:3072
    v_mfma_f32_16x16x32_bf16 v[76:79], v[132:135], v[196:199], v[76:79]
    ds_read_b64_tr_b16 v[176:177], v36 offset:1024
    v_mfma_f32_16x16x32_bf16 v[80:83], v[136:139], v[192:195], v[80:83]
    ds_read_b64_tr_b16 v[178:179], v36 offset:3072
    v_mfma_f32_16x16x32_bf16 v[84:87], v[136:139], v[196:199], v[84:87]
    ds_read_b64_tr_b16 v[180:181], v37 offset:1024
    v_mfma_f32_16x16x32_bf16 v[88:91], v[140:143], v[192:195], v[88:91]
    ds_read_b64_tr_b16 v[182:183], v37 offset:3072
    v_mfma_f32_16x16x32_bf16 v[92:95], v[140:143], v[196:199], v[92:95]
    ds_read_b64_tr_b16 v[184:185], v38 offset:1024
    v_mfma_f32_16x16x32_bf16 v[96:99], v[144:147], v[192:195], v[96:99]
    ds_read_b64_tr_b16 v[186:187], v38 offset:3072
    v_mfma_f32_16x16x32_bf16 v[100:103], v[144:147], v[196:199], v[100:103]
    ds_read_b64_tr_b16 v[188:189], v39 offset:1024
    v_mfma_f32_16x16x32_bf16 v[104:107], v[148:151], v[192:195], v[104:107]
    s_waitcnt vmcnt(8)
    ds_read_b64_tr_b16 v[190:191], v39 offset:3072
    v_mfma_f32_16x16x32_bf16 v[108:111], v[148:151], v[196:199], v[108:111]
    v_cmp_le_u32 vcc, 1, v29
    s_nop 0
    s_or_b32 s3, vcc_lo, s60
    s_and_b32 s3, s3, 255
    s_cmp_eq_u32 s3, 255
    s_cbranch_scc0 k1_spin7
k1_back8:
    v_mfma_f32_16x16x32_bf16 v[112:115], v[152:155], v[192:195], v[112:115]
    v_mfma_f32_16x16x32_bf16 v[116:119], v[152:155], v[196:199], v[116:119]
    v_mfma_f32_16x16x32_bf16 v[120:123], v[156:159], v[192:195], v[120:123]
    v_mfma_f32_16x16x32_bf16 v[124:127], v[156:159], v[196:199], v[124:127]
    s_waitcnt vmcnt(15)
    s_waitcnt lgkmcnt(0)
    s_waitcnt vmcnt(11)
    s_barrier
    ds_read_b64_tr_b16 v[128:129], v32 offset:16384
    ds_read_b64_tr_b16 v[130:131], v32 offset:18432
    v_mfma_f32_16x16x32_bf16 v[64:67], v[160:163], v[200:203], v[64:67]
    s_add_u32 s61, s20, 16384
    buffer_load_dwordx4 v[192:195], v20, s[36:39], s61 offen sc1
    ds_read_b64_tr_b16 v[132:133], v33 offset:16384
    ds_read_b64_tr_b16 v[134:135], v33 offset:18432
    v_mfma_f32_16x16x32_bf16 v[68:71], v[160:163], v[204:207], v[68:71]
    s_add_u32 s61, s20, 36864
    buffer_load_dwordx4 v[196:199], v20, s[36:39], s61 offen sc1
    ds_read_b64_tr_b16 v[136:137], v34 offset:16384
    ds_read_b64_tr_b16 v[138:139], v34 offset:18432
    v_mfma_f32_16x16x32_bf16 v[72:75], v[164:167], v[200:203], v[72:75]
    buffer_store_dword v24, v22, s[36:39], s17 offen sc1
    ds_read_b64_tr_b16 v[140:141], v35 offset:16384
    ds_read_b64_tr_b16 v[142:143], v35 offset:18432
    v_mfma_f32_16x16x32_bf16 v[76:79], v[164:167], v[204:207], v[76:79]
    s_add_u32 m0, s53, 0
    s_add_u32 s15, s52, 0
    buffer_load_dwordx4 v20, s[36:39], s15 offen offset:0 sc1 lds
    ds_read_b64_tr_b16 v[144:145], v36 offset:16384
    v_mfma_f32_16x16x32_bf16 v[80:83], v[168:171], v[200:203], v[80:83]
    buffer_load_dwordx4 v20, s[36:39], s15 offen offset:1024 sc1 lds
    ds_read_b64_tr_b16 v[146:147], v36 offset:18432
    v_mfma_f32_16x16x32_bf16 v[84:87], v[168:171], v[204:207], v[84:87]
    buffer_load_dwordx4 v20, s[36:39], s15 offen offset:2048 sc1 lds
    ds_read_b64_tr_b16 v[148:149], v37 offset:16384
    v_mfma_f32_16x16x32_bf16 v[88:91], v[172:175], v[200:203], v[88:91]
    buffer_load_dwordx4 v20, s[36:39], s15 offen offset:3072 sc1 lds
    ds_read_b64_tr_b16 v[150:151], v37 offset:18432
    v_mfma_f32_16x16x32_bf16 v[92:95], v[172:175], v[204:207], v[92:95]
    s_add_u32 m0, s53, 16384
    s_add_u32 s15, s52, 16384
    buffer_load_dwordx4 v20, s[36:39], s15 offen offset:0 sc1 lds
    ds_read_b64_tr_b16 v[152:153], v38 offset:16384
    v_mfma_f32_16x16x32_bf16 v[96:99], v[176:179], v[200:203], v[96:99]
    buffer_load_dwordx4 v20, s[36:39], s15 offen offset:1024 sc1 lds
    ds_read_b64_tr_b16 v[154:155], v38 offset:18432
    v_mfma_f32_16x16x32_bf16 v[100:103], v[176:179], v[204:207], v[100:103]
    buffer_load_dwordx4 v20, s[36:39], s15 offen offset:2048 sc1 lds
    ds_read_b64_tr_b16 v[156:157], v39 offset:16384
    v_mfma_f32_16x16x32_bf16 v[104:107], v[180:183], v[200:203], v[104:107]
    buffer_load_dwordx4 v20, s[36:39], s15 offen offset:3072 sc1 lds
    ds_read_b64_tr_b16 v[158:159], v39 offset:18432
    v_mfma_f32_16x16x32_bf16 v[108:111], v[180:183], v[204:207], v[108:111]
    v_add_u32 v1, 192, v1
    v_mfma_f32_16x16x32_bf16 v[112:115], v[184:187], v[200:203], v[112:115]
    v_mul_u32_u24 v2, 52429, v1
    v_mfma_f32_16x16x32_bf16 v[116:119], v[184:187], v[204:207], v[116:119]
    v_lshrrev_b32 v2, 20, v2
    v_mfma_f32_16x16x32_bf16 v[120:123], v[188:191], v[200:203], v[120:123]
    v_mul_u32_u24 v7, 20, v2
    v_mfma_f32_16x16x32_bf16 v[124:127], v[188:191], v[204:207], v[124:127]
    v_sub_u32 v1, v1, v7
    s_waitcnt vmcnt(23)
    s_waitcnt lgkmcnt(0)
    ds_read_b64_tr_b16 v[160:161], v32 offset:17408
    ds_read_b64_tr_b16 v[162:163], v32 offset:19456
    v_mfma_f32_16x16x32_bf16 v[64:67], v[128:131], v[208:211], v[64:67]
    s_add_u32 s61, s20, 17408
    buffer_load_dwordx4 v[200:203], v20, s[36:39], s61 offen sc1
    ds_read_b64_tr_b16 v[164:165], v33 offset:17408
    ds_read_b64_tr_b16 v[166:167], v33 offset:19456
    v_mfma_f32_16x16x32_bf16 v[68:71], v[128:131], v[212:215], v[68:71]
    s_add_u32 s61, s20, 37888
    buffer_load_dwordx4 v[204:207], v20, s[36:39], s61 offen sc1
    ds_read_b64_tr_b16 v[168:169], v34 offset:17408
    ds_read_b64_tr_b16 v[170:171], v34 offset:19456
    v_mfma_f32_16x16x32_bf16 v[72:75], v[132:135], v[208:211], v[72:75]
    v_bfe_u32 v7, v2, 2, 1
    ds_read_b64_tr_b16 v[172:173], v35 offset:17408
    ds_read_b64_tr_b16 v[174:175], v35 offset:19456
    v_mfma_f32_16x16x32_bf16 v[76:79], v[132:135], v[212:215], v[76:79]
    v_xor_b32 v1, v1, v7
    ds_read_b64_tr_b16 v[176:177], v36 offset:17408
    v_mfma_f32_16x16x32_bf16 v[80:83], v[136:139], v[208:211], v[80:83]
    v_mul_u32_u24 v2, 1280, v2
    ds_read_b64_tr_b16 v[178:179], v36 offset:19456
    v_mfma_f32_16x16x32_bf16 v[84:87], v[136:139], v[212:215], v[84:87]
    v_lshl_add_u32 v7, v1, 4, v2
    ds_read_b64_tr_b16 v[180:181], v37 offset:17408
    v_mfma_f32_16x16x32_bf16 v[88:91], v[140:143], v[208:211], v[88:91]
    v_add_u32 v1, s45, v0
    ds_read_b64_tr_b16 v[182:183], v37 offset:19456
    v_mfma_f32_16x16x32_bf16 v[92:95], v[140:143], v[212:215], v[92:95]
    v_add_u32 v1, 256, v1
    ds_read_b64_tr_b16 v[184:185], v38 offset:17408
    v_mfma_f32_16x16x32_bf16 v[96:99], v[144:147], v[208:211], v[96:99]
    v_mul_u32_u24 v2, 52429, v1
    ds_read_b64_tr_b16 v[186:187], v38 offset:19456
    v_mfma_f32_16x16x32_bf16 v[100:103], v[144:147], v[212:215], v[100:103]
    v_lshrrev_b32 v2, 20, v2
    ds_read_b64_tr_b16 v[188:189], v39 offset:17408
    v_mfma_f32_16x16x32_bf16 v[104:107], v[148:151], v[208:211], v[104:107]
    v_mul_u32_u24 v8, 20, v2
    ds_read_b64_tr_b16 v[190:191], v39 offset:19456
    v_mfma_f32_16x16x32_bf16 v[108:111], v[148:151], v[212:215], v[108:111]
    v_sub_u32 v1, v1, v8
    v_mfma_f32_16x16x32_bf16 v[112:115], v[152:155], v[208:211], v[112:115]
    v_bfe_u32 v8, v2, 2, 1
    v_mfma_f32_16x16x32_bf16 v[116:119], v[152:155], v[212:215], v[116:119]
    v_xor_b32 v1, v1, v8
    v_mfma_f32_16x16x32_bf16 v[120:123], v[156:159], v[208:211], v[120:123]
    v_mul_u32_u24 v2, 1280, v2
    v_mfma_f32_16x16x32_bf16 v[124:127], v[156:159], v[212:215], v[124:127]
    v_lshl_add_u32 v8, v1, 4, v2
    s_waitcnt vmcnt(22)
    s_waitcnt lgkmcnt(0)
    ds_read_b64_tr_b16 v[128:129], v32 offset:32768
    ds_read_b64_tr_b16 v[130:131], v32 offset:34816
    v_mfma_f32_16x16x32_bf16 v[64:67], v[160:163], v[216:219], v[64:67]
    s_add_u32 s61, s20, 18432
    buffer_load_dwordx4 v[208:211], v20, s[36:39], s61 offen sc1
    ds_read_b64_tr_b16 v[132:133], v33 offset:32768
    ds_read_b64_tr_b16 v[134:135], v33 offset:34816
    v_mfma_f32_16x16x32_bf16 v[68:71], v[160:163], v[220:223], v[68:71]
    s_add_u32 s61, s20, 38912
    buffer_load_dwordx4 v[212:215], v20, s[36:39], s61 offen sc1
    ds_read_b64_tr_b16 v[136:137], v34 offset:32768
    ds_read_b64_tr_b16 v[138:139], v34 offset:34816
    v_mfma_f32_16x16x32_bf16 v[72:75], v[164:167], v[216:219], v[72:75]
    s_lshl_b32 s3, s5, 14
    s_add_u32 s44, s3, 0x4000
    s_cmp_eq_u32 s5, 0
    s_cselect_b32 s44, 0, s44
    s_lshl_b32 s45, s5, 12
    s_add_u32 s45, s45, 0x4000
    ds_read_b64_tr_b16 v[140:141], v35 offset:32768
    ds_read_b64_tr_b16 v[142:143], v35 offset:34816
    v_mfma_f32_16x16x32_bf16 v[76:79], v[164:167], v[220:223], v[76:79]
    v_add_u32 v13, s44, v20
    ds_read_b64_tr_b16 v[144:145], v36 offset:32768
    v_mfma_f32_16x16x32_bf16 v[80:83], v[168:171], v[216:219], v[80:83]
    v_add_u32 v14, s45, v20
    ds_read_b64_tr_b16 v[146:147], v36 offset:34816
    v_mfma_f32_16x16x32_bf16 v[84:87], v[168:171], v[220:223], v[84:87]
    v_lshrrev_b32 v1, 2, v0
    ds_read_b64_tr_b16 v[148:149], v37 offset:32768
    v_mfma_f32_16x16x32_bf16 v[88:91], v[172:175], v[216:219], v[88:91]
    v_mul_u32_u24 v1, 320, v1
    ds_read_b64_tr_b16 v[150:151], v37 offset:34816
    v_mfma_f32_16x16x32_bf16 v[92:95], v[172:175], v[220:223], v[92:95]
    v_and_b32 v2, 3, v0
    ds_read_b64_tr_b16 v[152:153], v38 offset:32768
    v_mfma_f32_16x16x32_bf16 v[96:99], v[176:179], v[216:219], v[96:99]
    v_bfe_u32 v3, v0, 4, 1
    ds_read_b64_tr_b16 v[154:155], v38 offset:34816
    v_mfma_f32_16x16x32_bf16 v[100:103], v[176:179], v[220:223], v[100:103]
    v_xor_b32 v3, v3, v2
    ds_read_b64_tr_b16 v[156:157], v39 offset:32768
    v_mfma_f32_16x16x32_bf16 v[104:107], v[180:183], v[216:219], v[104:107]
    v_lshl_add_u32 v1, v3, 4, v1
    ds_read_b64_tr_b16 v[158:159], v39 offset:34816
    v_mfma_f32_16x16x32_bf16 v[108:111], v[180:183], v[220:223], v[108:111]
    v_and_b32 v2, 1, v0
    v_mfma_f32_16x16x32_bf16 v[112:115], v[184:187], v[216:219], v[112:115]
    v_lshl_add_u32 v9, v2, 3, v1
    v_mfma_f32_16x16x32_bf16 v[116:119], v[184:187], v[220:223], v[116:119]
    v_add_u32 v9, 122880, v9
    v_mfma_f32_16x16x32_bf16 v[120:123], v[188:191], v[216:219], v[120:123]
    v_xor_b32 v10, 8, v9
    v_mfma_f32_16x16x32_bf16 v[124:127], v[188:191], v[220:223], v[124:127]
    s_lshr_b32 s3, s2, 3
    s_lshl_b32 s3, s3, 3
    s_add_u32 s3, s3, s22
    s_and_b32 s61, s3, 127
    s_mul_i32 s46, s61, 2560
    s_lshr_b32 s3, s3, 7
    s_mul_i32 s3, s3, 2621440
    s_add_u32 s46, s46, s3
    s_and_b32 s3, s2, 7
    s_mul_i32 s3, s3, 327680
    s_add_u32 s46, s46, s3
    s_waitcnt vmcnt(21)
    s_waitcnt lgkmcnt(0)
    ds_read_b64_tr_b16 v[160:161], v32 offset:33792
    ds_read_b64_tr_b16 v[162:163], v32 offset:35840
    v_mfma_f32_16x16x32_bf16 v[64:67], v[128:131], v[224:227], v[64:67]
    s_add_u32 s61, s20, 19456
    buffer_load_dwordx4 v[216:219], v20, s[36:39], s61 offen sc1
    ds_read_b64_tr_b16 v[164:165], v33 offset:33792
    ds_read_b64_tr_b16 v[166:167], v33 offset:35840
    v_mfma_f32_16x16x32_bf16 v[68:71], v[128:131], v[228:231], v[68:71]
    s_add_u32 s61, s20, 39936
    buffer_load_dwordx4 v[220:223], v20, s[36:39], s61 offen sc1
    ds_read_b64_tr_b16 v[168:169], v34 offset:33792
    ds_read_b64_tr_b16 v[170:171], v34 offset:35840
    v_mfma_f32_16x16x32_bf16 v[72:75], v[132:135], v[224:227], v[72:75]
    s_xor_b32 s47, s4, 1
    ds_read_b64_tr_b16 v[172:173], v35 offset:33792
    ds_read_b64_tr_b16 v[174:175], v35 offset:35840
    v_mfma_f32_16x16x32_bf16 v[76:79], v[132:135], v[228:231], v[76:79]
    v_lshlrev_b32 v26, 6, v0
    ds_read_b64_tr_b16 v[176:177], v36 offset:33792
    v_mfma_f32_16x16x32_bf16 v[80:83], v[136:139], v[224:227], v[80:83]
    s_sub_u32 s3, 15, s9
    s_lshl_b32 s3, s3, 2
    s_add_u32 s3, s3, s5
    s_lshl_b32 s12, s3, 1
    s_add_u32 s12, s12, s4
    s_lshl_b32 s12, s12, 17
    s_lshl_b32 s3, s6, 12
    s_add_u32 s12, s12, s3
    s_add_u32 s12, s12, 33554432
    ds_read_b64_tr_b16 v[178:179], v36 offset:35840
    v_mfma_f32_16x16x32_bf16 v[84:87], v[136:139], v[228:231], v[84:87]
    v_mov_b32 v1, 1073741824
    ds_read_b64_tr_b16 v[180:181], v37 offset:33792
    v_mfma_f32_16x16x32_bf16 v[88:91], v[140:143], v[224:227], v[88:91]
    v_lshlrev_b32 v2, 6, v0
    ds_read_b64_tr_b16 v[182:183], v37 offset:35840
    v_mfma_f32_16x16x32_bf16 v[92:95], v[140:143], v[228:231], v[92:95]
    v_cmp_gt_u32 vcc, 40, v0
    s_nop 1
    v_cndmask_b32 v54, v1, v2, vcc
    ds_read_b64_tr_b16 v[184:185], v38 offset:33792
    v_mfma_f32_16x16x32_bf16 v[96:99], v[144:147], v[224:227], v[96:99]
    v_cmp_eq_u32 vcc, 0, v0
    s_nop 1
    v_cndmask_b32 v11, v1, v0, vcc
    ds_read_b64_tr_b16 v[186:187], v38 offset:35840
    v_mfma_f32_16x16x32_bf16 v[100:103], v[144:147], v[228:231], v[100:103]
    v_cmp_gt_u32 vcc, 4, v0
    s_nop 1
    v_cndmask_b32 v12, v1, v21, vcc
    ds_read_b64_tr_b16 v[188:189], v39 offset:33792
    v_mfma_f32_16x16x32_bf16 v[104:107], v[148:151], v[224:227], v[104:107]
    ds_read_b64_tr_b16 v[190:191], v39 offset:35840
    v_mfma_f32_16x16x32_bf16 v[108:111], v[148:151], v[228:231], v[108:111]
    v_mfma_f32_16x16x32_bf16 v[112:115], v[152:155], v[224:227], v[112:115]
    v_mfma_f32_16x16x32_bf16 v[116:119], v[152:155], v[228:231], v[116:119]
    v_mfma_f32_16x16x32_bf16 v[120:123], v[156:159], v[224:227], v[120:123]
    v_mfma_f32_16x16x32_bf16 v[124:127], v[156:159], v[228:231], v[124:127]
    s_waitcnt vmcnt(21)
    s_waitcnt lgkmcnt(0)
    s_barrier
    ds_read_b64_tr_b16 v[128:129], v32 offset:49152
    ds_read_b64_tr_b16 v[130:131], v32 offset:51200
    v_mfma_f32_16x16x32_bf16 v[64:67], v[160:163], v[232:235], v[64:67]
    v_mov_b32 v224, 0
    ds_read_b64_tr_b16 v[132:133], v33 offset:49152
    ds_read_b64_tr_b16 v[134:135], v33 offset:51200
    v_mfma_f32_16x16x32_bf16 v[68:71], v[160:163], v[236:239], v[68:71]
    v_mov_b32 v225, 0
    ds_read_b64_tr_b16 v[136:137], v34 offset:49152
    ds_read_b64_tr_b16 v[138:139], v34 offset:51200
    v_mfma_f32_16x16x32_bf16 v[72:75], v[164:167], v[232:235], v[72:75]
    v_mov_b32 v226, 0
    ds_read_b64_tr_b16 v[140:141], v35 offset:49152
    ds_read_b64_tr_b16 v[142:143], v35 offset:51200
    v_mfma_f32_16x16x32_bf16 v[76:79], v[164:167], v[236:239], v[76:79]
    v_mov_b32 v227, 0
    ds_read_b64_tr_b16 v[144:145], v36 offset:49152
    v_mfma_f32_16x16x32_bf16 v[80:83], v[168:171], v[232:235], v[80:83]
    v_mov_b32 v228, 0
    ds_read_b64_tr_b16 v[146:147], v36 offset:51200
    v_mfma_f32_16x16x32_bf16 v[84:87], v[168:171], v[236:239], v[84:87]
    v_mov_b32 v229, 0
    ds_read_b64_tr_b16 v[148:149], v37 offset:49152
    v_mfma_f32_16x16x32_bf16 v[88:91], v[172:175], v[232:235], v[88:91]
    v_mov_b32 v230, 0
    ds_read_b64_tr_b16 v[150:151], v37 offset:51200
    v_mfma_f32_16x16x32_bf16 v[92:95], v[172:175], v[236:239], v[92:95]
    v_mov_b32 v231, 0
    ds_read_b64_tr_b16 v[152:153], v38 offset:49152
    v_mfma_f32_16x16x32_bf16 v[96:99], v[176:179], v[232:235], v[96:99]
    s_add_u32 m0, s53, 65536
    s_add_u32 s15, s52, 32768
    buffer_load_dwordx4 v20, s[36:39], s15 offen offset:0 sc1 lds
    ds_read_b64_tr_b16 v[154:155], v38 offset:51200
    v_mfma_f32_16x16x32_bf16 v[100:103], v[176:179], v[236:239], v[100:103]
    buffer_load_dwordx4 v20, s[36:39], s15 offen offset:1024 sc1 lds
    ds_read_b64_tr_b16 v[156:157], v39 offset:49152
    v_mfma_f32_16x16x32_bf16 v[104:107], v[180:183], v[232:235], v[104:107]
    buffer_load_dwordx4 v20, s[36:39], s15 offen offset:2048 sc1 lds
    ds_read_b64_tr_b16 v[158:159], v39 offset:51200
    v_mfma_f32_16x16x32_bf16 v[108:111], v[180:183], v[236:239], v[108:111]
    buffer_load_dwordx4 v20, s[36:39], s15 offen offset:3072 sc1 lds
    v_mfma_f32_16x16x32_bf16 v[112:115], v[184:187], v[232:235], v[112:115]
    v_mfma_f32_16x16x32_bf16 v[116:119], v[184:187], v[236:239], v[116:119]
    v_mfma_f32_16x16x32_bf16 v[120:123], v[188:191], v[232:235], v[120:123]
    v_mfma_f32_16x16x32_bf16 v[124:127], v[188:191], v[236:239], v[124:127]
    s_waitcnt vmcnt(23)
    s_waitcnt lgkmcnt(0)
    ds_read_b64_tr_b16 v[160:161], v32 offset:50176
    ds_read_b64_tr_b16 v[162:163], v32 offset:52224
    v_mfma_f32_16x16x32_bf16 v[64:67], v[128:131], v[240:243], v[64:67]
    v_mov_b32 v232, 0
    ds_read_b64_tr_b16 v[164:165], v33 offset:50176
    ds_read_b64_tr_b16 v[166:167], v33 offset:52224
    v_mfma_f32_16x16x32_bf16 v[68:71], v[128:131], v[244:247], v[68:71]
    v_mov_b32 v233, 0
    ds_read_b64_tr_b16 v[168:169], v34 offset:50176
    ds_read_b64_tr_b16 v[170:171], v34 offset:52224
    v_mfma_f32_16x16x32_bf16 v[72:75], v[132:135], v[240:243], v[72:75]
    v_mov_b32 v234, 0
    ds_read_b64_tr_b16 v[172:173], v35 offset:50176
    ds_read_b64_tr_b16 v[174:175], v35 offset:52224
    v_mfma_f32_16x16x32_bf16 v[76:79], v[132:135], v[244:247], v[76:79]
    v_mov_b32 v235, 0
    ds_read_b64_tr_b16 v[176:177], v36 offset:50176
    v_mfma_f32_16x16x32_bf16 v[80:83], v[136:139], v[240:243], v[80:83]
    v_mov_b32 v236, 0
    ds_read_b64_tr_b16 v[178:179], v36 offset:52224
    v_mfma_f32_16x16x32_bf16 v[84:87], v[136:139], v[244:247], v[84:87]
    v_mov_b32 v237, 0
    ds_read_b64_tr_b16 v[180:181], v37 offset:50176
    v_mfma_f32_16x16x32_bf16 v[88:91], v[140:143], v[240:243], v[88:91]
    v_mov_b32 v238, 0
    ds_read_b64_tr_b16 v[182:183], v37 offset:52224
    v_mfma_f32_16x16x32_bf16 v[92:95], v[140:143], v[244:247], v[92:95]
    v_mov_b32 v239, 0
    ds_read_b64_tr_b16 v[184:185], v38 offset:50176
    v_mfma_f32_16x16x32_bf16 v[96:99], v[144:147], v[240:243], v[96:99]
    ds_read_b64_tr_b16 v[186:187], v38 offset:52224
    v_mfma_f32_16x16x32_bf16 v[100:103], v[144:147], v[244:247], v[100:103]
    ds_read_b64_tr_b16 v[188:189], v39 offset:50176
    v_mfma_f32_16x16x32_bf16 v[104:107], v[148:151], v[240:243], v[104:107]
    ds_read_b64_tr_b16 v[190:191], v39 offset:52224
    v_mfma_f32_16x16x32_bf16 v[108:111], v[148:151], v[244:247], v[108:111]
    v_mfma_f32_16x16x32_bf16 v[112:115], v[152:155], v[240:243], v[112:115]
    v_mfma_f32_16x16x32_bf16 v[116:119], v[152:155], v[244:247], v[116:119]
    v_mfma_f32_16x16x32_bf16 v[120:123], v[156:159], v[240:243], v[120:123]
    v_mfma_f32_16x16x32_bf16 v[124:127], v[156:159], v[244:247], v[124:127]
    s_waitcnt vmcnt(21)
    s_waitcnt lgkmcnt(0)
    v_add_u32 v32, 0x10000, v32
    v_add_u32 v33, 0x10000, v33
    v_add_u32 v34, 0x10000, v34
    v_add_u32 v35, 0x10000, v35
    v_add_u32 v36, 0x10000, v36
    v_add_u32 v37, 0x10000, v37
    v_add_u32 v38, 0x10000, v38
    v_add_u32 v39, 0x10000, v39
    ds_read_b64_tr_b16 v[128:129], v32 offset:0
    ds_read_b64_tr_b16 v[130:131], v32 offset:2048
    v_mfma_f32_16x16x32_bf16 v[64:67], v[160:163], v[248:251], v[64:67]
    v_mov_b32 v240, 0
    ds_read_b64_tr_b16 v[132:133], v33 offset:0
    ds_read_b64_tr_b16 v[134:135], v33 offset:2048
    v_mfma_f32_16x16x32_bf16 v[68:71], v[160:163], v[252:255], v[68:71]
    v_mov_b32 v241, 0
    ds_read_b64_tr_b16 v[136:137], v34 offset:0
    ds_read_b64_tr_b16 v[138:139], v34 offset:2048
    v_mfma_f32_16x16x32_bf16 v[72:75], v[164:167], v[248:251], v[72:75]
    v_mov_b32 v242, 0
    ds_read_b64_tr_b16 v[140:141], v35 offset:0
    ds_read_b64_tr_b16 v[142:143], v35 offset:2048
    v_mfma_f32_16x16x32_bf16 v[76:79], v[164:167], v[252:255], v[76:79]
    v_mov_b32 v243, 0
    ds_read_b64_tr_b16 v[144:145], v36 offset:0
    v_mfma_f32_16x16x32_bf16 v[80:83], v[168:171], v[248:251], v[80:83]
    v_mov_b32 v244, 0
    ds_read_b64_tr_b16 v[146:147], v36 offset:2048
    v_mfma_f32_16x16x32_bf16 v[84:87], v[168:171], v[252:255], v[84:87]
    v_mov_b32 v245, 0
    ds_read_b64_tr_b16 v[148:149], v37 offset:0
    v_mfma_f32_16x16x32_bf16 v[88:91], v[172:175], v[248:251], v[88:91]
    v_mov_b32 v246, 0
    ds_read_b64_tr_b16 v[150:151], v37 offset:2048
    v_mfma_f32_16x16x32_bf16 v[92:95], v[172:175], v[252:255], v[92:95]
    v_mov_b32 v247, 0
    ds_read_b64_tr_b16 v[152:153], v38 offset:0
    v_mfma_f32_16x16x32_bf16 v[96:99], v[176:179], v[248:251], v[96:99]
    ds_read_b64_tr_b16 v[154:155], v38 offset:2048
    v_mfma_f32_16x16x32_bf16 v[100:103], v[176:179], v[252:255], v[100:103]
    ds_read_b64_tr_b16 v[156:157], v39 offset:0
    v_mfma_f32_16x16x32_bf16 v[104:107], v[180:183], v[248:251], v[104:107]
    ds_read_b64_tr_b16 v[158:159], v39 offset:2048
    v_mfma_f32_16x16x32_bf16 v[108:111], v[180:183], v[252:255], v[108:111]
    v_mfma_f32_16x16x32_bf16 v[112:115], v[184:187], v[248:251], v[112:115]
    v_mfma_f32_16x16x32_bf16 v[116:119], v[184:187], v[252:255], v[116:119]
    v_mfma_f32_16x16x32_bf16 v[120:123], v[188:191], v[248:251], v[120:123]
    v_mfma_f32_16x16x32_bf16 v[124:127], v[188:191], v[252:255], v[124:127]
    s_waitcnt vmcnt(19)
    s_waitcnt lgkmcnt(0)
    ds_read_b64_tr_b16 v[160:161], v32 offset:1024
    ds_read_b64_tr_b16 v[162:163], v32 offset:3072
    v_mfma_f32_16x16x32_bf16 v[64:67], v[128:131], v[192:195], v[64:67]
    v_mov_b32 v248, 0
    ds_read_b64_tr_b16 v[164:165], v33 offset:1024
    ds_read_b64_tr_b16 v[166:167], v33 offset:3072
    v_mfma_f32_16x16x32_bf16 v[68:71], v[128:131], v[196:199], v[68:71]
    v_mov_b32 v249, 0
    ds_read_b64_tr_b16 v[168:169], v34 offset:1024
    ds_read_b64_tr_b16 v[170:171], v34 offset:3072
    v_mfma_f32_16x16x32_bf16 v[72:75], v[132:135], v[192:195], v[72:75]
    v_mov_b32 v250, 0
    ds_read_b64_tr_b16 v[172:173], v35 offset:1024
    ds_read_b64_tr_b16 v[174:175], v35 offset:3072
    v_mfma_f32_16x16x32_bf16 v[76:79], v[132:135], v[196:199], v[76:79]
    v_mov_b32 v251, 0
    ds_read_b64_tr_b16 v[176:177], v36 offset:1024
    v_mfma_f32_16x16x32_bf16 v[80:83], v[136:139], v[192:195], v[80:83]
    v_mov_b32 v252, 0
    ds_read_b64_tr_b16 v[178:179], v36 offset:3072
    v_mfma_f32_16x16x32_bf16 v[84:87], v[136:139], v[196:199], v[84:87]
    v_mov_b32 v253, 0
    ds_read_b64_tr_b16 v[180:181], v37 offset:1024
    v_mfma_f32_16x16x32_bf16 v[88:91], v[140:143], v[192:195], v[88:91]
    v_mov_b32 v254, 0
    ds_read_b64_tr_b16 v[182:183], v37 offset:3072
    v_mfma_f32_16x16x32_bf16 v[92:95], v[140:143], v[196:199], v[92:95]
    v_mov_b32 v255, 0
    ds_read_b64_tr_b16 v[184:185], v38 offset:1024
    v_mfma_f32_16x16x32_bf16 v[96:99], v[144:147], v[192:195], v[96:99]
    ds_read_b64_tr_b16 v[186:187], v38 offset:3072
    v_mfma_f32_16x16x32_bf16 v[100:103], v[144:147], v[196:199], v[100:103]
    ds_read_b64_tr_b16 v[188:189], v39 offset:1024
    v_mfma_f32_16x16x32_bf16 v[104:107], v[148:151], v[192:195], v[104:107]
    ds_read_b64_tr_b16 v[190:191], v39 offset:3072
    v_mfma_f32_16x16x32_bf16 v[108:111], v[148:151], v[196:199], v[108:111]
    v_mfma_f32_16x16x32_bf16 v[112:115], v[152:155], v[192:195], v[112:115]
    v_mfma_f32_16x16x32_bf16 v[116:119], v[152:155], v[196:199], v[116:119]
    v_mfma_f32_16x16x32_bf16 v[120:123], v[156:159], v[192:195], v[120:123]
    v_mfma_f32_16x16x32_bf16 v[124:127], v[156:159], v[196:199], v[124:127]
    s_waitcnt vmcnt(8)
    s_waitcnt lgkmcnt(0)
    ds_read_b64_tr_b16 v[128:129], v32 offset:16384
    ds_read_b64_tr_b16 v[130:131], v32 offset:18432
    v_mfma_f32_16x16x32_bf16 v[64:67], v[160:163], v[200:203], v[64:67]
    v_mov_b32 v192, 0
    ds_read_b64_tr_b16 v[132:133], v33 offset:16384
    ds_read_b64_tr_b16 v[134:135], v33 offset:18432
    v_mfma_f32_16x16x32_bf16 v[68:71], v[160:163], v[204:207], v[68:71]
    v_mov_b32 v193, 0
    ds_read_b64_tr_b16 v[136:137], v34 offset:16384
    ds_read_b64_tr_b16 v[138:139], v34 offset:18432
    v_mfma_f32_16x16x32_bf16 v[72:75], v[164:167], v[200:203], v[72:75]
    v_mov_b32 v194, 0
    ds_read_b64_tr_b16 v[140:141], v35 offset:16384
    ds_read_b64_tr_b16 v[142:143], v35 offset:18432
    v_mfma_f32_16x16x32_bf16 v[76:79], v[164:167], v[204:207], v[76:79]
    v_mov_b32 v195, 0
    ds_read_b64_tr_b16 v[144:145], v36 offset:16384
    v_mfma_f32_16x16x32_bf16 v[80:83], v[168:171], v[200:203], v[80:83]
    v_mov_b32 v196, 0
    ds_read_b64_tr_b16 v[146:147], v36 offset:18432
    v_mfma_f32_16x16x32_bf16 v[84:87], v[168:171], v[204:207], v[84:87]
    v_mov_b32 v197, 0
    ds_read_b64_tr_b16 v[148:149], v37 offset:16384
    v_mfma_f32_16x16x32_bf16 v[88:91], v[172:175], v[200:203], v[88:91]
    v_mov_b32 v198, 0
    ds_read_b64_tr_b16 v[150:151], v37 offset:18432
    v_mfma_f32_16x16x32_bf16 v[92:95], v[172:175], v[204:207], v[92:95]
    v_mov_b32 v199, 0
    ds_read_b64_tr_b16 v[152:153], v38 offset:16384
    v_mfma_f32_16x16x32_bf16 v[96:99], v[176:179], v[200:203], v[96:99]
    buffer_load_dword v29, v31, s[36:39], s18 offen sc1
    ds_read_b64_tr_b16 v[154:155], v38 offset:18432
    v_mfma_f32_16x16x32_bf16 v[100:103], v[176:179], v[204:207], v[100:103]
    s_mov_b32 s11, 0x3e0293ee
    ds_read_b64_tr_b16 v[156:157], v39 offset:16384
    v_mfma_f32_16x16x32_bf16 v[104:107], v[180:183], v[200:203], v[104:107]
    ds_read_b64_tr_b16 v[158:159], v39 offset:18432
    v_mfma_f32_16x16x32_bf16 v[108:111], v[180:183], v[204:207], v[108:111]
    v_mfma_f32_16x16x32_bf16 v[112:115], v[184:187], v[200:203], v[112:115]
    v_mfma_f32_16x16x32_bf16 v[116:119], v[184:187], v[204:207], v[116:119]
    v_mfma_f32_16x16x32_bf16 v[120:123], v[188:191], v[200:203], v[120:123]
    v_mfma_f32_16x16x32_bf16 v[124:127], v[188:191], v[204:207], v[124:127]
    s_waitcnt vmcnt(7)
    s_waitcnt lgkmcnt(0)
    ds_read_b64_tr_b16 v[160:161], v32 offset:17408
    ds_read_b64_tr_b16 v[162:163], v32 offset:19456
    v_mfma_f32_16x16x32_bf16 v[64:67], v[128:131], v[208:211], v[64:67]
    v_mov_b32 v200, 0
    ds_read_b64_tr_b16 v[164:165], v33 offset:17408
    ds_read_b64_tr_b16 v[166:167], v33 offset:19456
    v_mfma_f32_16x16x32_bf16 v[68:71], v[128:131], v[212:215], v[68:71]
    v_mov_b32 v201, 0
    ds_read_b64_tr_b16 v[168:169], v34 offset:17408
    ds_read_b64_tr_b16 v[170:171], v34 offset:19456
    v_mfma_f32_16x16x32_bf16 v[72:75], v[132:135], v[208:211], v[72:75]
    v_mov_b32 v202, 0
    ds_read_b64_tr_b16 v[172:173], v35 offset:17408
    ds_read_b64_tr_b16 v[174:175], v35 offset:19456
    v_mfma_f32_16x16x32_bf16 v[76:79], v[132:135], v[212:215], v[76:79]
    v_mov_b32 v203, 0
    ds_read_b64_tr_b16 v[176:177], v36 offset:17408
    v_mfma_f32_16x16x32_bf16 v[80:83], v[136:139], v[208:211], v[80:83]
    v_mov_b32 v204, 0
    ds_read_b64_tr_b16 v[178:179], v36 offset:19456
    v_mfma_f32_16x16x32_bf16 v[84:87], v[136:139], v[212:215], v[84:87]
    v_mov_b32 v205, 0
    ds_read_b64_tr_b16 v[180:181], v37 offset:17408
    v_mfma_f32_16x16x32_bf16 v[88:91], v[140:143], v[208:211], v[88:91]
    v_mov_b32 v206, 0
    ds_read_b64_tr_b16 v[182:183], v37 offset:19456
    v_mfma_f32_16x16x32_bf16 v[92:95], v[140:143], v[212:215], v[92:95]
    v_mov_b32 v207, 0
    ds_read_b64_tr_b16 v[184:185], v38 offset:17408
    v_mfma_f32_16x16x32_bf16 v[96:99], v[144:147], v[208:211], v[96:99]
    ds_read_b64_tr_b16 v[186:187], v38 offset:19456
    v_mfma_f32_16x16x32_bf16 v[100:103], v[144:147], v[212:215], v[100:103]
    ds_read_b64_tr_b16 v[188:189], v39 offset:17408
    v_mfma_f32_16x16x32_bf16 v[104:107], v[148:151], v[208:211], v[104:107]
    ds_read_b64_tr_b16 v[190:191], v39 offset:19456
    v_mfma_f32_16x16x32_bf16 v[108:111], v[148:151], v[212:215], v[108:111]
    v_mfma_f32_16x16x32_bf16 v[112:115], v[152:155], v[208:211], v[112:115]
    v_mfma_f32_16x16x32_bf16 v[116:119], v[152:155], v[212:215], v[116:119]
    v_mfma_f32_16x16x32_bf16 v[120:123], v[156:159], v[208:211], v[120:123]
    v_mfma_f32_16x16x32_bf16 v[124:127], v[156:159], v[212:215], v[124:127]
    s_waitcnt vmcnt(5)
    s_waitcnt lgkmcnt(0)
    v_mfma_f32_16x16x32_bf16 v[64:67], v[160:163], v[216:219], v[64:67]
    v_mov_b32 v208, 0
    v_mfma_f32_16x16x32_bf16 v[68:71], v[160:163], v[220:223], v[68:71]
    v_mov_b32 v209, 0
    v_mfma_f32_16x16x32_bf16 v[72:75], v[164:167], v[216:219], v[72:75]
    v_mov_b32 v210, 0
    v_mfma_f32_16x16x32_bf16 v[76:79], v[164:167], v[220:223], v[76:79]
    v_mov_b32 v211, 0
    v_mfma_f32_16x16x32_bf16 v[80:83], v[168:171], v[216:219], v[80:83]
    v_mov_b32 v212, 0
    v_mfma_f32_16x16x32_bf16 v[84:87], v[168:171], v[220:223], v[84:87]
    v_mov_b32 v213, 0
    v_mfma_f32_16x16x32_bf16 v[88:91], v[172:175], v[216:219], v[88:91]
    v_mov_b32 v214, 0
    v_mul_f32 v64, s11, v64
    v_mul_f32 v65, s11, v65
    v_mul_f32 v66, s11, v66
    v_mul_f32 v67, s11, v67
    v_mul_f32 v72, s11, v72
    v_mul_f32 v73, s11, v73
    v_mul_f32 v74, s11, v74
    v_mul_f32 v75, s11, v75
    v_cvt_pk_bf16_f32 v128, v64, v65
    v_cvt_pk_bf16_f32 v129, v66, v67
    v_cvt_pk_bf16_f32 v130, v72, v73
    v_cvt_pk_bf16_f32 v131, v74, v75
    v_mul_f32 v68, s11, v68
    v_mul_f32 v69, s11, v69
    v_mul_f32 v70, s11, v70
    v_mul_f32 v71, s11, v71
    v_mul_f32 v76, s11, v76
    v_mul_f32 v77, s11, v77
    v_mul_f32 v78, s11, v78
    v_mul_f32 v79, s11, v79
    v_cvt_pk_bf16_f32 v132, v68, v69
    v_cvt_pk_bf16_f32 v133, v70, v71
    v_cvt_pk_bf16_f32 v134, v76, v77
    v_cvt_pk_bf16_f32 v135, v78, v79
    v_mfma_f32_16x16x32_bf16 v[92:95], v[172:175], v[220:223], v[92:95]
    v_mov_b32 v215, 0
    v_mfma_f32_16x16x32_bf16 v[96:99], v[176:179], v[216:219], v[96:99]
    v_mfma_f32_16x16x32_bf16 v[100:103], v[176:179], v[220:223], v[100:103]
    v_mfma_f32_16x16x32_bf16 v[104:107], v[180:183], v[216:219], v[104:107]
    v_mul_f32 v80, s11, v80
    v_mul_f32 v81, s11, v81
    v_mul_f32 v82, s11, v82
    v_mul_f32 v83, s11, v83
    v_mul_f32 v88, s11, v88
    v_mul_f32 v89, s11, v89
    v_mul_f32 v90, s11, v90
    v_mul_f32 v91, s11, v91
    v_cvt_pk_bf16_f32 v136, v80, v81
    v_cvt_pk_bf16_f32 v137, v82, v83
    v_cvt_pk_bf16_f32 v138, v88, v89
    v_cvt_pk_bf16_f32 v139, v90, v91
    v_mul_f32 v84, s11, v84
    v_mul_f32 v85, s11, v85
    v_mul_f32 v86, s11, v86
    v_mul_f32 v87, s11, v87
    v_mul_f32 v92, s11, v92
    v_mul_f32 v93, s11, v93
    v_mul_f32 v94, s11, v94
    v_mul_f32 v95, s11, v95
    v_cvt_pk_bf16_f32 v140, v84, v85
    v_cvt_pk_bf16_f32 v141, v86, v87
    v_cvt_pk_bf16_f32 v142, v92, v93
    v_cvt_pk_bf16_f32 v143, v94, v95
    v_mfma_f32_16x16x32_bf16 v[108:111], v[180:183], v[220:223], v[108:111]
    v_mfma_f32_16x16x32_bf16 v[112:115], v[184:187], v[216:219], v[112:115]
    v_mfma_f32_16x16x32_bf16 v[116:119], v[184:187], v[220:223], v[116:119]
    v_mfma_f32_16x16x32_bf16 v[120:123], v[188:191], v[216:219], v[120:123]
    v_mul_f32 v96, s11, v96
    v_mul_f32 v97, s11, v97
    v_mul_f32 v98, s11, v98
    v_mul_f32 v99, s11, v99
    v_mul_f32 v104, s11, v104
    v_mul_f32 v105, s11, v105
    v_mul_f32 v106, s11, v106
    v_mul_f32 v107, s11, v107
    v_cvt_pk_bf16_f32 v144, v96, v97
    v_cvt_pk_bf16_f32 v145, v98, v99
    v_cvt_pk_bf16_f32 v146, v104, v105
    v_cvt_pk_bf16_f32 v147, v106, v107
    v_mul_f32 v100, s11, v100
    v_mul_f32 v101, s11, v101
    v_mul_f32 v102, s11, v102
    v_mul_f32 v103, s11, v103
    v_mul_f32 v108, s11, v108
    v_mul_f32 v109, s11, v109
    v_mul_f32 v110, s11, v110
    v_mul_f32 v111, s11, v111
    v_cvt_pk_bf16_f32 v148, v100, v101
    v_cvt_pk_bf16_f32 v149, v102, v103
    v_cvt_pk_bf16_f32 v150, v108, v109
    v_cvt_pk_bf16_f32 v151, v110, v111
    v_mfma_f32_16x16x32_bf16 v[124:127], v[188:191], v[220:223], v[124:127]
    v_mul_f32 v112, s11, v112
    v_mul_f32 v113, s11, v113
    v_mul_f32 v114, s11, v114
    v_mul_f32 v115, s11, v115
    v_mul_f32 v120, s11, v120
    v_mul_f32 v121, s11, v121
    v_mul_f32 v122, s11, v122
    v_mul_f32 v123, s11, v123
    v_cvt_pk_bf16_f32 v152, v112, v113
    v_cvt_pk_bf16_f32 v153, v114, v115
    v_cvt_pk_bf16_f32 v154, v120, v121
    v_cvt_pk_bf16_f32 v155, v122, v123
    v_mul_f32 v116, s11, v116
    v_mul_f32 v117, s11, v117
    v_mul_f32 v118, s11, v118
    v_mul_f32 v119, s11, v119
    v_mul_f32 v124, s11, v124
    v_mul_f32 v125, s11, v125
    v_mul_f32 v126, s11, v126
    v_mul_f32 v127, s11, v127
    v_cvt_pk_bf16_f32 v156, v116, v117
    v_cvt_pk_bf16_f32 v157, v118, v119
    v_cvt_pk_bf16_f32 v158, v124, v125
    v_cvt_pk_bf16_f32 v159, v126, v127
    v_mov_b32 v216, 0
    v_mov_b32 v217, 0
    v_mov_b32 v218, 0
    v_mov_b32 v219, 0
    v_mov_b32 v220, 0
    v_mov_b32 v221, 0
    v_mov_b32 v222, 0
    v_mov_b32 v223, 0
    v_mov_b32 v72, 0
    v_mov_b32 v73, 0
    v_mov_b32 v74, 0
    v_mov_b32 v75, 0
    v_mov_b32 v76, 0
    v_mov_b32 v77, 0
    v_mov_b32 v78, 0
    v_mov_b32 v79, 0
    s_branch k1_att
k1_vpath:
    s_waitcnt vmcnt(9)
    s_barrier
    ds_read_b128 v[64:67], v10 offset:49152
    ds_read_b64_tr_b16 v[192:193], v18 offset:0
    ds_read_b64_tr_b16 v[194:195], v18 offset:2048
    ds_read_b64_tr_b16 v[196:197], v19 offset:0
    ds_read_b64_tr_b16 v[198:199], v19 offset:2048
    ds_read_b128 v[68:71], v10 offset:51200
    ds_read_b128 v[72:75], v10 offset:53248
    ds_read_b128 v[76:79], v10 offset:55296
    s_waitcnt lgkmcnt(0)
    ds_read_b128 v[80:83], v11 offset:49152
    ds_read_b64_tr_b16 v[200:201], v18 offset:1024
    v_mfma_f32_16x16x32_bf16 v[96:99], v[64:67], v[192:195], 0
    v_and_b32 v1, 7, v0
    v_xor_b32 v1, s22, v1
    ds_read_b64_tr_b16 v[202:203], v18 offset:3072
    ds_read_b64_tr_b16 v[204:205], v19 offset:1024
    v_mfma_f32_16x16x32_bf16 v[100:103], v[64:67], v[196:199], 0
    s_add_u32 m0, s12, 16384
    s_add_u32 s15, s13, 256
    buffer_load_dwordx4 v4, s[24:27], s15 offen lds
    ds_read_b64_tr_b16 v[206:207], v19 offset:3072
    ds_read_b128 v[84:87], v11 offset:51200
    v_mfma_f32_16x16x32_bf16 v[104:107], v[68:71], v[192:195], 0
    v_lshlrev_b32 v1, 4, v1
    v_lshl_add_u32 v1, v0, 7, v1
    ds_read_b128 v[88:91], v11 offset:53248
    ds_read_b128 v[92:95], v11 offset:55296
    v_mfma_f32_16x16x32_bf16 v[108:111], v[68:71], v[196:199], 0
    buffer_load_dwordx4 v5, s[24:27], s15 offen offset:1024 lds
    v_mfma_f32_16x16x32_bf16 v[112:115], v[72:75], v[192:195], 0
    v_add_u32 v1, 49152, v1
    v_bfe_u32 v2, v0, 2, 3
    v_mfma_f32_16x16x32_bf16 v[116:119], v[72:75], v[196:199], 0
    s_add_u32 m0, s12, 32768
    s_add_u32 s15, s14, 1048576
    buffer_load_dwordx4 v6, s[28:31], s15 offen nt lds
    v_mfma_f32_16x16x32_bf16 v[120:123], v[76:79], v[192:195], 0
    v_xor_b32 v2, s22, v2
    v_lshlrev_b32 v2, 4, v2
    v_mfma_f32_16x16x32_bf16 v[124:127], v[76:79], v[196:199], 0
    buffer_load_dwordx4 v7, s[28:31], s15 offen offset:1024 nt lds
    s_waitcnt lgkmcnt(0)
    s_waitcnt vmcnt(9)
    s_barrier
    ds_read_b128 v[64:67], v12 offset:16384
    ds_read_b64_tr_b16 v[208:209], v14 offset:0
    v_mfma_f32_16x16x32_bf16 v[96:99], v[80:83], v[200:203], v[96:99]
    v_lshrrev_b32 v3, 2, v0
    v_lshl_add_u32 v2, v3, 7, v2
    ds_read_b64_tr_b16 v[210:211], v14 offset:2048
    ds_read_b64_tr_b16 v[212:213], v15 offset:0
    v_mfma_f32_16x16x32_bf16 v[100:103], v[80:83], v[204:207], v[100:103]
    s_add_u32 m0, s12, 65536
    s_add_u32 s15, s13, 384
    buffer_load_dwordx4 v4, s[24:27], s15 offen lds
    ds_read_b64_tr_b16 v[214:215], v15 offset:2048
    ds_read_b128 v[68:71], v12 offset:18432
    v_mfma_f32_16x16x32_bf16 v[104:107], v[84:87], v[200:203], v[104:107]
    v_and_b32 v3, 3, v0
    v_lshl_add_u32 v2, v3, 2, v2
    ds_read_b128 v[72:75], v12 offset:20480
    ds_read_b128 v[76:79], v12 offset:22528
    v_mfma_f32_16x16x32_bf16 v[108:111], v[84:87], v[204:207], v[108:111]
    buffer_load_dwordx4 v5, s[24:27], s15 offen offset:1024 lds
    v_mfma_f32_16x16x32_bf16 v[112:115], v[88:91], v[200:203], v[112:115]
    v_add_u32 v2, 57344, v2
    s_waitcnt vmcnt(6)
    v_mfma_f32_16x16x32_bf16 v[116:119], v[88:91], v[204:207], v[116:119]
    s_add_u32 m0, s12, 81920
    s_add_u32 s15, s14, 1572864
    buffer_load_dwordx4 v6, s[28:31], s15 offen nt lds
    v_mfma_f32_16x16x32_bf16 v[120:123], v[92:95], v[200:203], v[120:123]
    s_cmp_lt_u32 s10, 240
    s_cselect_b32 s3, 2, 64
    s_lshl_b32 s3, s3, 6
    s_cmp_lt_u32 s10, 80
    s_cselect_b32 s3, 0, s3
    v_mfma_f32_16x16x32_bf16 v[124:127], v[92:95], v[204:207], v[124:127]
    buffer_load_dwordx4 v7, s[28:31], s15 offen offset:1024 nt lds
    s_waitcnt lgkmcnt(0)
    ds_read_b128 v[80:83], v13 offset:16384
    ds_read_b64_tr_b16 v[216:217], v14 offset:1024
    v_mfma_f32_16x16x32_bf16 v[96:99], v[64:67], v[208:211], v[96:99]
    buffer_atomic_add v30, v22, s[44:47], s3 offen sc1
    ds_read_b64_tr_b16 v[218:219], v14 offset:3072
    ds_read_b64_tr_b16 v[220:221], v15 offset:1024
    v_mfma_f32_16x16x32_bf16 v[100:103], v[64:67], v[212:215], v[100:103]
    s_add_u32 m0, s12, 98304
    s_add_u32 s15, s13, 512
    buffer_load_dwordx4 v4, s[24:27], s15 offen lds
    ds_read_b64_tr_b16 v[222:223], v15 offset:3072
    ds_read_b128 v[84:87], v13 offset:18432
    v_mfma_f32_16x16x32_bf16 v[104:107], v[68:71], v[208:211], v[104:107]
    ds_read_b128 v[88:91], v13 offset:20480
    ds_read_b128 v[92:95], v13 offset:22528
    v_mfma_f32_16x16x32_bf16 v[108:111], v[68:71], v[212:215], v[108:111]
    buffer_load_dwordx4 v5, s[24:27], s15 offen offset:1024 lds
    v_mfma_f32_16x16x32_bf16 v[112:115], v[72:75], v[208:211], v[112:115]
    v_mfma_f32_16x16x32_bf16 v[116:119], v[72:75], v[212:215], v[116:119]
    s_add_u32 m0, s12, 114688
    s_add_u32 s15, s14, 2097152
    buffer_load_dwordx4 v6, s[28:31], s15 offen nt lds
    v_mfma_f32_16x16x32_bf16 v[120:123], v[76:79], v[208:211], v[120:123]
    v_mfma_f32_16x16x32_bf16 v[124:127], v[76:79], v[212:215], v[124:127]
    buffer_load_dwordx4 v7, s[28:31], s15 offen offset:1024 nt lds
    s_waitcnt lgkmcnt(0)
    s_waitcnt vmcnt(9)
    s_barrier
    ds_read_b128 v[64:67], v8 offset:16384
    ds_read_b64_tr_b16 v[224:225], v14 offset:32768
    v_mfma_f32_16x16x32_bf16 v[96:99], v[80:83], v[216:219], v[96:99]
    ds_read_b64_tr_b16 v[226:227], v14 offset:34816
    ds_read_b64_tr_b16 v[228:229], v15 offset:32768
    v_mfma_f32_16x16x32_bf16 v[100:103], v[80:83], v[220:223], v[100:103]
    s_add_u32 m0, s12, 131072
    s_add_u32 s15, s13, 640
    buffer_load_dwordx4 v4, s[24:27], s15 offen lds
    ds_read_b64_tr_b16 v[230:231], v15 offset:34816
    ds_read_b128 v[68:71], v8 offset:18432
    v_mfma_f32_16x16x32_bf16 v[104:107], v[84:87], v[216:219], v[104:107]
    ds_read_b128 v[72:75], v8 offset:20480
    ds_read_b128 v[76:79], v8 offset:22528
    v_mfma_f32_16x16x32_bf16 v[108:111], v[84:87], v[220:223], v[108:111]
    buffer_load_dwordx4 v5, s[24:27], s15 offen offset:1024 lds
    v_mfma_f32_16x16x32_bf16 v[112:115], v[88:91], v[216:219], v[112:115]
    v_mfma_f32_16x16x32_bf16 v[116:119], v[88:91], v[220:223], v[116:119]
    s_add_u32 m0, s12, 147456
    s_add_u32 s15, s14, 2621440
    buffer_load_dwordx4 v6, s[28:31], s15 offen nt lds
    v_mfma_f32_16x16x32_bf16 v[120:123], v[92:95], v[216:219], v[120:123]
    v_mfma_f32_16x16x32_bf16 v[124:127], v[92:95], v[220:223], v[124:127]
    buffer_load_dwordx4 v7, s[28:31], s15 offen offset:1024 nt lds
    s_waitcnt lgkmcnt(0)
    ds_read_b128 v[80:83], v9 offset:16384
    ds_read_b64_tr_b16 v[232:233], v14 offset:33792
    v_mfma_f32_16x16x32_bf16 v[96:99], v[64:67], v[224:227], v[96:99]
    ds_read_b64_tr_b16 v[234:235], v14 offset:35840
    ds_read_b64_tr_b16 v[236:237], v15 offset:33792
    v_mfma_f32_16x16x32_bf16 v[100:103], v[64:67], v[228:231], v[100:103]
    s_add_u32 m0, s12, 0
    s_add_u32 s15, s13, 768
    buffer_load_dwordx4 v4, s[24:27], s15 offen lds
    ds_read_b64_tr_b16 v[238:239], v15 offset:35840
    ds_read_b128 v[84:87], v9 offset:18432
    v_mfma_f32_16x16x32_bf16 v[104:107], v[68:71], v[224:227], v[104:107]
    ds_read_b128 v[88:91], v9 offset:20480
    ds_read_b128 v[92:95], v9 offset:22528
    v_mfma_f32_16x16x32_bf16 v[108:111], v[68:71], v[228:231], v[108:111]
    buffer_load_dwordx4 v5, s[24:27], s15 offen offset:1024 lds
    v_mfma_f32_16x16x32_bf16 v[112:115], v[72:75], v[224:227], v[112:115]
    v_mfma_f32_16x16x32_bf16 v[116:119], v[72:75], v[228:231], v[116:119]
    v_mfma_f32_16x16x32_bf16 v[120:123], v[76:79], v[224:227], v[120:123]
    v_mfma_f32_16x16x32_bf16 v[124:127], v[76:79], v[228:231], v[124:127]
    s_waitcnt lgkmcnt(0)
    s_waitcnt vmcnt(11)
    s_barrier
    ds_read_b128 v[64:67], v10 offset:0
    ds_read_b64_tr_b16 v[240:241], v16 offset:16384
    v_mfma_f32_16x16x32_bf16 v[96:99], v[80:83], v[232:235], v[96:99]
    ds_read_b64_tr_b16 v[242:243], v16 offset:18432
    ds_read_b64_tr_b16 v[244:245], v17 offset:16384
    v_mfma_f32_16x16x32_bf16 v[100:103], v[80:83], v[236:239], v[100:103]
    s_add_u32 m0, s12, 16384
    s_add_u32 s15, s14, 3145728
    buffer_load_dwordx4 v6, s[28:31], s15 offen nt lds
    ds_read_b64_tr_b16 v[246:247], v17 offset:18432
    ds_read_b128 v[68:71], v10 offset:2048
    v_mfma_f32_16x16x32_bf16 v[104:107], v[84:87], v[232:235], v[104:107]
    ds_read_b128 v[72:75], v10 offset:4096
    ds_read_b128 v[76:79], v10 offset:6144
    v_mfma_f32_16x16x32_bf16 v[108:111], v[84:87], v[236:239], v[108:111]
    buffer_load_dwordx4 v7, s[28:31], s15 offen offset:1024 nt lds
    v_mfma_f32_16x16x32_bf16 v[112:115], v[88:91], v[232:235], v[112:115]
    v_mfma_f32_16x16x32_bf16 v[116:119], v[88:91], v[236:239], v[116:119]
    s_add_u32 m0, s12, 32768
    s_add_u32 s15, s13, 896
    buffer_load_dwordx4 v4, s[24:27], s15 offen lds
    v_mfma_f32_16x16x32_bf16 v[120:123], v[92:95], v[232:235], v[120:123]
    v_mfma_f32_16x16x32_bf16 v[124:127], v[92:95], v[236:239], v[124:127]
    buffer_load_dwordx4 v5, s[24:27], s15 offen offset:1024 lds
    s_waitcnt lgkmcnt(0)
    ds_read_b128 v[80:83], v11 offset:0
    ds_read_b64_tr_b16 v[248:249], v16 offset:17408
    v_mfma_f32_16x16x32_bf16 v[96:99], v[64:67], v[240:243], v[96:99]
    buffer_load_dword v29, v22, s[44:47], 0 offen offset:0 sc1
    ds_read_b64_tr_b16 v[250:251], v16 offset:19456
    ds_read_b64_tr_b16 v[252:253], v17 offset:17408
    v_mfma_f32_16x16x32_bf16 v[100:103], v[64:67], v[244:247], v[100:103]
    ds_read_b64_tr_b16 v[254:255], v17 offset:19456
    ds_read_b128 v[84:87], v11 offset:2048
    v_mfma_f32_16x16x32_bf16 v[104:107], v[68:71], v[240:243], v[104:107]
    ds_read_b128 v[88:91], v11 offset:4096
    ds_read_b128 v[92:95], v11 offset:6144
    v_mfma_f32_16x16x32_bf16 v[108:111], v[68:71], v[244:247], v[108:111]
    v_mfma_f32_16x16x32_bf16 v[112:115], v[72:75], v[240:243], v[112:115]
    v_mfma_f32_16x16x32_bf16 v[116:119], v[72:75], v[244:247], v[116:119]
    v_mfma_f32_16x16x32_bf16 v[120:123], v[76:79], v[240:243], v[120:123]
    v_mfma_f32_16x16x32_bf16 v[124:127], v[76:79], v[244:247], v[124:127]
    s_waitcnt lgkmcnt(0)
    s_waitcnt vmcnt(11)
    s_barrier
    ds_read_b128 v[64:67], v10 offset:32768
    ds_read_b64_tr_b16 v[128:129], v16 offset:49152
    v_mfma_f32_16x16x32_bf16 v[96:99], v[80:83], v[248:251], v[96:99]
    s_lshr_b32 s3, s2, 3
    s_lshl_b32 s3, s3, 3
    s_add_u32 s3, s3, s22
    s_mul_i32 s3, s3, 4096
    s_add_u32 s3, s3, 1048576
    ds_read_b64_tr_b16 v[130:131], v16 offset:51200
    ds_read_b64_tr_b16 v[132:133], v17 offset:49152
    v_mfma_f32_16x16x32_bf16 v[100:103], v[80:83], v[252:255], v[100:103]
    s_add_u32 m0, s12, 65536
    s_add_u32 s15, s14, 3670016
    buffer_load_dwordx4 v6, s[28:31], s15 offen nt lds
    ds_read_b64_tr_b16 v[134:135], v17 offset:51200
    ds_read_b128 v[68:71], v10 offset:34816
    v_mfma_f32_16x16x32_bf16 v[104:107], v[84:87], v[248:251], v[104:107]
    buffer_load_dword v48, v50, s[24:27], s3 offen
    ds_read_b128 v[72:75], v10 offset:36864
    ds_read_b128 v[76:79], v10 offset:38912
    v_mfma_f32_16x16x32_bf16 v[108:111], v[84:87], v[252:255], v[108:111]
    buffer_load_dwordx4 v7, s[28:31], s15 offen offset:1024 nt lds
    v_mfma_f32_16x16x32_bf16 v[112:115], v[88:91], v[248:251], v[112:115]
    v_mfma_f32_16x16x32_bf16 v[116:119], v[88:91], v[252:255], v[116:119]
    s_add_u32 m0, s12, 81920
    s_add_u32 s15, s13, 524288
    buffer_load_dwordx4 v4, s[24:27], s15 offen lds
    v_mfma_f32_16x16x32_bf16 v[120:123], v[92:95], v[248:251], v[120:123]
    v_mfma_f32_16x16x32_bf16 v[124:127], v[92:95], v[252:255], v[124:127]
    buffer_load_dwordx4 v5, s[24:27], s15 offen offset:1024 lds
    s_waitcnt lgkmcnt(0)
    ds_read_b128 v[80:83], v11 offset:32768
    ds_read_b64_tr_b16 v[136:137], v16 offset:50176
    v_mfma_f32_16x16x32_bf16 v[96:99], v[64:67], v[128:131], v[96:99]
    s_mul_i32 s3, s9, 80
    s_mul_i32 s61, s22, 10
    s_add_u32 s3, s3, s61
    s_lshl_b32 s3, s3, 13
    s_lshl_b32 s61, s6, 8
    s_add_u32 s3, s3, s61
    ds_read_b64_tr_b16 v[138:139], v16 offset:52224
    ds_read_b64_tr_b16 v[140:141], v17 offset:50176
    v_mfma_f32_16x16x32_bf16 v[100:103], v[64:67], v[132:135], v[100:103]
    buffer_load_dword v49, v51, s[32:35], s3 offen
    ds_read_b64_tr_b16 v[142:143], v17 offset:52224
    ds_read_b128 v[84:87], v11 offset:34816
    v_mfma_f32_16x16x32_bf16 v[104:107], v[68:71], v[128:131], v[104:107]
    ds_read_b128 v[88:91], v11 offset:36864
    ds_read_b128 v[92:95], v11 offset:38912
    v_mfma_f32_16x16x32_bf16 v[108:111], v[68:71], v[132:135], v[108:111]
    v_mfma_f32_16x16x32_bf16 v[112:115], v[72:75], v[128:131], v[112:115]
    v_mfma_f32_16x16x32_bf16 v[116:119], v[72:75], v[132:135], v[116:119]
    v_mfma_f32_16x16x32_bf16 v[120:123], v[76:79], v[128:131], v[120:123]
    v_mfma_f32_16x16x32_bf16 v[124:127], v[76:79], v[132:135], v[124:127]
    s_waitcnt lgkmcnt(0)
    s_waitcnt vmcnt(13)
    s_barrier
    ds_read_b128 v[64:67], v12 offset:0
    ds_read_b64_tr_b16 v[144:145], v18 offset:16384
    v_mfma_f32_16x16x32_bf16 v[96:99], v[80:83], v[136:139], v[96:99]
    ds_read_b64_tr_b16 v[146:147], v18 offset:18432
    ds_read_b64_tr_b16 v[148:149], v19 offset:16384
    v_mfma_f32_16x16x32_bf16 v[100:103], v[80:83], v[140:143], v[100:103]
    s_add_u32 m0, s12, 98304
    s_add_u32 s15, s13, 524416
    buffer_load_dwordx4 v4, s[24:27], s15 offen lds
    ds_read_b64_tr_b16 v[150:151], v19 offset:18432
    ds_read_b128 v[68:71], v12 offset:2048
    v_mfma_f32_16x16x32_bf16 v[104:107], v[84:87], v[136:139], v[104:107]
    ds_read_b128 v[72:75], v12 offset:4096
    ds_read_b128 v[76:79], v12 offset:6144
    v_mfma_f32_16x16x32_bf16 v[108:111], v[84:87], v[140:143], v[108:111]
    buffer_load_dwordx4 v5, s[24:27], s15 offen offset:1024 lds
    v_mfma_f32_16x16x32_bf16 v[112:115], v[88:91], v[136:139], v[112:115]
    v_mfma_f32_16x16x32_bf16 v[116:119], v[88:91], v[140:143], v[116:119]
    s_add_u32 m0, s12, 114688
    s_add_u32 s15, s13, 524544
    buffer_load_dwordx4 v4, s[24:27], s15 offen lds
    v_mfma_f32_16x16x32_bf16 v[120:123], v[92:95], v[136:139], v[120:123]
    v_mfma_f32_16x16x32_bf16 v[124:127], v[92:95], v[140:143], v[124:127]
    buffer_load_dwordx4 v5, s[24:27], s15 offen offset:1024 lds
    s_waitcnt lgkmcnt(0)
    ds_read_b128 v[80:83], v13 offset:0
    ds_read_b64_tr_b16 v[152:153], v18 offset:17408
    v_mfma_f32_16x16x32_bf16 v[96:99], v[64:67], v[144:147], v[96:99]
    ds_read_b64_tr_b16 v[154:155], v18 offset:19456
    ds_read_b64_tr_b16 v[156:157], v19 offset:17408
    v_mfma_f32_16x16x32_bf16 v[100:103], v[64:67], v[148:151], v[100:103]
    ds_read_b64_tr_b16 v[158:159], v19 offset:19456
    ds_read_b128 v[84:87], v13 offset:2048
    v_mfma_f32_16x16x32_bf16 v[104:107], v[68:71], v[144:147], v[104:107]
    ds_read_b128 v[88:91], v13 offset:4096
    ds_read_b128 v[92:95], v13 offset:6144
    v_mfma_f32_16x16x32_bf16 v[108:111], v[68:71], v[148:151], v[108:111]
    v_mfma_f32_16x16x32_bf16 v[112:115], v[72:75], v[144:147], v[112:115]
    v_mfma_f32_16x16x32_bf16 v[116:119], v[72:75], v[148:151], v[116:119]
    s_waitcnt vmcnt(10)
    v_readfirstlane_b32 s3, v29
    s_nop 0
    s_or_b32 s3, s3, s60
    s_cmp_ge_u32 s3, 80
    s_cbranch_scc0 k1_spin9
k1_back10:
    v_mfma_f32_16x16x32_bf16 v[120:123], v[76:79], v[144:147], v[120:123]
    v_mfma_f32_16x16x32_bf16 v[124:127], v[76:79], v[148:151], v[124:127]
    s_waitcnt lgkmcnt(0)
    s_waitcnt vmcnt(13)
    s_barrier
    ds_read_b128 v[64:67], v8 offset:0
    ds_read_b64_tr_b16 v[160:161], v14 offset:16384
    v_mfma_f32_16x16x32_bf16 v[96:99], v[80:83], v[152:155], v[96:99]
    s_mov_b32 s3, 83886080
    buffer_load_dwordx4 v[32:35], v20, s[36:39], s3 offen sc1
    ds_read_b64_tr_b16 v[162:163], v14 offset:18432
    ds_read_b64_tr_b16 v[164:165], v15 offset:16384
    v_mfma_f32_16x16x32_bf16 v[100:103], v[80:83], v[156:159], v[100:103]
    s_add_u32 m0, s12, 131072
    s_add_u32 s15, s13, 524672
    buffer_load_dwordx4 v4, s[24:27], s15 offen lds
    ds_read_b64_tr_b16 v[166:167], v15 offset:18432
    ds_read_b128 v[68:71], v8 offset:2048
    v_mfma_f32_16x16x32_bf16 v[104:107], v[84:87], v[152:155], v[104:107]
    buffer_load_dwordx4 v[40:43], v20, s[36:39], s3 offen offset:1280 sc1
    buffer_load_dword v36, v21, s[36:39], s3 offen offset:1024 sc1
    ds_read_b128 v[72:75], v8 offset:4096
    ds_read_b128 v[76:79], v8 offset:6144
    v_mfma_f32_16x16x32_bf16 v[108:111], v[84:87], v[156:159], v[108:111]
    buffer_load_dwordx4 v5, s[24:27], s15 offen offset:1024 lds
    v_mfma_f32_16x16x32_bf16 v[112:115], v[88:91], v[152:155], v[112:115]
    buffer_load_dword v37, v21, s[36:39], s3 offen offset:2304 sc1
    v_mfma_f32_16x16x32_bf16 v[116:119], v[88:91], v[156:159], v[116:119]
    s_add_u32 m0, s12, 147456
    s_add_u32 s15, s13, 524800
    buffer_load_dwordx4 v4, s[24:27], s15 offen lds
    v_mfma_f32_16x16x32_bf16 v[120:123], v[92:95], v[152:155], v[120:123]
    v_mfma_f32_16x16x32_bf16 v[124:127], v[92:95], v[156:159], v[124:127]
    buffer_load_dwordx4 v5, s[24:27], s15 offen offset:1024 lds
    s_waitcnt lgkmcnt(0)
    ds_read_b128 v[80:83], v9 offset:0
    ds_read_b64_tr_b16 v[168:169], v14 offset:17408
    v_mfma_f32_16x16x32_bf16 v[96:99], v[64:67], v[160:163], v[96:99]
    ds_read_b64_tr_b16 v[170:171], v14 offset:19456
    ds_read_b64_tr_b16 v[172:173], v15 offset:17408
    v_mfma_f32_16x16x32_bf16 v[100:103], v[64:67], v[164:167], v[100:103]
    ds_read_b64_tr_b16 v[174:175], v15 offset:19456
    ds_read_b128 v[84:87], v9 offset:2048
    v_mfma_f32_16x16x32_bf16 v[104:107], v[68:71], v[160:163], v[104:107]
    ds_read_b128 v[88:91], v9 offset:4096
    ds_read_b128 v[92:95], v9 offset:6144
    v_mfma_f32_16x16x32_bf16 v[108:111], v[68:71], v[164:167], v[108:111]
    v_mfma_f32_16x16x32_bf16 v[112:115], v[72:75], v[160:163], v[112:115]
    v_mfma_f32_16x16x32_bf16 v[116:119], v[72:75], v[164:167], v[116:119]
    v_mfma_f32_16x16x32_bf16 v[120:123], v[76:79], v[160:163], v[120:123]
    v_mfma_f32_16x16x32_bf16 v[124:127], v[76:79], v[164:167], v[124:127]
    s_waitcnt lgkmcnt(0)
    s_waitcnt vmcnt(15)
    s_barrier
    ds_read_b128 v[64:67], v8 offset:32768
    ds_read_b64_tr_b16 v[176:177], v16 offset:0
    v_mfma_f32_16x16x32_bf16 v[96:99], v[80:83], v[168:171], v[96:99]
    ds_read_b64_tr_b16 v[178:179], v16 offset:2048
    ds_read_b64_tr_b16 v[180:181], v17 offset:0
    v_mfma_f32_16x16x32_bf16 v[100:103], v[80:83], v[172:175], v[100:103]
    s_add_u32 m0, s12, 0
    s_add_u32 s15, s13, 524928
    buffer_load_dwordx4 v4, s[24:27], s15 offen lds
    ds_read_b64_tr_b16 v[182:183], v17 offset:2048
    ds_read_b128 v[68:71], v8 offset:34816
    v_mfma_f32_16x16x32_bf16 v[104:107], v[84:87], v[168:171], v[104:107]
    ds_read_b128 v[72:75], v8 offset:36864
    ds_read_b128 v[76:79], v8 offset:38912
    v_mfma_f32_16x16x32_bf16 v[108:111], v[84:87], v[172:175], v[108:111]
    buffer_load_dwordx4 v5, s[24:27], s15 offen offset:1024 lds
    v_mfma_f32_16x16x32_bf16 v[112:115], v[88:91], v[168:171], v[112:115]
    v_mfma_f32_16x16x32_bf16 v[116:119], v[88:91], v[172:175], v[116:119]
    s_add_u32 m0, s12, 16384
    s_add_u32 s15, s13, 525056
    buffer_load_dwordx4 v4, s[24:27], s15 offen lds
    v_mfma_f32_16x16x32_bf16 v[120:123], v[92:95], v[168:171], v[120:123]
    v_mfma_f32_16x16x32_bf16 v[124:127], v[92:95], v[172:175], v[124:127]
    buffer_load_dwordx4 v5, s[24:27], s15 offen offset:1024 lds
    s_waitcnt lgkmcnt(0)
    ds_read_b128 v[80:83], v9 offset:32768
    ds_read_b64_tr_b16 v[184:185], v16 offset:1024
    v_mfma_f32_16x16x32_bf16 v[96:99], v[64:67], v[176:179], v[96:99]
    ds_read_b64_tr_b16 v[186:187], v16 offset:3072
    ds_read_b64_tr_b16 v[188:189], v17 offset:1024
    v_mfma_f32_16x16x32_bf16 v[100:103], v[64:67], v[180:183], v[100:103]
    ds_read_b64_tr_b16 v[190:191], v17 offset:3072
    ds_read_b128 v[84:87], v9 offset:34816
    v_mfma_f32_16x16x32_bf16 v[104:107], v[68:71], v[176:179], v[104:107]
    ds_read_b128 v[88:91], v9 offset:36864
    ds_read_b128 v[92:95], v9 offset:38912
    v_mfma_f32_16x16x32_bf16 v[108:111], v[68:71], v[180:183], v[108:111]
    v_mfma_f32_16x16x32_bf16 v[112:115], v[72:75], v[176:179], v[112:115]
    v_mfma_f32_16x16x32_bf16 v[116:119], v[72:75], v[180:183], v[116:119]
    v_mfma_f32_16x16x32_bf16 v[120:123], v[76:79], v[176:179], v[120:123]
    v_mfma_f32_16x16x32_bf16 v[124:127], v[76:79], v[180:183], v[124:127]
    s_waitcnt lgkmcnt(0)
    s_waitcnt vmcnt(14)
    s_barrier
    ds_read_b128 v[64:67], v10 offset:16384
    ds_read_b128 v[68:71], v10 offset:18432
    v_mfma_f32_16x16x32_bf16 v[96:99], v[80:83], v[184:187], v[96:99]
    s_waitcnt vmcnt(6)
    v_lshlrev_b32 v38, 16, v24
    ds_read_b128 v[72:75], v10 offset:20480
    ds_read_b128 v[76:79], v10 offset:22528
    v_mfma_f32_16x16x32_bf16 v[100:103], v[80:83], v[188:191], v[100:103]
    s_add_u32 m0, s12, 32768
    s_add_u32 s15, s13, 525184
    buffer_load_dwordx4 v4, s[24:27], s15 offen lds
    v_mfma_f32_16x16x32_bf16 v[104:107], v[84:87], v[184:187], v[104:107]
    v_and_b32 v39, 0xffff0000, v24
    v_lshlrev_b32 v44, 16, v40
    v_mfma_f32_16x16x32_bf16 v[108:111], v[84:87], v[188:191], v[108:111]
    buffer_load_dwordx4 v5, s[24:27], s15 offen offset:1024 lds
    v_mfma_f32_16x16x32_bf16 v[112:115], v[88:91], v[184:187], v[112:115]
    v_and_b32 v45, 0xffff0000, v40
    v_mul_f32 v38, v38, v44
    v_mfma_f32_16x16x32_bf16 v[116:119], v[88:91], v[188:191], v[116:119]
    s_add_u32 m0, s12, 65536
    s_add_u32 s15, s13, 1048576
    buffer_load_dwordx4 v4, s[24:27], s15 offen lds
    v_mfma_f32_16x16x32_bf16 v[120:123], v[92:95], v[184:187], v[120:123]
    v_mul_f32 v39, v39, v45
    v_cvt_pk_bf16_f32 v46, v38, v39
    v_mfma_f32_16x16x32_bf16 v[124:127], v[92:95], v[188:191], v[124:127]
    buffer_load_dwordx4 v5, s[24:27], s15 offen offset:1024 lds
    s_waitcnt lgkmcnt(0)
    v_cvt_pk_bf16_f32 v48, v96, v97
    v_cvt_pk_bf16_f32 v49, v98, v99
    v_cvt_pk_bf16_f32 v50, v104, v105
    v_cvt_pk_bf16_f32 v51, v106, v107
    v_cvt_pk_bf16_f32 v52, v100, v101
    v_cvt_pk_bf16_f32 v53, v102, v103
    v_cvt_pk_bf16_f32 v54, v108, v109
    v_cvt_pk_bf16_f32 v55, v110, v111
    ds_read_b128 v[80:83], v11 offset:16384
    ds_read_b128 v[84:87], v11 offset:18432
    v_mfma_f32_16x16x32_bf16 v[96:99], v[64:67], v[192:195], 0
    ds_read_b128 v[88:91], v11 offset:20480
    ds_read_b128 v[92:95], v11 offset:22528
    v_mfma_f32_16x16x32_bf16 v[100:103], v[64:67], v[196:199], 0
    v_mfma_f32_16x16x32_bf16 v[104:107], v[68:71], v[192:195], 0
    v_mfma_f32_16x16x32_bf16 v[108:111], v[68:71], v[196:199], 0
    v_cvt_pk_bf16_f32 v56, v112, v113
    v_cvt_pk_bf16_f32 v57, v114, v115
    v_cvt_pk_bf16_f32 v58, v120, v121
    v_cvt_pk_bf16_f32 v59, v122, v123
    v_cvt_pk_bf16_f32 v60, v116, v117
    v_cvt_pk_bf16_f32 v61, v118, v119
    v_cvt_pk_bf16_f32 v62, v124, v125
    v_cvt_pk_bf16_f32 v63, v126, v127
    v_mfma_f32_16x16x32_bf16 v[112:115], v[72:75], v[192:195], 0
    v_mfma_f32_16x16x32_bf16 v[116:119], v[72:75], v[196:199], 0
    v_mfma_f32_16x16x32_bf16 v[120:123], v[76:79], v[192:195], 0
    v_mfma_f32_16x16x32_bf16 v[124:127], v[76:79], v[196:199], 0
    s_waitcnt lgkmcnt(0)
    ds_read_b128 v[64:67], v10 offset:32768
    ds_read_b128 v[68:71], v10 offset:34816
    v_mfma_f32_16x16x32_bf16 v[96:99], v[80:83], v[200:203], v[96:99]
    v_lshlrev_b32 v38, 16, v46
    v_and_b32 v39, 0xffff0000, v46
    ds_read_b128 v[72:75], v10 offset:36864
    ds_read_b128 v[76:79], v10 offset:38912
    v_mfma_f32_16x16x32_bf16 v[100:103], v[80:83], v[204:207], v[100:103]
    v_lshlrev_b32 v44, 16, v32
    v_and_b32 v45, 0xffff0000, v32
    v_mfma_f32_16x16x32_bf16 v[104:107], v[84:87], v[200:203], v[104:107]
    v_add_f32 v38, v38, v44
    v_add_f32 v39, v39, v45
    v_mfma_f32_16x16x32_bf16 v[108:111], v[84:87], v[204:207], v[108:111]
    v_cvt_pk_bf16_f32 v24, v38, v39
    v_lshlrev_b32 v38, 16, v25
    v_mfma_f32_16x16x32_bf16 v[112:115], v[88:91], v[200:203], v[112:115]
    v_and_b32 v39, 0xffff0000, v25
    v_lshlrev_b32 v44, 16, v41
    v_mfma_f32_16x16x32_bf16 v[116:119], v[88:91], v[204:207], v[116:119]
    v_and_b32 v45, 0xffff0000, v41
    v_mul_f32 v38, v38, v44
    v_mfma_f32_16x16x32_bf16 v[120:123], v[92:95], v[200:203], v[120:123]
    s_add_u32 s11, s16, 0
    buffer_store_dwordx4 v[48:51], v20, s[36:39], s11 offen sc1
    v_mfma_f32_16x16x32_bf16 v[124:127], v[92:95], v[204:207], v[124:127]
    v_mul_f32 v39, v39, v45
    v_cvt_pk_bf16_f32 v46, v38, v39
    s_waitcnt lgkmcnt(0)
    ds_read_b128 v[80:83], v11 offset:32768
    ds_read_b128 v[84:87], v11 offset:34816
    v_mfma_f32_16x16x32_bf16 v[96:99], v[64:67], v[208:211], v[96:99]
    v_lshlrev_b32 v38, 16, v46
    v_and_b32 v39, 0xffff0000, v46
    ds_read_b128 v[88:91], v11 offset:36864
    ds_read_b128 v[92:95], v11 offset:38912
    v_mfma_f32_16x16x32_bf16 v[100:103], v[64:67], v[212:215], v[100:103]
    v_lshlrev_b32 v44, 16, v33
    v_and_b32 v45, 0xffff0000, v33
    v_mfma_f32_16x16x32_bf16 v[104:107], v[68:71], v[208:211], v[104:107]
    v_add_f32 v38, v38, v44
    v_add_f32 v39, v39, v45
    v_mfma_f32_16x16x32_bf16 v[108:111], v[68:71], v[212:215], v[108:111]
    v_cvt_pk_bf16_f32 v25, v38, v39
    v_lshlrev_b32 v38, 16, v26
    v_mfma_f32_16x16x32_bf16 v[112:115], v[72:75], v[208:211], v[112:115]
    v_and_b32 v39, 0xffff0000, v26
    v_lshlrev_b32 v44, 16, v42
    v_mfma_f32_16x16x32_bf16 v[116:119], v[72:75], v[212:215], v[116:119]
    v_and_b32 v45, 0xffff0000, v42
    v_mul_f32 v38, v38, v44
    v_mfma_f32_16x16x32_bf16 v[120:123], v[76:79], v[208:211], v[120:123]
    v_mul_f32 v39, v39, v45
    v_cvt_pk_bf16_f32 v46, v38, v39
    v_mfma_f32_16x16x32_bf16 v[124:127], v[76:79], v[212:215], v[124:127]
    v_lshlrev_b32 v38, 16, v46
    v_and_b32 v39, 0xffff0000, v46
    s_waitcnt lgkmcnt(0)
    s_waitcnt vmcnt(12)
    s_barrier
    ds_read_b128 v[64:67], v10 offset:49152
    ds_read_b128 v[68:71], v10 offset:51200
    v_mfma_f32_16x16x32_bf16 v[96:99], v[80:83], v[216:219], v[96:99]
    v_lshlrev_b32 v44, 16, v34
    v_and_b32 v45, 0xffff0000, v34
    ds_read_b128 v[72:75], v10 offset:53248
    ds_read_b128 v[76:79], v10 offset:55296
    v_mfma_f32_16x16x32_bf16 v[100:103], v[80:83], v[220:223], v[100:103]
    s_add_u32 m0, s12, 81920
    s_add_u32 s15, s13, 1048704
    buffer_load_dwordx4 v4, s[24:27], s15 offen lds
    v_mfma_f32_16x16x32_bf16 v[104:107], v[84:87], v[216:219], v[104:107]
    v_add_f32 v38, v38, v44
    v_add_f32 v39, v39, v45
    v_mfma_f32_16x16x32_bf16 v[108:111], v[84:87], v[220:223], v[108:111]
    buffer_load_dwordx4 v5, s[24:27], s15 offen offset:1024 lds
    v_mfma_f32_16x16x32_bf16 v[112:115], v[88:91], v[216:219], v[112:115]
    v_cvt_pk_bf16_f32 v26, v38, v39
    v_lshlrev_b32 v38, 16, v27
    v_mfma_f32_16x16x32_bf16 v[116:119], v[88:91], v[220:223], v[116:119]
    v_and_b32 v39, 0xffff0000, v27
    v_lshlrev_b32 v44, 16, v43
    v_mfma_f32_16x16x32_bf16 v[120:123], v[92:95], v[216:219], v[120:123]
    v_and_b32 v45, 0xffff0000, v43
    v_mul_f32 v38, v38, v44
    v_mfma_f32_16x16x32_bf16 v[124:127], v[92:95], v[220:223], v[124:127]
    v_mul_f32 v39, v39, v45
    v_cvt_pk_bf16_f32 v46, v38, v39
    s_waitcnt lgkmcnt(0)
    ds_read_b128 v[80:83], v11 offset:49152
    ds_read_b128 v[84:87], v11 offset:51200
    v_mfma_f32_16x16x32_bf16 v[96:99], v[64:67], v[224:227], v[96:99]
    v_lshlrev_b32 v38, 16, v46
    v_and_b32 v39, 0xffff0000, v46
    ds_read_b128 v[88:91], v11 offset:53248
    ds_read_b128 v[92:95], v11 offset:55296
    v_mfma_f32_16x16x32_bf16 v[100:103], v[64:67], v[228:231], v[100:103]
    s_add_u32 m0, s12, 98304
    s_add_u32 s15, s13, 1048832
    buffer_load_dwordx4 v4, s[24:27], s15 offen lds
    v_mfma_f32_16x16x32_bf16 v[104:107], v[68:71], v[224:227], v[104:107]
    v_lshlrev_b32 v44, 16, v35
    v_and_b32 v45, 0xffff0000, v35
    v_mfma_f32_16x16x32_bf16 v[108:111], v[68:71], v[228:231], v[108:111]
    buffer_load_dwordx4 v5, s[24:27], s15 offen offset:1024 lds
    v_mfma_f32_16x16x32_bf16 v[112:115], v[72:75], v[224:227], v[112:115]
    v_add_f32 v38, v38, v44
    v_add_f32 v39, v39, v45
    v_mfma_f32_16x16x32_bf16 v[116:119], v[72:75], v[228:231], v[116:119]
    v_cvt_pk_bf16_f32 v27, v38, v39
    ds_write_b128 v1, v[24:27]
    v_mfma_f32_16x16x32_bf16 v[120:123], v[76:79], v[224:227], v[120:123]
    v_lshlrev_b32 v38, 16, v28
    v_and_b32 v39, 0xffff0000, v28
    v_mfma_f32_16x16x32_bf16 v[124:127], v[76:79], v[228:231], v[124:127]
    v_lshlrev_b32 v44, 16, v37
    v_and_b32 v45, 0xffff0000, v37
    s_waitcnt lgkmcnt(0)
    ds_read_b128 v[64:67], v12 offset:0
    ds_read_b128 v[68:71], v12 offset:2048
    v_mfma_f32_16x16x32_bf16 v[96:99], v[80:83], v[232:235], v[96:99]
    v_mul_f32 v38, v38, v44
    v_mul_f32 v39, v39, v45
    ds_read_b128 v[72:75], v12 offset:4096
    ds_read_b128 v[76:79], v12 offset:6144
    v_mfma_f32_16x16x32_bf16 v[100:103], v[80:83], v[236:239], v[100:103]
    v_cvt_pk_bf16_f32 v46, v38, v39
    v_lshlrev_b32 v38, 16, v46
    v_mfma_f32_16x16x32_bf16 v[104:107], v[84:87], v[232:235], v[104:107]
    v_and_b32 v39, 0xffff0000, v46
    v_lshlrev_b32 v44, 16, v36
    v_mfma_f32_16x16x32_bf16 v[108:111], v[84:87], v[236:239], v[108:111]
    v_and_b32 v45, 0xffff0000, v36
    v_add_f32 v38, v38, v44
    v_mfma_f32_16x16x32_bf16 v[112:115], v[88:91], v[232:235], v[112:115]
    v_add_f32 v39, v39, v45
    v_cvt_pk_bf16_f32 v28, v38, v39
    v_mfma_f32_16x16x32_bf16 v[116:119], v[88:91], v[236:239], v[116:119]
    ds_write_b32 v2, v28
    s_lshl_b32 s3, s22, 10
    s_add_u32 s3, s3, 49152
    v_add_u32 v1, s3, v20
    v_mfma_f32_16x16x32_bf16 v[120:123], v[92:95], v[232:235], v[120:123]
    s_add_u32 s11, s16, 1024
    buffer_store_dwordx4 v[52:55], v20, s[36:39], s11 offen sc1
    v_mfma_f32_16x16x32_bf16 v[124:127], v[92:95], v[236:239], v[124:127]
    s_lshl_b32 s3, s22, 8
    s_add_u32 s3, s3, 57344
    v_add_u32 v2, s3, v20
    s_waitcnt lgkmcnt(0)
    ds_read_b128 v[80:83], v13 offset:0
    ds_read_b128 v[84:87], v13 offset:2048
    v_mfma_f32_16x16x32_bf16 v[96:99], v[64:67], v[240:243], v[96:99]
    v_lshrrev_b32 v39, 3, v0
    v_and_b32 v44, 7, v0
    ds_read_b128 v[88:91], v13 offset:4096
    ds_read_b128 v[92:95], v13 offset:6144
    v_mfma_f32_16x16x32_bf16 v[100:103], v[64:67], v[244:247], v[100:103]
    v_xor_b32 v3, v44, v39
    v_lshlrev_b32 v3, 4, v3
    v_mfma_f32_16x16x32_bf16 v[104:107], v[68:71], v[240:243], v[104:107]
    v_lshl_add_u32 v3, v39, 8, v3
    s_lshl_b32 s3, s22, 11
    v_add_u32 v3, s3, v3
    v_mfma_f32_16x16x32_bf16 v[108:111], v[68:71], v[244:247], v[108:111]
    s_lshl_b32 s3, s22, 1
    v_add_u32 v39, s3, v39
    v_mfma_f32_16x16x32_bf16 v[112:115], v[72:75], v[240:243], v[112:115]
    v_and_b32 v45, 7, v39
    v_xor_b32 v38, v44, v45
    v_mfma_f32_16x16x32_bf16 v[116:119], v[72:75], v[244:247], v[116:119]
    v_lshlrev_b32 v38, 4, v38
    v_lshl_add_u32 v38, v39, 8, v38
    v_mfma_f32_16x16x32_bf16 v[120:123], v[76:79], v[240:243], v[120:123]
    v_add_u32 v38, 0x4000, v38
    v_lshrrev_b32 v45, 4, v0
    v_mfma_f32_16x16x32_bf16 v[124:127], v[76:79], v[244:247], v[124:127]
    v_lshl_or_b32 v38, v45, 28, v38
    s_waitcnt lgkmcnt(0)
    s_waitcnt vmcnt(12)
    s_barrier
    ds_read_b128 v[64:67], v12 offset:16384
    ds_read_b128 v[68:71], v12 offset:18432
    v_mfma_f32_16x16x32_bf16 v[96:99], v[80:83], v[248:251], v[96:99]
    ds_read_b128 v[32:35], v1
    ds_read_b128 v[40:43], v2
    ds_read_b128 v[72:75], v12 offset:20480
    ds_read_b128 v[76:79], v12 offset:22528
    v_mfma_f32_16x16x32_bf16 v[100:103], v[80:83], v[252:255], v[100:103]
    s_add_u32 m0, s12, 114688
    s_add_u32 s15, s13, 1048960
    buffer_load_dwordx4 v4, s[24:27], s15 offen lds
    v_mfma_f32_16x16x32_bf16 v[104:107], v[84:87], v[248:251], v[104:107]
    v_mfma_f32_16x16x32_bf16 v[108:111], v[84:87], v[252:255], v[108:111]
    buffer_load_dwordx4 v5, s[24:27], s15 offen offset:1024 lds
    v_mfma_f32_16x16x32_bf16 v[112:115], v[88:91], v[248:251], v[112:115]
    v_mfma_f32_16x16x32_bf16 v[116:119], v[88:91], v[252:255], v[116:119]
    v_mfma_f32_16x16x32_bf16 v[120:123], v[92:95], v[248:251], v[120:123]
    v_mfma_f32_16x16x32_bf16 v[124:127], v[92:95], v[252:255], v[124:127]
    s_waitcnt lgkmcnt(0)
    ds_read_b128 v[80:83], v13 offset:16384
    ds_read_b128 v[84:87], v13 offset:18432
    v_mfma_f32_16x16x32_bf16 v[96:99], v[64:67], v[128:131], v[96:99]
    buffer_store_dwordx4 v[32:35], v3, s[36:39], s21 offen sc1
    buffer_store_dwordx4 v[40:43], v38, s[36:39], s21 offen sc1
    ds_read_b128 v[88:91], v13 offset:20480
    ds_read_b128 v[92:95], v13 offset:22528
    v_mfma_f32_16x16x32_bf16 v[100:103], v[64:67], v[132:135], v[100:103]
    s_add_u32 m0, s12, 131072
    s_add_u32 s15, s13, 1049088
    buffer_load_dwordx4 v4, s[24:27], s15 offen lds
    v_mfma_f32_16x16x32_bf16 v[104:107], v[68:71], v[128:131], v[104:107]
    v_mfma_f32_16x16x32_bf16 v[108:111], v[68:71], v[132:135], v[108:111]
    buffer_load_dwordx4 v5, s[24:27], s15 offen offset:1024 lds
    v_mfma_f32_16x16x32_bf16 v[112:115], v[72:75], v[128:131], v[112:115]
    v_mfma_f32_16x16x32_bf16 v[116:119], v[72:75], v[132:135], v[116:119]
    v_mfma_f32_16x16x32_bf16 v[120:123], v[76:79], v[128:131], v[120:123]
    v_mfma_f32_16x16x32_bf16 v[124:127], v[76:79], v[132:135], v[124:127]
    s_waitcnt lgkmcnt(0)
    ds_read_b128 v[64:67], v8 offset:0
    ds_read_b128 v[68:71], v8 offset:2048
    v_mfma_f32_16x16x32_bf16 v[96:99], v[80:83], v[136:139], v[96:99]
    ds_read_b128 v[72:75], v8 offset:4096
    ds_read_b128 v[76:79], v8 offset:6144
    v_mfma_f32_16x16x32_bf16 v[100:103], v[80:83], v[140:143], v[100:103]
    v_mfma_f32_16x16x32_bf16 v[104:107], v[84:87], v[136:139], v[104:107]
    v_mfma_f32_16x16x32_bf16 v[108:111], v[84:87], v[140:143], v[108:111]
    v_mfma_f32_16x16x32_bf16 v[112:115], v[88:91], v[136:139], v[112:115]
    v_mfma_f32_16x16x32_bf16 v[116:119], v[88:91], v[140:143], v[116:119]
    v_mfma_f32_16x16x32_bf16 v[120:123], v[92:95], v[136:139], v[120:123]
    s_add_u32 s11, s16, 8192
    buffer_store_dwordx4 v[56:59], v20, s[36:39], s11 offen sc1
    v_mfma_f32_16x16x32_bf16 v[124:127], v[92:95], v[140:143], v[124:127]
    s_waitcnt lgkmcnt(0)
    ds_read_b128 v[80:83], v9 offset:0
    ds_read_b128 v[84:87], v9 offset:2048
    v_mfma_f32_16x16x32_bf16 v[96:99], v[64:67], v[144:147], v[96:99]
    ds_read_b128 v[88:91], v9 offset:4096
    ds_read_b128 v[92:95], v9 offset:6144
    v_mfma_f32_16x16x32_bf16 v[100:103], v[64:67], v[148:151], v[100:103]
    v_mfma_f32_16x16x32_bf16 v[104:107], v[68:71], v[144:147], v[104:107]
    v_mfma_f32_16x16x32_bf16 v[108:111], v[68:71], v[148:151], v[108:111]
    v_mfma_f32_16x16x32_bf16 v[112:115], v[72:75], v[144:147], v[112:115]
    v_mfma_f32_16x16x32_bf16 v[116:119], v[72:75], v[148:151], v[116:119]
    v_mfma_f32_16x16x32_bf16 v[120:123], v[76:79], v[144:147], v[120:123]
    v_mfma_f32_16x16x32_bf16 v[124:127], v[76:79], v[148:151], v[124:127]
    s_waitcnt lgkmcnt(0)
    s_waitcnt vmcnt(15)
    s_barrier
    ds_read_b128 v[64:67], v8 offset:16384
    ds_read_b128 v[68:71], v8 offset:18432
    v_mfma_f32_16x16x32_bf16 v[96:99], v[80:83], v[152:155], v[96:99]
    ds_read_b128 v[72:75], v8 offset:20480
    ds_read_b128 v[76:79], v8 offset:22528
    v_mfma_f32_16x16x32_bf16 v[100:103], v[80:83], v[156:159], v[100:103]
    s_add_u32 m0, s12, 147456
    s_add_u32 s15, s13, 1049216
    buffer_load_dwordx4 v4, s[24:27], s15 offen lds
    v_mfma_f32_16x16x32_bf16 v[104:107], v[84:87], v[152:155], v[104:107]
    v_mfma_f32_16x16x32_bf16 v[108:111], v[84:87], v[156:159], v[108:111]
    buffer_load_dwordx4 v5, s[24:27], s15 offen offset:1024 lds
    v_mfma_f32_16x16x32_bf16 v[112:115], v[88:91], v[152:155], v[112:115]
    v_mfma_f32_16x16x32_bf16 v[116:119], v[88:91], v[156:159], v[116:119]
    v_mfma_f32_16x16x32_bf16 v[120:123], v[92:95], v[152:155], v[120:123]
    v_mfma_f32_16x16x32_bf16 v[124:127], v[92:95], v[156:159], v[124:127]
    s_waitcnt lgkmcnt(0)
    ds_read_b128 v[80:83], v9 offset:16384
    ds_read_b128 v[84:87], v9 offset:18432
    v_mfma_f32_16x16x32_bf16 v[96:99], v[64:67], v[160:163], v[96:99]
    ds_read_b128 v[88:91], v9 offset:20480
    ds_read_b128 v[92:95], v9 offset:22528
    v_mfma_f32_16x16x32_bf16 v[100:103], v[64:67], v[164:167], v[100:103]
    s_add_u32 m0, s12, 0
    s_add_u32 s15, s13, 1049344
    buffer_load_dwordx4 v4, s[24:27], s15 offen lds
    v_mfma_f32_16x16x32_bf16 v[104:107], v[68:71], v[160:163], v[104:107]
    v_mfma_f32_16x16x32_bf16 v[108:111], v[68:71], v[164:167], v[108:111]
    buffer_load_dwordx4 v5, s[24:27], s15 offen offset:1024 lds
    v_mfma_f32_16x16x32_bf16 v[112:115], v[72:75], v[160:163], v[112:115]
    v_mfma_f32_16x16x32_bf16 v[116:119], v[72:75], v[164:167], v[116:119]
    v_mfma_f32_16x16x32_bf16 v[120:123], v[76:79], v[160:163], v[120:123]
    v_mfma_f32_16x16x32_bf16 v[124:127], v[76:79], v[164:167], v[124:127]
    s_waitcnt lgkmcnt(0)
    ds_read_b128 v[64:67], v8 offset:32768
    ds_read_b128 v[68:71], v8 offset:34816
    v_mfma_f32_16x16x32_bf16 v[96:99], v[80:83], v[168:171], v[96:99]
    ds_read_b128 v[72:75], v8 offset:36864
    ds_read_b128 v[76:79], v8 offset:38912
    v_mfma_f32_16x16x32_bf16 v[100:103], v[80:83], v[172:175], v[100:103]
    v_mfma_f32_16x16x32_bf16 v[104:107], v[84:87], v[168:171], v[104:107]
    v_mfma_f32_16x16x32_bf16 v[108:111], v[84:87], v[172:175], v[108:111]
    v_mfma_f32_16x16x32_bf16 v[112:115], v[88:91], v[168:171], v[112:115]
    v_mfma_f32_16x16x32_bf16 v[116:119], v[88:91], v[172:175], v[116:119]
    v_mfma_f32_16x16x32_bf16 v[120:123], v[92:95], v[168:171], v[120:123]
    s_add_u32 s11, s16, 9216
    buffer_store_dwordx4 v[60:63], v20, s[36:39], s11 offen sc1
    v_mfma_f32_16x16x32_bf16 v[124:127], v[92:95], v[172:175], v[124:127]
    s_waitcnt lgkmcnt(0)
    ds_read_b128 v[80:83], v9 offset:32768
    ds_read_b128 v[84:87], v9 offset:34816
    v_mfma_f32_16x16x32_bf16 v[96:99], v[64:67], v[176:179], v[96:99]
    ds_read_b128 v[88:91], v9 offset:36864
    ds_read_b128 v[92:95], v9 offset:38912
    v_mfma_f32_16x16x32_bf16 v[100:103], v[64:67], v[180:183], v[100:103]
    v_mfma_f32_16x16x32_bf16 v[104:107], v[68:71], v[176:179], v[104:107]
    v_mfma_f32_16x16x32_bf16 v[108:111], v[68:71], v[180:183], v[108:111]
    v_mfma_f32_16x16x32_bf16 v[112:115], v[72:75], v[176:179], v[112:115]
    v_mfma_f32_16x16x32_bf16 v[116:119], v[72:75], v[180:183], v[116:119]
    s_waitcnt vmcnt(8)
    v_mfma_f32_16x16x32_bf16 v[120:123], v[76:79], v[176:179], v[120:123]
    v_mfma_f32_16x16x32_bf16 v[124:127], v[76:79], v[180:183], v[124:127]
    s_waitcnt lgkmcnt(0)
    s_waitcnt vmcnt(15)
    s_barrier
    ds_read_b128 v[64:67], v10 offset:0
    ds_read_b128 v[68:71], v10 offset:2048
    v_mfma_f32_16x16x32_bf16 v[96:99], v[80:83], v[184:187], v[96:99]
    s_lshr_b32 s3, s2, 4
    s_lshl_b32 s3, s3, 8
    ds_read_b128 v[72:75], v10 offset:4096
    ds_read_b128 v[76:79], v10 offset:6144
    v_mfma_f32_16x16x32_bf16 v[100:103], v[80:83], v[188:191], v[100:103]
    s_add_u32 m0, s12, 16384
    s_add_u32 s15, s13, 1049472
    buffer_load_dwordx4 v4, s[24:27], s15 offen lds
    v_mfma_f32_16x16x32_bf16 v[104:107], v[84:87], v[184:187], v[104:107]
    s_and_b32 s18, s2, 15
    s_lshl_b32 s18, s18, 2
    v_mfma_f32_16x16x32_bf16 v[108:111], v[84:87], v[188:191], v[108:111]
    buffer_load_dwordx4 v5, s[24:27], s15 offen offset:1024 lds
    v_mfma_f32_16x16x32_bf16 v[112:115], v[88:91], v[184:187], v[112:115]
    s_add_u32 s3, s3, s18
    s_add_u32 s3, s3, 83951616
    v_mfma_f32_16x16x32_bf16 v[116:119], v[88:91], v[188:191], v[116:119]
    buffer_store_dword v30, v22, s[36:39], s3 offen sc1
    v_xor_b32 v32, 0, v47
    v_mfma_f32_16x16x32_bf16 v[120:123], v[92:95], v[184:187], v[120:123]
    v_xor_b32 v33, 32, v47
    v_xor_b32 v34, 64, v47
    v_mfma_f32_16x16x32_bf16 v[124:127], v[92:95], v[188:191], v[124:127]
    v_xor_b32 v35, 96, v47
    v_xor_b32 v36, 128, v47
    s_waitcnt lgkmcnt(0)
    v_cvt_pk_bf16_f32 v48, v96, v97
    v_cvt_pk_bf16_f32 v49, v98, v99
    v_cvt_pk_bf16_f32 v50, v104, v105
    v_cvt_pk_bf16_f32 v51, v106, v107
    v_cvt_pk_bf16_f32 v52, v100, v101
    v_cvt_pk_bf16_f32 v53, v102, v103
    v_cvt_pk_bf16_f32 v54, v108, v109
    v_cvt_pk_bf16_f32 v55, v110, v111
    ds_read_b128 v[80:83], v11 offset:0
    ds_read_b128 v[84:87], v11 offset:2048
    v_mfma_f32_16x16x32_bf16 v[96:99], v[64:67], v[192:195], 0
    ds_read_b128 v[88:91], v11 offset:4096
    ds_read_b128 v[92:95], v11 offset:6144
    v_mfma_f32_16x16x32_bf16 v[100:103], v[64:67], v[196:199], 0
    s_add_u32 m0, s12, 32768
    s_add_u32 s15, s13, 1572864
    buffer_load_dwordx4 v4, s[24:27], s15 offen lds
    v_mfma_f32_16x16x32_bf16 v[104:107], v[68:71], v[192:195], 0
    v_mfma_f32_16x16x32_bf16 v[108:111], v[68:71], v[196:199], 0
    buffer_load_dwordx4 v5, s[24:27], s15 offen offset:1024 lds
    v_cvt_pk_bf16_f32 v56, v112, v113
    v_cvt_pk_bf16_f32 v57, v114, v115
    v_cvt_pk_bf16_f32 v58, v120, v121
    v_cvt_pk_bf16_f32 v59, v122, v123
    v_cvt_pk_bf16_f32 v60, v116, v117
    v_cvt_pk_bf16_f32 v61, v118, v119
    v_cvt_pk_bf16_f32 v62, v124, v125
    v_cvt_pk_bf16_f32 v63, v126, v127
    v_mfma_f32_16x16x32_bf16 v[112:115], v[72:75], v[192:195], 0
    v_mfma_f32_16x16x32_bf16 v[116:119], v[72:75], v[196:199], 0
    v_mfma_f32_16x16x32_bf16 v[120:123], v[76:79], v[192:195], 0
    v_mfma_f32_16x16x32_bf16 v[124:127], v[76:79], v[196:199], 0
    s_waitcnt lgkmcnt(0)
    ds_read_b128 v[64:67], v10 offset:16384
    ds_read_b128 v[68:71], v10 offset:18432
    v_mfma_f32_16x16x32_bf16 v[96:99], v[80:83], v[200:203], v[96:99]
    v_xor_b32 v37, 160, v47
    v_xor_b32 v38, 192, v47
    ds_read_b128 v[72:75], v10 offset:20480
    ds_read_b128 v[76:79], v10 offset:22528
    v_mfma_f32_16x16x32_bf16 v[100:103], v[80:83], v[204:207], v[100:103]
    s_add_u32 m0, s12, 49152
    s_add_u32 s15, s13, 1572992
    buffer_load_dwordx4 v4, s[24:27], s15 offen lds
    v_mfma_f32_16x16x32_bf16 v[104:107], v[84:87], v[200:203], v[104:107]
    v_xor_b32 v39, 224, v47
    buffer_load_dword v29, v22, s[44:47], 0 offen offset:128 sc1
    v_mfma_f32_16x16x32_bf16 v[108:111], v[84:87], v[204:207], v[108:111]
    buffer_load_dwordx4 v5, s[24:27], s15 offen offset:1024 lds
    v_mfma_f32_16x16x32_bf16 v[112:115], v[88:91], v[200:203], v[112:115]
    v_mfma_f32_16x16x32_bf16 v[116:119], v[88:91], v[204:207], v[116:119]
    v_mfma_f32_16x16x32_bf16 v[120:123], v[92:95], v[200:203], v[120:123]
    s_add_u32 s11, s16, 262144
    buffer_store_dwordx4 v[48:51], v20, s[36:39], s11 offen sc1
    v_mfma_f32_16x16x32_bf16 v[124:127], v[92:95], v[204:207], v[124:127]
    s_waitcnt lgkmcnt(0)
    ds_read_b128 v[80:83], v11 offset:16384
    ds_read_b128 v[84:87], v11 offset:18432
    v_mfma_f32_16x16x32_bf16 v[96:99], v[64:67], v[208:211], v[96:99]
    ds_read_b128 v[88:91], v11 offset:20480
    ds_read_b128 v[92:95], v11 offset:22528
    v_mfma_f32_16x16x32_bf16 v[100:103], v[64:67], v[212:215], v[100:103]
    v_mfma_f32_16x16x32_bf16 v[104:107], v[68:71], v[208:211], v[104:107]
    v_mfma_f32_16x16x32_bf16 v[108:111], v[68:71], v[212:215], v[108:111]
    v_mfma_f32_16x16x32_bf16 v[112:115], v[72:75], v[208:211], v[112:115]
    v_mfma_f32_16x16x32_bf16 v[116:119], v[72:75], v[212:215], v[116:119]
    v_mfma_f32_16x16x32_bf16 v[120:123], v[76:79], v[208:211], v[120:123]
    v_mfma_f32_16x16x32_bf16 v[124:127], v[76:79], v[212:215], v[124:127]
    s_waitcnt lgkmcnt(0)
    s_waitcnt vmcnt(19)
    s_barrier
    ds_read_b128 v[64:67], v10 offset:32768
    ds_read_b128 v[68:71], v10 offset:34816
    v_mfma_f32_16x16x32_bf16 v[96:99], v[80:83], v[216:219], v[96:99]
    ds_read_b128 v[72:75], v10 offset:36864
    ds_read_b128 v[76:79], v10 offset:38912
    v_mfma_f32_16x16x32_bf16 v[100:103], v[80:83], v[220:223], v[100:103]
    s_add_u32 m0, s12, 65536
    s_add_u32 s15, s13, 1573120
    buffer_load_dwordx4 v4, s[24:27], s15 offen lds
    v_mfma_f32_16x16x32_bf16 v[104:107], v[84:87], v[216:219], v[104:107]
    v_mfma_f32_16x16x32_bf16 v[108:111], v[84:87], v[220:223], v[108:111]
    buffer_load_dwordx4 v5, s[24:27], s15 offen offset:1024 lds
    v_mfma_f32_16x16x32_bf16 v[112:115], v[88:91], v[216:219], v[112:115]
    v_mfma_f32_16x16x32_bf16 v[116:119], v[88:91], v[220:223], v[116:119]
    v_mfma_f32_16x16x32_bf16 v[120:123], v[92:95], v[216:219], v[120:123]
    v_mfma_f32_16x16x32_bf16 v[124:127], v[92:95], v[220:223], v[124:127]
    s_waitcnt lgkmcnt(0)
    ds_read_b128 v[80:83], v11 offset:32768
    ds_read_b128 v[84:87], v11 offset:34816
    v_mfma_f32_16x16x32_bf16 v[96:99], v[64:67], v[224:227], v[96:99]
    ds_read_b128 v[88:91], v11 offset:36864
    ds_read_b128 v[92:95], v11 offset:38912
    v_mfma_f32_16x16x32_bf16 v[100:103], v[64:67], v[228:231], v[100:103]
    s_add_u32 m0, s12, 81920
    s_add_u32 s15, s13, 1573248
    buffer_load_dwordx4 v4, s[24:27], s15 offen lds
    v_mfma_f32_16x16x32_bf16 v[104:107], v[68:71], v[224:227], v[104:107]
    v_mfma_f32_16x16x32_bf16 v[108:111], v[68:71], v[228:231], v[108:111]
    buffer_load_dwordx4 v5, s[24:27], s15 offen offset:1024 lds
    v_mfma_f32_16x16x32_bf16 v[112:115], v[72:75], v[224:227], v[112:115]
    v_mfma_f32_16x16x32_bf16 v[116:119], v[72:75], v[228:231], v[116:119]
    v_mfma_f32_16x16x32_bf16 v[120:123], v[76:79], v[224:227], v[120:123]
    v_mfma_f32_16x16x32_bf16 v[124:127], v[76:79], v[228:231], v[124:127]
    s_waitcnt lgkmcnt(0)
    ds_read_b128 v[64:67], v10 offset:49152
    ds_read_b128 v[68:71], v10 offset:51200
    v_mfma_f32_16x16x32_bf16 v[96:99], v[80:83], v[232:235], v[96:99]
    ds_read_b128 v[72:75], v10 offset:53248
    ds_read_b128 v[76:79], v10 offset:55296
    v_mfma_f32_16x16x32_bf16 v[100:103], v[80:83], v[236:239], v[100:103]
    v_mfma_f32_16x16x32_bf16 v[104:107], v[84:87], v[232:235], v[104:107]
    v_mfma_f32_16x16x32_bf16 v[108:111], v[84:87], v[236:239], v[108:111]
    v_mfma_f32_16x16x32_bf16 v[112:115], v[88:91], v[232:235], v[112:115]
    v_mfma_f32_16x16x32_bf16 v[116:119], v[88:91], v[236:239], v[116:119]
    v_mfma_f32_16x16x32_bf16 v[120:123], v[92:95], v[232:235], v[120:123]
    s_add_u32 s11, s16, 263168
    buffer_store_dwordx4 v[52:55], v20, s[36:39], s11 offen sc1
    v_mfma_f32_16x16x32_bf16 v[124:127], v[92:95], v[236:239], v[124:127]
    s_waitcnt lgkmcnt(0)
    ds_read_b128 v[80:83], v11 offset:49152
    ds_read_b128 v[84:87], v11 offset:51200
    v_mfma_f32_16x16x32_bf16 v[96:99], v[64:67], v[240:243], v[96:99]
    ds_read_b128 v[88:91], v11 offset:53248
    ds_read_b128 v[92:95], v11 offset:55296
    v_mfma_f32_16x16x32_bf16 v[100:103], v[64:67], v[244:247], v[100:103]
    v_mfma_f32_16x16x32_bf16 v[104:107], v[68:71], v[240:243], v[104:107]
    v_mfma_f32_16x16x32_bf16 v[108:111], v[68:71], v[244:247], v[108:111]
    v_mfma_f32_16x16x32_bf16 v[112:115], v[72:75], v[240:243], v[112:115]
    v_mfma_f32_16x16x32_bf16 v[116:119], v[72:75], v[244:247], v[116:119]
    s_waitcnt vmcnt(7)
    v_readfirstlane_b32 s3, v29
    s_nop 0
    s_or_b32 s3, s3, s60
    s_cmp_ge_u32 s3, 160
    s_cbranch_scc0 k1_spin11
k1_back12:
    v_mfma_f32_16x16x32_bf16 v[120:123], v[76:79], v[240:243], v[120:123]
    v_mfma_f32_16x16x32_bf16 v[124:127], v[76:79], v[244:247], v[124:127]
    s_waitcnt lgkmcnt(0)
    s_waitcnt vmcnt(17)
    s_barrier
    ds_read_b128 v[64:67], v12 offset:0
    ds_read_b128 v[68:71], v12 offset:2048
    v_mfma_f32_16x16x32_bf16 v[96:99], v[80:83], v[248:251], v[96:99]
    ds_read_b128 v[72:75], v12 offset:4096
    ds_read_b128 v[76:79], v12 offset:6144
    v_mfma_f32_16x16x32_bf16 v[100:103], v[80:83], v[252:255], v[100:103]
    s_add_u32 m0, s12, 98304
    s_add_u32 s15, s13, 1573376
    buffer_load_dwordx4 v4, s[24:27], s15 offen lds
    v_mfma_f32_16x16x32_bf16 v[104:107], v[84:87], v[248:251], v[104:107]
    v_mfma_f32_16x16x32_bf16 v[108:111], v[84:87], v[252:255], v[108:111]
    buffer_load_dwordx4 v5, s[24:27], s15 offen offset:1024 lds
    v_mfma_f32_16x16x32_bf16 v[112:115], v[88:91], v[248:251], v[112:115]
    v_mfma_f32_16x16x32_bf16 v[116:119], v[88:91], v[252:255], v[116:119]
    v_mfma_f32_16x16x32_bf16 v[120:123], v[92:95], v[248:251], v[120:123]
    v_mfma_f32_16x16x32_bf16 v[124:127], v[92:95], v[252:255], v[124:127]
    s_waitcnt lgkmcnt(0)
    ds_read_b128 v[80:83], v13 offset:0
    ds_read_b128 v[84:87], v13 offset:2048
    v_mfma_f32_16x16x32_bf16 v[96:99], v[64:67], v[128:131], v[96:99]
    s_lshl_b32 s18, s23, 8
    s_add_u32 s18, s18, 83951616
    ds_read_b128 v[88:91], v13 offset:4096
    ds_read_b128 v[92:95], v13 offset:6144
    v_mfma_f32_16x16x32_bf16 v[100:103], v[64:67], v[132:135], v[100:103]
    s_add_u32 m0, s12, 114688
    s_add_u32 s15, s13, 1573504
    buffer_load_dwordx4 v4, s[24:27], s15 offen lds
    v_mfma_f32_16x16x32_bf16 v[104:107], v[68:71], v[128:131], v[104:107]
    buffer_load_dword v29, v23, s[36:39], s18 offen sc1
    v_mfma_f32_16x16x32_bf16 v[108:111], v[68:71], v[132:135], v[108:111]
    buffer_load_dwordx4 v5, s[24:27], s15 offen offset:1024 lds
    v_mfma_f32_16x16x32_bf16 v[112:115], v[72:75], v[128:131], v[112:115]
    v_mfma_f32_16x16x32_bf16 v[116:119], v[72:75], v[132:135], v[116:119]
    v_mfma_f32_16x16x32_bf16 v[120:123], v[76:79], v[128:131], v[120:123]
    v_mfma_f32_16x16x32_bf16 v[124:127], v[76:79], v[132:135], v[124:127]
    s_waitcnt lgkmcnt(0)
    ds_read_b128 v[64:67], v12 offset:16384
    ds_read_b128 v[68:71], v12 offset:18432
    v_mfma_f32_16x16x32_bf16 v[96:99], v[80:83], v[136:139], v[96:99]
    ds_read_b128 v[72:75], v12 offset:20480
    ds_read_b128 v[76:79], v12 offset:22528
    v_mfma_f32_16x16x32_bf16 v[100:103], v[80:83], v[140:143], v[100:103]
    v_mfma_f32_16x16x32_bf16 v[104:107], v[84:87], v[136:139], v[104:107]
    v_mfma_f32_16x16x32_bf16 v[108:111], v[84:87], v[140:143], v[108:111]
    v_mfma_f32_16x16x32_bf16 v[112:115], v[88:91], v[136:139], v[112:115]
    v_mfma_f32_16x16x32_bf16 v[116:119], v[88:91], v[140:143], v[116:119]
    v_mfma_f32_16x16x32_bf16 v[120:123], v[92:95], v[136:139], v[120:123]
    s_add_u32 s11, s16, 270336
    buffer_store_dwordx4 v[56:59], v20, s[36:39], s11 offen sc1
    v_mfma_f32_16x16x32_bf16 v[124:127], v[92:95], v[140:143], v[124:127]
    s_waitcnt lgkmcnt(0)
    ds_read_b128 v[80:83], v13 offset:16384
    ds_read_b128 v[84:87], v13 offset:18432
    v_mfma_f32_16x16x32_bf16 v[96:99], v[64:67], v[144:147], v[96:99]
    ds_read_b128 v[88:91], v13 offset:20480
    ds_read_b128 v[92:95], v13 offset:22528
    v_mfma_f32_16x16x32_bf16 v[100:103], v[64:67], v[148:151], v[100:103]
    v_mfma_f32_16x16x32_bf16 v[104:107], v[68:71], v[144:147], v[104:107]
    v_mfma_f32_16x16x32_bf16 v[108:111], v[68:71], v[148:151], v[108:111]
    v_mfma_f32_16x16x32_bf16 v[112:115], v[72:75], v[144:147], v[112:115]
    v_mfma_f32_16x16x32_bf16 v[116:119], v[72:75], v[148:151], v[116:119]
    v_mfma_f32_16x16x32_bf16 v[120:123], v[76:79], v[144:147], v[120:123]
    v_mfma_f32_16x16x32_bf16 v[124:127], v[76:79], v[148:151], v[124:127]
    s_waitcnt lgkmcnt(0)
    s_waitcnt vmcnt(18)
    s_barrier
    ds_read_b128 v[64:67], v8 offset:0
    ds_read_b128 v[68:71], v8 offset:2048
    v_mfma_f32_16x16x32_bf16 v[96:99], v[80:83], v[152:155], v[96:99]
    ds_read_b128 v[72:75], v8 offset:4096
    ds_read_b128 v[76:79], v8 offset:6144
    v_mfma_f32_16x16x32_bf16 v[100:103], v[80:83], v[156:159], v[100:103]
    s_add_u32 m0, s12, 131072
    s_add_u32 s15, s13, 1573632
    buffer_load_dwordx4 v4, s[24:27], s15 offen lds
    v_mfma_f32_16x16x32_bf16 v[104:107], v[84:87], v[152:155], v[104:107]
    v_mfma_f32_16x16x32_bf16 v[108:111], v[84:87], v[156:159], v[108:111]
    buffer_load_dwordx4 v5, s[24:27], s15 offen offset:1024 lds
    v_mfma_f32_16x16x32_bf16 v[112:115], v[88:91], v[152:155], v[112:115]
    v_mfma_f32_16x16x32_bf16 v[116:119], v[88:91], v[156:159], v[116:119]
    v_mfma_f32_16x16x32_bf16 v[120:123], v[92:95], v[152:155], v[120:123]
    v_mfma_f32_16x16x32_bf16 v[124:127], v[92:95], v[156:159], v[124:127]
    s_waitcnt lgkmcnt(0)
    ds_read_b128 v[80:83], v9 offset:0
    ds_read_b128 v[84:87], v9 offset:2048
    v_mfma_f32_16x16x32_bf16 v[96:99], v[64:67], v[160:163], v[96:99]
    ds_read_b128 v[88:91], v9 offset:4096
    ds_read_b128 v[92:95], v9 offset:6144
    v_mfma_f32_16x16x32_bf16 v[100:103], v[64:67], v[164:167], v[100:103]
    s_add_u32 m0, s12, 147456
    s_add_u32 s15, s13, 1573760
    buffer_load_dwordx4 v4, s[24:27], s15 offen lds
    v_mfma_f32_16x16x32_bf16 v[104:107], v[68:71], v[160:163], v[104:107]
    v_mfma_f32_16x16x32_bf16 v[108:111], v[68:71], v[164:167], v[108:111]
    buffer_load_dwordx4 v5, s[24:27], s15 offen offset:1024 lds
    v_mfma_f32_16x16x32_bf16 v[112:115], v[72:75], v[160:163], v[112:115]
    v_mfma_f32_16x16x32_bf16 v[116:119], v[72:75], v[164:167], v[116:119]
    v_mfma_f32_16x16x32_bf16 v[120:123], v[76:79], v[160:163], v[120:123]
    v_mfma_f32_16x16x32_bf16 v[124:127], v[76:79], v[164:167], v[124:127]
    s_waitcnt lgkmcnt(0)
    ds_read_b128 v[64:67], v8 offset:16384
    ds_read_b128 v[68:71], v8 offset:18432
    v_mfma_f32_16x16x32_bf16 v[96:99], v[80:83], v[168:171], v[96:99]
    ds_read_b128 v[72:75], v8 offset:20480
    ds_read_b128 v[76:79], v8 offset:22528
    v_mfma_f32_16x16x32_bf16 v[100:103], v[80:83], v[172:175], v[100:103]
    v_mfma_f32_16x16x32_bf16 v[104:107], v[84:87], v[168:171], v[104:107]
    v_mfma_f32_16x16x32_bf16 v[108:111], v[84:87], v[172:175], v[108:111]
    v_mfma_f32_16x16x32_bf16 v[112:115], v[88:91], v[168:171], v[112:115]
    v_mfma_f32_16x16x32_bf16 v[116:119], v[88:91], v[172:175], v[116:119]
    v_mfma_f32_16x16x32_bf16 v[120:123], v[92:95], v[168:171], v[120:123]
    s_add_u32 s11, s16, 271360
    buffer_store_dwordx4 v[60:63], v20, s[36:39], s11 offen sc1
    v_mfma_f32_16x16x32_bf16 v[124:127], v[92:95], v[172:175], v[124:127]
    s_waitcnt lgkmcnt(0)
    ds_read_b128 v[80:83], v9 offset:16384
    ds_read_b128 v[84:87], v9 offset:18432
    v_mfma_f32_16x16x32_bf16 v[96:99], v[64:67], v[176:179], v[96:99]
    ds_read_b128 v[88:91], v9 offset:20480
    ds_read_b128 v[92:95], v9 offset:22528
    v_mfma_f32_16x16x32_bf16 v[100:103], v[64:67], v[180:183], v[100:103]
    v_mfma_f32_16x16x32_bf16 v[104:107], v[68:71], v[176:179], v[104:107]
    v_mfma_f32_16x16x32_bf16 v[108:111], v[68:71], v[180:183], v[108:111]
    v_mfma_f32_16x16x32_bf16 v[112:115], v[72:75], v[176:179], v[112:115]
    v_mfma_f32_16x16x32_bf16 v[116:119], v[72:75], v[180:183], v[116:119]
    s_waitcnt vmcnt(7)
    v_cmp_le_u32 vcc, 1, v29
    s_nop 0
    s_or_b32 s3, vcc_lo, s19
    s_and_b32 s3, s3, 65535
    s_cmp_eq_u32 s3, 65535
    s_cbranch_scc0 k1_spin13
k1_back14:
    v_mfma_f32_16x16x32_bf16 v[120:123], v[76:79], v[176:179], v[120:123]
    v_mfma_f32_16x16x32_bf16 v[124:127], v[76:79], v[180:183], v[124:127]
    s_waitcnt lgkmcnt(0)
    s_waitcnt vmcnt(17)
    s_barrier
    ds_read_b128 v[64:67], v8 offset:32768
    ds_read_b128 v[68:71], v8 offset:34816
    v_mfma_f32_16x16x32_bf16 v[96:99], v[80:83], v[184:187], v[96:99]
    s_lshl_b32 s18, s6, 8
    s_add_u32 s18, s18, 83955712
    ds_read_b128 v[72:75], v8 offset:36864
    ds_read_b128 v[76:79], v8 offset:38912
    v_mfma_f32_16x16x32_bf16 v[100:103], v[80:83], v[188:191], v[100:103]
    s_add_u32 m0, s12, 0
    s_add_u32 s15, s14, 0
    buffer_load_dwordx4 v6, s[32:35], s15 offen lds
    v_mfma_f32_16x16x32_bf16 v[104:107], v[84:87], v[184:187], v[104:107]
    s_lshl_b32 s17, s9, 2
    s_add_u32 s17, s17, s18
    v_mfma_f32_16x16x32_bf16 v[108:111], v[84:87], v[188:191], v[108:111]
    buffer_load_dwordx4 v7, s[32:35], s15 offen offset:1024 lds
    v_mfma_f32_16x16x32_bf16 v[112:115], v[88:91], v[184:187], v[112:115]
    v_mov_b32 v24, 2
    v_mfma_f32_16x16x32_bf16 v[116:119], v[88:91], v[188:191], v[116:119]
    v_mfma_f32_16x16x32_bf16 v[120:123], v[92:95], v[184:187], v[120:123]
    v_mfma_f32_16x16x32_bf16 v[124:127], v[92:95], v[188:191], v[124:127]
    s_waitcnt lgkmcnt(0)
    v_cvt_pk_bf16_f32 v48, v96, v97
    v_cvt_pk_bf16_f32 v49, v98, v99
    v_cvt_pk_bf16_f32 v50, v104, v105
    v_cvt_pk_bf16_f32 v51, v106, v107
    v_cvt_pk_bf16_f32 v52, v100, v101
    v_cvt_pk_bf16_f32 v53, v102, v103
    v_cvt_pk_bf16_f32 v54, v108, v109
    v_cvt_pk_bf16_f32 v55, v110, v111
    ds_read_b128 v[80:83], v9 offset:32768
    ds_read_b128 v[84:87], v9 offset:34816
    v_mfma_f32_16x16x32_bf16 v[96:99], v[64:67], v[192:195], 0
    ds_read_b128 v[88:91], v9 offset:36864
    ds_read_b128 v[92:95], v9 offset:38912
    v_mfma_f32_16x16x32_bf16 v[100:103], v[64:67], v[196:199], 0
    s_add_u32 m0, s12, 16384
    s_add_u32 s15, s14, 524288
    buffer_load_dwordx4 v6, s[32:35], s15 offen lds
    v_mfma_f32_16x16x32_bf16 v[104:107], v[68:71], v[192:195], 0
    v_mfma_f32_16x16x32_bf16 v[108:111], v[68:71], v[196:199], 0
    buffer_load_dwordx4 v7, s[32:35], s15 offen offset:1024 lds
    v_cvt_pk_bf16_f32 v56, v112, v113
    v_cvt_pk_bf16_f32 v57, v114, v115
    v_cvt_pk_bf16_f32 v58, v120, v121
    v_cvt_pk_bf16_f32 v59, v122, v123
    v_cvt_pk_bf16_f32 v60, v116, v117
    v_cvt_pk_bf16_f32 v61, v118, v119
    v_cvt_pk_bf16_f32 v62, v124, v125
    v_cvt_pk_bf16_f32 v63, v126, v127
    v_mfma_f32_16x16x32_bf16 v[112:115], v[72:75], v[192:195], 0
    v_mfma_f32_16x16x32_bf16 v[116:119], v[72:75], v[196:199], 0
    v_mfma_f32_16x16x32_bf16 v[120:123], v[76:79], v[192:195], 0
    v_mfma_f32_16x16x32_bf16 v[124:127], v[76:79], v[196:199], 0
    s_waitcnt lgkmcnt(0)
    ds_read_b128 v[64:67], v8 offset:49152
    ds_read_b128 v[68:71], v8 offset:51200
    v_mfma_f32_16x16x32_bf16 v[96:99], v[80:83], v[200:203], v[96:99]
    s_add_u32 s61, s20, 0
    buffer_load_dwordx4 v[192:195], v20, s[36:39], s61 offen sc1
    s_add_u32 s61, s20, 20480
    buffer_load_dwordx4 v[196:199], v20, s[36:39], s61 offen sc1
    ds_read_b128 v[72:75], v8 offset:53248
    ds_read_b128 v[76:79], v8 offset:55296
    v_mfma_f32_16x16x32_bf16 v[100:103], v[80:83], v[204:207], v[100:103]
    v_mfma_f32_16x16x32_bf16 v[104:107], v[84:87], v[200:203], v[104:107]
    v_mfma_f32_16x16x32_bf16 v[108:111], v[84:87], v[204:207], v[108:111]
    v_mfma_f32_16x16x32_bf16 v[112:115], v[88:91], v[200:203], v[112:115]
    v_mfma_f32_16x16x32_bf16 v[116:119], v[88:91], v[204:207], v[116:119]
    v_mfma_f32_16x16x32_bf16 v[120:123], v[92:95], v[200:203], v[120:123]
    s_add_u32 s11, s16, 524288
    buffer_store_dwordx4 v[48:51], v20, s[36:39], s11 offen sc1
    v_mfma_f32_16x16x32_bf16 v[124:127], v[92:95], v[204:207], v[124:127]
    s_waitcnt lgkmcnt(0)
    ds_read_b128 v[80:83], v9 offset:49152
    ds_read_b128 v[84:87], v9 offset:51200
    v_mfma_f32_16x16x32_bf16 v[96:99], v[64:67], v[208:211], v[96:99]
    s_add_u32 s61, s20, 1024
    buffer_load_dwordx4 v[200:203], v20, s[36:39], s61 offen sc1
    s_add_u32 s61, s20, 21504
    buffer_load_dwordx4 v[204:207], v20, s[36:39], s61 offen sc1
    ds_read_b128 v[88:91], v9 offset:53248
    ds_read_b128 v[92:95], v9 offset:55296
    v_mfma_f32_16x16x32_bf16 v[100:103], v[64:67], v[212:215], v[100:103]
    v_mfma_f32_16x16x32_bf16 v[104:107], v[68:71], v[208:211], v[104:107]
    v_mfma_f32_16x16x32_bf16 v[108:111], v[68:71], v[212:215], v[108:111]
    v_mfma_f32_16x16x32_bf16 v[112:115], v[72:75], v[208:211], v[112:115]
    v_mfma_f32_16x16x32_bf16 v[116:119], v[72:75], v[212:215], v[116:119]
    s_waitcnt vmcnt(9)
    v_mfma_f32_16x16x32_bf16 v[120:123], v[76:79], v[208:211], v[120:123]
    v_mfma_f32_16x16x32_bf16 v[124:127], v[76:79], v[212:215], v[124:127]
    s_waitcnt lgkmcnt(0)
    s_waitcnt vmcnt(21)
    s_barrier
    ds_read_b128 v[64:67], v10 offset:0
    ds_read_b128 v[68:71], v10 offset:2048
    v_mfma_f32_16x16x32_bf16 v[96:99], v[80:83], v[216:219], v[96:99]
    buffer_store_dword v30, v22, s[36:39], s17 offen sc1
    s_add_u32 s61, s20, 2048
    buffer_load_dwordx4 v[208:211], v20, s[36:39], s61 offen sc1
    ds_read_b128 v[72:75], v10 offset:4096
    ds_read_b128 v[76:79], v10 offset:6144
    v_mfma_f32_16x16x32_bf16 v[100:103], v[80:83], v[220:223], v[100:103]
    s_add_u32 m0, s12, 32768
    s_add_u32 s15, s14, 1048576
    buffer_load_dwordx4 v6, s[32:35], s15 offen lds
    v_mfma_f32_16x16x32_bf16 v[104:107], v[84:87], v[216:219], v[104:107]
    s_add_u32 s61, s20, 22528
    buffer_load_dwordx4 v[212:215], v20, s[36:39], s61 offen sc1
    v_mfma_f32_16x16x32_bf16 v[108:111], v[84:87], v[220:223], v[108:111]
    buffer_load_dwordx4 v7, s[32:35], s15 offen offset:1024 lds
    v_mfma_f32_16x16x32_bf16 v[112:115], v[88:91], v[216:219], v[112:115]
    v_mfma_f32_16x16x32_bf16 v[116:119], v[88:91], v[220:223], v[116:119]
    v_mfma_f32_16x16x32_bf16 v[120:123], v[92:95], v[216:219], v[120:123]
    v_mfma_f32_16x16x32_bf16 v[124:127], v[92:95], v[220:223], v[124:127]
    s_waitcnt lgkmcnt(0)
    ds_read_b128 v[80:83], v11 offset:0
    ds_read_b128 v[84:87], v11 offset:2048
    v_mfma_f32_16x16x32_bf16 v[96:99], v[64:67], v[224:227], v[96:99]
    s_add_u32 s61, s20, 3072
    buffer_load_dwordx4 v[216:219], v20, s[36:39], s61 offen sc1
    s_add_u32 s61, s20, 23552
    buffer_load_dwordx4 v[220:223], v20, s[36:39], s61 offen sc1
    ds_read_b128 v[88:91], v11 offset:4096
    ds_read_b128 v[92:95], v11 offset:6144
    v_mfma_f32_16x16x32_bf16 v[100:103], v[64:67], v[228:231], v[100:103]
    s_add_u32 m0, s12, 49152
    s_add_u32 s15, s14, 1572864
    buffer_load_dwordx4 v6, s[32:35], s15 offen lds
    v_mfma_f32_16x16x32_bf16 v[104:107], v[68:71], v[224:227], v[104:107]
    v_mfma_f32_16x16x32_bf16 v[108:111], v[68:71], v[228:231], v[108:111]
    buffer_load_dwordx4 v7, s[32:35], s15 offen offset:1024 lds
    v_mfma_f32_16x16x32_bf16 v[112:115], v[72:75], v[224:227], v[112:115]
    v_mfma_f32_16x16x32_bf16 v[116:119], v[72:75], v[228:231], v[116:119]
    v_mfma_f32_16x16x32_bf16 v[120:123], v[76:79], v[224:227], v[120:123]
    v_mfma_f32_16x16x32_bf16 v[124:127], v[76:79], v[228:231], v[124:127]
    s_waitcnt lgkmcnt(0)
    ds_read_b128 v[64:67], v10 offset:16384
    ds_read_b128 v[68:71], v10 offset:18432
    v_mfma_f32_16x16x32_bf16 v[96:99], v[80:83], v[232:235], v[96:99]
    s_add_u32 s61, s20, 4096
    buffer_load_dwordx4 v[224:227], v20, s[36:39], s61 offen sc1
    s_add_u32 s61, s20, 24576
    buffer_load_dwordx4 v[228:231], v20, s[36:39], s61 offen sc1
    ds_read_b128 v[72:75], v10 offset:20480
    ds_read_b128 v[76:79], v10 offset:22528
    v_mfma_f32_16x16x32_bf16 v[100:103], v[80:83], v[236:239], v[100:103]
    v_mfma_f32_16x16x32_bf16 v[104:107], v[84:87], v[232:235], v[104:107]
    v_mfma_f32_16x16x32_bf16 v[108:111], v[84:87], v[236:239], v[108:111]
    v_mfma_f32_16x16x32_bf16 v[112:115], v[88:91], v[232:235], v[112:115]
    v_mfma_f32_16x16x32_bf16 v[116:119], v[88:91], v[236:239], v[116:119]
    v_mfma_f32_16x16x32_bf16 v[120:123], v[92:95], v[232:235], v[120:123]
    s_add_u32 s11, s16, 525312
    buffer_store_dwordx4 v[52:55], v20, s[36:39], s11 offen sc1
    v_mfma_f32_16x16x32_bf16 v[124:127], v[92:95], v[236:239], v[124:127]
    s_waitcnt lgkmcnt(0)
    ds_read_b128 v[80:83], v11 offset:16384
    ds_read_b128 v[84:87], v11 offset:18432
    v_mfma_f32_16x16x32_bf16 v[96:99], v[64:67], v[240:243], v[96:99]
    s_add_u32 s61, s20, 5120
    buffer_load_dwordx4 v[232:235], v20, s[36:39], s61 offen sc1
    s_add_u32 s61, s20, 25600
    buffer_load_dwordx4 v[236:239], v20, s[36:39], s61 offen sc1
    ds_read_b128 v[88:91], v11 offset:20480
    ds_read_b128 v[92:95], v11 offset:22528
    v_mfma_f32_16x16x32_bf16 v[100:103], v[64:67], v[244:247], v[100:103]
    v_mfma_f32_16x16x32_bf16 v[104:107], v[68:71], v[240:243], v[104:107]
    v_mfma_f32_16x16x32_bf16 v[108:111], v[68:71], v[244:247], v[108:111]
    v_mfma_f32_16x16x32_bf16 v[112:115], v[72:75], v[240:243], v[112:115]
    v_mfma_f32_16x16x32_bf16 v[116:119], v[72:75], v[244:247], v[116:119]
    v_mfma_f32_16x16x32_bf16 v[120:123], v[76:79], v[240:243], v[120:123]
    v_mfma_f32_16x16x32_bf16 v[124:127], v[76:79], v[244:247], v[124:127]
    s_waitcnt lgkmcnt(0)
    s_waitcnt vmcnt(29)
    s_barrier
    ds_read_b128 v[64:67], v10 offset:32768
    ds_read_b128 v[68:71], v10 offset:34816
    v_mfma_f32_16x16x32_bf16 v[96:99], v[80:83], v[248:251], v[96:99]
    s_add_u32 s61, s20, 6144
    buffer_load_dwordx4 v[240:243], v20, s[36:39], s61 offen sc1
    s_add_u32 s61, s20, 26624
    buffer_load_dwordx4 v[244:247], v20, s[36:39], s61 offen sc1
    ds_read_b128 v[72:75], v10 offset:36864
    ds_read_b128 v[76:79], v10 offset:38912
    v_mfma_f32_16x16x32_bf16 v[100:103], v[80:83], v[252:255], v[100:103]
    s_add_u32 m0, s12, 65536
    s_add_u32 s15, s14, 2097152
    buffer_load_dwordx4 v6, s[32:35], s15 offen lds
    v_mfma_f32_16x16x32_bf16 v[104:107], v[84:87], v[248:251], v[104:107]
    v_mfma_f32_16x16x32_bf16 v[108:111], v[84:87], v[252:255], v[108:111]
    buffer_load_dwordx4 v7, s[32:35], s15 offen offset:1024 lds
    v_mfma_f32_16x16x32_bf16 v[112:115], v[88:91], v[248:251], v[112:115]
    v_mfma_f32_16x16x32_bf16 v[116:119], v[88:91], v[252:255], v[116:119]
    v_mfma_f32_16x16x32_bf16 v[120:123], v[92:95], v[248:251], v[120:123]
    v_mfma_f32_16x16x32_bf16 v[124:127], v[92:95], v[252:255], v[124:127]
    s_waitcnt lgkmcnt(0)
    ds_read_b128 v[80:83], v11 offset:32768
    ds_read_b128 v[84:87], v11 offset:34816
    v_mfma_f32_16x16x32_bf16 v[96:99], v[64:67], v[128:131], v[96:99]
    s_add_u32 s61, s20, 7168
    buffer_load_dwordx4 v[248:251], v20, s[36:39], s61 offen sc1
    s_add_u32 s61, s20, 27648
    buffer_load_dwordx4 v[252:255], v20, s[36:39], s61 offen sc1
    ds_read_b128 v[88:91], v11 offset:36864
    ds_read_b128 v[92:95], v11 offset:38912
    v_mfma_f32_16x16x32_bf16 v[100:103], v[64:67], v[132:135], v[100:103]
    s_add_u32 m0, s12, 81920
    s_add_u32 s15, s14, 2621440
    buffer_load_dwordx4 v6, s[32:35], s15 offen lds
    v_mfma_f32_16x16x32_bf16 v[104:107], v[68:71], v[128:131], v[104:107]
    v_mfma_f32_16x16x32_bf16 v[108:111], v[68:71], v[132:135], v[108:111]
    buffer_load_dwordx4 v7, s[32:35], s15 offen offset:1024 lds
    v_mfma_f32_16x16x32_bf16 v[112:115], v[72:75], v[128:131], v[112:115]
    v_mfma_f32_16x16x32_bf16 v[116:119], v[72:75], v[132:135], v[116:119]
    v_mfma_f32_16x16x32_bf16 v[120:123], v[76:79], v[128:131], v[120:123]
    v_mfma_f32_16x16x32_bf16 v[124:127], v[76:79], v[132:135], v[124:127]
    s_waitcnt lgkmcnt(0)
    ds_read_b128 v[64:67], v10 offset:49152
    ds_read_b128 v[68:71], v10 offset:51200
    v_mfma_f32_16x16x32_bf16 v[96:99], v[80:83], v[136:139], v[96:99]
    ds_read_b128 v[72:75], v10 offset:53248
    ds_read_b128 v[76:79], v10 offset:55296
    v_mfma_f32_16x16x32_bf16 v[100:103], v[80:83], v[140:143], v[100:103]
    v_mfma_f32_16x16x32_bf16 v[104:107], v[84:87], v[136:139], v[104:107]
    v_mfma_f32_16x16x32_bf16 v[108:111], v[84:87], v[140:143], v[108:111]
    v_mfma_f32_16x16x32_bf16 v[112:115], v[88:91], v[136:139], v[112:115]
    v_mfma_f32_16x16x32_bf16 v[116:119], v[88:91], v[140:143], v[116:119]
    v_mfma_f32_16x16x32_bf16 v[120:123], v[92:95], v[136:139], v[120:123]
    s_add_u32 s11, s16, 532480
    buffer_store_dwordx4 v[56:59], v20, s[36:39], s11 offen sc1
    v_mfma_f32_16x16x32_bf16 v[124:127], v[92:95], v[140:143], v[124:127]
    s_waitcnt lgkmcnt(0)
    ds_read_b128 v[80:83], v11 offset:49152
    ds_read_b128 v[84:87], v11 offset:51200
    v_mfma_f32_16x16x32_bf16 v[96:99], v[64:67], v[144:147], v[96:99]
    ds_read_b128 v[88:91], v11 offset:53248
    ds_read_b128 v[92:95], v11 offset:55296
    v_mfma_f32_16x16x32_bf16 v[100:103], v[64:67], v[148:151], v[100:103]
    v_mfma_f32_16x16x32_bf16 v[104:107], v[68:71], v[144:147], v[104:107]
    v_mfma_f32_16x16x32_bf16 v[108:111], v[68:71], v[148:151], v[108:111]
    v_mfma_f32_16x16x32_bf16 v[112:115], v[72:75], v[144:147], v[112:115]
    v_mfma_f32_16x16x32_bf16 v[116:119], v[72:75], v[148:151], v[116:119]
    v_mfma_f32_16x16x32_bf16 v[120:123], v[76:79], v[144:147], v[120:123]
    v_mfma_f32_16x16x32_bf16 v[124:127], v[76:79], v[148:151], v[124:127]
    s_waitcnt lgkmcnt(0)
    s_waitcnt vmcnt(33)
    s_barrier
    ds_read_b128 v[64:67], v12 offset:0
    ds_read_b128 v[68:71], v12 offset:2048
    v_mfma_f32_16x16x32_bf16 v[96:99], v[80:83], v[152:155], v[96:99]
    ds_read_b128 v[72:75], v12 offset:4096
    ds_read_b128 v[76:79], v12 offset:6144
    v_mfma_f32_16x16x32_bf16 v[100:103], v[80:83], v[156:159], v[100:103]
    s_add_u32 m0, s12, 98304
    s_add_u32 s15, s14, 3145728
    buffer_load_dwordx4 v6, s[32:35], s15 offen lds
    v_mfma_f32_16x16x32_bf16 v[104:107], v[84:87], v[152:155], v[104:107]
    v_mfma_f32_16x16x32_bf16 v[108:111], v[84:87], v[156:159], v[108:111]
    buffer_load_dwordx4 v7, s[32:35], s15 offen offset:1024 lds
    v_mfma_f32_16x16x32_bf16 v[112:115], v[88:91], v[152:155], v[112:115]
    v_mfma_f32_16x16x32_bf16 v[116:119], v[88:91], v[156:159], v[116:119]
    v_mfma_f32_16x16x32_bf16 v[120:123], v[92:95], v[152:155], v[120:123]
    v_mfma_f32_16x16x32_bf16 v[124:127], v[92:95], v[156:159], v[124:127]
    s_waitcnt lgkmcnt(0)
    ds_read_b128 v[80:83], v13 offset:0
    ds_read_b128 v[84:87], v13 offset:2048
    v_mfma_f32_16x16x32_bf16 v[96:99], v[64:67], v[160:163], v[96:99]
    ds_read_b128 v[88:91], v13 offset:4096
    ds_read_b128 v[92:95], v13 offset:6144
    v_mfma_f32_16x16x32_bf16 v[100:103], v[64:67], v[164:167], v[100:103]
    s_add_u32 m0, s12, 114688
    s_add_u32 s15, s14, 3670016
    buffer_load_dwordx4 v6, s[32:35], s15 offen lds
    v_mfma_f32_16x16x32_bf16 v[104:107], v[68:71], v[160:163], v[104:107]
    v_mfma_f32_16x16x32_bf16 v[108:111], v[68:71], v[164:167], v[108:111]
    buffer_load_dwordx4 v7, s[32:35], s15 offen offset:1024 lds
    v_mfma_f32_16x16x32_bf16 v[112:115], v[72:75], v[160:163], v[112:115]
    v_mfma_f32_16x16x32_bf16 v[116:119], v[72:75], v[164:167], v[116:119]
    v_mfma_f32_16x16x32_bf16 v[120:123], v[76:79], v[160:163], v[120:123]
    v_mfma_f32_16x16x32_bf16 v[124:127], v[76:79], v[164:167], v[124:127]
    s_waitcnt lgkmcnt(0)
    ds_read_b128 v[64:67], v12 offset:16384
    ds_read_b128 v[68:71], v12 offset:18432
    v_mfma_f32_16x16x32_bf16 v[96:99], v[80:83], v[168:171], v[96:99]
    ds_read_b128 v[72:75], v12 offset:20480
    ds_read_b128 v[76:79], v12 offset:22528
    v_mfma_f32_16x16x32_bf16 v[100:103], v[80:83], v[172:175], v[100:103]
    v_mfma_f32_16x16x32_bf16 v[104:107], v[84:87], v[168:171], v[104:107]
    v_mfma_f32_16x16x32_bf16 v[108:111], v[84:87], v[172:175], v[108:111]
    v_mfma_f32_16x16x32_bf16 v[112:115], v[88:91], v[168:171], v[112:115]
    v_mfma_f32_16x16x32_bf16 v[116:119], v[88:91], v[172:175], v[116:119]
    v_mfma_f32_16x16x32_bf16 v[120:123], v[92:95], v[168:171], v[120:123]
    s_add_u32 s11, s16, 533504
    buffer_store_dwordx4 v[60:63], v20, s[36:39], s11 offen sc1
    v_mfma_f32_16x16x32_bf16 v[124:127], v[92:95], v[172:175], v[124:127]
    s_waitcnt lgkmcnt(0)
    ds_read_b128 v[80:83], v13 offset:16384
    ds_read_b128 v[84:87], v13 offset:18432
    v_mfma_f32_16x16x32_bf16 v[96:99], v[64:67], v[176:179], v[96:99]
    ds_read_b128 v[88:91], v13 offset:20480
    ds_read_b128 v[92:95], v13 offset:22528
    v_mfma_f32_16x16x32_bf16 v[100:103], v[64:67], v[180:183], v[100:103]
    v_mfma_f32_16x16x32_bf16 v[104:107], v[68:71], v[176:179], v[104:107]
    v_mfma_f32_16x16x32_bf16 v[108:111], v[68:71], v[180:183], v[108:111]
    v_mfma_f32_16x16x32_bf16 v[112:115], v[72:75], v[176:179], v[112:115]
    v_mfma_f32_16x16x32_bf16 v[116:119], v[72:75], v[180:183], v[116:119]
    v_mfma_f32_16x16x32_bf16 v[120:123], v[76:79], v[176:179], v[120:123]
    v_mfma_f32_16x16x32_bf16 v[124:127], v[76:79], v[180:183], v[124:127]
    s_waitcnt lgkmcnt(0)
    s_waitcnt vmcnt(10)
    s_barrier
    ds_read_b64_tr_b16 v[128:129], v32 offset:0
    ds_read_b64_tr_b16 v[130:131], v32 offset:2048
    v_mfma_f32_16x16x32_bf16 v[96:99], v[80:83], v[184:187], v[96:99]
    ds_read_b64_tr_b16 v[132:133], v33 offset:0
    ds_read_b64_tr_b16 v[134:135], v33 offset:2048
    v_mfma_f32_16x16x32_bf16 v[100:103], v[80:83], v[188:191], v[100:103]
    s_add_u32 m0, s12, 131072
    s_add_u32 s15, s14, 4194304
    buffer_load_dwordx4 v6, s[32:35], s15 offen lds
    ds_read_b64_tr_b16 v[136:137], v34 offset:0
    ds_read_b64_tr_b16 v[138:139], v34 offset:2048
    v_mfma_f32_16x16x32_bf16 v[104:107], v[84:87], v[184:187], v[104:107]
    ds_read_b64_tr_b16 v[140:141], v35 offset:0
    ds_read_b64_tr_b16 v[142:143], v35 offset:2048
    v_mfma_f32_16x16x32_bf16 v[108:111], v[84:87], v[188:191], v[108:111]
    buffer_load_dwordx4 v7, s[32:35], s15 offen offset:1024 lds
    ds_read_b64_tr_b16 v[144:145], v36 offset:0
    ds_read_b64_tr_b16 v[146:147], v36 offset:2048
    v_mfma_f32_16x16x32_bf16 v[112:115], v[88:91], v[184:187], v[112:115]
    ds_read_b64_tr_b16 v[148:149], v37 offset:0
    ds_read_b64_tr_b16 v[150:151], v37 offset:2048
    v_mfma_f32_16x16x32_bf16 v[116:119], v[88:91], v[188:191], v[116:119]
    s_add_u32 m0, s12, 147456
    s_add_u32 s15, s14, 4718592
    buffer_load_dwordx4 v6, s[32:35], s15 offen lds
    ds_read_b64_tr_b16 v[152:153], v38 offset:0
    ds_read_b64_tr_b16 v[154:155], v38 offset:2048
    v_mfma_f32_16x16x32_bf16 v[120:123], v[92:95], v[184:187], v[120:123]
    ds_read_b64_tr_b16 v[156:157], v39 offset:0
    ds_read_b64_tr_b16 v[158:159], v39 offset:2048
    v_mfma_f32_16x16x32_bf16 v[124:127], v[92:95], v[188:191], v[124:127]
    buffer_load_dwordx4 v7, s[32:35], s15 offen offset:1024 lds
    s_waitcnt vmcnt(35)
    s_waitcnt lgkmcnt(0)
    v_cvt_pk_bf16_f32 v48, v96, v97
    v_cvt_pk_bf16_f32 v49, v98, v99
    v_cvt_pk_bf16_f32 v50, v104, v105
    v_cvt_pk_bf16_f32 v51, v106, v107
    ds_read_b64_tr_b16 v[160:161], v32 offset:1024
    ds_read_b64_tr_b16 v[162:163], v32 offset:3072
    v_mfma_f32_16x16x32_bf16 v[64:67], v[128:131], v[192:195], 0
    s_lshl_b32 s52, s6, 20
    ds_read_b64_tr_b16 v[164:165], v33 offset:1024
    ds_read_b64_tr_b16 v[166:167], v33 offset:3072
    v_mfma_f32_16x16x32_bf16 v[68:71], v[128:131], v[196:199], 0
    s_lshl_b32 s3, s5, 12
    v_cvt_pk_bf16_f32 v52, v100, v101
    v_cvt_pk_bf16_f32 v53, v102, v103
    v_cvt_pk_bf16_f32 v54, v108, v109
    v_cvt_pk_bf16_f32 v55, v110, v111
    ds_read_b64_tr_b16 v[168:169], v34 offset:1024
    ds_read_b64_tr_b16 v[170:171], v34 offset:3072
    v_mfma_f32_16x16x32_bf16 v[72:75], v[132:135], v[192:195], 0
    s_add_u32 s52, s52, s3
    ds_read_b64_tr_b16 v[172:173], v35 offset:1024
    ds_read_b64_tr_b16 v[174:175], v35 offset:3072
    v_mfma_f32_16x16x32_bf16 v[76:79], v[132:135], v[196:199], 0
    s_lshl_b32 s53, s4, 15
    v_cvt_pk_bf16_f32 v56, v112, v113
    v_cvt_pk_bf16_f32 v57, v114, v115
    v_cvt_pk_bf16_f32 v58, v120, v121
    v_cvt_pk_bf16_f32 v59, v122, v123
    ds_read_b64_tr_b16 v[176:177], v36 offset:1024
    v_mfma_f32_16x16x32_bf16 v[80:83], v[136:139], v[192:195], 0
    s_add_u32 s53, s53, s3
    ds_read_b64_tr_b16 v[178:179], v36 offset:3072
    v_mfma_f32_16x16x32_bf16 v[84:87], v[136:139], v[196:199], 0
    s_lshl_b32 s7, s9, 1
    v_cvt_pk_bf16_f32 v60, v116, v117
    v_cvt_pk_bf16_f32 v61, v118, v119
    v_cvt_pk_bf16_f32 v62, v124, v125
    v_cvt_pk_bf16_f32 v63, v126, v127
    ds_read_b64_tr_b16 v[180:181], v37 offset:1024
    v_mfma_f32_16x16x32_bf16 v[88:91], v[140:143], v[192:195], 0
    s_add_u32 s7, s7, 2
    ds_read_b64_tr_b16 v[182:183], v37 offset:3072
    v_mfma_f32_16x16x32_bf16 v[92:95], v[140:143], v[196:199], 0
    s_sub_u32 s8, s4, s7
    ds_read_b64_tr_b16 v[184:185], v38 offset:1024
    v_mfma_f32_16x16x32_bf16 v[96:99], v[144:147], v[192:195], 0
    s_cmp_eq_u32 s4, 1
    s_cselect_b32 s13, s7, 99
    ds_read_b64_tr_b16 v[186:187], v38 offset:3072
    v_mfma_f32_16x16x32_bf16 v[100:103], v[144:147], v[196:199], 0
    s_sub_u32 s14, s13, 1
    ds_read_b64_tr_b16 v[188:189], v39 offset:1024
    v_mfma_f32_16x16x32_bf16 v[104:107], v[148:151], v[192:195], 0
    s_add_u32 s11, s16, 786432
    buffer_store_dwordx4 v[48:51], v20, s[36:39], s11 offen sc1
    ds_read_b64_tr_b16 v[190:191], v39 offset:3072
    v_mfma_f32_16x16x32_bf16 v[108:111], v[148:151], v[196:199], 0
    s_sub_u32 s10, s13, 2
    v_mfma_f32_16x16x32_bf16 v[112:115], v[152:155], v[192:195], 0
    s_mov_b32 s48, 0x42700000
    v_mfma_f32_16x16x32_bf16 v[116:119], v[152:155], v[196:199], 0
    s_mov_b32 s49, 0xe0ad78ec
    v_mfma_f32_16x16x32_bf16 v[120:123], v[156:159], v[192:195], 0
    s_mov_b32 s50, 0
    v_mfma_f32_16x16x32_bf16 v[124:127], v[156:159], v[196:199], 0
    s_mov_b32 s51, 1
    s_waitcnt vmcnt(33)
    s_waitcnt lgkmcnt(0)
    ds_read_b64_tr_b16 v[128:129], v32 offset:16384
    ds_read_b64_tr_b16 v[130:131], v32 offset:18432
    v_mfma_f32_16x16x32_bf16 v[64:67], v[160:163], v[200:203], v[64:67]
    s_add_u32 s61, s20, 8192
    buffer_load_dwordx4 v[192:195], v20, s[36:39], s61 offen sc1
    ds_read_b64_tr_b16 v[132:133], v33 offset:16384
    ds_read_b64_tr_b16 v[134:135], v33 offset:18432
    v_mfma_f32_16x16x32_bf16 v[68:71], v[160:163], v[204:207], v[68:71]
    s_add_u32 s61, s20, 28672
    buffer_load_dwordx4 v[196:199], v20, s[36:39], s61 offen sc1
    ds_read_b64_tr_b16 v[136:137], v34 offset:16384
    ds_read_b64_tr_b16 v[138:139], v34 offset:18432
    v_mfma_f32_16x16x32_bf16 v[72:75], v[164:167], v[200:203], v[72:75]
    s_mov_b32 s59, 1
    ds_read_b64_tr_b16 v[140:141], v35 offset:16384
    ds_read_b64_tr_b16 v[142:143], v35 offset:18432
    v_mfma_f32_16x16x32_bf16 v[76:79], v[164:167], v[204:207], v[76:79]
    s_lshl_b32 s3, s4, 15
    ds_read_b64_tr_b16 v[144:145], v36 offset:16384
    v_mfma_f32_16x16x32_bf16 v[80:83], v[168:171], v[200:203], v[80:83]
    v_add_u32 v15, s3, v20
    ds_read_b64_tr_b16 v[146:147], v36 offset:18432
    v_mfma_f32_16x16x32_bf16 v[84:87], v[168:171], v[204:207], v[84:87]
    v_mov_b32 v16, v15
    ds_read_b64_tr_b16 v[148:149], v37 offset:16384
    v_mfma_f32_16x16x32_bf16 v[88:91], v[172:175], v[200:203], v[88:91]
    v_and_b32 v1, 15, v0
    ds_read_b64_tr_b16 v[150:151], v37 offset:18432
    v_mfma_f32_16x16x32_bf16 v[92:95], v[172:175], v[204:207], v[92:95]
    v_lshrrev_b32 v2, 4, v0
    ds_read_b64_tr_b16 v[152:153], v38 offset:16384
    v_mfma_f32_16x16x32_bf16 v[96:99], v[176:179], v[200:203], v[96:99]
    v_lshlrev_b32 v2, 2, v2
    ds_read_b64_tr_b16 v[154:155], v38 offset:18432
    v_mfma_f32_16x16x32_bf16 v[100:103], v[176:179], v[204:207], v[100:103]
    v_sub_u32 v1, v1, v2
    ds_read_b64_tr_b16 v[156:157], v39 offset:16384
    v_mfma_f32_16x16x32_bf16 v[104:107], v[180:183], v[200:203], v[104:107]
    s_add_u32 s11, s16, 787456
    buffer_store_dwordx4 v[52:55], v20, s[36:39], s11 offen sc1
    ds_read_b64_tr_b16 v[158:159], v39 offset:18432
    v_mfma_f32_16x16x32_bf16 v[108:111], v[180:183], v[204:207], v[108:111]
    s_lshl_b32 s3, s5, 5
    v_add_u32 v17, s3, v1
    v_mfma_f32_16x16x32_bf16 v[112:115], v[184:187], v[200:203], v[112:115]
    v_mov_b32 v19, 0xf149f2ca
    v_mfma_f32_16x16x32_bf16 v[116:119], v[184:187], v[204:207], v[116:119]
    s_lshl_b32 s3, s5, 13
    s_add_u32 s3, s3, 131072
    v_add_u32 v27, s3, v20
    v_mfma_f32_16x16x32_bf16 v[120:123], v[188:191], v[200:203], v[120:123]
    v_mov_b32 v40, 0x3f803f80
    v_mfma_f32_16x16x32_bf16 v[124:127], v[188:191], v[204:207], v[124:127]
    v_mov_b32 v41, 0x3f803f80
    s_waitcnt vmcnt(32)
    s_waitcnt lgkmcnt(0)
    ds_read_b64_tr_b16 v[160:161], v32 offset:17408
    ds_read_b64_tr_b16 v[162:163], v32 offset:19456
    v_mfma_f32_16x16x32_bf16 v[64:67], v[128:131], v[208:211], v[64:67]
    s_add_u32 s61, s20, 9216
    buffer_load_dwordx4 v[200:203], v20, s[36:39], s61 offen sc1
    ds_read_b64_tr_b16 v[164:165], v33 offset:17408
    ds_read_b64_tr_b16 v[166:167], v33 offset:19456
    v_mfma_f32_16x16x32_bf16 v[68:71], v[128:131], v[212:215], v[68:71]
    s_add_u32 s61, s20, 29696
    buffer_load_dwordx4 v[204:207], v20, s[36:39], s61 offen sc1
    ds_read_b64_tr_b16 v[168:169], v34 offset:17408
    ds_read_b64_tr_b16 v[170:171], v34 offset:19456
    v_mfma_f32_16x16x32_bf16 v[72:75], v[132:135], v[208:211], v[72:75]
    v_mov_b32 v42, 0x3f803f80
    ds_read_b64_tr_b16 v[172:173], v35 offset:17408
    ds_read_b64_tr_b16 v[174:175], v35 offset:19456
    v_mfma_f32_16x16x32_bf16 v[76:79], v[132:135], v[212:215], v[76:79]
    v_mov_b32 v43, 0x3f803f80
    ds_read_b64_tr_b16 v[176:177], v36 offset:17408
    v_mfma_f32_16x16x32_bf16 v[80:83], v[136:139], v[208:211], v[80:83]
    v_mov_b32 v44, 0
    ds_read_b64_tr_b16 v[178:179], v36 offset:19456
    v_mfma_f32_16x16x32_bf16 v[84:87], v[136:139], v[212:215], v[84:87]
    v_mov_b32 v45, 0
    ds_read_b64_tr_b16 v[180:181], v37 offset:17408
    v_mfma_f32_16x16x32_bf16 v[88:91], v[140:143], v[208:211], v[88:91]
    v_mov_b32 v46, 0
    ds_read_b64_tr_b16 v[182:183], v37 offset:19456
    v_mfma_f32_16x16x32_bf16 v[92:95], v[140:143], v[212:215], v[92:95]
    v_mov_b32 v47, 0
    ds_read_b64_tr_b16 v[184:185], v38 offset:17408
    v_mfma_f32_16x16x32_bf16 v[96:99], v[144:147], v[208:211], v[96:99]
    v_mov_b32 v48, 0
    ds_read_b64_tr_b16 v[186:187], v38 offset:19456
    v_mfma_f32_16x16x32_bf16 v[100:103], v[144:147], v[212:215], v[100:103]
    v_mov_b32 v49, 0
    ds_read_b64_tr_b16 v[188:189], v39 offset:17408
    v_mfma_f32_16x16x32_bf16 v[104:107], v[148:151], v[208:211], v[104:107]
    s_add_u32 s11, s16, 794624
    buffer_store_dwordx4 v[56:59], v20, s[36:39], s11 offen sc1
    ds_read_b64_tr_b16 v[190:191], v39 offset:19456
    v_mfma_f32_16x16x32_bf16 v[108:111], v[148:151], v[212:215], v[108:111]
    v_mov_b32 v50, 0
    v_mfma_f32_16x16x32_bf16 v[112:115], v[152:155], v[208:211], v[112:115]
    v_mov_b32 v51, 0
    v_mfma_f32_16x16x32_bf16 v[116:119], v[152:155], v[212:215], v[116:119]
    v_mfma_f32_16x16x32_bf16 v[120:123], v[156:159], v[208:211], v[120:123]
    v_mfma_f32_16x16x32_bf16 v[124:127], v[156:159], v[212:215], v[124:127]
    s_waitcnt vmcnt(32)
    s_waitcnt lgkmcnt(0)
    ds_read_b64_tr_b16 v[128:129], v32 offset:32768
    ds_read_b64_tr_b16 v[130:131], v32 offset:34816
    v_mfma_f32_16x16x32_bf16 v[64:67], v[160:163], v[216:219], v[64:67]
    s_add_u32 s61, s20, 10240
    buffer_load_dwordx4 v[208:211], v20, s[36:39], s61 offen sc1
    ds_read_b64_tr_b16 v[132:133], v33 offset:32768
    ds_read_b64_tr_b16 v[134:135], v33 offset:34816
    v_mfma_f32_16x16x32_bf16 v[68:71], v[160:163], v[220:223], v[68:71]
    s_add_u32 s61, s20, 30720
    buffer_load_dwordx4 v[212:215], v20, s[36:39], s61 offen sc1
    ds_read_b64_tr_b16 v[136:137], v34 offset:32768
    ds_read_b64_tr_b16 v[138:139], v34 offset:34816
    v_mfma_f32_16x16x32_bf16 v[72:75], v[164:167], v[216:219], v[72:75]
    ds_read_b64_tr_b16 v[140:141], v35 offset:32768
    ds_read_b64_tr_b16 v[142:143], v35 offset:34816
    v_mfma_f32_16x16x32_bf16 v[76:79], v[164:167], v[220:223], v[76:79]
    ds_read_b64_tr_b16 v[144:145], v36 offset:32768
    v_mfma_f32_16x16x32_bf16 v[80:83], v[168:171], v[216:219], v[80:83]
    ds_read_b64_tr_b16 v[146:147], v36 offset:34816
    v_mfma_f32_16x16x32_bf16 v[84:87], v[168:171], v[220:223], v[84:87]
    ds_read_b64_tr_b16 v[148:149], v37 offset:32768
    v_mfma_f32_16x16x32_bf16 v[88:91], v[172:175], v[216:219], v[88:91]
    ds_read_b64_tr_b16 v[150:151], v37 offset:34816
    v_mfma_f32_16x16x32_bf16 v[92:95], v[172:175], v[220:223], v[92:95]
    ds_read_b64_tr_b16 v[152:153], v38 offset:32768
    v_mfma_f32_16x16x32_bf16 v[96:99], v[176:179], v[216:219], v[96:99]
    ds_read_b64_tr_b16 v[154:155], v38 offset:34816
    v_mfma_f32_16x16x32_bf16 v[100:103], v[176:179], v[220:223], v[100:103]
    ds_read_b64_tr_b16 v[156:157], v39 offset:32768
    v_mfma_f32_16x16x32_bf16 v[104:107], v[180:183], v[216:219], v[104:107]
    s_add_u32 s11, s16, 795648
    buffer_store_dwordx4 v[60:63], v20, s[36:39], s11 offen sc1
    ds_read_b64_tr_b16 v[158:159], v39 offset:34816
    v_mfma_f32_16x16x32_bf16 v[108:111], v[180:183], v[220:223], v[108:111]
    v_mfma_f32_16x16x32_bf16 v[112:115], v[184:187], v[216:219], v[112:115]
    v_mfma_f32_16x16x32_bf16 v[116:119], v[184:187], v[220:223], v[116:119]
    v_mfma_f32_16x16x32_bf16 v[120:123], v[188:191], v[216:219], v[120:123]
    v_mfma_f32_16x16x32_bf16 v[124:127], v[188:191], v[220:223], v[124:127]
    s_waitcnt vmcnt(31)
    s_waitcnt lgkmcnt(0)
    ds_read_b64_tr_b16 v[160:161], v32 offset:33792
    ds_read_b64_tr_b16 v[162:163], v32 offset:35840
    v_mfma_f32_16x16x32_bf16 v[64:67], v[128:131], v[224:227], v[64:67]
    s_add_u32 s61, s20, 11264
    buffer_load_dwordx4 v[216:219], v20, s[36:39], s61 offen sc1
    ds_read_b64_tr_b16 v[164:165], v33 offset:33792
    ds_read_b64_tr_b16 v[166:167], v33 offset:35840
    v_mfma_f32_16x16x32_bf16 v[68:71], v[128:131], v[228:231], v[68:71]
    s_add_u32 s61, s20, 31744
    buffer_load_dwordx4 v[220:223], v20, s[36:39], s61 offen sc1
    ds_read_b64_tr_b16 v[168:169], v34 offset:33792
    ds_read_b64_tr_b16 v[170:171], v34 offset:35840
    v_mfma_f32_16x16x32_bf16 v[72:75], v[132:135], v[224:227], v[72:75]
    buffer_load_dword v29, v31, s[36:39], s18 offen sc1
    ds_read_b64_tr_b16 v[172:173], v35 offset:33792
    ds_read_b64_tr_b16 v[174:175], v35 offset:35840
    v_mfma_f32_16x16x32_bf16 v[76:79], v[132:135], v[228:231], v[76:79]
    s_mov_b32 s28, s64
    ds_read_b64_tr_b16 v[176:177], v36 offset:33792
    v_mfma_f32_16x16x32_bf16 v[80:83], v[136:139], v[224:227], v[80:83]
    s_mov_b32 s29, s65
    ds_read_b64_tr_b16 v[178:179], v36 offset:35840
    v_mfma_f32_16x16x32_bf16 v[84:87], v[136:139], v[228:231], v[84:87]
    s_mov_b32 s30, 5242880
    ds_read_b64_tr_b16 v[180:181], v37 offset:33792
    v_mfma_f32_16x16x32_bf16 v[88:91], v[140:143], v[224:227], v[88:91]
    s_mov_b32 s31, 0x00020000
    ds_read_b64_tr_b16 v[182:183], v37 offset:35840
    v_mfma_f32_16x16x32_bf16 v[92:95], v[140:143], v[228:231], v[92:95]
    s_lshl_b32 s3, s23, 2
    s_add_u32 s3, s3, s5
    s_lshl_b32 s3, s3, 7
    s_and_b32 s24, s6, 14
    s_lshl_b32 s24, s24, 3
    s_add_u32 s24, s24, s3
    ds_read_b64_tr_b16 v[184:185], v38 offset:33792
    v_mfma_f32_16x16x32_bf16 v[96:99], v[144:147], v[224:227], v[96:99]
    s_and_b32 s3, s6, 1
    s_lshl_b32 s3, s3, 2
    s_add_u32 s24, s24, s3
    s_lshr_b32 s3, s6, 4
    s_lshl_b32 s3, s3, 3
    s_add_u32 s24, s24, s3
    s_add_u32 s24, s24, 83968000
    ds_read_b64_tr_b16 v[186:187], v38 offset:35840
    v_mfma_f32_16x16x32_bf16 v[100:103], v[144:147], v[228:231], v[100:103]
    s_lshr_b32 s3, s2, 5
    s_xor_b32 s25, s4, 1
    s_lshl_b32 s25, s25, 3
    s_add_u32 s3, s3, s25
    s_lshl_b32 s3, s3, 2
    s_add_u32 s3, s3, s5
    s_lshl_b32 s26, s3, 18
    s_mul_i32 s32, s3, 40960
    s_lshl_b32 s25, s3, 7
    ds_read_b64_tr_b16 v[188:189], v39 offset:33792
    v_mfma_f32_16x16x32_bf16 v[104:107], v[148:151], v[224:227], v[104:107]
    s_and_b32 s3, s2, 7
    s_lshl_b32 s61, s3, 4
    s_add_u32 s25, s25, s61
    s_add_u32 s25, s25, 83968000
    s_lshl_b32 s61, s3, 13
    s_add_u32 s26, s26, s61
    s_add_u32 s26, s26, 33554432
    s_add_u32 s27, s26, 0x20000
    ds_read_b64_tr_b16 v[190:191], v39 offset:35840
    v_mfma_f32_16x16x32_bf16 v[108:111], v[148:151], v[228:231], v[108:111]
    s_mul_i32 s61, s3, 2621440
    s_add_u32 s32, s32, s61
    s_add_u32 s32, s32, 54525952
    s_mul_i32 s35, s3, 327680
    s_bfe_u32 s3, s2, 0x20003
    s_mul_i32 s61, s3, 320
    s_add_u32 s35, s35, s61
    s_lshl_b32 s61, s61, 4
    s_add_u32 s32, s32, s61
    v_mfma_f32_16x16x32_bf16 v[112:115], v[152:155], v[224:227], v[112:115]
    s_xor_b32 s3, s4, 1
    s_mul_i32 s3, s3, 163840
    s_add_u32 s33, s35, s3
    s_add_u32 s35, s35, 2621440
    s_mul_i32 s34, s4, 40960
    s_mul_i32 s3, s5, 10240
    s_add_u32 s34, s34, s3
    s_add_u32 s34, s34, 81920
    s_mul_i32 s45, s5, 640
    v_mfma_f32_16x16x32_bf16 v[116:119], v[152:155], v[228:231], v[116:119]
    v_add_u32 v1, s45, v0
    v_mfma_f32_16x16x32_bf16 v[120:123], v[156:159], v[224:227], v[120:123]
    v_mul_u32_u24 v2, 52429, v1
    v_mfma_f32_16x16x32_bf16 v[124:127], v[156:159], v[228:231], v[124:127]
    v_lshrrev_b32 v2, 20, v2
    s_waitcnt vmcnt(31)
    s_waitcnt lgkmcnt(0)
    ds_read_b64_tr_b16 v[128:129], v32 offset:49152
    ds_read_b64_tr_b16 v[130:131], v32 offset:51200
    v_mfma_f32_16x16x32_bf16 v[64:67], v[160:163], v[232:235], v[64:67]
    s_add_u32 s61, s20, 12288
    buffer_load_dwordx4 v[224:227], v20, s[36:39], s61 offen sc1
    ds_read_b64_tr_b16 v[132:133], v33 offset:49152
    ds_read_b64_tr_b16 v[134:135], v33 offset:51200
    v_mfma_f32_16x16x32_bf16 v[68:71], v[160:163], v[236:239], v[68:71]
    s_add_u32 s61, s20, 32768
    buffer_load_dwordx4 v[228:231], v20, s[36:39], s61 offen sc1
    ds_read_b64_tr_b16 v[136:137], v34 offset:49152
    ds_read_b64_tr_b16 v[138:139], v34 offset:51200
    v_mfma_f32_16x16x32_bf16 v[72:75], v[164:167], v[232:235], v[72:75]
    v_mul_u32_u24 v4, 20, v2
    ds_read_b64_tr_b16 v[140:141], v35 offset:49152
    ds_read_b64_tr_b16 v[142:143], v35 offset:51200
    v_mfma_f32_16x16x32_bf16 v[76:79], v[164:167], v[236:239], v[76:79]
    v_sub_u32 v1, v1, v4
    ds_read_b64_tr_b16 v[144:145], v36 offset:49152
    v_mfma_f32_16x16x32_bf16 v[80:83], v[168:171], v[232:235], v[80:83]
    v_bfe_u32 v4, v2, 2, 1
    ds_read_b64_tr_b16 v[146:147], v36 offset:51200
    v_mfma_f32_16x16x32_bf16 v[84:87], v[168:171], v[236:239], v[84:87]
    v_xor_b32 v1, v1, v4
    ds_read_b64_tr_b16 v[148:149], v37 offset:49152
    v_mfma_f32_16x16x32_bf16 v[88:91], v[172:175], v[232:235], v[88:91]
    v_mul_u32_u24 v2, 1280, v2
    ds_read_b64_tr_b16 v[150:151], v37 offset:51200
    v_mfma_f32_16x16x32_bf16 v[92:95], v[172:175], v[236:239], v[92:95]
    v_lshl_add_u32 v4, v1, 4, v2
    ds_read_b64_tr_b16 v[152:153], v38 offset:49152
    v_mfma_f32_16x16x32_bf16 v[96:99], v[176:179], v[232:235], v[96:99]
    v_add_u32 v1, s45, v0
    ds_read_b64_tr_b16 v[154:155], v38 offset:51200
    v_mfma_f32_16x16x32_bf16 v[100:103], v[176:179], v[236:239], v[100:103]
    v_add_u32 v1, 64, v1
    ds_read_b64_tr_b16 v[156:157], v39 offset:49152
    v_mfma_f32_16x16x32_bf16 v[104:107], v[180:183], v[232:235], v[104:107]
    v_mul_u32_u24 v2, 52429, v1
    ds_read_b64_tr_b16 v[158:159], v39 offset:51200
    v_mfma_f32_16x16x32_bf16 v[108:111], v[180:183], v[236:239], v[108:111]
    v_lshrrev_b32 v2, 20, v2
    v_mfma_f32_16x16x32_bf16 v[112:115], v[184:187], v[232:235], v[112:115]
    v_mul_u32_u24 v5, 20, v2
    v_mfma_f32_16x16x32_bf16 v[116:119], v[184:187], v[236:239], v[116:119]
    v_sub_u32 v1, v1, v5
    v_mfma_f32_16x16x32_bf16 v[120:123], v[188:191], v[232:235], v[120:123]
    v_bfe_u32 v5, v2, 2, 1
    v_mfma_f32_16x16x32_bf16 v[124:127], v[188:191], v[236:239], v[124:127]
    v_xor_b32 v1, v1, v5
    s_waitcnt vmcnt(31)
    s_waitcnt lgkmcnt(0)
    ds_read_b64_tr_b16 v[160:161], v32 offset:50176
    ds_read_b64_tr_b16 v[162:163], v32 offset:52224
    v_mfma_f32_16x16x32_bf16 v[64:67], v[128:131], v[240:243], v[64:67]
    s_add_u32 s61, s20, 13312
    buffer_load_dwordx4 v[232:235], v20, s[36:39], s61 offen sc1
    ds_read_b64_tr_b16 v[164:165], v33 offset:50176
    ds_read_b64_tr_b16 v[166:167], v33 offset:52224
    v_mfma_f32_16x16x32_bf16 v[68:71], v[128:131], v[244:247], v[68:71]
    s_add_u32 s61, s20, 33792
    buffer_load_dwordx4 v[236:239], v20, s[36:39], s61 offen sc1
    ds_read_b64_tr_b16 v[168:169], v34 offset:50176
    ds_read_b64_tr_b16 v[170:171], v34 offset:52224
    v_mfma_f32_16x16x32_bf16 v[72:75], v[132:135], v[240:243], v[72:75]
    v_mul_u32_u24 v2, 1280, v2
    ds_read_b64_tr_b16 v[172:173], v35 offset:50176
    ds_read_b64_tr_b16 v[174:175], v35 offset:52224
    v_mfma_f32_16x16x32_bf16 v[76:79], v[132:135], v[244:247], v[76:79]
    v_lshl_add_u32 v5, v1, 4, v2
    ds_read_b64_tr_b16 v[176:177], v36 offset:50176
    v_mfma_f32_16x16x32_bf16 v[80:83], v[136:139], v[240:243], v[80:83]
    v_add_u32 v1, s45, v0
    ds_read_b64_tr_b16 v[178:179], v36 offset:52224
    v_mfma_f32_16x16x32_bf16 v[84:87], v[136:139], v[244:247], v[84:87]
    v_add_u32 v1, 128, v1
    ds_read_b64_tr_b16 v[180:181], v37 offset:50176
    v_mfma_f32_16x16x32_bf16 v[88:91], v[140:143], v[240:243], v[88:91]
    v_mul_u32_u24 v2, 52429, v1
    ds_read_b64_tr_b16 v[182:183], v37 offset:52224
    v_mfma_f32_16x16x32_bf16 v[92:95], v[140:143], v[244:247], v[92:95]
    v_lshrrev_b32 v2, 20, v2
    ds_read_b64_tr_b16 v[184:185], v38 offset:50176
    v_mfma_f32_16x16x32_bf16 v[96:99], v[144:147], v[240:243], v[96:99]
    v_mul_u32_u24 v6, 20, v2
    ds_read_b64_tr_b16 v[186:187], v38 offset:52224
    v_mfma_f32_16x16x32_bf16 v[100:103], v[144:147], v[244:247], v[100:103]
    v_sub_u32 v1, v1, v6
    ds_read_b64_tr_b16 v[188:189], v39 offset:50176
    v_mfma_f32_16x16x32_bf16 v[104:107], v[148:151], v[240:243], v[104:107]
    v_bfe_u32 v6, v2, 2, 1
    ds_read_b64_tr_b16 v[190:191], v39 offset:52224
    v_mfma_f32_16x16x32_bf16 v[108:111], v[148:151], v[244:247], v[108:111]
    v_xor_b32 v1, v1, v6
    v_mfma_f32_16x16x32_bf16 v[112:115], v[152:155], v[240:243], v[112:115]
    v_mul_u32_u24 v2, 1280, v2
    v_mfma_f32_16x16x32_bf16 v[116:119], v[152:155], v[244:247], v[116:119]
    v_lshl_add_u32 v6, v1, 4, v2
    v_mfma_f32_16x16x32_bf16 v[120:123], v[156:159], v[240:243], v[120:123]
    v_add_u32 v1, s45, v0
    v_mfma_f32_16x16x32_bf16 v[124:127], v[156:159], v[244:247], v[124:127]
    s_waitcnt vmcnt(29)
    s_waitcnt lgkmcnt(0)
    v_add_u32 v32, 0x10000, v32
    v_add_u32 v33, 0x10000, v33
    v_add_u32 v34, 0x10000, v34
    v_add_u32 v35, 0x10000, v35
    v_add_u32 v36, 0x10000, v36
    v_add_u32 v37, 0x10000, v37
    v_add_u32 v38, 0x10000, v38
    v_add_u32 v39, 0x10000, v39
    ds_read_b64_tr_b16 v[128:129], v32 offset:0
    ds_read_b64_tr_b16 v[130:131], v32 offset:2048
    v_mfma_f32_16x16x32_bf16 v[64:67], v[160:163], v[248:251], v[64:67]
    s_add_u32 s61, s20, 14336
    buffer_load_dwordx4 v[240:243], v20, s[36:39], s61 offen sc1
    ds_read_b64_tr_b16 v[132:133], v33 offset:0
    ds_read_b64_tr_b16 v[134:135], v33 offset:2048
    v_mfma_f32_16x16x32_bf16 v[68:71], v[160:163], v[252:255], v[68:71]
    s_add_u32 s61, s20, 34816
    buffer_load_dwordx4 v[244:247], v20, s[36:39], s61 offen sc1
    ds_read_b64_tr_b16 v[136:137], v34 offset:0
    ds_read_b64_tr_b16 v[138:139], v34 offset:2048
    v_mfma_f32_16x16x32_bf16 v[72:75], v[164:167], v[248:251], v[72:75]
    ds_read_b64_tr_b16 v[140:141], v35 offset:0
    ds_read_b64_tr_b16 v[142:143], v35 offset:2048
    v_mfma_f32_16x16x32_bf16 v[76:79], v[164:167], v[252:255], v[76:79]
    ds_read_b64_tr_b16 v[144:145], v36 offset:0
    v_mfma_f32_16x16x32_bf16 v[80:83], v[168:171], v[248:251], v[80:83]
    ds_read_b64_tr_b16 v[146:147], v36 offset:2048
    v_mfma_f32_16x16x32_bf16 v[84:87], v[168:171], v[252:255], v[84:87]
    ds_read_b64_tr_b16 v[148:149], v37 offset:0
    v_mfma_f32_16x16x32_bf16 v[88:91], v[172:175], v[248:251], v[88:91]
    ds_read_b64_tr_b16 v[150:151], v37 offset:2048
    v_mfma_f32_16x16x32_bf16 v[92:95], v[172:175], v[252:255], v[92:95]
    ds_read_b64_tr_b16 v[152:153], v38 offset:0
    v_mfma_f32_16x16x32_bf16 v[96:99], v[176:179], v[248:251], v[96:99]
    ds_read_b64_tr_b16 v[154:155], v38 offset:2048
    v_mfma_f32_16x16x32_bf16 v[100:103], v[176:179], v[252:255], v[100:103]
    ds_read_b64_tr_b16 v[156:157], v39 offset:0
    v_mfma_f32_16x16x32_bf16 v[104:107], v[180:183], v[248:251], v[104:107]
    ds_read_b64_tr_b16 v[158:159], v39 offset:2048
    v_mfma_f32_16x16x32_bf16 v[108:111], v[180:183], v[252:255], v[108:111]
    v_mfma_f32_16x16x32_bf16 v[112:115], v[184:187], v[248:251], v[112:115]
    v_mfma_f32_16x16x32_bf16 v[116:119], v[184:187], v[252:255], v[116:119]
    v_mfma_f32_16x16x32_bf16 v[120:123], v[188:191], v[248:251], v[120:123]
    v_mfma_f32_16x16x32_bf16 v[124:127], v[188:191], v[252:255], v[124:127]
    s_waitcnt vmcnt(16)
    s_waitcnt lgkmcnt(0)
    ds_read_b64_tr_b16 v[160:161], v32 offset:1024
    ds_read_b64_tr_b16 v[162:163], v32 offset:3072
    v_mfma_f32_16x16x32_bf16 v[64:67], v[128:131], v[192:195], v[64:67]
    s_add_u32 s61, s20, 15360
    buffer_load_dwordx4 v[248:251], v20, s[36:39], s61 offen sc1
    ds_read_b64_tr_b16 v[164:165], v33 offset:1024
    ds_read_b64_tr_b16 v[166:167], v33 offset:3072
    v_mfma_f32_16x16x32_bf16 v[68:71], v[128:131], v[196:199], v[68:71]
    s_add_u32 s61, s20, 35840
    buffer_load_dwordx4 v[252:255], v20, s[36:39], s61 offen sc1
    ds_read_b64_tr_b16 v[168:169], v34 offset:1024
    ds_read_b64_tr_b16 v[170:171], v34 offset:3072
    v_mfma_f32_16x16x32_bf16 v[72:75], v[132:135], v[192:195], v[72:75]
    ds_read_b64_tr_b16 v[172:173], v35 offset:1024
    ds_read_b64_tr_b16 v[174:175], v35 offset:3072
    v_mfma_f32_16x16x32_bf16 v[76:79], v[132:135], v[196:199], v[76:79]
    ds_read_b64_tr_b16 v[176:177], v36 offset:1024
    v_mfma_f32_16x16x32_bf16 v[80:83], v[136:139], v[192:195], v[80:83]
    ds_read_b64_tr_b16 v[178:179], v36 offset:3072
    v_mfma_f32_16x16x32_bf16 v[84:87], v[136:139], v[196:199], v[84:87]
    ds_read_b64_tr_b16 v[180:181], v37 offset:1024
    v_mfma_f32_16x16x32_bf16 v[88:91], v[140:143], v[192:195], v[88:91]
    ds_read_b64_tr_b16 v[182:183], v37 offset:3072
    v_mfma_f32_16x16x32_bf16 v[92:95], v[140:143], v[196:199], v[92:95]
    ds_read_b64_tr_b16 v[184:185], v38 offset:1024
    v_mfma_f32_16x16x32_bf16 v[96:99], v[144:147], v[192:195], v[96:99]
    ds_read_b64_tr_b16 v[186:187], v38 offset:3072
    v_mfma_f32_16x16x32_bf16 v[100:103], v[144:147], v[196:199], v[100:103]
    ds_read_b64_tr_b16 v[188:189], v39 offset:1024
    v_mfma_f32_16x16x32_bf16 v[104:107], v[148:151], v[192:195], v[104:107]
    s_waitcnt vmcnt(8)
    ds_read_b64_tr_b16 v[190:191], v39 offset:3072
    v_mfma_f32_16x16x32_bf16 v[108:111], v[148:151], v[196:199], v[108:111]
    v_cmp_le_u32 vcc, 1, v29
    s_nop 0
    s_or_b32 s3, vcc_lo, s60
    s_and_b32 s3, s3, 255
    s_cmp_eq_u32 s3, 255
    s_cbranch_scc0 k1_spin15
k1_back16:
    v_mfma_f32_16x16x32_bf16 v[112:115], v[152:155], v[192:195], v[112:115]
    v_mfma_f32_16x16x32_bf16 v[116:119], v[152:155], v[196:199], v[116:119]
    v_mfma_f32_16x16x32_bf16 v[120:123], v[156:159], v[192:195], v[120:123]
    v_mfma_f32_16x16x32_bf16 v[124:127], v[156:159], v[196:199], v[124:127]
    s_waitcnt vmcnt(15)
    s_waitcnt lgkmcnt(0)
    s_waitcnt vmcnt(11)
    s_barrier
    ds_read_b64_tr_b16 v[128:129], v32 offset:16384
    ds_read_b64_tr_b16 v[130:131], v32 offset:18432
    v_mfma_f32_16x16x32_bf16 v[64:67], v[160:163], v[200:203], v[64:67]
    s_add_u32 s61, s20, 16384
    buffer_load_dwordx4 v[192:195], v20, s[36:39], s61 offen sc1
    ds_read_b64_tr_b16 v[132:133], v33 offset:16384
    ds_read_b64_tr_b16 v[134:135], v33 offset:18432
    v_mfma_f32_16x16x32_bf16 v[68:71], v[160:163], v[204:207], v[68:71]
    s_add_u32 s61, s20, 36864
    buffer_load_dwordx4 v[196:199], v20, s[36:39], s61 offen sc1
    ds_read_b64_tr_b16 v[136:137], v34 offset:16384
    ds_read_b64_tr_b16 v[138:139], v34 offset:18432
    v_mfma_f32_16x16x32_bf16 v[72:75], v[164:167], v[200:203], v[72:75]
    buffer_store_dword v24, v22, s[36:39], s17 offen sc1
    ds_read_b64_tr_b16 v[140:141], v35 offset:16384
    ds_read_b64_tr_b16 v[142:143], v35 offset:18432
    v_mfma_f32_16x16x32_bf16 v[76:79], v[164:167], v[204:207], v[76:79]
    s_add_u32 m0, s53, 0
    s_add_u32 s15, s52, 0
    buffer_load_dwordx4 v20, s[36:39], s15 offen offset:0 sc1 lds
    ds_read_b64_tr_b16 v[144:145], v36 offset:16384
    v_mfma_f32_16x16x32_bf16 v[80:83], v[168:171], v[200:203], v[80:83]
    buffer_load_dwordx4 v20, s[36:39], s15 offen offset:1024 sc1 lds
    ds_read_b64_tr_b16 v[146:147], v36 offset:18432
    v_mfma_f32_16x16x32_bf16 v[84:87], v[168:171], v[204:207], v[84:87]
    buffer_load_dwordx4 v20, s[36:39], s15 offen offset:2048 sc1 lds
    ds_read_b64_tr_b16 v[148:149], v37 offset:16384
    v_mfma_f32_16x16x32_bf16 v[88:91], v[172:175], v[200:203], v[88:91]
    buffer_load_dwordx4 v20, s[36:39], s15 offen offset:3072 sc1 lds
    ds_read_b64_tr_b16 v[150:151], v37 offset:18432
    v_mfma_f32_16x16x32_bf16 v[92:95], v[172:175], v[204:207], v[92:95]
    s_add_u32 m0, s53, 16384
    s_add_u32 s15, s52, 16384
    buffer_load_dwordx4 v20, s[36:39], s15 offen offset:0 sc1 lds
    ds_read_b64_tr_b16 v[152:153], v38 offset:16384
    v_mfma_f32_16x16x32_bf16 v[96:99], v[176:179], v[200:203], v[96:99]
    buffer_load_dwordx4 v20, s[36:39], s15 offen offset:1024 sc1 lds
    ds_read_b64_tr_b16 v[154:155], v38 offset:18432
    v_mfma_f32_16x16x32_bf16 v[100:103], v[176:179], v[204:207], v[100:103]
    buffer_load_dwordx4 v20, s[36:39], s15 offen offset:2048 sc1 lds
    ds_read_b64_tr_b16 v[156:157], v39 offset:16384
    v_mfma_f32_16x16x32_bf16 v[104:107], v[180:183], v[200:203], v[104:107]
    buffer_load_dwordx4 v20, s[36:39], s15 offen offset:3072 sc1 lds
    ds_read_b64_tr_b16 v[158:159], v39 offset:18432
    v_mfma_f32_16x16x32_bf16 v[108:111], v[180:183], v[204:207], v[108:111]
    v_add_u32 v1, 192, v1
    v_mfma_f32_16x16x32_bf16 v[112:115], v[184:187], v[200:203], v[112:115]
    v_mul_u32_u24 v2, 52429, v1
    v_mfma_f32_16x16x32_bf16 v[116:119], v[184:187], v[204:207], v[116:119]
    v_lshrrev_b32 v2, 20, v2
    v_mfma_f32_16x16x32_bf16 v[120:123], v[188:191], v[200:203], v[120:123]
    v_mul_u32_u24 v7, 20, v2
    v_mfma_f32_16x16x32_bf16 v[124:127], v[188:191], v[204:207], v[124:127]
    v_sub_u32 v1, v1, v7
    s_waitcnt vmcnt(23)
    s_waitcnt lgkmcnt(0)
    ds_read_b64_tr_b16 v[160:161], v32 offset:17408
    ds_read_b64_tr_b16 v[162:163], v32 offset:19456
    v_mfma_f32_16x16x32_bf16 v[64:67], v[128:131], v[208:211], v[64:67]
    s_add_u32 s61, s20, 17408
    buffer_load_dwordx4 v[200:203], v20, s[36:39], s61 offen sc1
    ds_read_b64_tr_b16 v[164:165], v33 offset:17408
    ds_read_b64_tr_b16 v[166:167], v33 offset:19456
    v_mfma_f32_16x16x32_bf16 v[68:71], v[128:131], v[212:215], v[68:71]
    s_add_u32 s61, s20, 37888
    buffer_load_dwordx4 v[204:207], v20, s[36:39], s61 offen sc1
    ds_read_b64_tr_b16 v[168:169], v34 offset:17408
    ds_read_b64_tr_b16 v[170:171], v34 offset:19456
    v_mfma_f32_16x16x32_bf16 v[72:75], v[132:135], v[208:211], v[72:75]
    v_bfe_u32 v7, v2, 2, 1
    ds_read_b64_tr_b16 v[172:173], v35 offset:17408
    ds_read_b64_tr_b16 v[174:175], v35 offset:19456
    v_mfma_f32_16x16x32_bf16 v[76:79], v[132:135], v[212:215], v[76:79]
    v_xor_b32 v1, v1, v7
    ds_read_b64_tr_b16 v[176:177], v36 offset:17408
    v_mfma_f32_16x16x32_bf16 v[80:83], v[136:139], v[208:211], v[80:83]
    v_mul_u32_u24 v2, 1280, v2
    ds_read_b64_tr_b16 v[178:179], v36 offset:19456
    v_mfma_f32_16x16x32_bf16 v[84:87], v[136:139], v[212:215], v[84:87]
    v_lshl_add_u32 v7, v1, 4, v2
    ds_read_b64_tr_b16 v[180:181], v37 offset:17408
    v_mfma_f32_16x16x32_bf16 v[88:91], v[140:143], v[208:211], v[88:91]
    v_add_u32 v1, s45, v0
    ds_read_b64_tr_b16 v[182:183], v37 offset:19456
    v_mfma_f32_16x16x32_bf16 v[92:95], v[140:143], v[212:215], v[92:95]
    v_add_u32 v1, 256, v1
    ds_read_b64_tr_b16 v[184:185], v38 offset:17408
    v_mfma_f32_16x16x32_bf16 v[96:99], v[144:147], v[208:211], v[96:99]
    v_mul_u32_u24 v2, 52429, v1
    ds_read_b64_tr_b16 v[186:187], v38 offset:19456
    v_mfma_f32_16x16x32_bf16 v[100:103], v[144:147], v[212:215], v[100:103]
    v_lshrrev_b32 v2, 20, v2
    ds_read_b64_tr_b16 v[188:189], v39 offset:17408
    v_mfma_f32_16x16x32_bf16 v[104:107], v[148:151], v[208:211], v[104:107]
    v_mul_u32_u24 v8, 20, v2
    ds_read_b64_tr_b16 v[190:191], v39 offset:19456
    v_mfma_f32_16x16x32_bf16 v[108:111], v[148:151], v[212:215], v[108:111]
    v_sub_u32 v1, v1, v8
    v_mfma_f32_16x16x32_bf16 v[112:115], v[152:155], v[208:211], v[112:115]
    v_bfe_u32 v8, v2, 2, 1
    v_mfma_f32_16x16x32_bf16 v[116:119], v[152:155], v[212:215], v[116:119]
    v_xor_b32 v1, v1, v8
    v_mfma_f32_16x16x32_bf16 v[120:123], v[156:159], v[208:211], v[120:123]
    v_mul_u32_u24 v2, 1280, v2
    v_mfma_f32_16x16x32_bf16 v[124:127], v[156:159], v[212:215], v[124:127]
    v_lshl_add_u32 v8, v1, 4, v2
    s_waitcnt vmcnt(22)
    s_waitcnt lgkmcnt(0)
    ds_read_b64_tr_b16 v[128:129], v32 offset:32768
    ds_read_b64_tr_b16 v[130:131], v32 offset:34816
    v_mfma_f32_16x16x32_bf16 v[64:67], v[160:163], v[216:219], v[64:67]
    s_add_u32 s61, s20, 18432
    buffer_load_dwordx4 v[208:211], v20, s[36:39], s61 offen sc1
    ds_read_b64_tr_b16 v[132:133], v33 offset:32768
    ds_read_b64_tr_b16 v[134:135], v33 offset:34816
    v_mfma_f32_16x16x32_bf16 v[68:71], v[160:163], v[220:223], v[68:71]
    s_add_u32 s61, s20, 38912
    buffer_load_dwordx4 v[212:215], v20, s[36:39], s61 offen sc1
    ds_read_b64_tr_b16 v[136:137], v34 offset:32768
    ds_read_b64_tr_b16 v[138:139], v34 offset:34816
    v_mfma_f32_16x16x32_bf16 v[72:75], v[164:167], v[216:219], v[72:75]
    s_lshl_b32 s3, s5, 14
    s_add_u32 s44, s3, 0x4000
    s_cmp_eq_u32 s5, 0
    s_cselect_b32 s44, 0, s44
    s_lshl_b32 s45, s5, 12
    s_add_u32 s45, s45, 0x4000
    ds_read_b64_tr_b16 v[140:141], v35 offset:32768
    ds_read_b64_tr_b16 v[142:143], v35 offset:34816
    v_mfma_f32_16x16x32_bf16 v[76:79], v[164:167], v[220:223], v[76:79]
    v_add_u32 v13, s44, v20
    ds_read_b64_tr_b16 v[144:145], v36 offset:32768
    v_mfma_f32_16x16x32_bf16 v[80:83], v[168:171], v[216:219], v[80:83]
    v_add_u32 v14, s45, v20
    ds_read_b64_tr_b16 v[146:147], v36 offset:34816
    v_mfma_f32_16x16x32_bf16 v[84:87], v[168:171], v[220:223], v[84:87]
    v_lshrrev_b32 v1, 2, v0
    ds_read_b64_tr_b16 v[148:149], v37 offset:32768
    v_mfma_f32_16x16x32_bf16 v[88:91], v[172:175], v[216:219], v[88:91]
    v_mul_u32_u24 v1, 320, v1
    ds_read_b64_tr_b16 v[150:151], v37 offset:34816
    v_mfma_f32_16x16x32_bf16 v[92:95], v[172:175], v[220:223], v[92:95]
    v_and_b32 v2, 3, v0
    ds_read_b64_tr_b16 v[152:153], v38 offset:32768
    v_mfma_f32_16x16x32_bf16 v[96:99], v[176:179], v[216:219], v[96:99]
    v_bfe_u32 v3, v0, 4, 1
    ds_read_b64_tr_b16 v[154:155], v38 offset:34816
    v_mfma_f32_16x16x32_bf16 v[100:103], v[176:179], v[220:223], v[100:103]
    v_xor_b32 v3, v3, v2
    ds_read_b64_tr_b16 v[156:157], v39 offset:32768
    v_mfma_f32_16x16x32_bf16 v[104:107], v[180:183], v[216:219], v[104:107]
    v_lshl_add_u32 v1, v3, 4, v1
    ds_read_b64_tr_b16 v[158:159], v39 offset:34816
    v_mfma_f32_16x16x32_bf16 v[108:111], v[180:183], v[220:223], v[108:111]
    v_and_b32 v2, 1, v0
    v_mfma_f32_16x16x32_bf16 v[112:115], v[184:187], v[216:219], v[112:115]
    v_lshl_add_u32 v9, v2, 3, v1
    v_mfma_f32_16x16x32_bf16 v[116:119], v[184:187], v[220:223], v[116:119]
    v_add_u32 v9, 122880, v9
    v_mfma_f32_16x16x32_bf16 v[120:123], v[188:191], v[216:219], v[120:123]
    v_xor_b32 v10, 8, v9
    v_mfma_f32_16x16x32_bf16 v[124:127], v[188:191], v[220:223], v[124:127]
    s_lshr_b32 s3, s2, 3
    s_lshl_b32 s3, s3, 3
    s_add_u32 s3, s3, s22
    s_and_b32 s61, s3, 127
    s_mul_i32 s46, s61, 2560
    s_lshr_b32 s3, s3, 7
    s_mul_i32 s3, s3, 2621440
    s_add_u32 s46, s46, s3
    s_and_b32 s3, s2, 7
    s_mul_i32 s3, s3, 327680
    s_add_u32 s46, s46, s3
    s_waitcnt vmcnt(21)
    s_waitcnt lgkmcnt(0)
    ds_read_b64_tr_b16 v[160:161], v32 offset:33792
    ds_read_b64_tr_b16 v[162:163], v32 offset:35840
    v_mfma_f32_16x16x32_bf16 v[64:67], v[128:131], v[224:227], v[64:67]
    s_add_u32 s61, s20, 19456
    buffer_load_dwordx4 v[216:219], v20, s[36:39], s61 offen sc1
    ds_read_b64_tr_b16 v[164:165], v33 offset:33792
    ds_read_b64_tr_b16 v[166:167], v33 offset:35840
    v_mfma_f32_16x16x32_bf16 v[68:71], v[128:131], v[228:231], v[68:71]
    s_add_u32 s61, s20, 39936
    buffer_load_dwordx4 v[220:223], v20, s[36:39], s61 offen sc1
    ds_read_b64_tr_b16 v[168:169], v34 offset:33792
    ds_read_b64_tr_b16 v[170:171], v34 offset:35840
    v_mfma_f32_16x16x32_bf16 v[72:75], v[132:135], v[224:227], v[72:75]
    s_xor_b32 s47, s4, 1
    ds_read_b64_tr_b16 v[172:173], v35 offset:33792
    ds_read_b64_tr_b16 v[174:175], v35 offset:35840
    v_mfma_f32_16x16x32_bf16 v[76:79], v[132:135], v[228:231], v[76:79]
    v_lshlrev_b32 v26, 6, v0
    ds_read_b64_tr_b16 v[176:177], v36 offset:33792
    v_mfma_f32_16x16x32_bf16 v[80:83], v[136:139], v[224:227], v[80:83]
    s_sub_u32 s3, 15, s9
    s_lshl_b32 s3, s3, 2
    s_add_u32 s3, s3, s5
    s_lshl_b32 s12, s3, 1
    s_add_u32 s12, s12, s4
    s_lshl_b32 s12, s12, 17
    s_lshl_b32 s3, s6, 12
    s_add_u32 s12, s12, s3
    s_add_u32 s12, s12, 33554432
    ds_read_b64_tr_b16 v[178:179], v36 offset:35840
    v_mfma_f32_16x16x32_bf16 v[84:87], v[136:139], v[228:231], v[84:87]
    v_mov_b32 v1, 1073741824
    ds_read_b64_tr_b16 v[180:181], v37 offset:33792
    v_mfma_f32_16x16x32_bf16 v[88:91], v[140:143], v[224:227], v[88:91]
    v_lshlrev_b32 v2, 6, v0
    ds_read_b64_tr_b16 v[182:183], v37 offset:35840
    v_mfma_f32_16x16x32_bf16 v[92:95], v[140:143], v[228:231], v[92:95]
    v_cmp_gt_u32 vcc, 40, v0
    s_nop 1
    v_cndmask_b32 v54, v1, v2, vcc
    ds_read_b64_tr_b16 v[184:185], v38 offset:33792
    v_mfma_f32_16x16x32_bf16 v[96:99], v[144:147], v[224:227], v[96:99]
    v_cmp_eq_u32 vcc, 0, v0
    s_nop 1
    v_cndmask_b32 v11, v1, v0, vcc
    ds_read_b64_tr_b16 v[186:187], v38 offset:35840
    v_mfma_f32_16x16x32_bf16 v[100:103], v[144:147], v[228:231], v[100:103]
    v_cmp_gt_u32 vcc, 4, v0
    s_nop 1
    v_cndmask_b32 v12, v1, v21, vcc
    ds_read_b64_tr_b16 v[188:189], v39 offset:33792
    v_mfma_f32_16x16x32_bf16 v[104:107], v[148:151], v[224:227], v[104:107]
    ds_read_b64_tr_b16 v[190:191], v39 offset:35840
    v_mfma_f32_16x16x32_bf16 v[108:111], v[148:151], v[228:231], v[108:111]
    v_mfma_f32_16x16x32_bf16 v[112:115], v[152:155], v[224:227], v[112:115]
    v_mfma_f32_16x16x32_bf16 v[116:119], v[152:155], v[228:231], v[116:119]
    v_mfma_f32_16x16x32_bf16 v[120:123], v[156:159], v[224:227], v[120:123]
    v_mfma_f32_16x16x32_bf16 v[124:127], v[156:159], v[228:231], v[124:127]
    s_waitcnt vmcnt(21)
    s_waitcnt lgkmcnt(0)
    s_barrier
    ds_read_b64_tr_b16 v[128:129], v32 offset:49152
    ds_read_b64_tr_b16 v[130:131], v32 offset:51200
    v_mfma_f32_16x16x32_bf16 v[64:67], v[160:163], v[232:235], v[64:67]
    v_mov_b32 v224, 0
    ds_read_b64_tr_b16 v[132:133], v33 offset:49152
    ds_read_b64_tr_b16 v[134:135], v33 offset:51200
    v_mfma_f32_16x16x32_bf16 v[68:71], v[160:163], v[236:239], v[68:71]
    v_mov_b32 v225, 0
    ds_read_b64_tr_b16 v[136:137], v34 offset:49152
    ds_read_b64_tr_b16 v[138:139], v34 offset:51200
    v_mfma_f32_16x16x32_bf16 v[72:75], v[164:167], v[232:235], v[72:75]
    v_mov_b32 v226, 0
    ds_read_b64_tr_b16 v[140:141], v35 offset:49152
    ds_read_b64_tr_b16 v[142:143], v35 offset:51200
    v_mfma_f32_16x16x32_bf16 v[76:79], v[164:167], v[236:239], v[76:79]
    v_mov_b32 v227, 0
    ds_read_b64_tr_b16 v[144:145], v36 offset:49152
    v_mfma_f32_16x16x32_bf16 v[80:83], v[168:171], v[232:235], v[80:83]
    v_mov_b32 v228, 0
    ds_read_b64_tr_b16 v[146:147], v36 offset:51200
    v_mfma_f32_16x16x32_bf16 v[84:87], v[168:171], v[236:239], v[84:87]
    v_mov_b32 v229, 0
    ds_read_b64_tr_b16 v[148:149], v37 offset:49152
    v_mfma_f32_16x16x32_bf16 v[88:91], v[172:175], v[232:235], v[88:91]
    v_mov_b32 v230, 0
    ds_read_b64_tr_b16 v[150:151], v37 offset:51200
    v_mfma_f32_16x16x32_bf16 v[92:95], v[172:175], v[236:239], v[92:95]
    v_mov_b32 v231, 0
    ds_read_b64_tr_b16 v[152:153], v38 offset:49152
    v_mfma_f32_16x16x32_bf16 v[96:99], v[176:179], v[232:235], v[96:99]
    s_add_u32 m0, s53, 65536
    s_add_u32 s15, s52, 32768
    buffer_load_dwordx4 v20, s[36:39], s15 offen offset:0 sc1 lds
    ds_read_b64_tr_b16 v[154:155], v38 offset:51200
    v_mfma_f32_16x16x32_bf16 v[100:103], v[176:179], v[236:239], v[100:103]
    buffer_load_dwordx4 v20, s[36:39], s15 offen offset:1024 sc1 lds
    ds_read_b64_tr_b16 v[156:157], v39 offset:49152
    v_mfma_f32_16x16x32_bf16 v[104:107], v[180:183], v[232:235], v[104:107]
    buffer_load_dwordx4 v20, s[36:39], s15 offen offset:2048 sc1 lds
    ds_read_b64_tr_b16 v[158:159], v39 offset:51200
    v_mfma_f32_16x16x32_bf16 v[108:111], v[180:183], v[236:239], v[108:111]
    buffer_load_dwordx4 v20, s[36:39], s15 offen offset:3072 sc1 lds
    v_mfma_f32_16x16x32_bf16 v[112:115], v[184:187], v[232:235], v[112:115]
    v_mfma_f32_16x16x32_bf16 v[116:119], v[184:187], v[236:239], v[116:119]
    v_mfma_f32_16x16x32_bf16 v[120:123], v[188:191], v[232:235], v[120:123]
    v_mfma_f32_16x16x32_bf16 v[124:127], v[188:191], v[236:239], v[124:127]
    s_waitcnt vmcnt(23)
    s_waitcnt lgkmcnt(0)
    ds_read_b64_tr_b16 v[160:161], v32 offset:50176
    ds_read_b64_tr_b16 v[162:163], v32 offset:52224
    v_mfma_f32_16x16x32_bf16 v[64:67], v[128:131], v[240:243], v[64:67]
    v_mov_b32 v232, 0
    ds_read_b64_tr_b16 v[164:165], v33 offset:50176
    ds_read_b64_tr_b16 v[166:167], v33 offset:52224
    v_mfma_f32_16x16x32_bf16 v[68:71], v[128:131], v[244:247], v[68:71]
    v_mov_b32 v233, 0
    ds_read_b64_tr_b16 v[168:169], v34 offset:50176
    ds_read_b64_tr_b16 v[170:171], v34 offset:52224
    v_mfma_f32_16x16x32_bf16 v[72:75], v[132:135], v[240:243], v[72:75]
    v_mov_b32 v234, 0
    ds_read_b64_tr_b16 v[172:173], v35 offset:50176
    ds_read_b64_tr_b16 v[174:175], v35 offset:52224
    v_mfma_f32_16x16x32_bf16 v[76:79], v[132:135], v[244:247], v[76:79]
    v_mov_b32 v235, 0
    ds_read_b64_tr_b16 v[176:177], v36 offset:50176
    v_mfma_f32_16x16x32_bf16 v[80:83], v[136:139], v[240:243], v[80:83]
    v_mov_b32 v236, 0
    ds_read_b64_tr_b16 v[178:179], v36 offset:52224
    v_mfma_f32_16x16x32_bf16 v[84:87], v[136:139], v[244:247], v[84:87]
    v_mov_b32 v237, 0
    ds_read_b64_tr_b16 v[180:181], v37 offset:50176
    v_mfma_f32_16x16x32_bf16 v[88:91], v[140:143], v[240:243], v[88:91]
    v_mov_b32 v238, 0
    ds_read_b64_tr_b16 v[182:183], v37 offset:52224
    v_mfma_f32_16x16x32_bf16 v[92:95], v[140:143], v[244:247], v[92:95]
    v_mov_b32 v239, 0
    ds_read_b64_tr_b16 v[184:185], v38 offset:50176
    v_mfma_f32_16x16x32_bf16 v[96:99], v[144:147], v[240:243], v[96:99]
    ds_read_b64_tr_b16 v[186:187], v38 offset:52224
    v_mfma_f32_16x16x32_bf16 v[100:103], v[144:147], v[244:247], v[100:103]
    ds_read_b64_tr_b16 v[188:189], v39 offset:50176
    v_mfma_f32_16x16x32_bf16 v[104:107], v[148:151], v[240:243], v[104:107]
    ds_read_b64_tr_b16 v[190:191], v39 offset:52224
    v_mfma_f32_16x16x32_bf16 v[108:111], v[148:151], v[244:247], v[108:111]
    v_mfma_f32_16x16x32_bf16 v[112:115], v[152:155], v[240:243], v[112:115]
    v_mfma_f32_16x16x32_bf16 v[116:119], v[152:155], v[244:247], v[116:119]
    v_mfma_f32_16x16x32_bf16 v[120:123], v[156:159], v[240:243], v[120:123]
    v_mfma_f32_16x16x32_bf16 v[124:127], v[156:159], v[244:247], v[124:127]
    s_waitcnt vmcnt(21)
    s_waitcnt lgkmcnt(0)
    v_add_u32 v32, 0x10000, v32
    v_add_u32 v33, 0x10000, v33
    v_add_u32 v34, 0x10000, v34
    v_add_u32 v35, 0x10000, v35
    v_add_u32 v36, 0x10000, v36
    v_add_u32 v37, 0x10000, v37
    v_add_u32 v38, 0x10000, v38
    v_add_u32 v39, 0x10000, v39
    ds_read_b64_tr_b16 v[128:129], v32 offset:0
    ds_read_b64_tr_b16 v[130:131], v32 offset:2048
    v_mfma_f32_16x16x32_bf16 v[64:67], v[160:163], v[248:251], v[64:67]
    v_mov_b32 v240, 0
    ds_read_b64_tr_b16 v[132:133], v33 offset:0
    ds_read_b64_tr_b16 v[134:135], v33 offset:2048
    v_mfma_f32_16x16x32_bf16 v[68:71], v[160:163], v[252:255], v[68:71]
    v_mov_b32 v241, 0
    ds_read_b64_tr_b16 v[136:137], v34 offset:0
    ds_read_b64_tr_b16 v[138:139], v34 offset:2048
    v_mfma_f32_16x16x32_bf16 v[72:75], v[164:167], v[248:251], v[72:75]
    v_mov_b32 v242, 0
    ds_read_b64_tr_b16 v[140:141], v35 offset:0
    ds_read_b64_tr_b16 v[142:143], v35 offset:2048
    v_mfma_f32_16x16x32_bf16 v[76:79], v[164:167], v[252:255], v[76:79]
    v_mov_b32 v243, 0
    ds_read_b64_tr_b16 v[144:145], v36 offset:0
    v_mfma_f32_16x16x32_bf16 v[80:83], v[168:171], v[248:251], v[80:83]
    v_mov_b32 v244, 0
    ds_read_b64_tr_b16 v[146:147], v36 offset:2048
    v_mfma_f32_16x16x32_bf16 v[84:87], v[168:171], v[252:255], v[84:87]
    v_mov_b32 v245, 0
    ds_read_b64_tr_b16 v[148:149], v37 offset:0
    v_mfma_f32_16x16x32_bf16 v[88:91], v[172:175], v[248:251], v[88:91]
    v_mov_b32 v246, 0
    ds_read_b64_tr_b16 v[150:151], v37 offset:2048
    v_mfma_f32_16x16x32_bf16 v[92:95], v[172:175], v[252:255], v[92:95]
    v_mov_b32 v247, 0
    ds_read_b64_tr_b16 v[152:153], v38 offset:0
    v_mfma_f32_16x16x32_bf16 v[96:99], v[176:179], v[248:251], v[96:99]
    ds_read_b64_tr_b16 v[154:155], v38 offset:2048
    v_mfma_f32_16x16x32_bf16 v[100:103], v[176:179], v[252:255], v[100:103]
    ds_read_b64_tr_b16 v[156:157], v39 offset:0
    v_mfma_f32_16x16x32_bf16 v[104:107], v[180:183], v[248:251], v[104:107]
    ds_read_b64_tr_b16 v[158:159], v39 offset:2048
    v_mfma_f32_16x16x32_bf16 v[108:111], v[180:183], v[252:255], v[108:111]
    v_mfma_f32_16x16x32_bf16 v[112:115], v[184:187], v[248:251], v[112:115]
    v_mfma_f32_16x16x32_bf16 v[116:119], v[184:187], v[252:255], v[116:119]
    v_mfma_f32_16x16x32_bf16 v[120:123], v[188:191], v[248:251], v[120:123]
    v_mfma_f32_16x16x32_bf16 v[124:127], v[188:191], v[252:255], v[124:127]
    s_waitcnt vmcnt(19)
    s_waitcnt lgkmcnt(0)
    ds_read_b64_tr_b16 v[160:161], v32 offset:1024
    ds_read_b64_tr_b16 v[162:163], v32 offset:3072
    v_mfma_f32_16x16x32_bf16 v[64:67], v[128:131], v[192:195], v[64:67]
    v_mov_b32 v248, 0
    ds_read_b64_tr_b16 v[164:165], v33 offset:1024
    ds_read_b64_tr_b16 v[166:167], v33 offset:3072
    v_mfma_f32_16x16x32_bf16 v[68:71], v[128:131], v[196:199], v[68:71]
    v_mov_b32 v249, 0
    ds_read_b64_tr_b16 v[168:169], v34 offset:1024
    ds_read_b64_tr_b16 v[170:171], v34 offset:3072
    v_mfma_f32_16x16x32_bf16 v[72:75], v[132:135], v[192:195], v[72:75]
    v_mov_b32 v250, 0
    ds_read_b64_tr_b16 v[172:173], v35 offset:1024
    ds_read_b64_tr_b16 v[174:175], v35 offset:3072
    v_mfma_f32_16x16x32_bf16 v[76:79], v[132:135], v[196:199], v[76:79]
    v_mov_b32 v251, 0
    ds_read_b64_tr_b16 v[176:177], v36 offset:1024
    v_mfma_f32_16x16x32_bf16 v[80:83], v[136:139], v[192:195], v[80:83]
    v_mov_b32 v252, 0
    ds_read_b64_tr_b16 v[178:179], v36 offset:3072
    v_mfma_f32_16x16x32_bf16 v[84:87], v[136:139], v[196:199], v[84:87]
    v_mov_b32 v253, 0
    ds_read_b64_tr_b16 v[180:181], v37 offset:1024
    v_mfma_f32_16x16x32_bf16 v[88:91], v[140:143], v[192:195], v[88:91]
    v_mov_b32 v254, 0
    ds_read_b64_tr_b16 v[182:183], v37 offset:3072
    v_mfma_f32_16x16x32_bf16 v[92:95], v[140:143], v[196:199], v[92:95]
    v_mov_b32 v255, 0
    ds_read_b64_tr_b16 v[184:185], v38 offset:1024
    v_mfma_f32_16x16x32_bf16 v[96:99], v[144:147], v[192:195], v[96:99]
    ds_read_b64_tr_b16 v[186:187], v38 offset:3072
    v_mfma_f32_16x16x32_bf16 v[100:103], v[144:147], v[196:199], v[100:103]
    ds_read_b64_tr_b16 v[188:189], v39 offset:1024
    v_mfma_f32_16x16x32_bf16 v[104:107], v[148:151], v[192:195], v[104:107]
    ds_read_b64_tr_b16 v[190:191], v39 offset:3072
    v_mfma_f32_16x16x32_bf16 v[108:111], v[148:151], v[196:199], v[108:111]
    v_mfma_f32_16x16x32_bf16 v[112:115], v[152:155], v[192:195], v[112:115]
    v_mfma_f32_16x16x32_bf16 v[116:119], v[152:155], v[196:199], v[116:119]
    v_mfma_f32_16x16x32_bf16 v[120:123], v[156:159], v[192:195], v[120:123]
    v_mfma_f32_16x16x32_bf16 v[124:127], v[156:159], v[196:199], v[124:127]
    s_waitcnt vmcnt(8)
    s_waitcnt lgkmcnt(0)
    ds_read_b64_tr_b16 v[128:129], v32 offset:16384
    ds_read_b64_tr_b16 v[130:131], v32 offset:18432
    v_mfma_f32_16x16x32_bf16 v[64:67], v[160:163], v[200:203], v[64:67]
    v_mov_b32 v192, 0
    ds_read_b64_tr_b16 v[132:133], v33 offset:16384
    ds_read_b64_tr_b16 v[134:135], v33 offset:18432
    v_mfma_f32_16x16x32_bf16 v[68:71], v[160:163], v[204:207], v[68:71]
    v_mov_b32 v193, 0
    ds_read_b64_tr_b16 v[136:137], v34 offset:16384
    ds_read_b64_tr_b16 v[138:139], v34 offset:18432
    v_mfma_f32_16x16x32_bf16 v[72:75], v[164:167], v[200:203], v[72:75]
    v_mov_b32 v194, 0
    ds_read_b64_tr_b16 v[140:141], v35 offset:16384
    ds_read_b64_tr_b16 v[142:143], v35 offset:18432
    v_mfma_f32_16x16x32_bf16 v[76:79], v[164:167], v[204:207], v[76:79]
    v_mov_b32 v195, 0
    ds_read_b64_tr_b16 v[144:145], v36 offset:16384
    v_mfma_f32_16x16x32_bf16 v[80:83], v[168:171], v[200:203], v[80:83]
    v_mov_b32 v196, 0
    ds_read_b64_tr_b16 v[146:147], v36 offset:18432
    v_mfma_f32_16x16x32_bf16 v[84:87], v[168:171], v[204:207], v[84:87]
    v_mov_b32 v197, 0
    ds_read_b64_tr_b16 v[148:149], v37 offset:16384
    v_mfma_f32_16x16x32_bf16 v[88:91], v[172:175], v[200:203], v[88:91]
    v_mov_b32 v198, 0
    ds_read_b64_tr_b16 v[150:151], v37 offset:18432
    v_mfma_f32_16x16x32_bf16 v[92:95], v[172:175], v[204:207], v[92:95]
    v_mov_b32 v199, 0
    ds_read_b64_tr_b16 v[152:153], v38 offset:16384
    v_mfma_f32_16x16x32_bf16 v[96:99], v[176:179], v[200:203], v[96:99]
    buffer_load_dword v29, v31, s[36:39], s18 offen sc1
    ds_read_b64_tr_b16 v[154:155], v38 offset:18432
    v_mfma_f32_16x16x32_bf16 v[100:103], v[176:179], v[204:207], v[100:103]
    s_mov_b32 s11, 0x3e0293ee
    ds_read_b64_tr_b16 v[156:157], v39 offset:16384
    v_mfma_f32_16x16x32_bf16 v[104:107], v[180:183], v[200:203], v[104:107]
    ds_read_b64_tr_b16 v[158:159], v39 offset:18432
    v_mfma_f32_16x16x32_bf16 v[108:111], v[180:183], v[204:207], v[108:111]
    v_mfma_f32_16x16x32_bf16 v[112:115], v[184:187], v[200:203], v[112:115]
    v_mfma_f32_16x16x32_bf16 v[116:119], v[184:187], v[204:207], v[116:119]
    v_mfma_f32_16x16x32_bf16 v[120:123], v[188:191], v[200:203], v[120:123]
    v_mfma_f32_16x16x32_bf16 v[124:127], v[188:191], v[204:207], v[124:127]
    s_waitcnt vmcnt(7)
    s_waitcnt lgkmcnt(0)
    ds_read_b64_tr_b16 v[160:161], v32 offset:17408
    ds_read_b64_tr_b16 v[162:163], v32 offset:19456
    v_mfma_f32_16x16x32_bf16 v[64:67], v[128:131], v[208:211], v[64:67]
    v_mov_b32 v200, 0
    ds_read_b64_tr_b16 v[164:165], v33 offset:17408
    ds_read_b64_tr_b16 v[166:167], v33 offset:19456
    v_mfma_f32_16x16x32_bf16 v[68:71], v[128:131], v[212:215], v[68:71]
    v_mov_b32 v201, 0
    ds_read_b64_tr_b16 v[168:169], v34 offset:17408
    ds_read_b64_tr_b16 v[170:171], v34 offset:19456
    v_mfma_f32_16x16x32_bf16 v[72:75], v[132:135], v[208:211], v[72:75]
    v_mov_b32 v202, 0
    ds_read_b64_tr_b16 v[172:173], v35 offset:17408
    ds_read_b64_tr_b16 v[174:175], v35 offset:19456
    v_mfma_f32_16x16x32_bf16 v[76:79], v[132:135], v[212:215], v[76:79]
    v_mov_b32 v203, 0
    ds_read_b64_tr_b16 v[176:177], v36 offset:17408
    v_mfma_f32_16x16x32_bf16 v[80:83], v[136:139], v[208:211], v[80:83]
    v_mov_b32 v204, 0
    ds_read_b64_tr_b16 v[178:179], v36 offset:19456
    v_mfma_f32_16x16x32_bf16 v[84:87], v[136:139], v[212:215], v[84:87]
    v_mov_b32 v205, 0
    ds_read_b64_tr_b16 v[180:181], v37 offset:17408
    v_mfma_f32_16x16x32_bf16 v[88:91], v[140:143], v[208:211], v[88:91]
    v_mov_b32 v206, 0
    ds_read_b64_tr_b16 v[182:183], v37 offset:19456
    v_mfma_f32_16x16x32_bf16 v[92:95], v[140:143], v[212:215], v[92:95]
    v_mov_b32 v207, 0
    ds_read_b64_tr_b16 v[184:185], v38 offset:17408
    v_mfma_f32_16x16x32_bf16 v[96:99], v[144:147], v[208:211], v[96:99]
    ds_read_b64_tr_b16 v[186:187], v38 offset:19456
    v_mfma_f32_16x16x32_bf16 v[100:103], v[144:147], v[212:215], v[100:103]
    ds_read_b64_tr_b16 v[188:189], v39 offset:17408
    v_mfma_f32_16x16x32_bf16 v[104:107], v[148:151], v[208:211], v[104:107]
    ds_read_b64_tr_b16 v[190:191], v39 offset:19456
    v_mfma_f32_16x16x32_bf16 v[108:111], v[148:151], v[212:215], v[108:111]
    v_mfma_f32_16x16x32_bf16 v[112:115], v[152:155], v[208:211], v[112:115]
    v_mfma_f32_16x16x32_bf16 v[116:119], v[152:155], v[212:215], v[116:119]
    v_mfma_f32_16x16x32_bf16 v[120:123], v[156:159], v[208:211], v[120:123]
    v_mfma_f32_16x16x32_bf16 v[124:127], v[156:159], v[212:215], v[124:127]
    s_waitcnt vmcnt(5)
    s_waitcnt lgkmcnt(0)
    v_mfma_f32_16x16x32_bf16 v[64:67], v[160:163], v[216:219], v[64:67]
    v_mov_b32 v208, 0
    v_mfma_f32_16x16x32_bf16 v[68:71], v[160:163], v[220:223], v[68:71]
    v_mov_b32 v209, 0
    v_mfma_f32_16x16x32_bf16 v[72:75], v[164:167], v[216:219], v[72:75]
    v_mov_b32 v210, 0
    v_mfma_f32_16x16x32_bf16 v[76:79], v[164:167], v[220:223], v[76:79]
    v_mov_b32 v211, 0
    v_mfma_f32_16x16x32_bf16 v[80:83], v[168:171], v[216:219], v[80:83]
    v_mov_b32 v212, 0
    v_mfma_f32_16x16x32_bf16 v[84:87], v[168:171], v[220:223], v[84:87]
    v_mov_b32 v213, 0
    v_mfma_f32_16x16x32_bf16 v[88:91], v[172:175], v[216:219], v[88:91]
    v_mov_b32 v214, 0
    v_mul_f32 v64, s11, v64
    v_mul_f32 v65, s11, v65
    v_mul_f32 v66, s11, v66
    v_mul_f32 v67, s11, v67
    v_mul_f32 v72, s11, v72
    v_mul_f32 v73, s11, v73
    v_mul_f32 v74, s11, v74
    v_mul_f32 v75, s11, v75
    v_cvt_pk_bf16_f32 v128, v64, v65
    v_cvt_pk_bf16_f32 v129, v66, v67
    v_cvt_pk_bf16_f32 v130, v72, v73
    v_cvt_pk_bf16_f32 v131, v74, v75
    v_mul_f32 v68, s11, v68
    v_mul_f32 v69, s11, v69
    v_mul_f32 v70, s11, v70
    v_mul_f32 v71, s11, v71
    v_mul_f32 v76, s11, v76
    v_mul_f32 v77, s11, v77
    v_mul_f32 v78, s11, v78
    v_mul_f32 v79, s11, v79
    v_cvt_pk_bf16_f32 v132, v68, v69
    v_cvt_pk_bf16_f32 v133, v70, v71
    v_cvt_pk_bf16_f32 v134, v76, v77
    v_cvt_pk_bf16_f32 v135, v78, v79
    v_mfma_f32_16x16x32_bf16 v[92:95], v[172:175], v[220:223], v[92:95]
    v_mov_b32 v215, 0
    v_mfma_f32_16x16x32_bf16 v[96:99], v[176:179], v[216:219], v[96:99]
    v_mfma_f32_16x16x32_bf16 v[100:103], v[176:179], v[220:223], v[100:103]
    v_mfma_f32_16x16x32_bf16 v[104:107], v[180:183], v[216:219], v[104:107]
    v_mul_f32 v80, s11, v80
    v_mul_f32 v81, s11, v81
    v_mul_f32 v82, s11, v82
    v_mul_f32 v83, s11, v83
    v_mul_f32 v88, s11, v88
    v_mul_f32 v89, s11, v89
    v_mul_f32 v90, s11, v90
    v_mul_f32 v91, s11, v91
    v_cvt_pk_bf16_f32 v136, v80, v81
    v_cvt_pk_bf16_f32 v137, v82, v83
    v_cvt_pk_bf16_f32 v138, v88, v89
    v_cvt_pk_bf16_f32 v139, v90, v91
    v_mul_f32 v84, s11, v84
    v_mul_f32 v85, s11, v85
    v_mul_f32 v86, s11, v86
    v_mul_f32 v87, s11, v87
    v_mul_f32 v92, s11, v92
    v_mul_f32 v93, s11, v93
    v_mul_f32 v94, s11, v94
    v_mul_f32 v95, s11, v95
    v_cvt_pk_bf16_f32 v140, v84, v85
    v_cvt_pk_bf16_f32 v141, v86, v87
    v_cvt_pk_bf16_f32 v142, v92, v93
    v_cvt_pk_bf16_f32 v143, v94, v95
    v_mfma_f32_16x16x32_bf16 v[108:111], v[180:183], v[220:223], v[108:111]
    v_mfma_f32_16x16x32_bf16 v[112:115], v[184:187], v[216:219], v[112:115]
    v_mfma_f32_16x16x32_bf16 v[116:119], v[184:187], v[220:223], v[116:119]
    v_mfma_f32_16x16x32_bf16 v[120:123], v[188:191], v[216:219], v[120:123]
    v_mul_f32 v96, s11, v96
    v_mul_f32 v97, s11, v97
    v_mul_f32 v98, s11, v98
    v_mul_f32 v99, s11, v99
    v_mul_f32 v104, s11, v104
    v_mul_f32 v105, s11, v105
    v_mul_f32 v106, s11, v106
    v_mul_f32 v107, s11, v107
    v_cvt_pk_bf16_f32 v144, v96, v97
    v_cvt_pk_bf16_f32 v145, v98, v99
    v_cvt_pk_bf16_f32 v146, v104, v105
    v_cvt_pk_bf16_f32 v147, v106, v107
    v_mul_f32 v100, s11, v100
    v_mul_f32 v101, s11, v101
    v_mul_f32 v102, s11, v102
    v_mul_f32 v103, s11, v103
    v_mul_f32 v108, s11, v108
    v_mul_f32 v109, s11, v109
    v_mul_f32 v110, s11, v110
    v_mul_f32 v111, s11, v111
    v_cvt_pk_bf16_f32 v148, v100, v101
    v_cvt_pk_bf16_f32 v149, v102, v103
    v_cvt_pk_bf16_f32 v150, v108, v109
    v_cvt_pk_bf16_f32 v151, v110, v111
    v_mfma_f32_16x16x32_bf16 v[124:127], v[188:191], v[220:223], v[124:127]
    v_mul_f32 v112, s11, v112
    v_mul_f32 v113, s11, v113
    v_mul_f32 v114, s11, v114
    v_mul_f32 v115, s11, v115
    v_mul_f32 v120, s11, v120
    v_mul_f32 v121, s11, v121
    v_mul_f32 v122, s11, v122
    v_mul_f32 v123, s11, v123
    v_cvt_pk_bf16_f32 v152, v112, v113
    v_cvt_pk_bf16_f32 v153, v114, v115
    v_cvt_pk_bf16_f32 v154, v120, v121
    v_cvt_pk_bf16_f32 v155, v122, v123
    v_mul_f32 v116, s11, v116
    v_mul_f32 v117, s11, v117
    v_mul_f32 v118, s11, v118
    v_mul_f32 v119, s11, v119
    v_mul_f32 v124, s11, v124
    v_mul_f32 v125, s11, v125
    v_mul_f32 v126, s11, v126
    v_mul_f32 v127, s11, v127
    v_cvt_pk_bf16_f32 v156, v116, v117
    v_cvt_pk_bf16_f32 v157, v118, v119
    v_cvt_pk_bf16_f32 v158, v124, v125
    v_cvt_pk_bf16_f32 v159, v126, v127
    v_mov_b32 v216, 0
    v_mov_b32 v217, 0
    v_mov_b32 v218, 0
    v_mov_b32 v219, 0
    v_mov_b32 v220, 0
    v_mov_b32 v221, 0
    v_mov_b32 v222, 0
    v_mov_b32 v223, 0
    v_mov_b32 v72, 0
    v_mov_b32 v73, 0
    v_mov_b32 v74, 0
    v_mov_b32 v75, 0
    v_mov_b32 v76, 0
    v_mov_b32 v77, 0
    v_mov_b32 v78, 0
    v_mov_b32 v79, 0
k1_att:
    s_waitcnt vmcnt(0)
    v_cmp_le_u32 vcc, 2, v29
    s_nop 0
    s_or_b32 s3, vcc_lo, s60
    s_and_b32 s3, s3, 255
    s_cmp_eq_u32 s3, 255
    s_cbranch_scc0 k1_spin17
k1_back18:
    v_mov_b32 v29, 0
    s_barrier
    s_cmp_lg_u32 s4, 0
    s_cbranch_scc1 k1_a19
    ds_write_b128 v27, v[128:131] offset:0
    ds_write_b128 v27, v[132:135] offset:1024
    ds_write_b128 v27, v[136:139] offset:2048
    ds_write_b128 v27, v[140:143] offset:3072
    ds_write_b128 v27, v[144:147] offset:4096
    ds_write_b128 v27, v[148:151] offset:5120
    ds_write_b128 v27, v[152:155] offset:6144
    ds_write_b128 v27, v[156:159] offset:7168
    s_lshr_b32 s54, s44, 4
    s_lshr_b32 s55, s45, 4
    v_add_u32 v1, s54, v0
    v_mul_u32_u24 v2, 52429, v1
    v_lshrrev_b32 v2, 20, v2
    v_mul_u32_u24 v32, 20, v2
    v_sub_u32 v1, v1, v32
    v_bfe_u32 v32, v2, 2, 1
    v_xor_b32 v1, v1, v32
    v_mul_u32_u24 v2, 1280, v2
    v_lshl_add_u32 v32, v1, 4, v2
    v_add_u32 v1, s54, v0
    v_add_u32 v1, 64, v1
    v_mul_u32_u24 v2, 52429, v1
    v_lshrrev_b32 v2, 20, v2
    v_mul_u32_u24 v33, 20, v2
    v_sub_u32 v1, v1, v33
    v_bfe_u32 v33, v2, 2, 1
    v_xor_b32 v1, v1, v33
    v_mul_u32_u24 v2, 1280, v2
    v_lshl_add_u32 v33, v1, 4, v2
    v_add_u32 v1, s54, v0
    v_add_u32 v1, 128, v1
    v_mul_u32_u24 v2, 52429, v1
    v_lshrrev_b32 v2, 20, v2
    v_mul_u32_u24 v34, 20, v2
    v_sub_u32 v1, v1, v34
    v_bfe_u32 v34, v2, 2, 1
    v_xor_b32 v1, v1, v34
    v_mul_u32_u24 v2, 1280, v2
    v_lshl_add_u32 v34, v1, 4, v2
    v_add_u32 v1, s54, v0
    v_add_u32 v1, 192, v1
    v_mul_u32_u24 v2, 52429, v1
    v_lshrrev_b32 v2, 20, v2
    v_mul_u32_u24 v35, 20, v2
    v_sub_u32 v1, v1, v35
    v_bfe_u32 v35, v2, 2, 1
    v_xor_b32 v1, v1, v35
    v_mul_u32_u24 v2, 1280, v2
    v_lshl_add_u32 v35, v1, 4, v2
    v_add_u32 v1, s54, v0
    v_add_u32 v1, 256, v1
    v_mul_u32_u24 v2, 52429, v1
    v_lshrrev_b32 v2, 20, v2
    v_mul_u32_u24 v36, 20, v2
    v_sub_u32 v1, v1, v36
    v_bfe_u32 v36, v2, 2, 1
    v_xor_b32 v1, v1, v36
    v_mul_u32_u24 v2, 1280, v2
    v_lshl_add_u32 v36, v1, 4, v2
    v_add_u32 v1, s55, v0
    v_mul_u32_u24 v2, 52429, v1
    v_lshrrev_b32 v2, 20, v2
    v_mul_u32_u24 v37, 20, v2
    v_sub_u32 v1, v1, v37
    v_bfe_u32 v37, v2, 2, 1
    v_xor_b32 v1, v1, v37
    v_mul_u32_u24 v2, 1280, v2
    v_lshl_add_u32 v37, v1, 4, v2
    v_add_u32 v1, s55, v0
    v_add_u32 v1, 64, v1
    v_mul_u32_u24 v2, 52429, v1
    v_lshrrev_b32 v2, 20, v2
    v_mul_u32_u24 v38, 20, v2
    v_sub_u32 v1, v1, v38
    v_bfe_u32 v38, v2, 2, 1
    v_xor_b32 v1, v1, v38
    v_mul_u32_u24 v2, 1280, v2
    v_lshl_add_u32 v38, v1, 4, v2
    v_add_u32 v1, s55, v0
    v_add_u32 v1, 128, v1
    v_mul_u32_u24 v2, 52429, v1
    v_lshrrev_b32 v2, 20, v2
    v_mul_u32_u24 v39, 20, v2
    v_sub_u32 v1, v1, v39
    v_bfe_u32 v39, v2, 2, 1
    v_xor_b32 v1, v1, v39
    v_mul_u32_u24 v2, 1280, v2
    v_lshl_add_u32 v39, v1, 4, v2
    v_add_u32 v1, s55, v0
    v_add_u32 v1, 192, v1
    v_mul_u32_u24 v2, 52429, v1
    v_lshrrev_b32 v2, 20, v2
    v_mul_u32_u24 v52, 20, v2
    v_sub_u32 v1, v1, v52
    v_bfe_u32 v52, v2, 2, 1
    v_xor_b32 v1, v1, v52
    v_mul_u32_u24 v2, 1280, v2
    v_lshl_add_u32 v52, v1, 4, v2
    s_waitcnt lgkmcnt(0)
    s_barrier
k1_a19:
    s_setprio 1
    ds_read_b128 v[80:83], v15 offset:0
    ds_read_b128 v[84:87], v15 offset:4096
    ds_read_b128 v[88:91], v15 offset:8192
    ds_read_b128 v[92:95], v15 offset:12288
    ds_read_b128 v[96:99], v15 offset:1024
    ds_read_b128 v[100:103], v15 offset:5120
    ds_read_b128 v[104:107], v15 offset:9216
    s_waitcnt lgkmcnt(6)
    v_mfma_f32_16x16x32_bf16 v[160:163], v[80:83], v[128:131], v[72:75]
    ds_read_b128 v[108:111], v15 offset:13312
    v_mfma_f32_16x16x32_bf16 v[164:167], v[80:83], v[132:135], v[76:79]
    s_waitcnt lgkmcnt(6)
    v_mfma_f32_16x16x32_bf16 v[168:171], v[84:87], v[128:131], v[72:75]
    ds_read_b128 v[80:83], v15 offset:2048
    v_mfma_f32_16x16x32_bf16 v[172:175], v[84:87], v[132:135], v[76:79]
    s_waitcnt lgkmcnt(6)
    v_mfma_f32_16x16x32_bf16 v[176:179], v[88:91], v[128:131], v[72:75]
    ds_read_b128 v[84:87], v15 offset:6144
    v_mfma_f32_16x16x32_bf16 v[180:183], v[88:91], v[132:135], v[76:79]
    s_waitcnt lgkmcnt(6)
    v_mfma_f32_16x16x32_bf16 v[184:187], v[92:95], v[128:131], v[72:75]
    ds_read_b128 v[88:91], v15 offset:10240
    v_mfma_f32_16x16x32_bf16 v[188:191], v[92:95], v[132:135], v[76:79]
    s_waitcnt lgkmcnt(6)
    v_mfma_f32_16x16x32_bf16 v[160:163], v[96:99], v[136:139], v[160:163]
    ds_read_b128 v[92:95], v15 offset:14336
    v_mfma_f32_16x16x32_bf16 v[164:167], v[96:99], v[140:143], v[164:167]
    s_waitcnt lgkmcnt(6)
    v_mfma_f32_16x16x32_bf16 v[168:171], v[100:103], v[136:139], v[168:171]
    ds_read_b128 v[96:99], v15 offset:3072
    v_mfma_f32_16x16x32_bf16 v[172:175], v[100:103], v[140:143], v[172:175]
    s_waitcnt lgkmcnt(6)
    v_mfma_f32_16x16x32_bf16 v[176:179], v[104:107], v[136:139], v[176:179]
    ds_read_b128 v[100:103], v15 offset:7168
    v_mfma_f32_16x16x32_bf16 v[180:183], v[104:107], v[140:143], v[180:183]
    s_waitcnt lgkmcnt(6)
    v_mfma_f32_16x16x32_bf16 v[184:187], v[108:111], v[136:139], v[184:187]
    ds_read_b128 v[104:107], v15 offset:11264
    v_mfma_f32_16x16x32_bf16 v[188:191], v[108:111], v[140:143], v[188:191]
    s_waitcnt lgkmcnt(6)
    v_mfma_f32_16x16x32_bf16 v[160:163], v[80:83], v[144:147], v[160:163]
    ds_read_b128 v[108:111], v15 offset:15360
    v_mfma_f32_16x16x32_bf16 v[164:167], v[80:83], v[148:151], v[164:167]
    s_waitcnt lgkmcnt(6)
    v_mfma_f32_16x16x32_bf16 v[168:171], v[84:87], v[144:147], v[168:171]
    v_mfma_f32_16x16x32_bf16 v[172:175], v[84:87], v[148:151], v[172:175]
    s_waitcnt lgkmcnt(5)
    v_mfma_f32_16x16x32_bf16 v[176:179], v[88:91], v[144:147], v[176:179]
    v_mfma_f32_16x16x32_bf16 v[180:183], v[88:91], v[148:151], v[180:183]
    s_waitcnt lgkmcnt(4)
    v_mfma_f32_16x16x32_bf16 v[184:187], v[92:95], v[144:147], v[184:187]
    v_mfma_f32_16x16x32_bf16 v[188:191], v[92:95], v[148:151], v[188:191]
    s_waitcnt lgkmcnt(3)
    v_mfma_f32_16x16x32_bf16 v[160:163], v[96:99], v[152:155], v[160:163]
    v_mfma_f32_16x16x32_bf16 v[164:167], v[96:99], v[156:159], v[164:167]
    s_waitcnt lgkmcnt(2)
    v_mfma_f32_16x16x32_bf16 v[168:171], v[100:103], v[152:155], v[168:171]
    v_mfma_f32_16x16x32_bf16 v[172:175], v[100:103], v[156:159], v[172:175]
    s_waitcnt lgkmcnt(1)
    v_mfma_f32_16x16x32_bf16 v[176:179], v[104:107], v[152:155], v[176:179]
    v_mfma_f32_16x16x32_bf16 v[180:183], v[104:107], v[156:159], v[180:183]
    s_waitcnt lgkmcnt(0)
    v_mfma_f32_16x16x32_bf16 v[184:187], v[108:111], v[152:155], v[184:187]
    v_mfma_f32_16x16x32_bf16 v[188:191], v[108:111], v[156:159], v[188:191]
    s_setprio 0
    v_xor_b32 v15, 0x10000, v15
    s_barrier
k1_loop20:
    s_cmp_lg_u32 s50, s13
    s_cbranch_scc1 k1_nofin24
    s_lshl_b32 s54, s9, 2
    s_add_u32 s54, s54, s5
    s_lshl_b32 s54, s54, 18
    s_lshl_b32 s55, s6, 12
    s_add_u32 s54, s54, s55
    s_add_u32 s54, s54, 33554432
    s_add_u32 s55, s54, 0x20000
    v_rcp_f32 v56, v44
    v_rcp_f32 v57, v48
    v_mov_b32 v44, 0
    v_mov_b32 v45, 0
    v_mov_b32 v46, 0
    v_mov_b32 v47, 0
    v_mov_b32 v48, 0
    v_mov_b32 v49, 0
    v_mov_b32 v50, 0
    v_mov_b32 v51, 0
    v_mul_f32 v192, v192, v56
    v_mul_f32 v193, v193, v56
    v_mul_f32 v194, v194, v56
    v_mul_f32 v195, v195, v56
    v_mul_f32 v200, v200, v56
    v_mul_f32 v201, v201, v56
    v_mul_f32 v202, v202, v56
    v_mul_f32 v203, v203, v56
    v_cvt_pk_bf16_f32 v80, v192, v193
    v_cvt_pk_bf16_f32 v81, v194, v195
    v_cvt_pk_bf16_f32 v82, v200, v201
    v_cvt_pk_bf16_f32 v83, v202, v203
    buffer_store_dwordx4 v[80:83], v20, s[36:39], s54 offen offset:0 sc1
    v_mov_b32 v192, 0
    v_mov_b32 v193, 0
    v_mov_b32 v194, 0
    v_mov_b32 v195, 0
    v_mov_b32 v200, 0
    v_mov_b32 v201, 0
    v_mov_b32 v202, 0
    v_mov_b32 v203, 0
    v_mul_f32 v196, v196, v57
    v_mul_f32 v197, v197, v57
    v_mul_f32 v198, v198, v57
    v_mul_f32 v199, v199, v57
    v_mul_f32 v204, v204, v57
    v_mul_f32 v205, v205, v57
    v_mul_f32 v206, v206, v57
    v_mul_f32 v207, v207, v57
    v_cvt_pk_bf16_f32 v84, v196, v197
    v_cvt_pk_bf16_f32 v85, v198, v199
    v_cvt_pk_bf16_f32 v86, v204, v205
    v_cvt_pk_bf16_f32 v87, v206, v207
    buffer_store_dwordx4 v[84:87], v20, s[36:39], s55 offen offset:0 sc1
    v_mov_b32 v196, 0
    v_mov_b32 v197, 0
    v_mov_b32 v198, 0
    v_mov_b32 v199, 0
    v_mov_b32 v204, 0
    v_mov_b32 v205, 0
    v_mov_b32 v206, 0
    v_mov_b32 v207, 0
    v_mul_f32 v208, v208, v56
    v_mul_f32 v209, v209, v56
    v_mul_f32 v210, v210, v56
    v_mul_f32 v211, v211, v56
    v_mul_f32 v216, v216, v56
    v_mul_f32 v217, v217, v56
    v_mul_f32 v218, v218, v56
    v_mul_f32 v219, v219, v56
    v_cvt_pk_bf16_f32 v88, v208, v209
    v_cvt_pk_bf16_f32 v89, v210, v211
    v_cvt_pk_bf16_f32 v90, v216, v217
    v_cvt_pk_bf16_f32 v91, v218, v219
    buffer_store_dwordx4 v[88:91], v20, s[36:39], s54 offen offset:1024 sc1
    v_mov_b32 v208, 0
    v_mov_b32 v209, 0
    v_mov_b32 v210, 0
    v_mov_b32 v211, 0
    v_mov_b32 v216, 0
    v_mov_b32 v217, 0
    v_mov_b32 v218, 0
    v_mov_b32 v219, 0
    v_mul_f32 v212, v212, v57
    v_mul_f32 v213, v213, v57
    v_mul_f32 v214, v214, v57
    v_mul_f32 v215, v215, v57
    v_mul_f32 v220, v220, v57
    v_mul_f32 v221, v221, v57
    v_mul_f32 v222, v222, v57
    v_mul_f32 v223, v223, v57
    v_cvt_pk_bf16_f32 v92, v212, v213
    v_cvt_pk_bf16_f32 v93, v214, v215
    v_cvt_pk_bf16_f32 v94, v220, v221
    v_cvt_pk_bf16_f32 v95, v222, v223
    buffer_store_dwordx4 v[92:95], v20, s[36:39], s55 offen offset:1024 sc1
    v_mov_b32 v212, 0
    v_mov_b32 v213, 0
    v_mov_b32 v214, 0
    v_mov_b32 v215, 0
    v_mov_b32 v220, 0
    v_mov_b32 v221, 0
    v_mov_b32 v222, 0
    v_mov_b32 v223, 0
    v_mul_f32 v224, v224, v56
    v_mul_f32 v225, v225, v56
    v_mul_f32 v226, v226, v56
    v_mul_f32 v227, v227, v56
    v_mul_f32 v232, v232, v56
    v_mul_f32 v233, v233, v56
    v_mul_f32 v234, v234, v56
    v_mul_f32 v235, v235, v56
    v_cvt_pk_bf16_f32 v96, v224, v225
    v_cvt_pk_bf16_f32 v97, v226, v227
    v_cvt_pk_bf16_f32 v98, v232, v233
    v_cvt_pk_bf16_f32 v99, v234, v235
    buffer_store_dwordx4 v[96:99], v20, s[36:39], s54 offen offset:2048 sc1
    v_mov_b32 v224, 0
    v_mov_b32 v225, 0
    v_mov_b32 v226, 0
    v_mov_b32 v227, 0
    v_mov_b32 v232, 0
    v_mov_b32 v233, 0
    v_mov_b32 v234, 0
    v_mov_b32 v235, 0
    v_mul_f32 v228, v228, v57
    v_mul_f32 v229, v229, v57
    v_mul_f32 v230, v230, v57
    v_mul_f32 v231, v231, v57
    v_mul_f32 v236, v236, v57
    v_mul_f32 v237, v237, v57
    v_mul_f32 v238, v238, v57
    v_mul_f32 v239, v239, v57
    v_cvt_pk_bf16_f32 v100, v228, v229
    v_cvt_pk_bf16_f32 v101, v230, v231
    v_cvt_pk_bf16_f32 v102, v236, v237
    v_cvt_pk_bf16_f32 v103, v238, v239
    buffer_store_dwordx4 v[100:103], v20, s[36:39], s55 offen offset:2048 sc1
    v_mov_b32 v228, 0
    v_mov_b32 v229, 0
    v_mov_b32 v230, 0
    v_mov_b32 v231, 0
    v_mov_b32 v236, 0
    v_mov_b32 v237, 0
    v_mov_b32 v238, 0
    v_mov_b32 v239, 0
    v_mul_f32 v240, v240, v56
    v_mul_f32 v241, v241, v56
    v_mul_f32 v242, v242, v56
    v_mul_f32 v243, v243, v56
    v_mul_f32 v248, v248, v56
    v_mul_f32 v249, v249, v56
    v_mul_f32 v250, v250, v56
    v_mul_f32 v251, v251, v56
    v_cvt_pk_bf16_f32 v104, v240, v241
    v_cvt_pk_bf16_f32 v105, v242, v243
    v_cvt_pk_bf16_f32 v106, v248, v249
    v_cvt_pk_bf16_f32 v107, v250, v251
    buffer_store_dwordx4 v[104:107], v20, s[36:39], s54 offen offset:3072 sc1
    v_mov_b32 v240, 0
    v_mov_b32 v241, 0
    v_mov_b32 v242, 0
    v_mov_b32 v243, 0
    v_mov_b32 v248, 0
    v_mov_b32 v249, 0
    v_mov_b32 v250, 0
    v_mov_b32 v251, 0
    v_mul_f32 v244, v244, v57
    v_mul_f32 v245, v245, v57
    v_mul_f32 v246, v246, v57
    v_mul_f32 v247, v247, v57
    v_mul_f32 v252, v252, v57
    v_mul_f32 v253, v253, v57
    v_mul_f32 v254, v254, v57
    v_mul_f32 v255, v255, v57
    v_cvt_pk_bf16_f32 v108, v244, v245
    v_cvt_pk_bf16_f32 v109, v246, v247
    v_cvt_pk_bf16_f32 v110, v252, v253
    v_cvt_pk_bf16_f32 v111, v254, v255
    buffer_store_dwordx4 v[108:111], v20, s[36:39], s55 offen offset:3072 sc1
    v_mov_b32 v244, 0
    v_mov_b32 v245, 0
    v_mov_b32 v246, 0
    v_mov_b32 v247, 0
    v_mov_b32 v252, 0
    v_mov_b32 v253, 0
    v_mov_b32 v254, 0
    v_mov_b32 v255, 0
k1_nofin24:
    s_cmp_lg_u32 s50, 13
    s_cbranch_scc1 k1_nopf25
    buffer_load_dword v53, v54, s[28:31], s46 offen
k1_nopf25:
    s_lshl_b32 s3, s22, 8
    s_add_u32 s3, s3, s50
    s_cmp_lg_u32 s3, 12
    s_cbranch_scc1 k1_nofl326
    s_lshl_b32 s3, s2, 2
    s_add_u32 s3, s3, 83976192
    buffer_store_dword v30, v11, s[36:39], s3 offen sc1
k1_nofl326:
    s_lshl_b32 s56, s59, 15
    s_add_u32 s56, s56, s52
    s_add_u32 s56, s56, 16384
    s_and_b32 s55, s50, 1
    s_lshl_b32 s55, s55, 16
    s_add_u32 s55, s55, s53
    s_xor_b32 s57, s55, 0x14000
    s_add_u32 s58, s50, 2
    s_lshl_b32 s54, s58, 1
    s_add_u32 s54, s54, s8
    s_cmp_lt_u32 s58, s7
    s_cselect_b32 s59, s58, s54
    s_lshl_b32 s54, s59, 15
    s_add_u32 s54, s54, s52
    s_cmp_gt_u32 s58, 16
    s_cselect_b32 s42, 0, s38
    s_sub_u32 s3, s50, s10
    s_cmp_ge_u32 s3, 2
    s_cbranch_scc1 k1_nomask27
    s_lshl_b32 s3, s3, 6
    v_subrev_u32 v18, s3, v17
    v_cmp_le_i32 s[94:95], 0, v18
    v_cmp_le_i32 s[96:97], 1, v18
    v_cmp_le_i32 s[98:99], 2, v18
    v_cmp_le_i32 s[100:101], 3, v18
    v_cndmask_b32 v160, v19, v160, s[94:95]
    v_cndmask_b32 v161, v19, v161, s[96:97]
    v_cndmask_b32 v162, v19, v162, s[98:99]
    v_cndmask_b32 v163, v19, v163, s[100:101]
    v_cmp_le_i32 s[94:95], -16, v18
    v_cmp_le_i32 s[96:97], -15, v18
    v_cmp_le_i32 s[98:99], -14, v18
    v_cmp_le_i32 s[100:101], -13, v18
    v_cndmask_b32 v164, v19, v164, s[94:95]
    v_cndmask_b32 v165, v19, v165, s[96:97]
    v_cndmask_b32 v166, v19, v166, s[98:99]
    v_cndmask_b32 v167, v19, v167, s[100:101]
    v_cmp_le_i32 s[94:95], 16, v18
    v_cmp_le_i32 s[96:97], 17, v18
    v_cmp_le_i32 s[98:99], 18, v18
    v_cmp_le_i32 s[100:101], 19, v18
    v_cndmask_b32 v168, v19, v168, s[94:95]
    v_cndmask_b32 v169, v19, v169, s[96:97]
    v_cndmask_b32 v170, v19, v170, s[98:99]
    v_cndmask_b32 v171, v19, v171, s[100:101]
    v_cmp_le_i32 s[94:95], 0, v18
    v_cmp_le_i32 s[96:97], 1, v18
    v_cmp_le_i32 s[98:99], 2, v18
    v_cmp_le_i32 s[100:101], 3, v18
    v_cndmask_b32 v172, v19, v172, s[94:95]
    v_cndmask_b32 v173, v19, v173, s[96:97]
    v_cndmask_b32 v174, v19, v174, s[98:99]
    v_cndmask_b32 v175, v19, v175, s[100:101]
    v_cmp_le_i32 s[94:95], 32, v18
    v_cmp_le_i32 s[96:97], 33, v18
    v_cmp_le_i32 s[98:99], 34, v18
    v_cmp_le_i32 s[100:101], 35, v18
    v_cndmask_b32 v176, v19, v176, s[94:95]
    v_cndmask_b32 v177, v19, v177, s[96:97]
    v_cndmask_b32 v178, v19, v178, s[98:99]
    v_cndmask_b32 v179, v19, v179, s[100:101]
    v_cmp_le_i32 s[94:95], 16, v18
    v_cmp_le_i32 s[96:97], 17, v18
    v_cmp_le_i32 s[98:99], 18, v18
    v_cmp_le_i32 s[100:101], 19, v18
    v_cndmask_b32 v180, v19, v180, s[94:95]
    v_cndmask_b32 v181, v19, v181, s[96:97]
    v_cndmask_b32 v182, v19, v182, s[98:99]
    v_cndmask_b32 v183, v19, v183, s[100:101]
    v_cmp_le_i32 s[94:95], 48, v18
    v_cmp_le_i32 s[96:97], 49, v18
    v_cmp_le_i32 s[98:99], 50, v18
    v_cmp_le_i32 s[100:101], 51, v18
    v_cndmask_b32 v184, v19, v184, s[94:95]
    v_cndmask_b32 v185, v19, v185, s[96:97]
    v_cndmask_b32 v186, v19, v186, s[98:99]
    v_cndmask_b32 v187, v19, v187, s[100:101]
    v_cmp_le_i32 s[94:95], 32, v18
    v_cmp_le_i32 s[96:97], 33, v18
    v_cmp_le_i32 s[98:99], 34, v18
    v_cmp_le_i32 s[100:101], 35, v18
    v_cndmask_b32 v188, v19, v188, s[94:95]
    v_cndmask_b32 v189, v19, v189, s[96:97]
    v_cndmask_b32 v190, v19, v190, s[98:99]
    v_cndmask_b32 v191, v19, v191, s[100:101]
k1_nomask27:
    s_cmp_lg_u32 s51, 0
    s_cbranch_scc1 k1_rare22
k1_sm21:
    s_mov_b32 m0, s57
    s_nop 0
    buffer_load_dwordx4 v20, s[36:39], s56 offen offset:0 sc1 lds
    v_exp_f32 v56, v160
    v_exp_f32 v57, v161
    v_exp_f32 v58, v162
    v_exp_f32 v59, v163
    v_exp_f32 v60, v168
    buffer_load_dwordx4 v20, s[36:39], s56 offen offset:1024 sc1 lds
    v_exp_f32 v61, v169
    v_exp_f32 v62, v170
    v_exp_f32 v63, v171
    v_cvt_pk_bf16_f32 v112, v56, v57
    v_cvt_pk_bf16_f32 v113, v58, v59
    v_cvt_pk_bf16_f32 v114, v60, v61
    v_cvt_pk_bf16_f32 v115, v62, v63
    v_or3_b32 v24, v112, v113, v114
    v_or_b32 v24, v24, v115
    buffer_load_dwordx4 v20, s[36:39], s56 offen offset:2048 sc1 lds
    v_exp_f32 v64, v164
    v_exp_f32 v65, v165
    v_exp_f32 v66, v166
    v_exp_f32 v67, v167
    v_exp_f32 v68, v172
    buffer_load_dwordx4 v20, s[36:39], s56 offen offset:3072 sc1 lds
    v_exp_f32 v69, v173
    v_exp_f32 v70, v174
    v_exp_f32 v71, v175
    v_cvt_pk_bf16_f32 v116, v64, v65
    v_cvt_pk_bf16_f32 v117, v66, v67
    v_cvt_pk_bf16_f32 v118, v68, v69
    v_cvt_pk_bf16_f32 v119, v70, v71
    v_or3_b32 v24, v24, v116, v117
    v_or3_b32 v24, v24, v118, v119
    s_mov_b32 m0, s55
    s_nop 0
    buffer_load_dwordx4 v20, s[40:43], s54 offen offset:0 sc1 lds
    v_exp_f32 v56, v176
    v_exp_f32 v57, v177
    v_exp_f32 v58, v178
    v_exp_f32 v59, v179
    v_exp_f32 v60, v184
    buffer_load_dwordx4 v20, s[40:43], s54 offen offset:1024 sc1 lds
    v_exp_f32 v61, v185
    v_exp_f32 v62, v186
    v_exp_f32 v63, v187
    v_cvt_pk_bf16_f32 v120, v56, v57
    v_cvt_pk_bf16_f32 v121, v58, v59
    v_cvt_pk_bf16_f32 v122, v60, v61
    v_cvt_pk_bf16_f32 v123, v62, v63
    v_or3_b32 v24, v24, v120, v121
    v_or3_b32 v24, v24, v122, v123
    buffer_load_dwordx4 v20, s[40:43], s54 offen offset:2048 sc1 lds
    v_exp_f32 v64, v180
    v_exp_f32 v65, v181
    v_exp_f32 v66, v182
    v_exp_f32 v67, v183
    v_exp_f32 v68, v188
    buffer_load_dwordx4 v20, s[40:43], s54 offen offset:3072 sc1 lds
    v_exp_f32 v69, v189
    v_exp_f32 v70, v190
    v_exp_f32 v71, v191
    v_cvt_pk_bf16_f32 v124, v64, v65
    v_cvt_pk_bf16_f32 v125, v66, v67
    v_cvt_pk_bf16_f32 v126, v68, v69
    v_cvt_pk_bf16_f32 v127, v70, v71
    v_or3_b32 v24, v24, v124, v125
    v_or3_b32 v24, v24, v126, v127
    v_and_b32 v24, 0x40004000, v24
    v_cmp_ne_u32 vcc, 0, v24
    s_cbranch_vccz k1_smd23
    s_cmp_eq_u32 s51, 2
    s_cbranch_scc1 k1_smd23
k1_rare22:
    v_max3_f32 v56, v160, v161, v162
    v_max3_f32 v56, v56, v163, v168
    v_max3_f32 v56, v56, v169, v170
    v_max3_f32 v56, v56, v171, v176
    v_max3_f32 v56, v56, v177, v178
    v_max3_f32 v56, v56, v179, v184
    v_max3_f32 v56, v56, v185, v186
    v_max_f32 v56, v56, v187
    v_max3_f32 v57, v164, v165, v166
    v_max3_f32 v57, v57, v167, v172
    v_max3_f32 v57, v57, v173, v174
    v_max3_f32 v57, v57, v175, v180
    v_max3_f32 v57, v57, v181, v182
    v_max3_f32 v57, v57, v183, v188
    v_max3_f32 v57, v57, v189, v190
    v_max_f32 v57, v57, v191
    v_mov_b32 v58, v56
    v_mov_b32 v59, v57
    s_nop 0
    v_permlane32_swap_b32 v56, v58
    v_permlane32_swap_b32 v57, v59
    v_max_f32 v56, v56, v58
    v_max_f32 v57, v57, v59
    v_mov_b32 v58, v56
    v_mov_b32 v59, v57
    s_nop 0
    v_permlane16_swap_b32 v56, v58
    v_permlane16_swap_b32 v57, v59
    v_max_f32 v56, v56, v58
    v_max_f32 v57, v57, v59
    v_add_f32 v56, s48, v56
    v_add_f32 v57, s48, v57
    s_cmp_lg_u32 s51, 0
    s_cbranch_scc0 k1_nf28
    v_max_f32 v56, s49, v56
    v_max_f32 v57, s49, v57
    s_branch k1_jn29
k1_nf28:
    v_max_f32 v56, 0, v56
    v_exp_f32 v58, -v56
    v_max_f32 v57, 0, v57
    v_exp_f32 v59, -v57
    v_mul_f32 v44, v44, v58
    v_mul_f32 v45, v45, v58
    v_mul_f32 v46, v46, v58
    v_mul_f32 v47, v47, v58
    v_mul_f32 v192, v192, v58
    v_mul_f32 v193, v193, v58
    v_mul_f32 v194, v194, v58
    v_mul_f32 v195, v195, v58
    v_mul_f32 v200, v200, v58
    v_mul_f32 v201, v201, v58
    v_mul_f32 v202, v202, v58
    v_mul_f32 v203, v203, v58
    v_mul_f32 v208, v208, v58
    v_mul_f32 v209, v209, v58
    v_mul_f32 v210, v210, v58
    v_mul_f32 v211, v211, v58
    v_mul_f32 v216, v216, v58
    v_mul_f32 v217, v217, v58
    v_mul_f32 v218, v218, v58
    v_mul_f32 v219, v219, v58
    v_mul_f32 v224, v224, v58
    v_mul_f32 v225, v225, v58
    v_mul_f32 v226, v226, v58
    v_mul_f32 v227, v227, v58
    v_mul_f32 v232, v232, v58
    v_mul_f32 v233, v233, v58
    v_mul_f32 v234, v234, v58
    v_mul_f32 v235, v235, v58
    v_mul_f32 v240, v240, v58
    v_mul_f32 v241, v241, v58
    v_mul_f32 v242, v242, v58
    v_mul_f32 v243, v243, v58
    v_mul_f32 v248, v248, v58
    v_mul_f32 v249, v249, v58
    v_mul_f32 v250, v250, v58
    v_mul_f32 v251, v251, v58
    v_mul_f32 v48, v48, v59
    v_mul_f32 v49, v49, v59
    v_mul_f32 v50, v50, v59
    v_mul_f32 v51, v51, v59
    v_mul_f32 v196, v196, v59
    v_mul_f32 v197, v197, v59
    v_mul_f32 v198, v198, v59
    v_mul_f32 v199, v199, v59
    v_mul_f32 v204, v204, v59
    v_mul_f32 v205, v205, v59
    v_mul_f32 v206, v206, v59
    v_mul_f32 v207, v207, v59
    v_mul_f32 v212, v212, v59
    v_mul_f32 v213, v213, v59
    v_mul_f32 v214, v214, v59
    v_mul_f32 v215, v215, v59
    v_mul_f32 v220, v220, v59
    v_mul_f32 v221, v221, v59
    v_mul_f32 v222, v222, v59
    v_mul_f32 v223, v223, v59
    v_mul_f32 v228, v228, v59
    v_mul_f32 v229, v229, v59
    v_mul_f32 v230, v230, v59
    v_mul_f32 v231, v231, v59
    v_mul_f32 v236, v236, v59
    v_mul_f32 v237, v237, v59
    v_mul_f32 v238, v238, v59
    v_mul_f32 v239, v239, v59
    v_mul_f32 v244, v244, v59
    v_mul_f32 v245, v245, v59
    v_mul_f32 v246, v246, v59
    v_mul_f32 v247, v247, v59
    v_mul_f32 v252, v252, v59
    v_mul_f32 v253, v253, v59
    v_mul_f32 v254, v254, v59
    v_mul_f32 v255, v255, v59
k1_jn29:
    v_sub_f32 v72, v72, v56
    v_sub_f32 v73, v73, v56
    v_sub_f32 v74, v74, v56
    v_sub_f32 v75, v75, v56
    v_sub_f32 v160, v160, v56
    v_sub_f32 v161, v161, v56
    v_sub_f32 v162, v162, v56
    v_sub_f32 v163, v163, v56
    v_sub_f32 v168, v168, v56
    v_sub_f32 v169, v169, v56
    v_sub_f32 v170, v170, v56
    v_sub_f32 v171, v171, v56
    v_sub_f32 v176, v176, v56
    v_sub_f32 v177, v177, v56
    v_sub_f32 v178, v178, v56
    v_sub_f32 v179, v179, v56
    v_sub_f32 v184, v184, v56
    v_sub_f32 v185, v185, v56
    v_sub_f32 v186, v186, v56
    v_sub_f32 v187, v187, v56
    v_sub_f32 v76, v76, v57
    v_sub_f32 v77, v77, v57
    v_sub_f32 v78, v78, v57
    v_sub_f32 v79, v79, v57
    v_sub_f32 v164, v164, v57
    v_sub_f32 v165, v165, v57
    v_sub_f32 v166, v166, v57
    v_sub_f32 v167, v167, v57
    v_sub_f32 v172, v172, v57
    v_sub_f32 v173, v173, v57
    v_sub_f32 v174, v174, v57
    v_sub_f32 v175, v175, v57
    v_sub_f32 v180, v180, v57
    v_sub_f32 v181, v181, v57
    v_sub_f32 v182, v182, v57
    v_sub_f32 v183, v183, v57
    v_sub_f32 v188, v188, v57
    v_sub_f32 v189, v189, v57
    v_sub_f32 v190, v190, v57
    v_sub_f32 v191, v191, v57
    s_mov_b32 s51, 2
    s_branch k1_sm21
k1_smd23:
    s_mov_b32 s51, 0
    v_mov_b32 v68, -1
    v_mov_b32 v69, -1
    v_mov_b32 v70, -1
    v_mov_b32 v71, -1
    s_cmp_ge_u32 s50, 4
    s_cbranch_scc1 k1_nocf30
    buffer_store_dwordx4 v[68:71], v20, s[36:39], s12 offen sc1
    s_add_u32 s12, s12, 1024
k1_nocf30:
    s_lshl_b32 s3, s50, 10
    s_add_u32 s3, s3, s32
    s_cmp_ge_u32 s50, 5
    s_cselect_b32 s94, 15360, 0
    s_add_u32 s3, s3, s94
    s_cmp_ge_u32 s50, 10
    s_cselect_b32 s3, 1073741824, s3
    buffer_store_dwordx4 v[68:71], v20, s[36:39], s3 offen sc1
    s_cmp_lg_u32 s50, s14
    s_cbranch_scc1 k1_nosw31
    ds_read_b128 v[128:131], v27 offset:0
    ds_read_b128 v[132:135], v27 offset:1024
    ds_read_b128 v[136:139], v27 offset:2048
    ds_read_b128 v[140:143], v27 offset:3072
    ds_read_b128 v[144:147], v27 offset:4096
    ds_read_b128 v[148:151], v27 offset:5120
    ds_read_b128 v[152:155], v27 offset:6144
    ds_read_b128 v[156:159], v27 offset:7168
    v_mov_b32 v72, 0
    v_mov_b32 v73, 0
    v_mov_b32 v74, 0
    v_mov_b32 v75, 0
    v_mov_b32 v76, 0
    v_mov_b32 v77, 0
    v_mov_b32 v78, 0
    v_mov_b32 v79, 0
    s_mov_b32 s51, 1
k1_nosw31:
    ds_read_b128 v[80:83], v16 offset:16384
    ds_read_b128 v[84:87], v16 offset:17408
    ds_read_b128 v[88:91], v16 offset:18432
    ds_read_b128 v[92:95], v16 offset:19456
    ds_read_b128 v[96:99], v16 offset:20480
    ds_read_b128 v[100:103], v16 offset:21504
    ds_read_b128 v[104:107], v16 offset:22528
    s_barrier
    s_setprio 1
    s_waitcnt lgkmcnt(6)
    v_mfma_f32_16x16x32_bf16 v[192:195], v[80:83], v[112:115], v[192:195]
    ds_read_b128 v[108:111], v16 offset:23552
    v_mfma_f32_16x16x32_bf16 v[196:199], v[80:83], v[116:119], v[196:199]
    s_waitcnt lgkmcnt(6)
    v_mfma_f32_16x16x32_bf16 v[200:203], v[84:87], v[112:115], v[200:203]
    ds_read_b128 v[80:83], v16 offset:24576
    v_mfma_f32_16x16x32_bf16 v[204:207], v[84:87], v[116:119], v[204:207]
    s_waitcnt lgkmcnt(6)
    v_mfma_f32_16x16x32_bf16 v[208:211], v[88:91], v[112:115], v[208:211]
    ds_read_b128 v[84:87], v16 offset:25600
    v_mfma_f32_16x16x32_bf16 v[212:215], v[88:91], v[116:119], v[212:215]
    v_mfma_f32_16x16x32_bf16 v[44:47], v[40:43], v[112:115], v[44:47]
    s_waitcnt lgkmcnt(6)
    v_mfma_f32_16x16x32_bf16 v[216:219], v[92:95], v[112:115], v[216:219]
    ds_read_b128 v[88:91], v16 offset:26624
    v_mfma_f32_16x16x32_bf16 v[220:223], v[92:95], v[116:119], v[220:223]
    s_waitcnt lgkmcnt(6)
    v_mfma_f32_16x16x32_bf16 v[224:227], v[96:99], v[112:115], v[224:227]
    ds_read_b128 v[92:95], v16 offset:27648
    v_mfma_f32_16x16x32_bf16 v[228:231], v[96:99], v[116:119], v[228:231]
    s_waitcnt lgkmcnt(6)
    v_mfma_f32_16x16x32_bf16 v[232:235], v[100:103], v[112:115], v[232:235]
    ds_read_b128 v[96:99], v16 offset:28672
    v_mfma_f32_16x16x32_bf16 v[236:239], v[100:103], v[116:119], v[236:239]
    v_mfma_f32_16x16x32_bf16 v[48:51], v[40:43], v[116:119], v[48:51]
    s_waitcnt lgkmcnt(6)
    v_mfma_f32_16x16x32_bf16 v[240:243], v[104:107], v[112:115], v[240:243]
    ds_read_b128 v[100:103], v16 offset:29696
    v_mfma_f32_16x16x32_bf16 v[244:247], v[104:107], v[116:119], v[244:247]
    s_waitcnt lgkmcnt(6)
    v_mfma_f32_16x16x32_bf16 v[248:251], v[108:111], v[112:115], v[248:251]
    ds_read_b128 v[104:107], v16 offset:30720
    v_mfma_f32_16x16x32_bf16 v[252:255], v[108:111], v[116:119], v[252:255]
    s_waitcnt lgkmcnt(6)
    v_mfma_f32_16x16x32_bf16 v[192:195], v[80:83], v[120:123], v[192:195]
    ds_read_b128 v[108:111], v16 offset:31744
    v_mfma_f32_16x16x32_bf16 v[196:199], v[80:83], v[124:127], v[196:199]
    s_waitcnt lgkmcnt(6)
    v_mfma_f32_16x16x32_bf16 v[200:203], v[84:87], v[120:123], v[200:203]
    ds_read_b128 v[80:83], v15 offset:0
    v_mfma_f32_16x16x32_bf16 v[204:207], v[84:87], v[124:127], v[204:207]
    s_waitcnt lgkmcnt(6)
    v_mfma_f32_16x16x32_bf16 v[208:211], v[88:91], v[120:123], v[208:211]
    ds_read_b128 v[84:87], v15 offset:4096
    v_mfma_f32_16x16x32_bf16 v[212:215], v[88:91], v[124:127], v[212:215]
    v_mfma_f32_16x16x32_bf16 v[44:47], v[40:43], v[120:123], v[44:47]
    s_waitcnt lgkmcnt(6)
    v_mfma_f32_16x16x32_bf16 v[216:219], v[92:95], v[120:123], v[216:219]
    ds_read_b128 v[88:91], v15 offset:8192
    v_mfma_f32_16x16x32_bf16 v[220:223], v[92:95], v[124:127], v[220:223]
    s_waitcnt lgkmcnt(6)
    v_mfma_f32_16x16x32_bf16 v[224:227], v[96:99], v[120:123], v[224:227]
    ds_read_b128 v[92:95], v15 offset:12288
    v_mfma_f32_16x16x32_bf16 v[228:231], v[96:99], v[124:127], v[228:231]
    s_waitcnt lgkmcnt(6)
    v_mfma_f32_16x16x32_bf16 v[232:235], v[100:103], v[120:123], v[232:235]
    ds_read_b128 v[96:99], v15 offset:1024
    v_mfma_f32_16x16x32_bf16 v[236:239], v[100:103], v[124:127], v[236:239]
    v_mfma_f32_16x16x32_bf16 v[48:51], v[40:43], v[124:127], v[48:51]
    s_waitcnt lgkmcnt(6)
    v_mfma_f32_16x16x32_bf16 v[240:243], v[104:107], v[120:123], v[240:243]
    ds_read_b128 v[100:103], v15 offset:5120
    v_mfma_f32_16x16x32_bf16 v[244:247], v[104:107], v[124:127], v[244:247]
    s_waitcnt lgkmcnt(6)
    v_mfma_f32_16x16x32_bf16 v[248:251], v[108:111], v[120:123], v[248:251]
    ds_read_b128 v[104:107], v15 offset:9216
    v_mfma_f32_16x16x32_bf16 v[252:255], v[108:111], v[124:127], v[252:255]
    s_waitcnt lgkmcnt(6)
    v_mfma_f32_16x16x32_bf16 v[160:163], v[80:83], v[128:131], v[72:75]
    ds_read_b128 v[108:111], v15 offset:13312
    v_mfma_f32_16x16x32_bf16 v[164:167], v[80:83], v[132:135], v[76:79]
    s_waitcnt lgkmcnt(6)
    v_mfma_f32_16x16x32_bf16 v[168:171], v[84:87], v[128:131], v[72:75]
    ds_read_b128 v[80:83], v15 offset:2048
    v_mfma_f32_16x16x32_bf16 v[172:175], v[84:87], v[132:135], v[76:79]
    s_waitcnt lgkmcnt(6)
    v_mfma_f32_16x16x32_bf16 v[176:179], v[88:91], v[128:131], v[72:75]
    ds_read_b128 v[84:87], v15 offset:6144
    v_mfma_f32_16x16x32_bf16 v[180:183], v[88:91], v[132:135], v[76:79]
    s_waitcnt lgkmcnt(6)
    v_mfma_f32_16x16x32_bf16 v[184:187], v[92:95], v[128:131], v[72:75]
    ds_read_b128 v[88:91], v15 offset:10240
    v_mfma_f32_16x16x32_bf16 v[188:191], v[92:95], v[132:135], v[76:79]
    s_waitcnt lgkmcnt(6)
    v_mfma_f32_16x16x32_bf16 v[160:163], v[96:99], v[136:139], v[160:163]
    ds_read_b128 v[92:95], v15 offset:14336
    v_mfma_f32_16x16x32_bf16 v[164:167], v[96:99], v[140:143], v[164:167]
    s_waitcnt lgkmcnt(6)
    v_mfma_f32_16x16x32_bf16 v[168:171], v[100:103], v[136:139], v[168:171]
    ds_read_b128 v[96:99], v15 offset:3072
    v_mfma_f32_16x16x32_bf16 v[172:175], v[100:103], v[140:143], v[172:175]
    s_waitcnt lgkmcnt(6)
    v_mfma_f32_16x16x32_bf16 v[176:179], v[104:107], v[136:139], v[176:179]
    ds_read_b128 v[100:103], v15 offset:7168
    v_mfma_f32_16x16x32_bf16 v[180:183], v[104:107], v[140:143], v[180:183]
    s_waitcnt lgkmcnt(6)
    v_mfma_f32_16x16x32_bf16 v[184:187], v[108:111], v[136:139], v[184:187]
    ds_read_b128 v[104:107], v15 offset:11264
    v_mfma_f32_16x16x32_bf16 v[188:191], v[108:111], v[140:143], v[188:191]
    s_waitcnt lgkmcnt(6)
    v_mfma_f32_16x16x32_bf16 v[160:163], v[80:83], v[144:147], v[160:163]
    ds_read_b128 v[108:111], v15 offset:15360
    v_mfma_f32_16x16x32_bf16 v[164:167], v[80:83], v[148:151], v[164:167]
    s_waitcnt lgkmcnt(6)
    v_mfma_f32_16x16x32_bf16 v[168:171], v[84:87], v[144:147], v[168:171]
    v_mfma_f32_16x16x32_bf16 v[172:175], v[84:87], v[148:151], v[172:175]
    s_waitcnt lgkmcnt(5)
    v_mfma_f32_16x16x32_bf16 v[176:179], v[88:91], v[144:147], v[176:179]
    v_mfma_f32_16x16x32_bf16 v[180:183], v[88:91], v[148:151], v[180:183]
    s_waitcnt lgkmcnt(4)
    v_mfma_f32_16x16x32_bf16 v[184:187], v[92:95], v[144:147], v[184:187]
    v_mfma_f32_16x16x32_bf16 v[188:191], v[92:95], v[148:151], v[188:191]
    s_waitcnt lgkmcnt(3)
    v_mfma_f32_16x16x32_bf16 v[160:163], v[96:99], v[152:155], v[160:163]
    v_mfma_f32_16x16x32_bf16 v[164:167], v[96:99], v[156:159], v[164:167]
    s_waitcnt lgkmcnt(2)
    v_mfma_f32_16x16x32_bf16 v[168:171], v[100:103], v[152:155], v[168:171]
    v_mfma_f32_16x16x32_bf16 v[172:175], v[100:103], v[156:159], v[172:175]
    s_waitcnt lgkmcnt(1)
    v_mfma_f32_16x16x32_bf16 v[176:179], v[104:107], v[152:155], v[176:179]
    v_mfma_f32_16x16x32_bf16 v[180:183], v[104:107], v[156:159], v[180:183]
    s_waitcnt lgkmcnt(0)
    v_mfma_f32_16x16x32_bf16 v[184:187], v[108:111], v[152:155], v[184:187]
    v_mfma_f32_16x16x32_bf16 v[188:191], v[108:111], v[156:159], v[188:191]
    s_setprio 0
    v_xor_b32 v15, 0x10000, v15
    v_xor_b32 v16, 0x10000, v16
    s_waitcnt vmcnt(1)
    s_cmp_lg_u32 s50, s13
    s_cbranch_scc1 k1_nofl32
    buffer_store_dword v30, v11, s[36:39], s24 offen sc1
k1_nofl32:
    s_add_u32 s50, s50, 1
    s_barrier
    s_cmp_lt_u32 s50, 16
    s_cbranch_scc1 k1_loop20
    s_cmp_lg_u32 s50, s13
    s_cbranch_scc1 k1_nofin36
    s_lshl_b32 s54, s9, 2
    s_add_u32 s54, s54, s5
    s_lshl_b32 s54, s54, 18
    s_lshl_b32 s55, s6, 12
    s_add_u32 s54, s54, s55
    s_add_u32 s54, s54, 33554432
    s_add_u32 s55, s54, 0x20000
    v_rcp_f32 v56, v44
    v_rcp_f32 v57, v48
    v_mov_b32 v44, 0
    v_mov_b32 v45, 0
    v_mov_b32 v46, 0
    v_mov_b32 v47, 0
    v_mov_b32 v48, 0
    v_mov_b32 v49, 0
    v_mov_b32 v50, 0
    v_mov_b32 v51, 0
    v_mul_f32 v192, v192, v56
    v_mul_f32 v193, v193, v56
    v_mul_f32 v194, v194, v56
    v_mul_f32 v195, v195, v56
    v_mul_f32 v200, v200, v56
    v_mul_f32 v201, v201, v56
    v_mul_f32 v202, v202, v56
    v_mul_f32 v203, v203, v56
    v_cvt_pk_bf16_f32 v80, v192, v193
    v_cvt_pk_bf16_f32 v81, v194, v195
    v_cvt_pk_bf16_f32 v82, v200, v201
    v_cvt_pk_bf16_f32 v83, v202, v203
    buffer_store_dwordx4 v[80:83], v20, s[36:39], s54 offen offset:0 sc1
    v_mov_b32 v192, 0
    v_mov_b32 v193, 0
    v_mov_b32 v194, 0
    v_mov_b32 v195, 0
    v_mov_b32 v200, 0
    v_mov_b32 v201, 0
    v_mov_b32 v202, 0
    v_mov_b32 v203, 0
    v_mul_f32 v196, v196, v57
    v_mul_f32 v197, v197, v57
    v_mul_f32 v198, v198, v57
    v_mul_f32 v199, v199, v57
    v_mul_f32 v204, v204, v57
    v_mul_f32 v205, v205, v57
    v_mul_f32 v206, v206, v57
    v_mul_f32 v207, v207, v57
    v_cvt_pk_bf16_f32 v84, v196, v197
    v_cvt_pk_bf16_f32 v85, v198, v199
    v_cvt_pk_bf16_f32 v86, v204, v205
    v_cvt_pk_bf16_f32 v87, v206, v207
    buffer_store_dwordx4 v[84:87], v20, s[36:39], s55 offen offset:0 sc1
    v_mov_b32 v196, 0
    v_mov_b32 v197, 0
    v_mov_b32 v198, 0
    v_mov_b32 v199, 0
    v_mov_b32 v204, 0
    v_mov_b32 v205, 0
    v_mov_b32 v206, 0
    v_mov_b32 v207, 0
    v_mul_f32 v208, v208, v56
    v_mul_f32 v209, v209, v56
    v_mul_f32 v210, v210, v56
    v_mul_f32 v211, v211, v56
    v_mul_f32 v216, v216, v56
    v_mul_f32 v217, v217, v56
    v_mul_f32 v218, v218, v56
    v_mul_f32 v219, v219, v56
    v_cvt_pk_bf16_f32 v88, v208, v209
    v_cvt_pk_bf16_f32 v89, v210, v211
    v_cvt_pk_bf16_f32 v90, v216, v217
    v_cvt_pk_bf16_f32 v91, v218, v219
    buffer_store_dwordx4 v[88:91], v20, s[36:39], s54 offen offset:1024 sc1
    v_mov_b32 v208, 0
    v_mov_b32 v209, 0
    v_mov_b32 v210, 0
    v_mov_b32 v211, 0
    v_mov_b32 v216, 0
    v_mov_b32 v217, 0
    v_mov_b32 v218, 0
    v_mov_b32 v219, 0
    v_mul_f32 v212, v212, v57
    v_mul_f32 v213, v213, v57
    v_mul_f32 v214, v214, v57
    v_mul_f32 v215, v215, v57
    v_mul_f32 v220, v220, v57
    v_mul_f32 v221, v221, v57
    v_mul_f32 v222, v222, v57
    v_mul_f32 v223, v223, v57
    v_cvt_pk_bf16_f32 v92, v212, v213
    v_cvt_pk_bf16_f32 v93, v214, v215
    v_cvt_pk_bf16_f32 v94, v220, v221
    v_cvt_pk_bf16_f32 v95, v222, v223
    buffer_store_dwordx4 v[92:95], v20, s[36:39], s55 offen offset:1024 sc1
    v_mov_b32 v212, 0
    v_mov_b32 v213, 0
    v_mov_b32 v214, 0
    v_mov_b32 v215, 0
    v_mov_b32 v220, 0
    v_mov_b32 v221, 0
    v_mov_b32 v222, 0
    v_mov_b32 v223, 0
    v_mul_f32 v224, v224, v56
    v_mul_f32 v225, v225, v56
    v_mul_f32 v226, v226, v56
    v_mul_f32 v227, v227, v56
    v_mul_f32 v232, v232, v56
    v_mul_f32 v233, v233, v56
    v_mul_f32 v234, v234, v56
    v_mul_f32 v235, v235, v56
    v_cvt_pk_bf16_f32 v96, v224, v225
    v_cvt_pk_bf16_f32 v97, v226, v227
    v_cvt_pk_bf16_f32 v98, v232, v233
    v_cvt_pk_bf16_f32 v99, v234, v235
    buffer_store_dwordx4 v[96:99], v20, s[36:39], s54 offen offset:2048 sc1
    v_mov_b32 v224, 0
    v_mov_b32 v225, 0
    v_mov_b32 v226, 0
    v_mov_b32 v227, 0
    v_mov_b32 v232, 0
    v_mov_b32 v233, 0
    v_mov_b32 v234, 0
    v_mov_b32 v235, 0
    v_mul_f32 v228, v228, v57
    v_mul_f32 v229, v229, v57
    v_mul_f32 v230, v230, v57
    v_mul_f32 v231, v231, v57
    v_mul_f32 v236, v236, v57
    v_mul_f32 v237, v237, v57
    v_mul_f32 v238, v238, v57
    v_mul_f32 v239, v239, v57
    v_cvt_pk_bf16_f32 v100, v228, v229
    v_cvt_pk_bf16_f32 v101, v230, v231
    v_cvt_pk_bf16_f32 v102, v236, v237
    v_cvt_pk_bf16_f32 v103, v238, v239
    buffer_store_dwordx4 v[100:103], v20, s[36:39], s55 offen offset:2048 sc1
    v_mov_b32 v228, 0
    v_mov_b32 v229, 0
    v_mov_b32 v230, 0
    v_mov_b32 v231, 0
    v_mov_b32 v236, 0
    v_mov_b32 v237, 0
    v_mov_b32 v238, 0
    v_mov_b32 v239, 0
    v_mul_f32 v240, v240, v56
    v_mul_f32 v241, v241, v56
    v_mul_f32 v242, v242, v56
    v_mul_f32 v243, v243, v56
    v_mul_f32 v248, v248, v56
    v_mul_f32 v249, v249, v56
    v_mul_f32 v250, v250, v56
    v_mul_f32 v251, v251, v56
    v_cvt_pk_bf16_f32 v104, v240, v241
    v_cvt_pk_bf16_f32 v105, v242, v243
    v_cvt_pk_bf16_f32 v106, v248, v249
    v_cvt_pk_bf16_f32 v107, v250, v251
    buffer_store_dwordx4 v[104:107], v20, s[36:39], s54 offen offset:3072 sc1
    v_mov_b32 v240, 0
    v_mov_b32 v241, 0
    v_mov_b32 v242, 0
    v_mov_b32 v243, 0
    v_mov_b32 v248, 0
    v_mov_b32 v249, 0
    v_mov_b32 v250, 0
    v_mov_b32 v251, 0
    v_mul_f32 v244, v244, v57
    v_mul_f32 v245, v245, v57
    v_mul_f32 v246, v246, v57
    v_mul_f32 v247, v247, v57
    v_mul_f32 v252, v252, v57
    v_mul_f32 v253, v253, v57
    v_mul_f32 v254, v254, v57
    v_mul_f32 v255, v255, v57
    v_cvt_pk_bf16_f32 v108, v244, v245
    v_cvt_pk_bf16_f32 v109, v246, v247
    v_cvt_pk_bf16_f32 v110, v252, v253
    v_cvt_pk_bf16_f32 v111, v254, v255
    buffer_store_dwordx4 v[108:111], v20, s[36:39], s55 offen offset:3072 sc1
    v_mov_b32 v244, 0
    v_mov_b32 v245, 0
    v_mov_b32 v246, 0
    v_mov_b32 v247, 0
    v_mov_b32 v252, 0
    v_mov_b32 v253, 0
    v_mov_b32 v254, 0
    v_mov_b32 v255, 0
k1_nofin36:
    buffer_load_dword v29, v12, s[36:39], s25 offen sc1
    s_add_u32 s54, s33, 20480
    s_lshl_b32 s3, s4, 6
    v_subrev_u32 v18, s3, v17
    v_cmp_le_i32 s[94:95], 0, v18
    v_cmp_le_i32 s[96:97], 1, v18
    v_cmp_le_i32 s[98:99], 2, v18
    v_cmp_le_i32 s[100:101], 3, v18
    v_cndmask_b32 v160, v19, v160, s[94:95]
    v_cndmask_b32 v161, v19, v161, s[96:97]
    v_cndmask_b32 v162, v19, v162, s[98:99]
    v_cndmask_b32 v163, v19, v163, s[100:101]
    v_cmp_le_i32 s[94:95], -16, v18
    v_cmp_le_i32 s[96:97], -15, v18
    v_cmp_le_i32 s[98:99], -14, v18
    v_cmp_le_i32 s[100:101], -13, v18
    v_cndmask_b32 v164, v19, v164, s[94:95]
    v_cndmask_b32 v165, v19, v165, s[96:97]
    v_cndmask_b32 v166, v19, v166, s[98:99]
    v_cndmask_b32 v167, v19, v167, s[100:101]
    v_cmp_le_i32 s[94:95], 16, v18
    v_cmp_le_i32 s[96:97], 17, v18
    v_cmp_le_i32 s[98:99], 18, v18
    v_cmp_le_i32 s[100:101], 19, v18
    v_cndmask_b32 v168, v19, v168, s[94:95]
    v_cndmask_b32 v169, v19, v169, s[96:97]
    v_cndmask_b32 v170, v19, v170, s[98:99]
    v_cndmask_b32 v171, v19, v171, s[100:101]
    v_cmp_le_i32 s[94:95], 0, v18
    v_cmp_le_i32 s[96:97], 1, v18
    v_cmp_le_i32 s[98:99], 2, v18
    v_cmp_le_i32 s[100:101], 3, v18
    v_cndmask_b32 v172, v19, v172, s[94:95]
    v_cndmask_b32 v173, v19, v173, s[96:97]
    v_cndmask_b32 v174, v19, v174, s[98:99]
    v_cndmask_b32 v175, v19, v175, s[100:101]
    v_cmp_le_i32 s[94:95], 32, v18
    v_cmp_le_i32 s[96:97], 33, v18
    v_cmp_le_i32 s[98:99], 34, v18
    v_cmp_le_i32 s[100:101], 35, v18
    v_cndmask_b32 v176, v19, v176, s[94:95]
    v_cndmask_b32 v177, v19, v177, s[96:97]
    v_cndmask_b32 v178, v19, v178, s[98:99]
    v_cndmask_b32 v179, v19, v179, s[100:101]
    v_cmp_le_i32 s[94:95], 16, v18
    v_cmp_le_i32 s[96:97], 17, v18
    v_cmp_le_i32 s[98:99], 18, v18
    v_cmp_le_i32 s[100:101], 19, v18
    v_cndmask_b32 v180, v19, v180, s[94:95]
    v_cndmask_b32 v181, v19, v181, s[96:97]
    v_cndmask_b32 v182, v19, v182, s[98:99]
    v_cndmask_b32 v183, v19, v183, s[100:101]
    v_cmp_le_i32 s[94:95], 48, v18
    v_cmp_le_i32 s[96:97], 49, v18
    v_cmp_le_i32 s[98:99], 50, v18
    v_cmp_le_i32 s[100:101], 51, v18
    v_cndmask_b32 v184, v19, v184, s[94:95]
    v_cndmask_b32 v185, v19, v185, s[96:97]
    v_cndmask_b32 v186, v19, v186, s[98:99]
    v_cndmask_b32 v187, v19, v187, s[100:101]
    v_cmp_le_i32 s[94:95], 32, v18
    v_cmp_le_i32 s[96:97], 33, v18
    v_cmp_le_i32 s[98:99], 34, v18
    v_cmp_le_i32 s[100:101], 35, v18
    v_cndmask_b32 v188, v19, v188, s[94:95]
    v_cndmask_b32 v189, v19, v189, s[96:97]
    v_cndmask_b32 v190, v19, v190, s[98:99]
    v_cndmask_b32 v191, v19, v191, s[100:101]
    s_cmp_lg_u32 s51, 0
    s_cbranch_scc1 k1_rare34
k1_sm33:
    s_add_u32 m0, s34, 0
    s_nop 0
    buffer_load_dwordx4 v4, s[28:31], s33 offen lds
    s_add_u32 m0, s34, 1024
    s_nop 0
    buffer_load_dwordx4 v5, s[28:31], s33 offen lds
    v_exp_f32 v56, v160
    v_exp_f32 v57, v161
    v_exp_f32 v58, v162
    v_exp_f32 v59, v163
    v_exp_f32 v60, v168
    s_add_u32 m0, s34, 2048
    s_nop 0
    buffer_load_dwordx4 v6, s[28:31], s33 offen lds
    v_exp_f32 v61, v169
    v_exp_f32 v62, v170
    v_exp_f32 v63, v171
    v_cvt_pk_bf16_f32 v112, v56, v57
    v_cvt_pk_bf16_f32 v113, v58, v59
    v_cvt_pk_bf16_f32 v114, v60, v61
    v_cvt_pk_bf16_f32 v115, v62, v63
    v_or3_b32 v24, v112, v113, v114
    v_or_b32 v24, v24, v115
    s_add_u32 m0, s34, 3072
    s_nop 0
    buffer_load_dwordx4 v7, s[28:31], s33 offen lds
    v_exp_f32 v64, v164
    v_exp_f32 v65, v165
    v_exp_f32 v66, v166
    v_exp_f32 v67, v167
    v_exp_f32 v68, v172
    s_add_u32 m0, s34, 4096
    s_nop 0
    buffer_load_dwordx4 v8, s[28:31], s33 offen lds
    v_exp_f32 v69, v173
    v_exp_f32 v70, v174
    v_exp_f32 v71, v175
    v_cvt_pk_bf16_f32 v116, v64, v65
    v_cvt_pk_bf16_f32 v117, v66, v67
    v_cvt_pk_bf16_f32 v118, v68, v69
    v_cvt_pk_bf16_f32 v119, v70, v71
    v_or3_b32 v24, v24, v116, v117
    v_or3_b32 v24, v24, v118, v119
    s_add_u32 m0, s34, 5120
    s_nop 0
    buffer_load_dwordx4 v4, s[28:31], s54 offen lds
    s_add_u32 m0, s34, 6144
    s_nop 0
    buffer_load_dwordx4 v5, s[28:31], s54 offen lds
    v_exp_f32 v56, v176
    v_exp_f32 v57, v177
    v_exp_f32 v58, v178
    v_exp_f32 v59, v179
    v_exp_f32 v60, v184
    s_add_u32 m0, s34, 7168
    s_nop 0
    buffer_load_dwordx4 v6, s[28:31], s54 offen lds
    v_exp_f32 v61, v185
    v_exp_f32 v62, v186
    v_exp_f32 v63, v187
    v_cvt_pk_bf16_f32 v120, v56, v57
    v_cvt_pk_bf16_f32 v121, v58, v59
    v_cvt_pk_bf16_f32 v122, v60, v61
    v_cvt_pk_bf16_f32 v123, v62, v63
    v_or3_b32 v24, v24, v120, v121
    v_or3_b32 v24, v24, v122, v123
    s_add_u32 m0, s34, 8192
    s_nop 0
    buffer_load_dwordx4 v7, s[28:31], s54 offen lds
    v_exp_f32 v64, v180
    v_exp_f32 v65, v181
    v_exp_f32 v66, v182
    v_exp_f32 v67, v183
    v_exp_f32 v68, v188
    s_add_u32 m0, s34, 9216
    s_nop 0
    buffer_load_dwordx4 v8, s[28:31], s54 offen lds
    v_exp_f32 v69, v189
    v_exp_f32 v70, v190
    v_exp_f32 v71, v191
    v_cvt_pk_bf16_f32 v124, v64, v65
    v_cvt_pk_bf16_f32 v125, v66, v67
    v_cvt_pk_bf16_f32 v126, v68, v69
    v_cvt_pk_bf16_f32 v127, v70, v71
    v_or3_b32 v24, v24, v124, v125
    v_or3_b32 v24, v24, v126, v127
    v_and_b32 v24, 0x40004000, v24
    v_cmp_ne_u32 vcc, 0, v24
    s_cbranch_vccz k1_smd35
    s_cmp_eq_u32 s51, 2
    s_cbranch_scc1 k1_smd35
k1_rare34:
    v_max3_f32 v56, v160, v161, v162
    v_max3_f32 v56, v56, v163, v168
    v_max3_f32 v56, v56, v169, v170
    v_max3_f32 v56, v56, v171, v176
    v_max3_f32 v56, v56, v177, v178
    v_max3_f32 v56, v56, v179, v184
    v_max3_f32 v56, v56, v185, v186
    v_max_f32 v56, v56, v187
    v_max3_f32 v57, v164, v165, v166
    v_max3_f32 v57, v57, v167, v172
    v_max3_f32 v57, v57, v173, v174
    v_max3_f32 v57, v57, v175, v180
    v_max3_f32 v57, v57, v181, v182
    v_max3_f32 v57, v57, v183, v188
    v_max3_f32 v57, v57, v189, v190
    v_max_f32 v57, v57, v191
    v_mov_b32 v58, v56
    v_mov_b32 v59, v57
    s_nop 0
    v_permlane32_swap_b32 v56, v58
    v_permlane32_swap_b32 v57, v59
    v_max_f32 v56, v56, v58
    v_max_f32 v57, v57, v59
    v_mov_b32 v58, v56
    v_mov_b32 v59, v57
    s_nop 0
    v_permlane16_swap_b32 v56, v58
    v_permlane16_swap_b32 v57, v59
    v_max_f32 v56, v56, v58
    v_max_f32 v57, v57, v59
    v_add_f32 v56, s48, v56
    v_add_f32 v57, s48, v57
    s_cmp_lg_u32 s51, 0
    s_cbranch_scc0 k1_nf38
    v_max_f32 v56, s49, v56
    v_max_f32 v57, s49, v57
    s_branch k1_jn39
k1_nf38:
    v_max_f32 v56, 0, v56
    v_exp_f32 v58, -v56
    v_max_f32 v57, 0, v57
    v_exp_f32 v59, -v57
    v_mul_f32 v44, v44, v58
    v_mul_f32 v45, v45, v58
    v_mul_f32 v46, v46, v58
    v_mul_f32 v47, v47, v58
    v_mul_f32 v192, v192, v58
    v_mul_f32 v193, v193, v58
    v_mul_f32 v194, v194, v58
    v_mul_f32 v195, v195, v58
    v_mul_f32 v200, v200, v58
    v_mul_f32 v201, v201, v58
    v_mul_f32 v202, v202, v58
    v_mul_f32 v203, v203, v58
    v_mul_f32 v208, v208, v58
    v_mul_f32 v209, v209, v58
    v_mul_f32 v210, v210, v58
    v_mul_f32 v211, v211, v58
    v_mul_f32 v216, v216, v58
    v_mul_f32 v217, v217, v58
    v_mul_f32 v218, v218, v58
    v_mul_f32 v219, v219, v58
    v_mul_f32 v224, v224, v58
    v_mul_f32 v225, v225, v58
    v_mul_f32 v226, v226, v58
    v_mul_f32 v227, v227, v58
    v_mul_f32 v232, v232, v58
    v_mul_f32 v233, v233, v58
    v_mul_f32 v234, v234, v58
    v_mul_f32 v235, v235, v58
    v_mul_f32 v240, v240, v58
    v_mul_f32 v241, v241, v58
    v_mul_f32 v242, v242, v58
    v_mul_f32 v243, v243, v58
    v_mul_f32 v248, v248, v58
    v_mul_f32 v249, v249, v58
    v_mul_f32 v250, v250, v58
    v_mul_f32 v251, v251, v58
    v_mul_f32 v48, v48, v59
    v_mul_f32 v49, v49, v59
    v_mul_f32 v50, v50, v59
    v_mul_f32 v51, v51, v59
    v_mul_f32 v196, v196, v59
    v_mul_f32 v197, v197, v59
    v_mul_f32 v198, v198, v59
    v_mul_f32 v199, v199, v59
    v_mul_f32 v204, v204, v59
    v_mul_f32 v205, v205, v59
    v_mul_f32 v206, v206, v59
    v_mul_f32 v207, v207, v59
    v_mul_f32 v212, v212, v59
    v_mul_f32 v213, v213, v59
    v_mul_f32 v214, v214, v59
    v_mul_f32 v215, v215, v59
    v_mul_f32 v220, v220, v59
    v_mul_f32 v221, v221, v59
    v_mul_f32 v222, v222, v59
    v_mul_f32 v223, v223, v59
    v_mul_f32 v228, v228, v59
    v_mul_f32 v229, v229, v59
    v_mul_f32 v230, v230, v59
    v_mul_f32 v231, v231, v59
    v_mul_f32 v236, v236, v59
    v_mul_f32 v237, v237, v59
    v_mul_f32 v238, v238, v59
    v_mul_f32 v239, v239, v59
    v_mul_f32 v244, v244, v59
    v_mul_f32 v245, v245, v59
    v_mul_f32 v246, v246, v59
    v_mul_f32 v247, v247, v59
    v_mul_f32 v252, v252, v59
    v_mul_f32 v253, v253, v59
    v_mul_f32 v254, v254, v59
    v_mul_f32 v255, v255, v59
k1_jn39:
    v_sub_f32 v72, v72, v56
    v_sub_f32 v73, v73, v56
    v_sub_f32 v74, v74, v56
    v_sub_f32 v75, v75, v56
    v_sub_f32 v160, v160, v56
    v_sub_f32 v161, v161, v56
    v_sub_f32 v162, v162, v56
    v_sub_f32 v163, v163, v56
    v_sub_f32 v168, v168, v56
    v_sub_f32 v169, v169, v56
    v_sub_f32 v170, v170, v56
    v_sub_f32 v171, v171, v56
    v_sub_f32 v176, v176, v56
    v_sub_f32 v177, v177, v56
    v_sub_f32 v178, v178, v56
    v_sub_f32 v179, v179, v56
    v_sub_f32 v184, v184, v56
    v_sub_f32 v185, v185, v56
    v_sub_f32 v186, v186, v56
    v_sub_f32 v187, v187, v56
    v_sub_f32 v76, v76, v57
    v_sub_f32 v77, v77, v57
    v_sub_f32 v78, v78, v57
    v_sub_f32 v79, v79, v57
    v_sub_f32 v164, v164, v57
    v_sub_f32 v165, v165, v57
    v_sub_f32 v166, v166, v57
    v_sub_f32 v167, v167, v57
    v_sub_f32 v172, v172, v57
    v_sub_f32 v173, v173, v57
    v_sub_f32 v174, v174, v57
    v_sub_f32 v175, v175, v57
    v_sub_f32 v180, v180, v57
    v_sub_f32 v181, v181, v57
    v_sub_f32 v182, v182, v57
    v_sub_f32 v183, v183, v57
    v_sub_f32 v188, v188, v57
    v_sub_f32 v189, v189, v57
    v_sub_f32 v190, v190, v57
    v_sub_f32 v191, v191, v57
    s_mov_b32 s51, 2
    s_branch k1_sm33
k1_smd35:
    s_mov_b32 s51, 0
    s_mov_b32 s3, 83976192
    buffer_load_dwordx4 v[4:7], v20, s[36:39], s3 offen sc1
    ds_read_b128 v[80:83], v16 offset:16384
    ds_read_b128 v[84:87], v16 offset:17408
    ds_read_b128 v[88:91], v16 offset:18432
    ds_read_b128 v[92:95], v16 offset:19456
    ds_read_b128 v[96:99], v16 offset:20480
    ds_read_b128 v[100:103], v16 offset:21504
    ds_read_b128 v[104:107], v16 offset:22528
    s_cmp_eq_u32 s4, 0
    s_cbranch_scc1 k1_g0p40
    s_waitcnt vmcnt(11)
    v_cmp_le_u32 vcc, 1, v29
    s_nop 0
    s_mov_b32 s3, vcc_lo
    s_and_b32 s3, s3, 15
    s_cmp_eq_u32 s3, 15
    s_cselect_b32 s66, 1, 0
    s_cselect_b32 s56, s26, 1073741824
    s_cselect_b32 s57, s27, 1073741824
    s_add_u32 s58, s56, 4096
    s_add_u32 s59, s57, 4096
    s_barrier
    s_setprio 1
    s_waitcnt lgkmcnt(6)
    v_mfma_f32_16x16x32_bf16 v[192:195], v[80:83], v[112:115], v[192:195]
    ds_read_b128 v[108:111], v16 offset:23552
    v_mfma_f32_16x16x32_bf16 v[196:199], v[80:83], v[116:119], v[196:199]
    s_waitcnt lgkmcnt(6)
    v_mfma_f32_16x16x32_bf16 v[200:203], v[84:87], v[112:115], v[200:203]
    ds_read_b128 v[80:83], v16 offset:24576
    v_mfma_f32_16x16x32_bf16 v[204:207], v[84:87], v[116:119], v[204:207]
    buffer_load_dwordx4 v[128:131], v20, s[36:39], s56 offen offset:0 sc1
    buffer_load_dwordx4 v[132:135], v20, s[36:39], s57 offen offset:0 sc1
    s_waitcnt lgkmcnt(6)
    v_mfma_f32_16x16x32_bf16 v[208:211], v[88:91], v[112:115], v[208:211]
    ds_read_b128 v[84:87], v16 offset:25600
    v_mfma_f32_16x16x32_bf16 v[212:215], v[88:91], v[116:119], v[212:215]
    v_mfma_f32_16x16x32_bf16 v[44:47], v[40:43], v[112:115], v[44:47]
    buffer_load_dwordx4 v[136:139], v20, s[36:39], s56 offen offset:1024 sc1
    buffer_load_dwordx4 v[140:143], v20, s[36:39], s57 offen offset:1024 sc1
    s_waitcnt lgkmcnt(6)
    v_mfma_f32_16x16x32_bf16 v[216:219], v[92:95], v[112:115], v[216:219]
    ds_read_b128 v[88:91], v16 offset:26624
    v_mfma_f32_16x16x32_bf16 v[220:223], v[92:95], v[116:119], v[220:223]
    buffer_load_dwordx4 v[144:147], v20, s[36:39], s56 offen offset:2048 sc1
    s_waitcnt lgkmcnt(6)
    v_mfma_f32_16x16x32_bf16 v[224:227], v[96:99], v[112:115], v[224:227]
    ds_read_b128 v[92:95], v16 offset:27648
    v_mfma_f32_16x16x32_bf16 v[228:231], v[96:99], v[116:119], v[228:231]
    buffer_load_dwordx4 v[148:151], v20, s[36:39], s57 offen offset:2048 sc1
    s_waitcnt lgkmcnt(6)
    v_mfma_f32_16x16x32_bf16 v[232:235], v[100:103], v[112:115], v[232:235]
    ds_read_b128 v[96:99], v16 offset:28672
    v_mfma_f32_16x16x32_bf16 v[236:239], v[100:103], v[116:119], v[236:239]
    v_mfma_f32_16x16x32_bf16 v[48:51], v[40:43], v[116:119], v[48:51]
    buffer_load_dwordx4 v[152:155], v20, s[36:39], s56 offen offset:3072 sc1
    s_waitcnt lgkmcnt(6)
    v_mfma_f32_16x16x32_bf16 v[240:243], v[104:107], v[112:115], v[240:243]
    ds_read_b128 v[100:103], v16 offset:29696
    v_mfma_f32_16x16x32_bf16 v[244:247], v[104:107], v[116:119], v[244:247]
    buffer_load_dwordx4 v[156:159], v20, s[36:39], s57 offen offset:3072 sc1
    s_waitcnt lgkmcnt(6)
    v_mfma_f32_16x16x32_bf16 v[248:251], v[108:111], v[112:115], v[248:251]
    ds_read_b128 v[104:107], v16 offset:30720
    v_mfma_f32_16x16x32_bf16 v[252:255], v[108:111], v[116:119], v[252:255]
    buffer_load_dwordx4 v[160:163], v20, s[36:39], s58 offen offset:0 sc1
    s_waitcnt lgkmcnt(6)
    v_mfma_f32_16x16x32_bf16 v[192:195], v[80:83], v[120:123], v[192:195]
    ds_read_b128 v[108:111], v16 offset:31744
    v_mfma_f32_16x16x32_bf16 v[196:199], v[80:83], v[124:127], v[196:199]
    buffer_load_dwordx4 v[164:167], v20, s[36:39], s59 offen offset:0 sc1
    s_waitcnt lgkmcnt(6)
    v_mfma_f32_16x16x32_bf16 v[200:203], v[84:87], v[120:123], v[200:203]
    v_mfma_f32_16x16x32_bf16 v[204:207], v[84:87], v[124:127], v[204:207]
    buffer_load_dwordx4 v[168:171], v20, s[36:39], s58 offen offset:1024 sc1
    s_waitcnt lgkmcnt(5)
    v_mfma_f32_16x16x32_bf16 v[208:211], v[88:91], v[120:123], v[208:211]
    v_mfma_f32_16x16x32_bf16 v[212:215], v[88:91], v[124:127], v[212:215]
    v_mfma_f32_16x16x32_bf16 v[44:47], v[40:43], v[120:123], v[44:47]
    buffer_load_dwordx4 v[172:175], v20, s[36:39], s59 offen offset:1024 sc1
    s_waitcnt lgkmcnt(4)
    v_mfma_f32_16x16x32_bf16 v[216:219], v[92:95], v[120:123], v[216:219]
    v_mfma_f32_16x16x32_bf16 v[220:223], v[92:95], v[124:127], v[220:223]
    buffer_load_dwordx4 v[176:179], v20, s[36:39], s58 offen offset:2048 sc1
    s_waitcnt lgkmcnt(3)
    v_mfma_f32_16x16x32_bf16 v[224:227], v[96:99], v[120:123], v[224:227]
    v_mfma_f32_16x16x32_bf16 v[228:231], v[96:99], v[124:127], v[228:231]
    buffer_load_dwordx4 v[180:183], v20, s[36:39], s59 offen offset:2048 sc1
    s_waitcnt lgkmcnt(2)
    v_mfma_f32_16x16x32_bf16 v[232:235], v[100:103], v[120:123], v[232:235]
    v_mfma_f32_16x16x32_bf16 v[236:239], v[100:103], v[124:127], v[236:239]
    v_mfma_f32_16x16x32_bf16 v[48:51], v[40:43], v[124:127], v[48:51]
    buffer_load_dwordx4 v[184:187], v20, s[36:39], s58 offen offset:3072 sc1
    s_waitcnt lgkmcnt(1)
    v_mfma_f32_16x16x32_bf16 v[240:243], v[104:107], v[120:123], v[240:243]
    v_mfma_f32_16x16x32_bf16 v[244:247], v[104:107], v[124:127], v[244:247]
    buffer_load_dwordx4 v[188:191], v20, s[36:39], s59 offen offset:3072 sc1
    s_waitcnt lgkmcnt(0)
    v_mfma_f32_16x16x32_bf16 v[248:251], v[108:111], v[120:123], v[248:251]
    v_mfma_f32_16x16x32_bf16 v[252:255], v[108:111], v[124:127], v[252:255]
    s_setprio 0
    s_waitcnt vmcnt(16)
    s_cmp_lg_u32 s50, s13
    s_cbranch_scc1 k1_nofl41
    buffer_store_dword v30, v11, s[36:39], s24 offen sc1
k1_nofl41:
    s_barrier
    ds_write_b128 v13, v[192:195] offset:0
    ds_write_b128 v13, v[196:199] offset:1024
    ds_write_b128 v13, v[200:203] offset:2048
    ds_write_b128 v13, v[204:207] offset:3072
    ds_write_b128 v13, v[208:211] offset:4096
    ds_write_b128 v13, v[212:215] offset:5120
    ds_write_b128 v13, v[216:219] offset:6144
    ds_write_b128 v13, v[220:223] offset:7168
    ds_write_b128 v13, v[224:227] offset:8192
    ds_write_b128 v13, v[228:231] offset:9216
    ds_write_b128 v13, v[232:235] offset:10240
    ds_write_b128 v13, v[236:239] offset:11264
    ds_write_b128 v13, v[240:243] offset:12288
    ds_write_b128 v13, v[244:247] offset:13312
    ds_write_b128 v13, v[248:251] offset:14336
    ds_write_b128 v13, v[252:255] offset:15360
    v_mov_b32 v80, v72
    v_mov_b32 v81, v76
    v_mov_b32 v82, v44
    v_mov_b32 v83, v48
    s_add_u32 s3, s56, 65536
    buffer_load_dword v3, v26, s[36:39], s3 offen sc1
    s_add_u32 s3, s57, 65536
    buffer_load_dword v3, v26, s[36:39], s3 offen sc1
    s_add_u32 s3, s56, 69632
    buffer_load_dword v3, v26, s[36:39], s3 offen sc1
    s_add_u32 s3, s57, 69632
    buffer_load_dword v3, v26, s[36:39], s3 offen sc1
    s_waitcnt lgkmcnt(0)
    s_barrier
    ds_write_b128 v14, v[80:83]
    s_waitcnt lgkmcnt(0)
    s_barrier
    ds_read_b64_tr_b16 v[32:33], v9 offset:0
    ds_read_b64_tr_b16 v[34:35], v9 offset:5120
    ds_read_b64_tr_b16 v[36:37], v10 offset:0
    ds_read_b64_tr_b16 v[38:39], v10 offset:5120
    ds_read_b64_tr_b16 v[40:41], v9 offset:64
    ds_read_b64_tr_b16 v[42:43], v9 offset:5184
    ds_read_b64_tr_b16 v[44:45], v10 offset:64
    ds_read_b64_tr_b16 v[46:47], v10 offset:5184
    ds_read_b64_tr_b16 v[48:49], v9 offset:128
    ds_read_b64_tr_b16 v[50:51], v9 offset:5248
    ds_read_b64_tr_b16 v[52:53], v10 offset:128
    ds_read_b64_tr_b16 v[54:55], v10 offset:5248
    ds_read_b64_tr_b16 v[56:57], v9 offset:192
    ds_read_b64_tr_b16 v[58:59], v9 offset:5312
    ds_read_b64_tr_b16 v[60:61], v10 offset:192
    ds_read_b64_tr_b16 v[62:63], v10 offset:5312
    ds_read_b64_tr_b16 v[64:65], v9 offset:256
    ds_read_b64_tr_b16 v[66:67], v9 offset:5376
    ds_read_b64_tr_b16 v[68:69], v10 offset:256
    ds_read_b64_tr_b16 v[70:71], v10 offset:5376
    s_cmp_lg_u32 s66, 0
    s_cbranch_scc1 k1_kl42
    buffer_load_dword v29, v12, s[36:39], s25 offen sc1
    s_waitcnt vmcnt(0)
    v_cmp_le_u32 vcc, 1, v29
    s_nop 0
    s_mov_b32 s3, vcc_lo
    s_and_b32 s3, s3, 15
    s_cmp_eq_u32 s3, 15
    s_cbranch_scc0 k1_spin43
k1_back44:
    buffer_load_dwordx4 v[128:131], v20, s[36:39], s26 offen offset:0 sc1
    buffer_load_dwordx4 v[132:135], v20, s[36:39], s27 offen offset:0 sc1
    buffer_load_dwordx4 v[136:139], v20, s[36:39], s26 offen offset:1024 sc1
    buffer_load_dwordx4 v[140:143], v20, s[36:39], s27 offen offset:1024 sc1
    buffer_load_dwordx4 v[144:147], v20, s[36:39], s26 offen offset:2048 sc1
    buffer_load_dwordx4 v[148:151], v20, s[36:39], s27 offen offset:2048 sc1
    buffer_load_dwordx4 v[152:155], v20, s[36:39], s26 offen offset:3072 sc1
    buffer_load_dwordx4 v[156:159], v20, s[36:39], s27 offen offset:3072 sc1
    s_add_u32 s3, s26, 4096
    buffer_load_dwordx4 v[160:163], v20, s[36:39], s3 offen offset:0 sc1
    s_add_u32 s3, s27, 4096
    buffer_load_dwordx4 v[164:167], v20, s[36:39], s3 offen offset:0 sc1
    s_add_u32 s3, s26, 4096
    buffer_load_dwordx4 v[168:171], v20, s[36:39], s3 offen offset:1024 sc1
    s_add_u32 s3, s27, 4096
    buffer_load_dwordx4 v[172:175], v20, s[36:39], s3 offen offset:1024 sc1
    s_add_u32 s3, s26, 4096
    buffer_load_dwordx4 v[176:179], v20, s[36:39], s3 offen offset:2048 sc1
    s_add_u32 s3, s27, 4096
    buffer_load_dwordx4 v[180:183], v20, s[36:39], s3 offen offset:2048 sc1
    s_add_u32 s3, s26, 4096
    buffer_load_dwordx4 v[184:187], v20, s[36:39], s3 offen offset:3072 sc1
    s_add_u32 s3, s27, 4096
    buffer_load_dwordx4 v[188:191], v20, s[36:39], s3 offen offset:3072 sc1
    s_add_u32 s3, s26, 65536
    buffer_load_dword v3, v26, s[36:39], s3 offen sc1
    s_add_u32 s3, s27, 65536
    buffer_load_dword v3, v26, s[36:39], s3 offen sc1
    s_add_u32 s3, s26, 69632
    buffer_load_dword v3, v26, s[36:39], s3 offen sc1
    s_add_u32 s3, s27, 69632
    buffer_load_dword v3, v26, s[36:39], s3 offen sc1
k1_kl42:
    s_waitcnt vmcnt(18)
    s_waitcnt lgkmcnt(0)
    v_mfma_f32_16x16x32_bf16 v[192:195], v[32:35], v[128:131], 0
    ds_read_b64_tr_b16 v[72:73], v9 offset:10240
    ds_read_b64_tr_b16 v[74:75], v9 offset:15360
    v_mfma_f32_16x16x32_bf16 v[232:235], v[32:35], v[132:135], 0
    ds_read_b64_tr_b16 v[76:77], v10 offset:10240
    ds_read_b64_tr_b16 v[78:79], v10 offset:15360
    v_mfma_f32_16x16x32_bf16 v[196:199], v[36:39], v[128:131], 0
    ds_read_b64_tr_b16 v[80:81], v9 offset:10304
    ds_read_b64_tr_b16 v[82:83], v9 offset:15424
    v_mfma_f32_16x16x32_bf16 v[236:239], v[36:39], v[132:135], 0
    ds_read_b64_tr_b16 v[84:85], v10 offset:10304
    ds_read_b64_tr_b16 v[86:87], v10 offset:15424
    v_mfma_f32_16x16x32_bf16 v[200:203], v[40:43], v[128:131], 0
    ds_read_b64_tr_b16 v[88:89], v9 offset:10368
    ds_read_b64_tr_b16 v[90:91], v9 offset:15488
    v_mfma_f32_16x16x32_bf16 v[240:243], v[40:43], v[132:135], 0
    ds_read_b64_tr_b16 v[92:93], v10 offset:10368
    ds_read_b64_tr_b16 v[94:95], v10 offset:15488
    v_mfma_f32_16x16x32_bf16 v[204:207], v[44:47], v[128:131], 0
    ds_read_b64_tr_b16 v[96:97], v9 offset:10432
    v_mfma_f32_16x16x32_bf16 v[244:247], v[44:47], v[132:135], 0
    ds_read_b64_tr_b16 v[98:99], v9 offset:15552
    v_mfma_f32_16x16x32_bf16 v[208:211], v[48:51], v[128:131], 0
    ds_read_b64_tr_b16 v[100:101], v10 offset:10432
    v_mfma_f32_16x16x32_bf16 v[248:251], v[48:51], v[132:135], 0
    ds_read_b64_tr_b16 v[102:103], v10 offset:15552
    v_mfma_f32_16x16x32_bf16 v[212:215], v[52:55], v[128:131], 0
    ds_read_b64_tr_b16 v[104:105], v9 offset:10496
    v_mfma_f32_16x16x32_bf16 v[252:255], v[52:55], v[132:135], 0
    ds_read_b64_tr_b16 v[106:107], v9 offset:15616
    v_mfma_f32_16x16x32_bf16 v[216:219], v[56:59], v[128:131], 0
    ds_read_b64_tr_b16 v[108:109], v10 offset:10496
    v_mfma_f32_16x16x32_bf16 v[112:115], v[56:59], v[132:135], 0
    ds_read_b64_tr_b16 v[110:111], v10 offset:15616
    v_mfma_f32_16x16x32_bf16 v[220:223], v[60:63], v[128:131], 0
    v_mfma_f32_16x16x32_bf16 v[116:119], v[60:63], v[132:135], 0
    v_mfma_f32_16x16x32_bf16 v[224:227], v[64:67], v[128:131], 0
    v_mfma_f32_16x16x32_bf16 v[120:123], v[64:67], v[132:135], 0
    v_mfma_f32_16x16x32_bf16 v[228:231], v[68:71], v[128:131], 0
    v_mfma_f32_16x16x32_bf16 v[124:127], v[68:71], v[132:135], 0
    s_waitcnt vmcnt(16)
    s_waitcnt lgkmcnt(0)
    v_mfma_f32_16x16x32_bf16 v[192:195], v[72:75], v[136:139], v[192:195]
    ds_read_b64_tr_b16 v[32:33], v9 offset:20480
    ds_read_b64_tr_b16 v[34:35], v9 offset:25600
    v_mfma_f32_16x16x32_bf16 v[232:235], v[72:75], v[140:143], v[232:235]
    ds_read_b64_tr_b16 v[36:37], v10 offset:20480
    ds_read_b64_tr_b16 v[38:39], v10 offset:25600
    v_mfma_f32_16x16x32_bf16 v[196:199], v[76:79], v[136:139], v[196:199]
    ds_read_b64_tr_b16 v[40:41], v9 offset:20544
    ds_read_b64_tr_b16 v[42:43], v9 offset:25664
    v_mfma_f32_16x16x32_bf16 v[236:239], v[76:79], v[140:143], v[236:239]
    ds_read_b64_tr_b16 v[44:45], v10 offset:20544
    ds_read_b64_tr_b16 v[46:47], v10 offset:25664
    v_mfma_f32_16x16x32_bf16 v[200:203], v[80:83], v[136:139], v[200:203]
    ds_read_b64_tr_b16 v[48:49], v9 offset:20608
    ds_read_b64_tr_b16 v[50:51], v9 offset:25728
    v_mfma_f32_16x16x32_bf16 v[240:243], v[80:83], v[140:143], v[240:243]
    ds_read_b64_tr_b16 v[52:53], v10 offset:20608
    ds_read_b64_tr_b16 v[54:55], v10 offset:25728
    v_mfma_f32_16x16x32_bf16 v[204:207], v[84:87], v[136:139], v[204:207]
    ds_read_b64_tr_b16 v[56:57], v9 offset:20672
    v_mfma_f32_16x16x32_bf16 v[244:247], v[84:87], v[140:143], v[244:247]
    ds_read_b64_tr_b16 v[58:59], v9 offset:25792
    v_mfma_f32_16x16x32_bf16 v[208:211], v[88:91], v[136:139], v[208:211]
    ds_read_b64_tr_b16 v[60:61], v10 offset:20672
    v_mfma_f32_16x16x32_bf16 v[248:251], v[88:91], v[140:143], v[248:251]
    ds_read_b64_tr_b16 v[62:63], v10 offset:25792
    v_mfma_f32_16x16x32_bf16 v[212:215], v[92:95], v[136:139], v[212:215]
    ds_read_b64_tr_b16 v[64:65], v9 offset:20736
    v_mfma_f32_16x16x32_bf16 v[252:255], v[92:95], v[140:143], v[252:255]
    ds_read_b64_tr_b16 v[66:67], v9 offset:25856
    v_mfma_f32_16x16x32_bf16 v[216:219], v[96:99], v[136:139], v[216:219]
    ds_read_b64_tr_b16 v[68:69], v10 offset:20736
    v_mfma_f32_16x16x32_bf16 v[112:115], v[96:99], v[140:143], v[112:115]
    ds_read_b64_tr_b16 v[70:71], v10 offset:25856
    v_mfma_f32_16x16x32_bf16 v[220:223], v[100:103], v[136:139], v[220:223]
    v_mfma_f32_16x16x32_bf16 v[116:119], v[100:103], v[140:143], v[116:119]
    v_mfma_f32_16x16x32_bf16 v[224:227], v[104:107], v[136:139], v[224:227]
    v_mfma_f32_16x16x32_bf16 v[120:123], v[104:107], v[140:143], v[120:123]
    v_mfma_f32_16x16x32_bf16 v[228:231], v[108:111], v[136:139], v[228:231]
    v_mfma_f32_16x16x32_bf16 v[124:127], v[108:111], v[140:143], v[124:127]
    s_waitcnt vmcnt(14)
    s_waitcnt lgkmcnt(0)
    v_mfma_f32_16x16x32_bf16 v[192:195], v[32:35], v[144:147], v[192:195]
    ds_read_b64_tr_b16 v[72:73], v9 offset:30720
    ds_read_b64_tr_b16 v[74:75], v9 offset:35840
    v_mfma_f32_16x16x32_bf16 v[232:235], v[32:35], v[148:151], v[232:235]
    ds_read_b64_tr_b16 v[76:77], v10 offset:30720
    ds_read_b64_tr_b16 v[78:79], v10 offset:35840
    v_mfma_f32_16x16x32_bf16 v[196:199], v[36:39], v[144:147], v[196:199]
    ds_read_b64_tr_b16 v[80:81], v9 offset:30784
    ds_read_b64_tr_b16 v[82:83], v9 offset:35904
    v_mfma_f32_16x16x32_bf16 v[236:239], v[36:39], v[148:151], v[236:239]
    ds_read_b64_tr_b16 v[84:85], v10 offset:30784
    ds_read_b64_tr_b16 v[86:87], v10 offset:35904
    v_mfma_f32_16x16x32_bf16 v[200:203], v[40:43], v[144:147], v[200:203]
    ds_read_b64_tr_b16 v[88:89], v9 offset:30848
    ds_read_b64_tr_b16 v[90:91], v9 offset:35968
    v_mfma_f32_16x16x32_bf16 v[240:243], v[40:43], v[148:151], v[240:243]
    ds_read_b64_tr_b16 v[92:93], v10 offset:30848
    ds_read_b64_tr_b16 v[94:95], v10 offset:35968
    v_mfma_f32_16x16x32_bf16 v[204:207], v[44:47], v[144:147], v[204:207]
    ds_read_b64_tr_b16 v[96:97], v9 offset:30912
    v_mfma_f32_16x16x32_bf16 v[244:247], v[44:47], v[148:151], v[244:247]
    ds_read_b64_tr_b16 v[98:99], v9 offset:36032
    v_mfma_f32_16x16x32_bf16 v[208:211], v[48:51], v[144:147], v[208:211]
    ds_read_b64_tr_b16 v[100:101], v10 offset:30912
    v_mfma_f32_16x16x32_bf16 v[248:251], v[48:51], v[148:151], v[248:251]
    ds_read_b64_tr_b16 v[102:103], v10 offset:36032
    v_mfma_f32_16x16x32_bf16 v[212:215], v[52:55], v[144:147], v[212:215]
    ds_read_b64_tr_b16 v[104:105], v9 offset:30976
    v_mfma_f32_16x16x32_bf16 v[252:255], v[52:55], v[148:151], v[252:255]
    ds_read_b64_tr_b16 v[106:107], v9 offset:36096
    v_mfma_f32_16x16x32_bf16 v[216:219], v[56:59], v[144:147], v[216:219]
    ds_read_b64_tr_b16 v[108:109], v10 offset:30976
    v_mfma_f32_16x16x32_bf16 v[112:115], v[56:59], v[148:151], v[112:115]
    ds_read_b64_tr_b16 v[110:111], v10 offset:36096
    v_mfma_f32_16x16x32_bf16 v[220:223], v[60:63], v[144:147], v[220:223]
    v_mfma_f32_16x16x32_bf16 v[116:119], v[60:63], v[148:151], v[116:119]
    v_mfma_f32_16x16x32_bf16 v[224:227], v[64:67], v[144:147], v[224:227]
    v_mfma_f32_16x16x32_bf16 v[120:123], v[64:67], v[148:151], v[120:123]
    v_mfma_f32_16x16x32_bf16 v[228:231], v[68:71], v[144:147], v[228:231]
    v_mfma_f32_16x16x32_bf16 v[124:127], v[68:71], v[148:151], v[124:127]
    s_waitcnt vmcnt(12)
    s_waitcnt lgkmcnt(0)
    v_add_u32 v9, 4294926336, v9
    v_add_u32 v10, 4294926336, v10
    v_mfma_f32_16x16x32_bf16 v[192:195], v[72:75], v[152:155], v[192:195]
    ds_read_b64_tr_b16 v[32:33], v9 offset:0
    ds_read_b64_tr_b16 v[34:35], v9 offset:5120
    v_mfma_f32_16x16x32_bf16 v[232:235], v[72:75], v[156:159], v[232:235]
    ds_read_b64_tr_b16 v[36:37], v10 offset:0
    ds_read_b64_tr_b16 v[38:39], v10 offset:5120
    v_mfma_f32_16x16x32_bf16 v[196:199], v[76:79], v[152:155], v[196:199]
    ds_read_b64_tr_b16 v[40:41], v9 offset:64
    ds_read_b64_tr_b16 v[42:43], v9 offset:5184
    v_mfma_f32_16x16x32_bf16 v[236:239], v[76:79], v[156:159], v[236:239]
    ds_read_b64_tr_b16 v[44:45], v10 offset:64
    ds_read_b64_tr_b16 v[46:47], v10 offset:5184
    v_mfma_f32_16x16x32_bf16 v[200:203], v[80:83], v[152:155], v[200:203]
    ds_read_b64_tr_b16 v[48:49], v9 offset:128
    ds_read_b64_tr_b16 v[50:51], v9 offset:5248
    v_mfma_f32_16x16x32_bf16 v[240:243], v[80:83], v[156:159], v[240:243]
    ds_read_b64_tr_b16 v[52:53], v10 offset:128
    ds_read_b64_tr_b16 v[54:55], v10 offset:5248
    v_mfma_f32_16x16x32_bf16 v[204:207], v[84:87], v[152:155], v[204:207]
    ds_read_b64_tr_b16 v[56:57], v9 offset:192
    v_mfma_f32_16x16x32_bf16 v[244:247], v[84:87], v[156:159], v[244:247]
    ds_read_b64_tr_b16 v[58:59], v9 offset:5312
    v_mfma_f32_16x16x32_bf16 v[208:211], v[88:91], v[152:155], v[208:211]
    ds_read_b64_tr_b16 v[60:61], v10 offset:192
    v_mfma_f32_16x16x32_bf16 v[248:251], v[88:91], v[156:159], v[248:251]
    ds_read_b64_tr_b16 v[62:63], v10 offset:5312
    v_mfma_f32_16x16x32_bf16 v[212:215], v[92:95], v[152:155], v[212:215]
    ds_read_b64_tr_b16 v[64:65], v9 offset:256
    v_mfma_f32_16x16x32_bf16 v[252:255], v[92:95], v[156:159], v[252:255]
    ds_read_b64_tr_b16 v[66:67], v9 offset:5376
    v_mfma_f32_16x16x32_bf16 v[216:219], v[96:99], v[152:155], v[216:219]
    ds_read_b64_tr_b16 v[68:69], v10 offset:256
    v_mfma_f32_16x16x32_bf16 v[112:115], v[96:99], v[156:159], v[112:115]
    ds_read_b64_tr_b16 v[70:71], v10 offset:5376
    v_mfma_f32_16x16x32_bf16 v[220:223], v[100:103], v[152:155], v[220:223]
    v_mfma_f32_16x16x32_bf16 v[116:119], v[100:103], v[156:159], v[116:119]
    v_mfma_f32_16x16x32_bf16 v[224:227], v[104:107], v[152:155], v[224:227]
    v_mfma_f32_16x16x32_bf16 v[120:123], v[104:107], v[156:159], v[120:123]
    v_mfma_f32_16x16x32_bf16 v[228:231], v[108:111], v[152:155], v[228:231]
    v_mfma_f32_16x16x32_bf16 v[124:127], v[108:111], v[156:159], v[124:127]
    s_waitcnt vmcnt(10)
    s_waitcnt lgkmcnt(0)
    v_mfma_f32_16x16x32_bf16 v[192:195], v[32:35], v[160:163], v[192:195]
    ds_read_b64_tr_b16 v[72:73], v9 offset:10240
    ds_read_b64_tr_b16 v[74:75], v9 offset:15360
    v_mfma_f32_16x16x32_bf16 v[232:235], v[32:35], v[164:167], v[232:235]
    ds_read_b64_tr_b16 v[76:77], v10 offset:10240
    ds_read_b64_tr_b16 v[78:79], v10 offset:15360
    v_mfma_f32_16x16x32_bf16 v[196:199], v[36:39], v[160:163], v[196:199]
    ds_read_b64_tr_b16 v[80:81], v9 offset:10304
    ds_read_b64_tr_b16 v[82:83], v9 offset:15424
    v_mfma_f32_16x16x32_bf16 v[236:239], v[36:39], v[164:167], v[236:239]
    ds_read_b64_tr_b16 v[84:85], v10 offset:10304
    ds_read_b64_tr_b16 v[86:87], v10 offset:15424
    v_mfma_f32_16x16x32_bf16 v[200:203], v[40:43], v[160:163], v[200:203]
    ds_read_b64_tr_b16 v[88:89], v9 offset:10368
    ds_read_b64_tr_b16 v[90:91], v9 offset:15488
    v_mfma_f32_16x16x32_bf16 v[240:243], v[40:43], v[164:167], v[240:243]
    ds_read_b64_tr_b16 v[92:93], v10 offset:10368
    ds_read_b64_tr_b16 v[94:95], v10 offset:15488
    v_mfma_f32_16x16x32_bf16 v[204:207], v[44:47], v[160:163], v[204:207]
    ds_read_b64_tr_b16 v[96:97], v9 offset:10432
    v_mfma_f32_16x16x32_bf16 v[244:247], v[44:47], v[164:167], v[244:247]
    ds_read_b64_tr_b16 v[98:99], v9 offset:15552
    v_mfma_f32_16x16x32_bf16 v[208:211], v[48:51], v[160:163], v[208:211]
    ds_read_b64_tr_b16 v[100:101], v10 offset:10432
    v_mfma_f32_16x16x32_bf16 v[248:251], v[48:51], v[164:167], v[248:251]
    ds_read_b64_tr_b16 v[102:103], v10 offset:15552
    v_mfma_f32_16x16x32_bf16 v[212:215], v[52:55], v[160:163], v[212:215]
    ds_read_b64_tr_b16 v[104:105], v9 offset:10496
    v_mfma_f32_16x16x32_bf16 v[252:255], v[52:55], v[164:167], v[252:255]
    ds_read_b64_tr_b16 v[106:107], v9 offset:15616
    v_mfma_f32_16x16x32_bf16 v[216:219], v[56:59], v[160:163], v[216:219]
    ds_read_b64_tr_b16 v[108:109], v10 offset:10496
    v_mfma_f32_16x16x32_bf16 v[112:115], v[56:59], v[164:167], v[112:115]
    ds_read_b64_tr_b16 v[110:111], v10 offset:15616
    v_mfma_f32_16x16x32_bf16 v[220:223], v[60:63], v[160:163], v[220:223]
    v_mfma_f32_16x16x32_bf16 v[116:119], v[60:63], v[164:167], v[116:119]
    v_mfma_f32_16x16x32_bf16 v[224:227], v[64:67], v[160:163], v[224:227]
    v_mfma_f32_16x16x32_bf16 v[120:123], v[64:67], v[164:167], v[120:123]
    v_mfma_f32_16x16x32_bf16 v[228:231], v[68:71], v[160:163], v[228:231]
    v_mfma_f32_16x16x32_bf16 v[124:127], v[68:71], v[164:167], v[124:127]
    s_add_u32 s3, s26, 65536
    buffer_load_dwordx4 v[128:131], v20, s[36:39], s3 offen offset:0 sc1
    s_add_u32 s3, s27, 65536
    buffer_load_dwordx4 v[132:135], v20, s[36:39], s3 offen offset:0 sc1
    s_add_u32 s3, s26, 65536
    buffer_load_dwordx4 v[136:139], v20, s[36:39], s3 offen offset:1024 sc1
    s_add_u32 s3, s27, 65536
    buffer_load_dwordx4 v[140:143], v20, s[36:39], s3 offen offset:1024 sc1
    s_waitcnt vmcnt(12)
    s_waitcnt lgkmcnt(0)
    v_mfma_f32_16x16x32_bf16 v[192:195], v[72:75], v[168:171], v[192:195]
    ds_read_b64_tr_b16 v[32:33], v9 offset:20480
    ds_read_b64_tr_b16 v[34:35], v9 offset:25600
    v_mfma_f32_16x16x32_bf16 v[232:235], v[72:75], v[172:175], v[232:235]
    ds_read_b64_tr_b16 v[36:37], v10 offset:20480
    ds_read_b64_tr_b16 v[38:39], v10 offset:25600
    v_mfma_f32_16x16x32_bf16 v[196:199], v[76:79], v[168:171], v[196:199]
    ds_read_b64_tr_b16 v[40:41], v9 offset:20544
    ds_read_b64_tr_b16 v[42:43], v9 offset:25664
    v_mfma_f32_16x16x32_bf16 v[236:239], v[76:79], v[172:175], v[236:239]
    ds_read_b64_tr_b16 v[44:45], v10 offset:20544
    ds_read_b64_tr_b16 v[46:47], v10 offset:25664
    v_mfma_f32_16x16x32_bf16 v[200:203], v[80:83], v[168:171], v[200:203]
    ds_read_b64_tr_b16 v[48:49], v9 offset:20608
    ds_read_b64_tr_b16 v[50:51], v9 offset:25728
    v_mfma_f32_16x16x32_bf16 v[240:243], v[80:83], v[172:175], v[240:243]
    ds_read_b64_tr_b16 v[52:53], v10 offset:20608
    ds_read_b64_tr_b16 v[54:55], v10 offset:25728
    v_mfma_f32_16x16x32_bf16 v[204:207], v[84:87], v[168:171], v[204:207]
    ds_read_b64_tr_b16 v[56:57], v9 offset:20672
    v_mfma_f32_16x16x32_bf16 v[244:247], v[84:87], v[172:175], v[244:247]
    ds_read_b64_tr_b16 v[58:59], v9 offset:25792
    v_mfma_f32_16x16x32_bf16 v[208:211], v[88:91], v[168:171], v[208:211]
    ds_read_b64_tr_b16 v[60:61], v10 offset:20672
    v_mfma_f32_16x16x32_bf16 v[248:251], v[88:91], v[172:175], v[248:251]
    ds_read_b64_tr_b16 v[62:63], v10 offset:25792
    v_mfma_f32_16x16x32_bf16 v[212:215], v[92:95], v[168:171], v[212:215]
    ds_read_b64_tr_b16 v[64:65], v9 offset:20736
    v_mfma_f32_16x16x32_bf16 v[252:255], v[92:95], v[172:175], v[252:255]
    ds_read_b64_tr_b16 v[66:67], v9 offset:25856
    v_mfma_f32_16x16x32_bf16 v[216:219], v[96:99], v[168:171], v[216:219]
    ds_read_b64_tr_b16 v[68:69], v10 offset:20736
    v_mfma_f32_16x16x32_bf16 v[112:115], v[96:99], v[172:175], v[112:115]
    ds_read_b64_tr_b16 v[70:71], v10 offset:25856
    v_mfma_f32_16x16x32_bf16 v[220:223], v[100:103], v[168:171], v[220:223]
    v_mfma_f32_16x16x32_bf16 v[116:119], v[100:103], v[172:175], v[116:119]
    v_mfma_f32_16x16x32_bf16 v[224:227], v[104:107], v[168:171], v[224:227]
    v_mfma_f32_16x16x32_bf16 v[120:123], v[104:107], v[172:175], v[120:123]
    v_mfma_f32_16x16x32_bf16 v[228:231], v[108:111], v[168:171], v[228:231]
    v_mfma_f32_16x16x32_bf16 v[124:127], v[108:111], v[172:175], v[124:127]
    s_add_u32 s3, s26, 65536
    buffer_load_dwordx4 v[144:147], v20, s[36:39], s3 offen offset:2048 sc1
    s_add_u32 s3, s27, 65536
    buffer_load_dwordx4 v[148:151], v20, s[36:39], s3 offen offset:2048 sc1
    s_add_u32 s3, s26, 65536
    buffer_load_dwordx4 v[152:155], v20, s[36:39], s3 offen offset:3072 sc1
    s_add_u32 s3, s27, 65536
    buffer_load_dwordx4 v[156:159], v20, s[36:39], s3 offen offset:3072 sc1
    s_waitcnt vmcnt(14)
    s_waitcnt lgkmcnt(0)
    v_mfma_f32_16x16x32_bf16 v[192:195], v[32:35], v[176:179], v[192:195]
    ds_read_b64_tr_b16 v[72:73], v9 offset:30720
    ds_read_b64_tr_b16 v[74:75], v9 offset:35840
    v_mfma_f32_16x16x32_bf16 v[232:235], v[32:35], v[180:183], v[232:235]
    ds_read_b64_tr_b16 v[76:77], v10 offset:30720
    ds_read_b64_tr_b16 v[78:79], v10 offset:35840
    v_mfma_f32_16x16x32_bf16 v[196:199], v[36:39], v[176:179], v[196:199]
    ds_read_b64_tr_b16 v[80:81], v9 offset:30784
    ds_read_b64_tr_b16 v[82:83], v9 offset:35904
    v_mfma_f32_16x16x32_bf16 v[236:239], v[36:39], v[180:183], v[236:239]
    ds_read_b64_tr_b16 v[84:85], v10 offset:30784
    ds_read_b64_tr_b16 v[86:87], v10 offset:35904
    v_mfma_f32_16x16x32_bf16 v[200:203], v[40:43], v[176:179], v[200:203]
    ds_read_b64_tr_b16 v[88:89], v9 offset:30848
    ds_read_b64_tr_b16 v[90:91], v9 offset:35968
    v_mfma_f32_16x16x32_bf16 v[240:243], v[40:43], v[180:183], v[240:243]
    ds_read_b64_tr_b16 v[92:93], v10 offset:30848
    ds_read_b64_tr_b16 v[94:95], v10 offset:35968
    v_mfma_f32_16x16x32_bf16 v[204:207], v[44:47], v[176:179], v[204:207]
    ds_read_b64_tr_b16 v[96:97], v9 offset:30912
    v_mfma_f32_16x16x32_bf16 v[244:247], v[44:47], v[180:183], v[244:247]
    ds_read_b64_tr_b16 v[98:99], v9 offset:36032
    v_mfma_f32_16x16x32_bf16 v[208:211], v[48:51], v[176:179], v[208:211]
    ds_read_b64_tr_b16 v[100:101], v10 offset:30912
    v_mfma_f32_16x16x32_bf16 v[248:251], v[48:51], v[180:183], v[248:251]
    ds_read_b64_tr_b16 v[102:103], v10 offset:36032
    v_mfma_f32_16x16x32_bf16 v[212:215], v[52:55], v[176:179], v[212:215]
    ds_read_b64_tr_b16 v[104:105], v9 offset:30976
    v_mfma_f32_16x16x32_bf16 v[252:255], v[52:55], v[180:183], v[252:255]
    ds_read_b64_tr_b16 v[106:107], v9 offset:36096
    v_mfma_f32_16x16x32_bf16 v[216:219], v[56:59], v[176:179], v[216:219]
    ds_read_b64_tr_b16 v[108:109], v10 offset:30976
    v_mfma_f32_16x16x32_bf16 v[112:115], v[56:59], v[180:183], v[112:115]
    ds_read_b64_tr_b16 v[110:111], v10 offset:36096
    v_mfma_f32_16x16x32_bf16 v[220:223], v[60:63], v[176:179], v[220:223]
    v_mfma_f32_16x16x32_bf16 v[116:119], v[60:63], v[180:183], v[116:119]
    v_mfma_f32_16x16x32_bf16 v[224:227], v[64:67], v[176:179], v[224:227]
    v_mfma_f32_16x16x32_bf16 v[120:123], v[64:67], v[180:183], v[120:123]
    v_mfma_f32_16x16x32_bf16 v[228:231], v[68:71], v[176:179], v[228:231]
    v_mfma_f32_16x16x32_bf16 v[124:127], v[68:71], v[180:183], v[124:127]
    s_add_u32 s3, s26, 69632
    buffer_load_dwordx4 v[160:163], v20, s[36:39], s3 offen offset:0 sc1
    s_add_u32 s3, s27, 69632
    buffer_load_dwordx4 v[164:167], v20, s[36:39], s3 offen offset:0 sc1
    s_add_u32 s3, s26, 69632
    buffer_load_dwordx4 v[168:171], v20, s[36:39], s3 offen offset:1024 sc1
    s_add_u32 s3, s27, 69632
    buffer_load_dwordx4 v[172:175], v20, s[36:39], s3 offen offset:1024 sc1
    s_waitcnt vmcnt(16)
    s_waitcnt lgkmcnt(0)
    v_add_u32 v9, 4294885376, v9
    v_add_u32 v10, 4294885376, v10
    s_barrier
    v_mfma_f32_16x16x32_bf16 v[192:195], v[72:75], v[184:187], v[192:195]
    ds_read_b64_tr_b16 v[32:33], v9 offset:0
    ds_read_b64_tr_b16 v[34:35], v9 offset:5120
    v_mfma_f32_16x16x32_bf16 v[232:235], v[72:75], v[188:191], v[232:235]
    ds_read_b64_tr_b16 v[36:37], v10 offset:0
    ds_read_b64_tr_b16 v[38:39], v10 offset:5120
    v_mfma_f32_16x16x32_bf16 v[196:199], v[76:79], v[184:187], v[196:199]
    ds_read_b64_tr_b16 v[40:41], v9 offset:64
    ds_read_b64_tr_b16 v[42:43], v9 offset:5184
    v_mfma_f32_16x16x32_bf16 v[236:239], v[76:79], v[188:191], v[236:239]
    ds_read_b64_tr_b16 v[44:45], v10 offset:64
    ds_read_b64_tr_b16 v[46:47], v10 offset:5184
    v_mfma_f32_16x16x32_bf16 v[200:203], v[80:83], v[184:187], v[200:203]
    ds_read_b64_tr_b16 v[48:49], v9 offset:128
    ds_read_b64_tr_b16 v[50:51], v9 offset:5248
    v_mfma_f32_16x16x32_bf16 v[240:243], v[80:83], v[188:191], v[240:243]
    ds_read_b64_tr_b16 v[52:53], v10 offset:128
    ds_read_b64_tr_b16 v[54:55], v10 offset:5248
    v_mfma_f32_16x16x32_bf16 v[204:207], v[84:87], v[184:187], v[204:207]
    ds_read_b64_tr_b16 v[56:57], v9 offset:192
    v_mfma_f32_16x16x32_bf16 v[244:247], v[84:87], v[188:191], v[244:247]
    ds_read_b64_tr_b16 v[58:59], v9 offset:5312
    v_mfma_f32_16x16x32_bf16 v[208:211], v[88:91], v[184:187], v[208:211]
    ds_read_b64_tr_b16 v[60:61], v10 offset:192
    v_mfma_f32_16x16x32_bf16 v[248:251], v[88:91], v[188:191], v[248:251]
    ds_read_b64_tr_b16 v[62:63], v10 offset:5312
    v_mfma_f32_16x16x32_bf16 v[212:215], v[92:95], v[184:187], v[212:215]
    ds_read_b64_tr_b16 v[64:65], v9 offset:256
    v_mfma_f32_16x16x32_bf16 v[252:255], v[92:95], v[188:191], v[252:255]
    ds_read_b64_tr_b16 v[66:67], v9 offset:5376
    v_mfma_f32_16x16x32_bf16 v[216:219], v[96:99], v[184:187], v[216:219]
    ds_read_b64_tr_b16 v[68:69], v10 offset:256
    v_mfma_f32_16x16x32_bf16 v[112:115], v[96:99], v[188:191], v[112:115]
    ds_read_b64_tr_b16 v[70:71], v10 offset:5376
    v_mfma_f32_16x16x32_bf16 v[220:223], v[100:103], v[184:187], v[220:223]
    v_mfma_f32_16x16x32_bf16 v[116:119], v[100:103], v[188:191], v[116:119]
    v_mfma_f32_16x16x32_bf16 v[224:227], v[104:107], v[184:187], v[224:227]
    v_mfma_f32_16x16x32_bf16 v[120:123], v[104:107], v[188:191], v[120:123]
    v_mfma_f32_16x16x32_bf16 v[228:231], v[108:111], v[184:187], v[228:231]
    v_mfma_f32_16x16x32_bf16 v[124:127], v[108:111], v[188:191], v[124:127]
    s_add_u32 s3, s26, 69632
    buffer_load_dwordx4 v[176:179], v20, s[36:39], s3 offen offset:2048 sc1
    s_add_u32 s3, s27, 69632
    buffer_load_dwordx4 v[180:183], v20, s[36:39], s3 offen offset:2048 sc1
    s_add_u32 s3, s26, 69632
    buffer_load_dwordx4 v[184:187], v20, s[36:39], s3 offen offset:3072 sc1
    s_add_u32 s3, s27, 69632
    buffer_load_dwordx4 v[188:191], v20, s[36:39], s3 offen offset:3072 sc1
    s_waitcnt vmcnt(14)
    s_waitcnt lgkmcnt(0)
    v_mfma_f32_16x16x32_bf16 v[192:195], v[32:35], v[128:131], v[192:195]
    ds_read_b64_tr_b16 v[72:73], v9 offset:10240
    ds_read_b64_tr_b16 v[74:75], v9 offset:15360
    v_mfma_f32_16x16x32_bf16 v[232:235], v[32:35], v[132:135], v[232:235]
    ds_read_b64_tr_b16 v[76:77], v10 offset:10240
    ds_read_b64_tr_b16 v[78:79], v10 offset:15360
    v_mfma_f32_16x16x32_bf16 v[196:199], v[36:39], v[128:131], v[196:199]
    ds_read_b64_tr_b16 v[80:81], v9 offset:10304
    ds_read_b64_tr_b16 v[82:83], v9 offset:15424
    v_mfma_f32_16x16x32_bf16 v[236:239], v[36:39], v[132:135], v[236:239]
    ds_read_b64_tr_b16 v[84:85], v10 offset:10304
    ds_read_b64_tr_b16 v[86:87], v10 offset:15424
    v_mfma_f32_16x16x32_bf16 v[200:203], v[40:43], v[128:131], v[200:203]
    ds_read_b64_tr_b16 v[88:89], v9 offset:10368
    ds_read_b64_tr_b16 v[90:91], v9 offset:15488
    v_mfma_f32_16x16x32_bf16 v[240:243], v[40:43], v[132:135], v[240:243]
    ds_read_b64_tr_b16 v[92:93], v10 offset:10368
    ds_read_b64_tr_b16 v[94:95], v10 offset:15488
    v_mfma_f32_16x16x32_bf16 v[204:207], v[44:47], v[128:131], v[204:207]
    ds_read_b64_tr_b16 v[96:97], v9 offset:10432
    v_mfma_f32_16x16x32_bf16 v[244:247], v[44:47], v[132:135], v[244:247]
    ds_read_b64_tr_b16 v[98:99], v9 offset:15552
    v_mfma_f32_16x16x32_bf16 v[208:211], v[48:51], v[128:131], v[208:211]
    ds_read_b64_tr_b16 v[100:101], v10 offset:10432
    v_mfma_f32_16x16x32_bf16 v[248:251], v[48:51], v[132:135], v[248:251]
    ds_read_b64_tr_b16 v[102:103], v10 offset:15552
    v_mfma_f32_16x16x32_bf16 v[212:215], v[52:55], v[128:131], v[212:215]
    ds_read_b64_tr_b16 v[104:105], v9 offset:10496
    v_mfma_f32_16x16x32_bf16 v[252:255], v[52:55], v[132:135], v[252:255]
    ds_read_b64_tr_b16 v[106:107], v9 offset:15616
    v_mfma_f32_16x16x32_bf16 v[216:219], v[56:59], v[128:131], v[216:219]
    ds_read_b64_tr_b16 v[108:109], v10 offset:10496
    v_mfma_f32_16x16x32_bf16 v[112:115], v[56:59], v[132:135], v[112:115]
    ds_read_b64_tr_b16 v[110:111], v10 offset:15616
    v_mfma_f32_16x16x32_bf16 v[220:223], v[60:63], v[128:131], v[220:223]
    v_mfma_f32_16x16x32_bf16 v[116:119], v[60:63], v[132:135], v[116:119]
    v_mfma_f32_16x16x32_bf16 v[224:227], v[64:67], v[128:131], v[224:227]
    v_mfma_f32_16x16x32_bf16 v[120:123], v[64:67], v[132:135], v[120:123]
    v_mfma_f32_16x16x32_bf16 v[228:231], v[68:71], v[128:131], v[228:231]
    v_mfma_f32_16x16x32_bf16 v[124:127], v[68:71], v[132:135], v[124:127]
    s_waitcnt vmcnt(12)
    s_waitcnt lgkmcnt(0)
    v_mfma_f32_16x16x32_bf16 v[192:195], v[72:75], v[136:139], v[192:195]
    ds_read_b64_tr_b16 v[32:33], v9 offset:20480
    ds_read_b64_tr_b16 v[34:35], v9 offset:25600
    v_mfma_f32_16x16x32_bf16 v[232:235], v[72:75], v[140:143], v[232:235]
    ds_read_b64_tr_b16 v[36:37], v10 offset:20480
    ds_read_b64_tr_b16 v[38:39], v10 offset:25600
    v_mfma_f32_16x16x32_bf16 v[196:199], v[76:79], v[136:139], v[196:199]
    ds_read_b64_tr_b16 v[40:41], v9 offset:20544
    ds_read_b64_tr_b16 v[42:43], v9 offset:25664
    v_mfma_f32_16x16x32_bf16 v[236:239], v[76:79], v[140:143], v[236:239]
    ds_read_b64_tr_b16 v[44:45], v10 offset:20544
    ds_read_b64_tr_b16 v[46:47], v10 offset:25664
    v_mfma_f32_16x16x32_bf16 v[200:203], v[80:83], v[136:139], v[200:203]
    ds_read_b64_tr_b16 v[48:49], v9 offset:20608
    ds_read_b64_tr_b16 v[50:51], v9 offset:25728
    v_mfma_f32_16x16x32_bf16 v[240:243], v[80:83], v[140:143], v[240:243]
    ds_read_b64_tr_b16 v[52:53], v10 offset:20608
    ds_read_b64_tr_b16 v[54:55], v10 offset:25728
    v_mfma_f32_16x16x32_bf16 v[204:207], v[84:87], v[136:139], v[204:207]
    ds_read_b64_tr_b16 v[56:57], v9 offset:20672
    v_mfma_f32_16x16x32_bf16 v[244:247], v[84:87], v[140:143], v[244:247]
    ds_read_b64_tr_b16 v[58:59], v9 offset:25792
    v_mfma_f32_16x16x32_bf16 v[208:211], v[88:91], v[136:139], v[208:211]
    ds_read_b64_tr_b16 v[60:61], v10 offset:20672
    v_mfma_f32_16x16x32_bf16 v[248:251], v[88:91], v[140:143], v[248:251]
    ds_read_b64_tr_b16 v[62:63], v10 offset:25792
    v_mfma_f32_16x16x32_bf16 v[212:215], v[92:95], v[136:139], v[212:215]
    ds_read_b64_tr_b16 v[64:65], v9 offset:20736
    v_mfma_f32_16x16x32_bf16 v[252:255], v[92:95], v[140:143], v[252:255]
    ds_read_b64_tr_b16 v[66:67], v9 offset:25856
    v_mfma_f32_16x16x32_bf16 v[216:219], v[96:99], v[136:139], v[216:219]
    ds_read_b64_tr_b16 v[68:69], v10 offset:20736
    v_mfma_f32_16x16x32_bf16 v[112:115], v[96:99], v[140:143], v[112:115]
    ds_read_b64_tr_b16 v[70:71], v10 offset:25856
    v_mfma_f32_16x16x32_bf16 v[220:223], v[100:103], v[136:139], v[220:223]
    v_mfma_f32_16x16x32_bf16 v[116:119], v[100:103], v[140:143], v[116:119]
    v_mfma_f32_16x16x32_bf16 v[224:227], v[104:107], v[136:139], v[224:227]
    v_mfma_f32_16x16x32_bf16 v[120:123], v[104:107], v[140:143], v[120:123]
    v_mfma_f32_16x16x32_bf16 v[228:231], v[108:111], v[136:139], v[228:231]
    v_mfma_f32_16x16x32_bf16 v[124:127], v[108:111], v[140:143], v[124:127]
    s_waitcnt vmcnt(10)
    s_waitcnt lgkmcnt(0)
    v_mfma_f32_16x16x32_bf16 v[192:195], v[32:35], v[144:147], v[192:195]
    ds_read_b64_tr_b16 v[72:73], v9 offset:30720
    ds_read_b64_tr_b16 v[74:75], v9 offset:35840
    v_mfma_f32_16x16x32_bf16 v[232:235], v[32:35], v[148:151], v[232:235]
    ds_read_b64_tr_b16 v[76:77], v10 offset:30720
    ds_read_b64_tr_b16 v[78:79], v10 offset:35840
    v_mfma_f32_16x16x32_bf16 v[196:199], v[36:39], v[144:147], v[196:199]
    ds_read_b64_tr_b16 v[80:81], v9 offset:30784
    ds_read_b64_tr_b16 v[82:83], v9 offset:35904
    v_mfma_f32_16x16x32_bf16 v[236:239], v[36:39], v[148:151], v[236:239]
    ds_read_b64_tr_b16 v[84:85], v10 offset:30784
    ds_read_b64_tr_b16 v[86:87], v10 offset:35904
    v_mfma_f32_16x16x32_bf16 v[200:203], v[40:43], v[144:147], v[200:203]
    ds_read_b64_tr_b16 v[88:89], v9 offset:30848
    ds_read_b64_tr_b16 v[90:91], v9 offset:35968
    v_mfma_f32_16x16x32_bf16 v[240:243], v[40:43], v[148:151], v[240:243]
    ds_read_b64_tr_b16 v[92:93], v10 offset:30848
    ds_read_b64_tr_b16 v[94:95], v10 offset:35968
    v_mfma_f32_16x16x32_bf16 v[204:207], v[44:47], v[144:147], v[204:207]
    ds_read_b64_tr_b16 v[96:97], v9 offset:30912
    v_mfma_f32_16x16x32_bf16 v[244:247], v[44:47], v[148:151], v[244:247]
    ds_read_b64_tr_b16 v[98:99], v9 offset:36032
    v_mfma_f32_16x16x32_bf16 v[208:211], v[48:51], v[144:147], v[208:211]
    ds_read_b64_tr_b16 v[100:101], v10 offset:30912
    v_mfma_f32_16x16x32_bf16 v[248:251], v[48:51], v[148:151], v[248:251]
    ds_read_b64_tr_b16 v[102:103], v10 offset:36032
    v_mfma_f32_16x16x32_bf16 v[212:215], v[52:55], v[144:147], v[212:215]
    ds_read_b64_tr_b16 v[104:105], v9 offset:30976
    v_mfma_f32_16x16x32_bf16 v[252:255], v[52:55], v[148:151], v[252:255]
    ds_read_b64_tr_b16 v[106:107], v9 offset:36096
    v_mfma_f32_16x16x32_bf16 v[216:219], v[56:59], v[144:147], v[216:219]
    ds_read_b64_tr_b16 v[108:109], v10 offset:30976
    v_mfma_f32_16x16x32_bf16 v[112:115], v[56:59], v[148:151], v[112:115]
    ds_read_b64_tr_b16 v[110:111], v10 offset:36096
    v_mfma_f32_16x16x32_bf16 v[220:223], v[60:63], v[144:147], v[220:223]
    v_mfma_f32_16x16x32_bf16 v[116:119], v[60:63], v[148:151], v[116:119]
    v_mfma_f32_16x16x32_bf16 v[224:227], v[64:67], v[144:147], v[224:227]
    v_mfma_f32_16x16x32_bf16 v[120:123], v[64:67], v[148:151], v[120:123]
    v_mfma_f32_16x16x32_bf16 v[228:231], v[68:71], v[144:147], v[228:231]
    v_mfma_f32_16x16x32_bf16 v[124:127], v[68:71], v[148:151], v[124:127]
    s_waitcnt vmcnt(8)
    s_waitcnt lgkmcnt(0)
    v_add_u32 v9, 40960, v9
    v_add_u32 v10, 40960, v10
    v_mfma_f32_16x16x32_bf16 v[192:195], v[72:75], v[152:155], v[192:195]
    ds_read_b64_tr_b16 v[32:33], v9 offset:0
    ds_read_b64_tr_b16 v[34:35], v9 offset:5120
    v_mfma_f32_16x16x32_bf16 v[232:235], v[72:75], v[156:159], v[232:235]
    ds_read_b64_tr_b16 v[36:37], v10 offset:0
    ds_read_b64_tr_b16 v[38:39], v10 offset:5120
    v_mfma_f32_16x16x32_bf16 v[196:199], v[76:79], v[152:155], v[196:199]
    ds_read_b64_tr_b16 v[40:41], v9 offset:64
    ds_read_b64_tr_b16 v[42:43], v9 offset:5184
    v_mfma_f32_16x16x32_bf16 v[236:239], v[76:79], v[156:159], v[236:239]
    ds_read_b64_tr_b16 v[44:45], v10 offset:64
    ds_read_b64_tr_b16 v[46:47], v10 offset:5184
    v_mfma_f32_16x16x32_bf16 v[200:203], v[80:83], v[152:155], v[200:203]
    ds_read_b64_tr_b16 v[48:49], v9 offset:128
    ds_read_b64_tr_b16 v[50:51], v9 offset:5248
    v_mfma_f32_16x16x32_bf16 v[240:243], v[80:83], v[156:159], v[240:243]
    ds_read_b64_tr_b16 v[52:53], v10 offset:128
    ds_read_b64_tr_b16 v[54:55], v10 offset:5248
    v_mfma_f32_16x16x32_bf16 v[204:207], v[84:87], v[152:155], v[204:207]
    ds_read_b64_tr_b16 v[56:57], v9 offset:192
    v_mfma_f32_16x16x32_bf16 v[244:247], v[84:87], v[156:159], v[244:247]
    ds_read_b64_tr_b16 v[58:59], v9 offset:5312
    v_mfma_f32_16x16x32_bf16 v[208:211], v[88:91], v[152:155], v[208:211]
    ds_read_b64_tr_b16 v[60:61], v10 offset:192
    v_mfma_f32_16x16x32_bf16 v[248:251], v[88:91], v[156:159], v[248:251]
    ds_read_b64_tr_b16 v[62:63], v10 offset:5312
    v_mfma_f32_16x16x32_bf16 v[212:215], v[92:95], v[152:155], v[212:215]
    ds_read_b64_tr_b16 v[64:65], v9 offset:256
    v_mfma_f32_16x16x32_bf16 v[252:255], v[92:95], v[156:159], v[252:255]
    ds_read_b64_tr_b16 v[66:67], v9 offset:5376
    v_mfma_f32_16x16x32_bf16 v[216:219], v[96:99], v[152:155], v[216:219]
    ds_read_b64_tr_b16 v[68:69], v10 offset:256
    v_mfma_f32_16x16x32_bf16 v[112:115], v[96:99], v[156:159], v[112:115]
    ds_read_b64_tr_b16 v[70:71], v10 offset:5376
    v_mfma_f32_16x16x32_bf16 v[220:223], v[100:103], v[152:155], v[220:223]
    v_mfma_f32_16x16x32_bf16 v[116:119], v[100:103], v[156:159], v[116:119]
    v_mfma_f32_16x16x32_bf16 v[224:227], v[104:107], v[152:155], v[224:227]
    v_mfma_f32_16x16x32_bf16 v[120:123], v[104:107], v[156:159], v[120:123]
    v_mfma_f32_16x16x32_bf16 v[228:231], v[108:111], v[152:155], v[228:231]
    v_mfma_f32_16x16x32_bf16 v[124:127], v[108:111], v[156:159], v[124:127]
    s_waitcnt vmcnt(6)
    s_waitcnt lgkmcnt(0)
    v_mfma_f32_16x16x32_bf16 v[192:195], v[32:35], v[160:163], v[192:195]
    ds_read_b64_tr_b16 v[72:73], v9 offset:10240
    ds_read_b64_tr_b16 v[74:75], v9 offset:15360
    v_mfma_f32_16x16x32_bf16 v[232:235], v[32:35], v[164:167], v[232:235]
    ds_read_b64_tr_b16 v[76:77], v10 offset:10240
    ds_read_b64_tr_b16 v[78:79], v10 offset:15360
    v_mfma_f32_16x16x32_bf16 v[196:199], v[36:39], v[160:163], v[196:199]
    ds_read_b64_tr_b16 v[80:81], v9 offset:10304
    ds_read_b64_tr_b16 v[82:83], v9 offset:15424
    v_mfma_f32_16x16x32_bf16 v[236:239], v[36:39], v[164:167], v[236:239]
    ds_read_b64_tr_b16 v[84:85], v10 offset:10304
    ds_read_b64_tr_b16 v[86:87], v10 offset:15424
    v_mfma_f32_16x16x32_bf16 v[200:203], v[40:43], v[160:163], v[200:203]
    ds_read_b64_tr_b16 v[88:89], v9 offset:10368
    ds_read_b64_tr_b16 v[90:91], v9 offset:15488
    v_mfma_f32_16x16x32_bf16 v[240:243], v[40:43], v[164:167], v[240:243]
    ds_read_b64_tr_b16 v[92:93], v10 offset:10368
    ds_read_b64_tr_b16 v[94:95], v10 offset:15488
    v_mfma_f32_16x16x32_bf16 v[204:207], v[44:47], v[160:163], v[204:207]
    ds_read_b64_tr_b16 v[96:97], v9 offset:10432
    v_mfma_f32_16x16x32_bf16 v[244:247], v[44:47], v[164:167], v[244:247]
    ds_read_b64_tr_b16 v[98:99], v9 offset:15552
    v_mfma_f32_16x16x32_bf16 v[208:211], v[48:51], v[160:163], v[208:211]
    ds_read_b64_tr_b16 v[100:101], v10 offset:10432
    v_mfma_f32_16x16x32_bf16 v[248:251], v[48:51], v[164:167], v[248:251]
    ds_read_b64_tr_b16 v[102:103], v10 offset:15552
    v_mfma_f32_16x16x32_bf16 v[212:215], v[52:55], v[160:163], v[212:215]
    ds_read_b64_tr_b16 v[104:105], v9 offset:10496
    v_mfma_f32_16x16x32_bf16 v[252:255], v[52:55], v[164:167], v[252:255]
    ds_read_b64_tr_b16 v[106:107], v9 offset:15616
    v_mfma_f32_16x16x32_bf16 v[216:219], v[56:59], v[160:163], v[216:219]
    ds_read_b64_tr_b16 v[108:109], v10 offset:10496
    v_mfma_f32_16x16x32_bf16 v[112:115], v[56:59], v[164:167], v[112:115]
    ds_read_b64_tr_b16 v[110:111], v10 offset:15616
    v_mfma_f32_16x16x32_bf16 v[220:223], v[60:63], v[160:163], v[220:223]
    v_mfma_f32_16x16x32_bf16 v[116:119], v[60:63], v[164:167], v[116:119]
    v_mfma_f32_16x16x32_bf16 v[224:227], v[64:67], v[160:163], v[224:227]
    v_mfma_f32_16x16x32_bf16 v[120:123], v[64:67], v[164:167], v[120:123]
    v_mfma_f32_16x16x32_bf16 v[228:231], v[68:71], v[160:163], v[228:231]
    v_mfma_f32_16x16x32_bf16 v[124:127], v[68:71], v[164:167], v[124:127]
    s_waitcnt vmcnt(4)
    s_waitcnt lgkmcnt(0)
    v_mfma_f32_16x16x32_bf16 v[192:195], v[72:75], v[168:171], v[192:195]
    ds_read_b64_tr_b16 v[32:33], v9 offset:20480
    ds_read_b64_tr_b16 v[34:35], v9 offset:25600
    v_mfma_f32_16x16x32_bf16 v[232:235], v[72:75], v[172:175], v[232:235]
    ds_read_b64_tr_b16 v[36:37], v10 offset:20480
    ds_read_b64_tr_b16 v[38:39], v10 offset:25600
    v_mfma_f32_16x16x32_bf16 v[196:199], v[76:79], v[168:171], v[196:199]
    ds_read_b64_tr_b16 v[40:41], v9 offset:20544
    ds_read_b64_tr_b16 v[42:43], v9 offset:25664
    v_mfma_f32_16x16x32_bf16 v[236:239], v[76:79], v[172:175], v[236:239]
    ds_read_b64_tr_b16 v[44:45], v10 offset:20544
    ds_read_b64_tr_b16 v[46:47], v10 offset:25664
    v_mfma_f32_16x16x32_bf16 v[200:203], v[80:83], v[168:171], v[200:203]
    ds_read_b64_tr_b16 v[48:49], v9 offset:20608
    ds_read_b64_tr_b16 v[50:51], v9 offset:25728
    v_mfma_f32_16x16x32_bf16 v[240:243], v[80:83], v[172:175], v[240:243]
    ds_read_b64_tr_b16 v[52:53], v10 offset:20608
    ds_read_b64_tr_b16 v[54:55], v10 offset:25728
    v_mfma_f32_16x16x32_bf16 v[204:207], v[84:87], v[168:171], v[204:207]
    ds_read_b64_tr_b16 v[56:57], v9 offset:20672
    v_mfma_f32_16x16x32_bf16 v[244:247], v[84:87], v[172:175], v[244:247]
    ds_read_b64_tr_b16 v[58:59], v9 offset:25792
    v_mfma_f32_16x16x32_bf16 v[208:211], v[88:91], v[168:171], v[208:211]
    ds_read_b64_tr_b16 v[60:61], v10 offset:20672
    v_mfma_f32_16x16x32_bf16 v[248:251], v[88:91], v[172:175], v[248:251]
    ds_read_b64_tr_b16 v[62:63], v10 offset:25792
    v_mfma_f32_16x16x32_bf16 v[212:215], v[92:95], v[168:171], v[212:215]
    ds_read_b64_tr_b16 v[64:65], v9 offset:20736
    v_mfma_f32_16x16x32_bf16 v[252:255], v[92:95], v[172:175], v[252:255]
    ds_read_b64_tr_b16 v[66:67], v9 offset:25856
    v_mfma_f32_16x16x32_bf16 v[216:219], v[96:99], v[168:171], v[216:219]
    ds_read_b64_tr_b16 v[68:69], v10 offset:20736
    v_mfma_f32_16x16x32_bf16 v[112:115], v[96:99], v[172:175], v[112:115]
    ds_read_b64_tr_b16 v[70:71], v10 offset:25856
    v_mfma_f32_16x16x32_bf16 v[220:223], v[100:103], v[168:171], v[220:223]
    v_mfma_f32_16x16x32_bf16 v[116:119], v[100:103], v[172:175], v[116:119]
    v_mfma_f32_16x16x32_bf16 v[224:227], v[104:107], v[168:171], v[224:227]
    v_mfma_f32_16x16x32_bf16 v[120:123], v[104:107], v[172:175], v[120:123]
    v_mfma_f32_16x16x32_bf16 v[228:231], v[108:111], v[168:171], v[228:231]
    v_mfma_f32_16x16x32_bf16 v[124:127], v[108:111], v[172:175], v[124:127]
    s_waitcnt vmcnt(2)
    s_waitcnt lgkmcnt(0)
    v_mfma_f32_16x16x32_bf16 v[192:195], v[32:35], v[176:179], v[192:195]
    ds_read_b64_tr_b16 v[72:73], v9 offset:30720
    ds_read_b64_tr_b16 v[74:75], v9 offset:35840
    v_mfma_f32_16x16x32_bf16 v[232:235], v[32:35], v[180:183], v[232:235]
    ds_read_b64_tr_b16 v[76:77], v10 offset:30720
    ds_read_b64_tr_b16 v[78:79], v10 offset:35840
    v_mfma_f32_16x16x32_bf16 v[196:199], v[36:39], v[176:179], v[196:199]
    ds_read_b64_tr_b16 v[80:81], v9 offset:30784
    ds_read_b64_tr_b16 v[82:83], v9 offset:35904
    v_mfma_f32_16x16x32_bf16 v[236:239], v[36:39], v[180:183], v[236:239]
    ds_read_b64_tr_b16 v[84:85], v10 offset:30784
    ds_read_b64_tr_b16 v[86:87], v10 offset:35904
    v_mfma_f32_16x16x32_bf16 v[200:203], v[40:43], v[176:179], v[200:203]
    ds_read_b64_tr_b16 v[88:89], v9 offset:30848
    ds_read_b64_tr_b16 v[90:91], v9 offset:35968
    v_mfma_f32_16x16x32_bf16 v[240:243], v[40:43], v[180:183], v[240:243]
    ds_read_b64_tr_b16 v[92:93], v10 offset:30848
    ds_read_b64_tr_b16 v[94:95], v10 offset:35968
    v_mfma_f32_16x16x32_bf16 v[204:207], v[44:47], v[176:179], v[204:207]
    ds_read_b64_tr_b16 v[96:97], v9 offset:30912
    v_mfma_f32_16x16x32_bf16 v[244:247], v[44:47], v[180:183], v[244:247]
    ds_read_b64_tr_b16 v[98:99], v9 offset:36032
    v_mfma_f32_16x16x32_bf16 v[208:211], v[48:51], v[176:179], v[208:211]
    ds_read_b64_tr_b16 v[100:101], v10 offset:30912
    v_mfma_f32_16x16x32_bf16 v[248:251], v[48:51], v[180:183], v[248:251]
    ds_read_b64_tr_b16 v[102:103], v10 offset:36032
    v_mfma_f32_16x16x32_bf16 v[212:215], v[52:55], v[176:179], v[212:215]
    ds_read_b64_tr_b16 v[104:105], v9 offset:30976
    v_mfma_f32_16x16x32_bf16 v[252:255], v[52:55], v[180:183], v[252:255]
    ds_read_b64_tr_b16 v[106:107], v9 offset:36096
    v_mfma_f32_16x16x32_bf16 v[216:219], v[56:59], v[176:179], v[216:219]
    ds_read_b64_tr_b16 v[108:109], v10 offset:30976
    v_mfma_f32_16x16x32_bf16 v[112:115], v[56:59], v[180:183], v[112:115]
    ds_read_b64_tr_b16 v[110:111], v10 offset:36096
    v_mfma_f32_16x16x32_bf16 v[220:223], v[60:63], v[176:179], v[220:223]
    v_mfma_f32_16x16x32_bf16 v[116:119], v[60:63], v[180:183], v[116:119]
    v_mfma_f32_16x16x32_bf16 v[224:227], v[64:67], v[176:179], v[224:227]
    v_mfma_f32_16x16x32_bf16 v[120:123], v[64:67], v[180:183], v[120:123]
    v_mfma_f32_16x16x32_bf16 v[228:231], v[68:71], v[176:179], v[228:231]
    v_mfma_f32_16x16x32_bf16 v[124:127], v[68:71], v[180:183], v[124:127]
    s_waitcnt vmcnt(0)
    s_waitcnt lgkmcnt(0)
    s_load_dwordx8 s[88:95], s[0:1], 56
    s_load_dwordx2 s[96:97], s[0:1], 104
    s_load_dwordx2 s[100:101], s[0:1], 0
    v_and_b32 v2, 15, v0
    v_mul_u32_u24 v2, 64, v2
    v_lshrrev_b32 v1, 4, v0
    v_lshl_add_u32 v2, v1, 4, v2
    s_add_u32 s56, s32, 20480
    v_add_u32 v3, 2048, v2
    v_mfma_f32_16x16x32_bf16 v[192:195], v[72:75], v[184:187], v[192:195]
    v_mfma_f32_16x16x32_bf16 v[232:235], v[72:75], v[188:191], v[232:235]
    v_mfma_f32_16x16x32_bf16 v[196:199], v[76:79], v[184:187], v[196:199]
    v_mfma_f32_16x16x32_bf16 v[236:239], v[76:79], v[188:191], v[236:239]
    v_mfma_f32_16x16x32_bf16 v[200:203], v[80:83], v[184:187], v[200:203]
    v_mfma_f32_16x16x32_bf16 v[240:243], v[80:83], v[188:191], v[240:243]
    v_mfma_f32_16x16x32_bf16 v[204:207], v[84:87], v[184:187], v[204:207]
    v_mfma_f32_16x16x32_bf16 v[244:247], v[84:87], v[188:191], v[244:247]
    v_mfma_f32_16x16x32_bf16 v[208:211], v[88:91], v[184:187], v[208:211]
    v_mfma_f32_16x16x32_bf16 v[248:251], v[88:91], v[188:191], v[248:251]
    v_mfma_f32_16x16x32_bf16 v[212:215], v[92:95], v[184:187], v[212:215]
    v_mfma_f32_16x16x32_bf16 v[252:255], v[92:95], v[188:191], v[252:255]
    v_mfma_f32_16x16x32_bf16 v[216:219], v[96:99], v[184:187], v[216:219]
    v_mfma_f32_16x16x32_bf16 v[112:115], v[96:99], v[188:191], v[112:115]
    v_mfma_f32_16x16x32_bf16 v[220:223], v[100:103], v[184:187], v[220:223]
    v_mfma_f32_16x16x32_bf16 v[116:119], v[100:103], v[188:191], v[116:119]
    v_mfma_f32_16x16x32_bf16 v[224:227], v[104:107], v[184:187], v[224:227]
    v_mfma_f32_16x16x32_bf16 v[120:123], v[104:107], v[188:191], v[120:123]
    v_mfma_f32_16x16x32_bf16 v[228:231], v[108:111], v[184:187], v[228:231]
    v_mfma_f32_16x16x32_bf16 v[124:127], v[108:111], v[188:191], v[124:127]
    v_bfe_u32 v1, v0, 4, 1
    v_cmp_eq_u32 vcc, 1, v1
    v_cvt_pk_bf16_f32 v32, v192, v193
    v_cvt_pk_bf16_f32 v33, v194, v195
    v_cvt_pk_bf16_f32 v34, v196, v197
    v_cvt_pk_bf16_f32 v35, v198, v199
    v_cndmask_b32 v36, v32, v34, vcc
    v_cndmask_b32 v37, v33, v35, vcc
    v_cndmask_b32 v38, v34, v32, vcc
    v_cndmask_b32 v39, v35, v33, vcc
    buffer_store_dwordx4 v[36:39], v2, s[36:39], s32 offen offset:0 sc1
    v_cvt_pk_bf16_f32 v40, v200, v201
    v_cvt_pk_bf16_f32 v41, v202, v203
    v_cvt_pk_bf16_f32 v42, v204, v205
    v_cvt_pk_bf16_f32 v43, v206, v207
    v_cndmask_b32 v44, v40, v42, vcc
    v_cndmask_b32 v45, v41, v43, vcc
    v_cndmask_b32 v46, v42, v40, vcc
    v_cndmask_b32 v47, v43, v41, vcc
    buffer_store_dwordx4 v[44:47], v2, s[36:39], s32 offen offset:1024 sc1
    v_cvt_pk_bf16_f32 v48, v208, v209
    v_cvt_pk_bf16_f32 v49, v210, v211
    v_cvt_pk_bf16_f32 v50, v212, v213
    v_cvt_pk_bf16_f32 v51, v214, v215
    v_cndmask_b32 v52, v48, v50, vcc
    v_cndmask_b32 v53, v49, v51, vcc
    v_cndmask_b32 v54, v50, v48, vcc
    v_cndmask_b32 v55, v51, v49, vcc
    buffer_store_dwordx4 v[52:55], v3, s[36:39], s32 offen offset:0 sc1
    v_cvt_pk_bf16_f32 v56, v216, v217
    v_cvt_pk_bf16_f32 v57, v218, v219
    v_cvt_pk_bf16_f32 v58, v220, v221
    v_cvt_pk_bf16_f32 v59, v222, v223
    v_cndmask_b32 v60, v56, v58, vcc
    v_cndmask_b32 v61, v57, v59, vcc
    v_cndmask_b32 v62, v58, v56, vcc
    v_cndmask_b32 v63, v59, v57, vcc
    buffer_store_dwordx4 v[60:63], v3, s[36:39], s32 offen offset:1024 sc1
    v_cvt_pk_bf16_f32 v32, v224, v225
    v_cvt_pk_bf16_f32 v33, v226, v227
    v_cvt_pk_bf16_f32 v34, v228, v229
    v_cvt_pk_bf16_f32 v35, v230, v231
    v_cndmask_b32 v36, v32, v34, vcc
    v_cndmask_b32 v37, v33, v35, vcc
    v_cndmask_b32 v38, v34, v32, vcc
    v_cndmask_b32 v39, v35, v33, vcc
    buffer_store_dwordx4 v[36:39], v3, s[36:39], s32 offen offset:2048 sc1
    v_cvt_pk_bf16_f32 v40, v232, v233
    v_cvt_pk_bf16_f32 v41, v234, v235
    v_cvt_pk_bf16_f32 v42, v236, v237
    v_cvt_pk_bf16_f32 v43, v238, v239
    v_cndmask_b32 v44, v40, v42, vcc
    v_cndmask_b32 v45, v41, v43, vcc
    v_cndmask_b32 v46, v42, v40, vcc
    v_cndmask_b32 v47, v43, v41, vcc
    buffer_store_dwordx4 v[44:47], v2, s[36:39], s56 offen offset:0 sc1
    v_cvt_pk_bf16_f32 v48, v240, v241
    v_cvt_pk_bf16_f32 v49, v242, v243
    v_cvt_pk_bf16_f32 v50, v244, v245
    v_cvt_pk_bf16_f32 v51, v246, v247
    v_cndmask_b32 v52, v48, v50, vcc
    v_cndmask_b32 v53, v49, v51, vcc
    v_cndmask_b32 v54, v50, v48, vcc
    v_cndmask_b32 v55, v51, v49, vcc
    buffer_store_dwordx4 v[52:55], v2, s[36:39], s56 offen offset:1024 sc1
    v_cvt_pk_bf16_f32 v56, v248, v249
    v_cvt_pk_bf16_f32 v57, v250, v251
    v_cvt_pk_bf16_f32 v58, v252, v253
    v_cvt_pk_bf16_f32 v59, v254, v255
    v_cndmask_b32 v60, v56, v58, vcc
    v_cndmask_b32 v61, v57, v59, vcc
    v_cndmask_b32 v62, v58, v56, vcc
    v_cndmask_b32 v63, v59, v57, vcc
    buffer_store_dwordx4 v[60:63], v3, s[36:39], s56 offen offset:0 sc1
    v_cvt_pk_bf16_f32 v32, v112, v113
    v_cvt_pk_bf16_f32 v33, v114, v115
    v_cvt_pk_bf16_f32 v34, v116, v117
    v_cvt_pk_bf16_f32 v35, v118, v119
    v_cndmask_b32 v36, v32, v34, vcc
    v_cndmask_b32 v37, v33, v35, vcc
    v_cndmask_b32 v38, v34, v32, vcc
    v_cndmask_b32 v39, v35, v33, vcc
    buffer_store_dwordx4 v[36:39], v3, s[36:39], s56 offen offset:1024 sc1
    v_cvt_pk_bf16_f32 v40, v120, v121
    v_cvt_pk_bf16_f32 v41, v122, v123
    v_cvt_pk_bf16_f32 v42, v124, v125
    v_cvt_pk_bf16_f32 v43, v126, v127
    v_cndmask_b32 v44, v40, v42, vcc
    v_cndmask_b32 v45, v41, v43, vcc
    v_cndmask_b32 v46, v42, v40, vcc
    v_cndmask_b32 v47, v43, v41, vcc
    buffer_store_dwordx4 v[44:47], v3, s[36:39], s56 offen offset:2048 sc1
    s_barrier
    s_branch k1_fin
k1_g0p40:
    s_barrier
    s_setprio 1
    s_waitcnt lgkmcnt(6)
    v_mfma_f32_16x16x32_bf16 v[192:195], v[80:83], v[112:115], v[192:195]
    ds_read_b128 v[108:111], v16 offset:23552
    v_mfma_f32_16x16x32_bf16 v[196:199], v[80:83], v[116:119], v[196:199]
    s_waitcnt lgkmcnt(6)
    v_mfma_f32_16x16x32_bf16 v[200:203], v[84:87], v[112:115], v[200:203]
    ds_read_b128 v[80:83], v16 offset:24576
    v_mfma_f32_16x16x32_bf16 v[204:207], v[84:87], v[116:119], v[204:207]
    s_waitcnt lgkmcnt(6)
    v_mfma_f32_16x16x32_bf16 v[208:211], v[88:91], v[112:115], v[208:211]
    ds_read_b128 v[84:87], v16 offset:25600
    v_mfma_f32_16x16x32_bf16 v[212:215], v[88:91], v[116:119], v[212:215]
    v_mfma_f32_16x16x32_bf16 v[44:47], v[40:43], v[112:115], v[44:47]
    s_waitcnt lgkmcnt(6)
    v_mfma_f32_16x16x32_bf16 v[216:219], v[92:95], v[112:115], v[216:219]
    ds_read_b128 v[88:91], v16 offset:26624
    v_mfma_f32_16x16x32_bf16 v[220:223], v[92:95], v[116:119], v[220:223]
    s_waitcnt lgkmcnt(6)
    v_mfma_f32_16x16x32_bf16 v[224:227], v[96:99], v[112:115], v[224:227]
    ds_read_b128 v[92:95], v16 offset:27648
    v_mfma_f32_16x16x32_bf16 v[228:231], v[96:99], v[116:119], v[228:231]
    s_waitcnt lgkmcnt(6)
    v_mfma_f32_16x16x32_bf16 v[232:235], v[100:103], v[112:115], v[232:235]
    ds_read_b128 v[96:99], v16 offset:28672
    v_mfma_f32_16x16x32_bf16 v[236:239], v[100:103], v[116:119], v[236:239]
    v_mfma_f32_16x16x32_bf16 v[48:51], v[40:43], v[116:119], v[48:51]
    s_waitcnt lgkmcnt(6)
    v_mfma_f32_16x16x32_bf16 v[240:243], v[104:107], v[112:115], v[240:243]
    ds_read_b128 v[100:103], v16 offset:29696
    v_mfma_f32_16x16x32_bf16 v[244:247], v[104:107], v[116:119], v[244:247]
    s_waitcnt lgkmcnt(6)
    v_mfma_f32_16x16x32_bf16 v[248:251], v[108:111], v[112:115], v[248:251]
    ds_read_b128 v[104:107], v16 offset:30720
    v_mfma_f32_16x16x32_bf16 v[252:255], v[108:111], v[116:119], v[252:255]
    s_waitcnt lgkmcnt(6)
    v_mfma_f32_16x16x32_bf16 v[192:195], v[80:83], v[120:123], v[192:195]
    ds_read_b128 v[108:111], v16 offset:31744
    v_mfma_f32_16x16x32_bf16 v[196:199], v[80:83], v[124:127], v[196:199]
    s_waitcnt lgkmcnt(6)
    v_mfma_f32_16x16x32_bf16 v[200:203], v[84:87], v[120:123], v[200:203]
    v_mfma_f32_16x16x32_bf16 v[204:207], v[84:87], v[124:127], v[204:207]
    s_waitcnt lgkmcnt(5)
    v_mfma_f32_16x16x32_bf16 v[208:211], v[88:91], v[120:123], v[208:211]
    v_mfma_f32_16x16x32_bf16 v[212:215], v[88:91], v[124:127], v[212:215]
    v_mfma_f32_16x16x32_bf16 v[44:47], v[40:43], v[120:123], v[44:47]
    s_waitcnt lgkmcnt(4)
    v_mfma_f32_16x16x32_bf16 v[216:219], v[92:95], v[120:123], v[216:219]
    v_mfma_f32_16x16x32_bf16 v[220:223], v[92:95], v[124:127], v[220:223]
    s_waitcnt lgkmcnt(3)
    v_mfma_f32_16x16x32_bf16 v[224:227], v[96:99], v[120:123], v[224:227]
    v_mfma_f32_16x16x32_bf16 v[228:231], v[96:99], v[124:127], v[228:231]
    s_waitcnt lgkmcnt(2)
    v_mfma_f32_16x16x32_bf16 v[232:235], v[100:103], v[120:123], v[232:235]
    v_mfma_f32_16x16x32_bf16 v[236:239], v[100:103], v[124:127], v[236:239]
    v_mfma_f32_16x16x32_bf16 v[48:51], v[40:43], v[124:127], v[48:51]
    s_waitcnt lgkmcnt(1)
    v_mfma_f32_16x16x32_bf16 v[240:243], v[104:107], v[120:123], v[240:243]
    v_mfma_f32_16x16x32_bf16 v[244:247], v[104:107], v[124:127], v[244:247]
    s_waitcnt lgkmcnt(0)
    v_mfma_f32_16x16x32_bf16 v[248:251], v[108:111], v[120:123], v[248:251]
    v_mfma_f32_16x16x32_bf16 v[252:255], v[108:111], v[124:127], v[252:255]
    s_waitcnt vmcnt(0)
    s_barrier
    s_setprio 2
    ds_read_b128 v[128:131], v13 offset:0
    ds_read_b128 v[132:135], v13 offset:1024
    ds_read_b128 v[136:139], v13 offset:2048
    ds_read_b128 v[140:143], v13 offset:3072
    ds_read_b128 v[144:147], v13 offset:4096
    ds_read_b128 v[148:151], v13 offset:5120
    ds_read_b128 v[152:155], v13 offset:6144
    ds_read_b128 v[156:159], v13 offset:7168
    ds_read_b128 v[160:163], v13 offset:8192
    ds_read_b128 v[164:167], v13 offset:9216
    ds_read_b128 v[168:171], v13 offset:10240
    ds_read_b128 v[172:175], v13 offset:11264
    ds_read_b128 v[176:179], v13 offset:12288
    ds_read_b128 v[180:183], v13 offset:13312
    ds_read_b128 v[184:187], v13 offset:14336
    ds_read_b128 v[188:191], v13 offset:15360
    s_lshl_b32 s54, s23, 2
    s_add_u32 s54, s54, s5
    s_lshl_b32 s54, s54, 18
    s_lshl_b32 s55, s6, 12
    s_add_u32 s54, s54, s55
    s_add_u32 s54, s54, 33554432
    s_add_u32 s55, s54, 0x20000
    v_bfe_u32 v15, v0, 3, 1
    v_bfe_u32 v16, v0, 4, 1
    v_lshl_add_u32 v15, v16, 4, v15
    v_bfe_u32 v16, v0, 2, 1
    v_lshl_add_u32 v15, v16, 5, v15
    v_and_b32 v16, 3, v0
    v_lshl_add_u32 v15, v15, 2, v16
    v_lshlrev_b32 v15, 10, v15
    v_min_u32 v16, v4, v5
    v_min3_u32 v16, v16, v6, v7
    v_cmp_eq_u32 vcc, 0, v16
    s_nop 0
    s_cmp_eq_u64 vcc, 0
    s_cbranch_scc0 k1_fsp
k1_fbk:
    s_barrier
    ds_read_b128 v[64:67], v14
    s_waitcnt lgkmcnt(0)
    v_min_f32 v68, v72, v64
    v_min_f32 v69, v76, v65
    v_sub_f32 v56, v68, v72
    v_sub_f32 v64, v68, v64
    v_sub_f32 v57, v69, v76
    v_sub_f32 v65, v69, v65
    v_exp_f32 v56, v56
    v_exp_f32 v64, v64
    v_exp_f32 v57, v57
    v_exp_f32 v65, v65
    v_mul_f32 v58, v44, v56
    v_fma_f32 v58, v66, v64, v58
    v_mul_f32 v59, v48, v57
    v_fma_f32 v59, v67, v65, v59
    v_rcp_f32 v58, v58
    v_rcp_f32 v59, v59
    v_mul_f32 v56, v56, v58
    v_mul_f32 v64, v64, v58
    v_mul_f32 v57, v57, v59
    v_mul_f32 v65, v65, v59
    v_mul_f32 v192, v192, v56
    v_mul_f32 v193, v193, v56
    v_mul_f32 v194, v194, v56
    v_mul_f32 v195, v195, v56
    v_fma_f32 v192, v128, v64, v192
    v_fma_f32 v193, v129, v64, v193
    v_fma_f32 v194, v130, v64, v194
    v_fma_f32 v195, v131, v64, v195
    v_mul_f32 v200, v200, v56
    v_mul_f32 v201, v201, v56
    v_mul_f32 v202, v202, v56
    v_mul_f32 v203, v203, v56
    v_fma_f32 v200, v136, v64, v200
    v_fma_f32 v201, v137, v64, v201
    v_fma_f32 v202, v138, v64, v202
    v_fma_f32 v203, v139, v64, v203
    v_cvt_pk_bf16_f32 v80, v192, v193
    v_cvt_pk_bf16_f32 v81, v194, v195
    v_cvt_pk_bf16_f32 v82, v200, v201
    v_cvt_pk_bf16_f32 v83, v202, v203
    buffer_store_dwordx4 v[80:83], v20, s[36:39], s54 offen offset:0 sc1
    v_mul_f32 v196, v196, v57
    v_mul_f32 v197, v197, v57
    v_mul_f32 v198, v198, v57
    v_mul_f32 v199, v199, v57
    v_fma_f32 v196, v132, v65, v196
    v_fma_f32 v197, v133, v65, v197
    v_fma_f32 v198, v134, v65, v198
    v_fma_f32 v199, v135, v65, v199
    v_mul_f32 v204, v204, v57
    v_mul_f32 v205, v205, v57
    v_mul_f32 v206, v206, v57
    v_mul_f32 v207, v207, v57
    v_fma_f32 v204, v140, v65, v204
    v_fma_f32 v205, v141, v65, v205
    v_fma_f32 v206, v142, v65, v206
    v_fma_f32 v207, v143, v65, v207
    v_cvt_pk_bf16_f32 v84, v196, v197
    v_cvt_pk_bf16_f32 v85, v198, v199
    v_cvt_pk_bf16_f32 v86, v204, v205
    v_cvt_pk_bf16_f32 v87, v206, v207
    buffer_store_dwordx4 v[84:87], v20, s[36:39], s55 offen offset:0 sc1
    v_mul_f32 v208, v208, v56
    v_mul_f32 v209, v209, v56
    v_mul_f32 v210, v210, v56
    v_mul_f32 v211, v211, v56
    v_fma_f32 v208, v144, v64, v208
    v_fma_f32 v209, v145, v64, v209
    v_fma_f32 v210, v146, v64, v210
    v_fma_f32 v211, v147, v64, v211
    v_mul_f32 v216, v216, v56
    v_mul_f32 v217, v217, v56
    v_mul_f32 v218, v218, v56
    v_mul_f32 v219, v219, v56
    v_fma_f32 v216, v152, v64, v216
    v_fma_f32 v217, v153, v64, v217
    v_fma_f32 v218, v154, v64, v218
    v_fma_f32 v219, v155, v64, v219
    v_cvt_pk_bf16_f32 v88, v208, v209
    v_cvt_pk_bf16_f32 v89, v210, v211
    v_cvt_pk_bf16_f32 v90, v216, v217
    v_cvt_pk_bf16_f32 v91, v218, v219
    buffer_store_dwordx4 v[88:91], v20, s[36:39], s54 offen offset:1024 sc1
    v_mul_f32 v212, v212, v57
    v_mul_f32 v213, v213, v57
    v_mul_f32 v214, v214, v57
    v_mul_f32 v215, v215, v57
    v_fma_f32 v212, v148, v65, v212
    v_fma_f32 v213, v149, v65, v213
    v_fma_f32 v214, v150, v65, v214
    v_fma_f32 v215, v151, v65, v215
    v_mul_f32 v220, v220, v57
    v_mul_f32 v221, v221, v57
    v_mul_f32 v222, v222, v57
    v_mul_f32 v223, v223, v57
    v_fma_f32 v220, v156, v65, v220
    v_fma_f32 v221, v157, v65, v221
    v_fma_f32 v222, v158, v65, v222
    v_fma_f32 v223, v159, v65, v223
    v_cvt_pk_bf16_f32 v92, v212, v213
    v_cvt_pk_bf16_f32 v93, v214, v215
    v_cvt_pk_bf16_f32 v94, v220, v221
    v_cvt_pk_bf16_f32 v95, v222, v223
    buffer_store_dwordx4 v[92:95], v20, s[36:39], s55 offen offset:1024 sc1
    v_mul_f32 v224, v224, v56
    v_mul_f32 v225, v225, v56
    v_mul_f32 v226, v226, v56
    v_mul_f32 v227, v227, v56
    v_fma_f32 v224, v160, v64, v224
    v_fma_f32 v225, v161, v64, v225
    v_fma_f32 v226, v162, v64, v226
    v_fma_f32 v227, v163, v64, v227
    v_mul_f32 v232, v232, v56
    v_mul_f32 v233, v233, v56
    v_mul_f32 v234, v234, v56
    v_mul_f32 v235, v235, v56
    v_fma_f32 v232, v168, v64, v232
    v_fma_f32 v233, v169, v64, v233
    v_fma_f32 v234, v170, v64, v234
    v_fma_f32 v235, v171, v64, v235
    v_cvt_pk_bf16_f32 v96, v224, v225
    v_cvt_pk_bf16_f32 v97, v226, v227
    v_cvt_pk_bf16_f32 v98, v232, v233
    v_cvt_pk_bf16_f32 v99, v234, v235
    buffer_store_dwordx4 v[96:99], v20, s[36:39], s54 offen offset:2048 sc1
    v_mul_f32 v228, v228, v57
    v_mul_f32 v229, v229, v57
    v_mul_f32 v230, v230, v57
    v_mul_f32 v231, v231, v57
    v_fma_f32 v228, v164, v65, v228
    v_fma_f32 v229, v165, v65, v229
    v_fma_f32 v230, v166, v65, v230
    v_fma_f32 v231, v167, v65, v231
    v_mul_f32 v236, v236, v57
    v_mul_f32 v237, v237, v57
    v_mul_f32 v238, v238, v57
    v_mul_f32 v239, v239, v57
    v_fma_f32 v236, v172, v65, v236
    v_fma_f32 v237, v173, v65, v237
    v_fma_f32 v238, v174, v65, v238
    v_fma_f32 v239, v175, v65, v239
    v_cvt_pk_bf16_f32 v100, v228, v229
    v_cvt_pk_bf16_f32 v101, v230, v231
    v_cvt_pk_bf16_f32 v102, v236, v237
    v_cvt_pk_bf16_f32 v103, v238, v239
    buffer_store_dwordx4 v[100:103], v20, s[36:39], s55 offen offset:2048 sc1
    v_mul_f32 v240, v240, v56
    v_mul_f32 v241, v241, v56
    v_mul_f32 v242, v242, v56
    v_mul_f32 v243, v243, v56
    v_fma_f32 v240, v176, v64, v240
    v_fma_f32 v241, v177, v64, v241
    v_fma_f32 v242, v178, v64, v242
    v_fma_f32 v243, v179, v64, v243
    v_mul_f32 v248, v248, v56
    v_mul_f32 v249, v249, v56
    v_mul_f32 v250, v250, v56
    v_mul_f32 v251, v251, v56
    v_fma_f32 v248, v184, v64, v248
    v_fma_f32 v249, v185, v64, v249
    v_fma_f32 v250, v186, v64, v250
    v_fma_f32 v251, v187, v64, v251
    v_cvt_pk_bf16_f32 v104, v240, v241
    v_cvt_pk_bf16_f32 v105, v242, v243
    v_cvt_pk_bf16_f32 v106, v248, v249
    v_cvt_pk_bf16_f32 v107, v250, v251
    buffer_store_dwordx4 v[104:107], v20, s[36:39], s54 offen offset:3072 sc1
    v_mul_f32 v244, v244, v57
    v_mul_f32 v245, v245, v57
    v_mul_f32 v246, v246, v57
    v_mul_f32 v247, v247, v57
    v_fma_f32 v244, v180, v65, v244
    v_fma_f32 v245, v181, v65, v245
    v_fma_f32 v246, v182, v65, v246
    v_fma_f32 v247, v183, v65, v247
    v_mul_f32 v252, v252, v57
    v_mul_f32 v253, v253, v57
    v_mul_f32 v254, v254, v57
    v_mul_f32 v255, v255, v57
    v_fma_f32 v252, v188, v65, v252
    v_fma_f32 v253, v189, v65, v253
    v_fma_f32 v254, v190, v65, v254
    v_fma_f32 v255, v191, v65, v255
    v_cvt_pk_bf16_f32 v108, v244, v245
    v_cvt_pk_bf16_f32 v109, v246, v247
    v_cvt_pk_bf16_f32 v110, v252, v253
    v_cvt_pk_bf16_f32 v111, v254, v255
    buffer_store_dwordx4 v[108:111], v20, s[36:39], s55 offen offset:3072 sc1
    s_add_u32 s56, s35, 0
    s_add_u32 m0, s44, 0
    s_nop 0
    buffer_load_dwordx4 v32, s[28:31], s56 offen lds
    s_add_u32 m0, s44, 1024
    s_nop 0
    buffer_load_dwordx4 v33, s[28:31], s56 offen lds
    s_add_u32 m0, s44, 2048
    s_nop 0
    buffer_load_dwordx4 v34, s[28:31], s56 offen lds
    s_add_u32 m0, s44, 3072
    s_nop 0
    buffer_load_dwordx4 v35, s[28:31], s56 offen lds
    s_add_u32 m0, s44, 4096
    s_nop 0
    buffer_load_dwordx4 v36, s[28:31], s56 offen lds
    s_add_u32 s56, s35, 20480
    s_add_u32 m0, s44, 5120
    s_nop 0
    buffer_load_dwordx4 v32, s[28:31], s56 offen lds
    s_add_u32 m0, s44, 6144
    s_nop 0
    buffer_load_dwordx4 v33, s[28:31], s56 offen lds
    s_add_u32 m0, s44, 7168
    s_nop 0
    buffer_load_dwordx4 v34, s[28:31], s56 offen lds
    s_add_u32 m0, s44, 8192
    s_nop 0
    buffer_load_dwordx4 v35, s[28:31], s56 offen lds
    s_add_u32 m0, s44, 9216
    s_nop 0
    buffer_load_dwordx4 v36, s[28:31], s56 offen lds
    s_add_u32 s56, s35, 40960
    s_add_u32 m0, s44, 10240
    s_nop 0
    buffer_load_dwordx4 v32, s[28:31], s56 offen lds
    s_add_u32 m0, s44, 11264
    s_nop 0
    buffer_load_dwordx4 v33, s[28:31], s56 offen lds
    s_add_u32 m0, s44, 12288
    s_nop 0
    buffer_load_dwordx4 v34, s[28:31], s56 offen lds
    s_add_u32 m0, s44, 13312
    s_nop 0
    buffer_load_dwordx4 v35, s[28:31], s56 offen lds
    s_add_u32 m0, s44, 14336
    s_nop 0
    buffer_load_dwordx4 v36, s[28:31], s56 offen lds
    s_add_u32 s56, s35, 61440
    s_add_u32 m0, s44, 15360
    s_nop 0
    buffer_load_dwordx4 v32, s[28:31], s56 offen lds
    s_add_u32 m0, s45, 0
    s_nop 0
    buffer_load_dwordx4 v37, s[28:31], s35 offen lds
    s_add_u32 m0, s45, 1024
    s_nop 0
    buffer_load_dwordx4 v38, s[28:31], s35 offen lds
    s_add_u32 m0, s45, 2048
    s_nop 0
    buffer_load_dwordx4 v39, s[28:31], s35 offen lds
    s_add_u32 m0, s45, 3072
    s_nop 0
    buffer_load_dwordx4 v52, s[28:31], s35 offen lds
    buffer_load_dword v29, v15, s[36:39], s26 offen sc1
    ds_read_b64_tr_b16 v[32:33], v9 offset:0
    ds_read_b64_tr_b16 v[34:35], v9 offset:5120
    ds_read_b64_tr_b16 v[36:37], v10 offset:0
    ds_read_b64_tr_b16 v[38:39], v10 offset:5120
    ds_read_b64_tr_b16 v[40:41], v9 offset:64
    ds_read_b64_tr_b16 v[42:43], v9 offset:5184
    ds_read_b64_tr_b16 v[44:45], v10 offset:64
    ds_read_b64_tr_b16 v[46:47], v10 offset:5184
    ds_read_b64_tr_b16 v[48:49], v9 offset:128
    ds_read_b64_tr_b16 v[50:51], v9 offset:5248
    ds_read_b64_tr_b16 v[52:53], v10 offset:128
    ds_read_b64_tr_b16 v[54:55], v10 offset:5248
    ds_read_b64_tr_b16 v[56:57], v9 offset:192
    ds_read_b64_tr_b16 v[58:59], v9 offset:5312
    ds_read_b64_tr_b16 v[60:61], v10 offset:192
    ds_read_b64_tr_b16 v[62:63], v10 offset:5312
    ds_read_b64_tr_b16 v[64:65], v9 offset:256
    ds_read_b64_tr_b16 v[66:67], v9 offset:5376
    ds_read_b64_tr_b16 v[68:69], v10 offset:256
    ds_read_b64_tr_b16 v[70:71], v10 offset:5376
    s_mov_b32 s16, 0
    s_waitcnt vmcnt(1)
    s_barrier
k1_redo:
    s_waitcnt vmcnt(0)
    v_cmp_eq_u32 vcc, -1, v29
    s_nop 0
    s_and_b32 s3, vcc_lo, 65535
    s_cmp_eq_u32 s3, 0
    s_cbranch_scc0 k1_hslo
k1_hblo:
    buffer_load_dwordx4 v[128:131], v20, s[36:39], s26 offen offset:0 sc1
    buffer_load_dwordx4 v[132:135], v20, s[36:39], s27 offen offset:0 sc1
    buffer_load_dwordx4 v[136:139], v20, s[36:39], s26 offen offset:1024 sc1
    buffer_load_dwordx4 v[140:143], v20, s[36:39], s27 offen offset:1024 sc1
    buffer_load_dwordx4 v[144:147], v20, s[36:39], s26 offen offset:2048 sc1
    buffer_load_dwordx4 v[148:151], v20, s[36:39], s27 offen offset:2048 sc1
    buffer_load_dwordx4 v[152:155], v20, s[36:39], s26 offen offset:3072 sc1
    buffer_load_dwordx4 v[156:159], v20, s[36:39], s27 offen offset:3072 sc1
    s_add_u32 s3, s26, 4096
    buffer_load_dwordx4 v[160:163], v20, s[36:39], s3 offen offset:0 sc1
    s_add_u32 s3, s27, 4096
    buffer_load_dwordx4 v[164:167], v20, s[36:39], s3 offen offset:0 sc1
    s_add_u32 s3, s26, 4096
    buffer_load_dwordx4 v[168:171], v20, s[36:39], s3 offen offset:1024 sc1
    s_add_u32 s3, s27, 4096
    buffer_load_dwordx4 v[172:175], v20, s[36:39], s3 offen offset:1024 sc1
    s_add_u32 s3, s26, 4096
    buffer_load_dwordx4 v[176:179], v20, s[36:39], s3 offen offset:2048 sc1
    s_add_u32 s3, s27, 4096
    buffer_load_dwordx4 v[180:183], v20, s[36:39], s3 offen offset:2048 sc1
    s_add_u32 s3, s26, 4096
    buffer_load_dwordx4 v[184:187], v20, s[36:39], s3 offen offset:3072 sc1
    s_add_u32 s3, s27, 4096
    buffer_load_dwordx4 v[188:191], v20, s[36:39], s3 offen offset:3072 sc1
    buffer_load_dword v29, v15, s[36:39], s26 offen sc1
    s_add_u32 s3, s26, 65536
    buffer_load_dword v3, v26, s[36:39], s3 offen sc1
    s_add_u32 s3, s27, 65536
    buffer_load_dword v3, v26, s[36:39], s3 offen sc1
    s_add_u32 s3, s26, 69632
    buffer_load_dword v3, v26, s[36:39], s3 offen sc1
    s_add_u32 s3, s27, 69632
    buffer_load_dword v3, v26, s[36:39], s3 offen sc1
    s_setprio 0
    v_mov_b32 v16, 0
    v_mov_b32 v17, 0
    s_waitcnt vmcnt(19)
    s_waitcnt lgkmcnt(0)
    v_mfma_f32_16x16x32_bf16 v[192:195], v[32:35], v[128:131], 0
    ds_read_b64_tr_b16 v[72:73], v9 offset:10240
    ds_read_b64_tr_b16 v[74:75], v9 offset:15360
    v_mfma_f32_16x16x32_bf16 v[232:235], v[32:35], v[132:135], 0
    ds_read_b64_tr_b16 v[76:77], v10 offset:10240
    ds_read_b64_tr_b16 v[78:79], v10 offset:15360
    v_mfma_f32_16x16x32_bf16 v[196:199], v[36:39], v[128:131], 0
    ds_read_b64_tr_b16 v[80:81], v9 offset:10304
    ds_read_b64_tr_b16 v[82:83], v9 offset:15424
    v_mfma_f32_16x16x32_bf16 v[236:239], v[36:39], v[132:135], 0
    ds_read_b64_tr_b16 v[84:85], v10 offset:10304
    ds_read_b64_tr_b16 v[86:87], v10 offset:15424
    v_mfma_f32_16x16x32_bf16 v[200:203], v[40:43], v[128:131], 0
    ds_read_b64_tr_b16 v[88:89], v9 offset:10368
    ds_read_b64_tr_b16 v[90:91], v9 offset:15488
    v_mfma_f32_16x16x32_bf16 v[240:243], v[40:43], v[132:135], 0
    ds_read_b64_tr_b16 v[92:93], v10 offset:10368
    ds_read_b64_tr_b16 v[94:95], v10 offset:15488
    v_mfma_f32_16x16x32_bf16 v[204:207], v[44:47], v[128:131], 0
    ds_read_b64_tr_b16 v[96:97], v9 offset:10432
    v_mfma_f32_16x16x32_bf16 v[244:247], v[44:47], v[132:135], 0
    ds_read_b64_tr_b16 v[98:99], v9 offset:15552
    v_mfma_f32_16x16x32_bf16 v[208:211], v[48:51], v[128:131], 0
    ds_read_b64_tr_b16 v[100:101], v10 offset:10432
    v_mfma_f32_16x16x32_bf16 v[248:251], v[48:51], v[132:135], 0
    ds_read_b64_tr_b16 v[102:103], v10 offset:15552
    v_mfma_f32_16x16x32_bf16 v[212:215], v[52:55], v[128:131], 0
    ds_read_b64_tr_b16 v[104:105], v9 offset:10496
    v_mfma_f32_16x16x32_bf16 v[252:255], v[52:55], v[132:135], 0
    ds_read_b64_tr_b16 v[106:107], v9 offset:15616
    v_mfma_f32_16x16x32_bf16 v[216:219], v[56:59], v[128:131], 0
    ds_read_b64_tr_b16 v[108:109], v10 offset:10496
    v_mfma_f32_16x16x32_bf16 v[112:115], v[56:59], v[132:135], 0
    ds_read_b64_tr_b16 v[110:111], v10 offset:15616
    v_mfma_f32_16x16x32_bf16 v[220:223], v[60:63], v[128:131], 0
    v_mfma_f32_16x16x32_bf16 v[116:119], v[60:63], v[132:135], 0
    v_mfma_f32_16x16x32_bf16 v[224:227], v[64:67], v[128:131], 0
    v_max3_u32 v16, v16, v128, v129
    v_mfma_f32_16x16x32_bf16 v[120:123], v[64:67], v[132:135], 0
    v_max3_u32 v17, v17, v130, v131
    v_mfma_f32_16x16x32_bf16 v[228:231], v[68:71], v[128:131], 0
    v_max3_u32 v16, v16, v132, v133
    v_mfma_f32_16x16x32_bf16 v[124:127], v[68:71], v[132:135], 0
    v_max3_u32 v17, v17, v134, v135
    s_waitcnt vmcnt(17)
    s_waitcnt lgkmcnt(0)
    v_mfma_f32_16x16x32_bf16 v[192:195], v[72:75], v[136:139], v[192:195]
    ds_read_b64_tr_b16 v[32:33], v9 offset:20480
    ds_read_b64_tr_b16 v[34:35], v9 offset:25600
    v_mfma_f32_16x16x32_bf16 v[232:235], v[72:75], v[140:143], v[232:235]
    ds_read_b64_tr_b16 v[36:37], v10 offset:20480
    ds_read_b64_tr_b16 v[38:39], v10 offset:25600
    v_mfma_f32_16x16x32_bf16 v[196:199], v[76:79], v[136:139], v[196:199]
    ds_read_b64_tr_b16 v[40:41], v9 offset:20544
    ds_read_b64_tr_b16 v[42:43], v9 offset:25664
    v_mfma_f32_16x16x32_bf16 v[236:239], v[76:79], v[140:143], v[236:239]
    ds_read_b64_tr_b16 v[44:45], v10 offset:20544
    ds_read_b64_tr_b16 v[46:47], v10 offset:25664
    v_mfma_f32_16x16x32_bf16 v[200:203], v[80:83], v[136:139], v[200:203]
    ds_read_b64_tr_b16 v[48:49], v9 offset:20608
    ds_read_b64_tr_b16 v[50:51], v9 offset:25728
    v_mfma_f32_16x16x32_bf16 v[240:243], v[80:83], v[140:143], v[240:243]
    ds_read_b64_tr_b16 v[52:53], v10 offset:20608
    ds_read_b64_tr_b16 v[54:55], v10 offset:25728
    v_mfma_f32_16x16x32_bf16 v[204:207], v[84:87], v[136:139], v[204:207]
    ds_read_b64_tr_b16 v[56:57], v9 offset:20672
    v_mfma_f32_16x16x32_bf16 v[244:247], v[84:87], v[140:143], v[244:247]
    ds_read_b64_tr_b16 v[58:59], v9 offset:25792
    v_mfma_f32_16x16x32_bf16 v[208:211], v[88:91], v[136:139], v[208:211]
    ds_read_b64_tr_b16 v[60:61], v10 offset:20672
    v_mfma_f32_16x16x32_bf16 v[248:251], v[88:91], v[140:143], v[248:251]
    ds_read_b64_tr_b16 v[62:63], v10 offset:25792
    v_mfma_f32_16x16x32_bf16 v[212:215], v[92:95], v[136:139], v[212:215]
    ds_read_b64_tr_b16 v[64:65], v9 offset:20736
    v_mfma_f32_16x16x32_bf16 v[252:255], v[92:95], v[140:143], v[252:255]
    ds_read_b64_tr_b16 v[66:67], v9 offset:25856
    v_mfma_f32_16x16x32_bf16 v[216:219], v[96:99], v[136:139], v[216:219]
    ds_read_b64_tr_b16 v[68:69], v10 offset:20736
    v_mfma_f32_16x16x32_bf16 v[112:115], v[96:99], v[140:143], v[112:115]
    ds_read_b64_tr_b16 v[70:71], v10 offset:25856
    v_mfma_f32_16x16x32_bf16 v[220:223], v[100:103], v[136:139], v[220:223]
    v_mfma_f32_16x16x32_bf16 v[116:119], v[100:103], v[140:143], v[116:119]
    v_mfma_f32_16x16x32_bf16 v[224:227], v[104:107], v[136:139], v[224:227]
    v_max3_u32 v16, v16, v136, v137
    v_mfma_f32_16x16x32_bf16 v[120:123], v[104:107], v[140:143], v[120:123]
    v_max3_u32 v17, v17, v138, v139
    v_mfma_f32_16x16x32_bf16 v[228:231], v[108:111], v[136:139], v[228:231]
    v_max3_u32 v16, v16, v140, v141
    v_mfma_f32_16x16x32_bf16 v[124:127], v[108:111], v[140:143], v[124:127]
    v_max3_u32 v17, v17, v142, v143
    s_waitcnt vmcnt(15)
    s_waitcnt lgkmcnt(0)
    v_mfma_f32_16x16x32_bf16 v[192:195], v[32:35], v[144:147], v[192:195]
    ds_read_b64_tr_b16 v[72:73], v9 offset:30720
    ds_read_b64_tr_b16 v[74:75], v9 offset:35840
    v_mfma_f32_16x16x32_bf16 v[232:235], v[32:35], v[148:151], v[232:235]
    ds_read_b64_tr_b16 v[76:77], v10 offset:30720
    ds_read_b64_tr_b16 v[78:79], v10 offset:35840
    v_mfma_f32_16x16x32_bf16 v[196:199], v[36:39], v[144:147], v[196:199]
    ds_read_b64_tr_b16 v[80:81], v9 offset:30784
    ds_read_b64_tr_b16 v[82:83], v9 offset:35904
    v_mfma_f32_16x16x32_bf16 v[236:239], v[36:39], v[148:151], v[236:239]
    ds_read_b64_tr_b16 v[84:85], v10 offset:30784
    ds_read_b64_tr_b16 v[86:87], v10 offset:35904
    v_mfma_f32_16x16x32_bf16 v[200:203], v[40:43], v[144:147], v[200:203]
    ds_read_b64_tr_b16 v[88:89], v9 offset:30848
    ds_read_b64_tr_b16 v[90:91], v9 offset:35968
    v_mfma_f32_16x16x32_bf16 v[240:243], v[40:43], v[148:151], v[240:243]
    ds_read_b64_tr_b16 v[92:93], v10 offset:30848
    ds_read_b64_tr_b16 v[94:95], v10 offset:35968
    v_mfma_f32_16x16x32_bf16 v[204:207], v[44:47], v[144:147], v[204:207]
    ds_read_b64_tr_b16 v[96:97], v9 offset:30912
    v_mfma_f32_16x16x32_bf16 v[244:247], v[44:47], v[148:151], v[244:247]
    ds_read_b64_tr_b16 v[98:99], v9 offset:36032
    v_mfma_f32_16x16x32_bf16 v[208:211], v[48:51], v[144:147], v[208:211]
    ds_read_b64_tr_b16 v[100:101], v10 offset:30912
    v_mfma_f32_16x16x32_bf16 v[248:251], v[48:51], v[148:151], v[248:251]
    ds_read_b64_tr_b16 v[102:103], v10 offset:36032
    v_mfma_f32_16x16x32_bf16 v[212:215], v[52:55], v[144:147], v[212:215]
    ds_read_b64_tr_b16 v[104:105], v9 offset:30976
    v_mfma_f32_16x16x32_bf16 v[252:255], v[52:55], v[148:151], v[252:255]
    ds_read_b64_tr_b16 v[106:107], v9 offset:36096
    v_mfma_f32_16x16x32_bf16 v[216:219], v[56:59], v[144:147], v[216:219]
    ds_read_b64_tr_b16 v[108:109], v10 offset:30976
    v_mfma_f32_16x16x32_bf16 v[112:115], v[56:59], v[148:151], v[112:115]
    ds_read_b64_tr_b16 v[110:111], v10 offset:36096
    v_mfma_f32_16x16x32_bf16 v[220:223], v[60:63], v[144:147], v[220:223]
    v_mfma_f32_16x16x32_bf16 v[116:119], v[60:63], v[148:151], v[116:119]
    v_mfma_f32_16x16x32_bf16 v[224:227], v[64:67], v[144:147], v[224:227]
    v_max3_u32 v16, v16, v144, v145
    v_mfma_f32_16x16x32_bf16 v[120:123], v[64:67], v[148:151], v[120:123]
    v_max3_u32 v17, v17, v146, v147
    v_mfma_f32_16x16x32_bf16 v[228:231], v[68:71], v[144:147], v[228:231]
    v_max3_u32 v16, v16, v148, v149
    v_mfma_f32_16x16x32_bf16 v[124:127], v[68:71], v[148:151], v[124:127]
    v_max3_u32 v17, v17, v150, v151
    s_waitcnt vmcnt(4)
    v_cmp_eq_u32 vcc, -1, v29
    s_nop 0
    s_and_b32 s3, vcc_lo, 4294901760
    s_cmp_eq_u32 s3, 0
    s_cbranch_scc0 k1_hshi
k1_hbhi:
    s_add_u32 s3, s26, 65536
    buffer_load_dwordx4 v[128:131], v20, s[36:39], s3 offen offset:0 sc1
    s_add_u32 s3, s27, 65536
    buffer_load_dwordx4 v[132:135], v20, s[36:39], s3 offen offset:0 sc1
    s_add_u32 s3, s26, 65536
    buffer_load_dwordx4 v[136:139], v20, s[36:39], s3 offen offset:1024 sc1
    s_add_u32 s3, s27, 65536
    buffer_load_dwordx4 v[140:143], v20, s[36:39], s3 offen offset:1024 sc1
    s_add_u32 s3, s26, 65536
    buffer_load_dwordx4 v[144:147], v20, s[36:39], s3 offen offset:2048 sc1
    s_add_u32 s3, s27, 65536
    buffer_load_dwordx4 v[148:151], v20, s[36:39], s3 offen offset:2048 sc1
    s_waitcnt vmcnt(19)
    s_waitcnt lgkmcnt(0)
    v_add_u32 v9, 4294926336, v9
    v_add_u32 v10, 4294926336, v10
    v_mfma_f32_16x16x32_bf16 v[192:195], v[72:75], v[152:155], v[192:195]
    ds_read_b64_tr_b16 v[32:33], v9 offset:0
    ds_read_b64_tr_b16 v[34:35], v9 offset:5120
    v_mfma_f32_16x16x32_bf16 v[232:235], v[72:75], v[156:159], v[232:235]
    ds_read_b64_tr_b16 v[36:37], v10 offset:0
    ds_read_b64_tr_b16 v[38:39], v10 offset:5120
    v_mfma_f32_16x16x32_bf16 v[196:199], v[76:79], v[152:155], v[196:199]
    ds_read_b64_tr_b16 v[40:41], v9 offset:64
    ds_read_b64_tr_b16 v[42:43], v9 offset:5184
    v_mfma_f32_16x16x32_bf16 v[236:239], v[76:79], v[156:159], v[236:239]
    ds_read_b64_tr_b16 v[44:45], v10 offset:64
    ds_read_b64_tr_b16 v[46:47], v10 offset:5184
    v_mfma_f32_16x16x32_bf16 v[200:203], v[80:83], v[152:155], v[200:203]
    ds_read_b64_tr_b16 v[48:49], v9 offset:128
    ds_read_b64_tr_b16 v[50:51], v9 offset:5248
    v_mfma_f32_16x16x32_bf16 v[240:243], v[80:83], v[156:159], v[240:243]
    ds_read_b64_tr_b16 v[52:53], v10 offset:128
    ds_read_b64_tr_b16 v[54:55], v10 offset:5248
    v_mfma_f32_16x16x32_bf16 v[204:207], v[84:87], v[152:155], v[204:207]
    ds_read_b64_tr_b16 v[56:57], v9 offset:192
    v_mfma_f32_16x16x32_bf16 v[244:247], v[84:87], v[156:159], v[244:247]
    ds_read_b64_tr_b16 v[58:59], v9 offset:5312
    v_mfma_f32_16x16x32_bf16 v[208:211], v[88:91], v[152:155], v[208:211]
    ds_read_b64_tr_b16 v[60:61], v10 offset:192
    v_mfma_f32_16x16x32_bf16 v[248:251], v[88:91], v[156:159], v[248:251]
    ds_read_b64_tr_b16 v[62:63], v10 offset:5312
    v_mfma_f32_16x16x32_bf16 v[212:215], v[92:95], v[152:155], v[212:215]
    ds_read_b64_tr_b16 v[64:65], v9 offset:256
    v_mfma_f32_16x16x32_bf16 v[252:255], v[92:95], v[156:159], v[252:255]
    ds_read_b64_tr_b16 v[66:67], v9 offset:5376
    v_mfma_f32_16x16x32_bf16 v[216:219], v[96:99], v[152:155], v[216:219]
    ds_read_b64_tr_b16 v[68:69], v10 offset:256
    v_mfma_f32_16x16x32_bf16 v[112:115], v[96:99], v[156:159], v[112:115]
    ds_read_b64_tr_b16 v[70:71], v10 offset:5376
    v_mfma_f32_16x16x32_bf16 v[220:223], v[100:103], v[152:155], v[220:223]
    v_mfma_f32_16x16x32_bf16 v[116:119], v[100:103], v[156:159], v[116:119]
    v_mfma_f32_16x16x32_bf16 v[224:227], v[104:107], v[152:155], v[224:227]
    v_max3_u32 v16, v16, v152, v153
    v_mfma_f32_16x16x32_bf16 v[120:123], v[104:107], v[156:159], v[120:123]
    v_max3_u32 v17, v17, v154, v155
    v_mfma_f32_16x16x32_bf16 v[228:231], v[108:111], v[152:155], v[228:231]
    v_max3_u32 v16, v16, v156, v157
    v_mfma_f32_16x16x32_bf16 v[124:127], v[108:111], v[156:159], v[124:127]
    v_max3_u32 v17, v17, v158, v159
    s_add_u32 s3, s26, 65536
    buffer_load_dwordx4 v[152:155], v20, s[36:39], s3 offen offset:3072 sc1
    s_add_u32 s3, s27, 65536
    buffer_load_dwordx4 v[156:159], v20, s[36:39], s3 offen offset:3072 sc1
    s_waitcnt vmcnt(19)
    s_waitcnt lgkmcnt(0)
    v_mfma_f32_16x16x32_bf16 v[192:195], v[32:35], v[160:163], v[192:195]
    ds_read_b64_tr_b16 v[72:73], v9 offset:10240
    ds_read_b64_tr_b16 v[74:75], v9 offset:15360
    v_mfma_f32_16x16x32_bf16 v[232:235], v[32:35], v[164:167], v[232:235]
    ds_read_b64_tr_b16 v[76:77], v10 offset:10240
    ds_read_b64_tr_b16 v[78:79], v10 offset:15360
    v_mfma_f32_16x16x32_bf16 v[196:199], v[36:39], v[160:163], v[196:199]
    ds_read_b64_tr_b16 v[80:81], v9 offset:10304
    ds_read_b64_tr_b16 v[82:83], v9 offset:15424
    v_mfma_f32_16x16x32_bf16 v[236:239], v[36:39], v[164:167], v[236:239]
    ds_read_b64_tr_b16 v[84:85], v10 offset:10304
    ds_read_b64_tr_b16 v[86:87], v10 offset:15424
    v_mfma_f32_16x16x32_bf16 v[200:203], v[40:43], v[160:163], v[200:203]
    ds_read_b64_tr_b16 v[88:89], v9 offset:10368
    ds_read_b64_tr_b16 v[90:91], v9 offset:15488
    v_mfma_f32_16x16x32_bf16 v[240:243], v[40:43], v[164:167], v[240:243]
    ds_read_b64_tr_b16 v[92:93], v10 offset:10368
    ds_read_b64_tr_b16 v[94:95], v10 offset:15488
    v_mfma_f32_16x16x32_bf16 v[204:207], v[44:47], v[160:163], v[204:207]
    ds_read_b64_tr_b16 v[96:97], v9 offset:10432
    v_mfma_f32_16x16x32_bf16 v[244:247], v[44:47], v[164:167], v[244:247]
    ds_read_b64_tr_b16 v[98:99], v9 offset:15552
    v_mfma_f32_16x16x32_bf16 v[208:211], v[48:51], v[160:163], v[208:211]
    ds_read_b64_tr_b16 v[100:101], v10 offset:10432
    v_mfma_f32_16x16x32_bf16 v[248:251], v[48:51], v[164:167], v[248:251]
    ds_read_b64_tr_b16 v[102:103], v10 offset:15552
    v_mfma_f32_16x16x32_bf16 v[212:215], v[52:55], v[160:163], v[212:215]
    ds_read_b64_tr_b16 v[104:105], v9 offset:10496
    v_mfma_f32_16x16x32_bf16 v[252:255], v[52:55], v[164:167], v[252:255]
    ds_read_b64_tr_b16 v[106:107], v9 offset:15616
    v_mfma_f32_16x16x32_bf16 v[216:219], v[56:59], v[160:163], v[216:219]
    ds_read_b64_tr_b16 v[108:109], v10 offset:10496
    v_mfma_f32_16x16x32_bf16 v[112:115], v[56:59], v[164:167], v[112:115]
    ds_read_b64_tr_b16 v[110:111], v10 offset:15616
    v_mfma_f32_16x16x32_bf16 v[220:223], v[60:63], v[160:163], v[220:223]
    v_mfma_f32_16x16x32_bf16 v[116:119], v[60:63], v[164:167], v[116:119]
    v_mfma_f32_16x16x32_bf16 v[224:227], v[64:67], v[160:163], v[224:227]
    v_max3_u32 v16, v16, v160, v161
    v_mfma_f32_16x16x32_bf16 v[120:123], v[64:67], v[164:167], v[120:123]
    v_max3_u32 v17, v17, v162, v163
    v_mfma_f32_16x16x32_bf16 v[228:231], v[68:71], v[160:163], v[228:231]
    v_max3_u32 v16, v16, v164, v165
    v_mfma_f32_16x16x32_bf16 v[124:127], v[68:71], v[164:167], v[124:127]
    v_max3_u32 v17, v17, v166, v167
    s_add_u32 s3, s26, 69632
    buffer_load_dwordx4 v[160:163], v20, s[36:39], s3 offen offset:0 sc1
    s_add_u32 s3, s27, 69632
    buffer_load_dwordx4 v[164:167], v20, s[36:39], s3 offen offset:0 sc1
    s_waitcnt vmcnt(19)
    s_waitcnt lgkmcnt(0)
    v_mfma_f32_16x16x32_bf16 v[192:195], v[72:75], v[168:171], v[192:195]
    ds_read_b64_tr_b16 v[32:33], v9 offset:20480
    ds_read_b64_tr_b16 v[34:35], v9 offset:25600
    v_mfma_f32_16x16x32_bf16 v[232:235], v[72:75], v[172:175], v[232:235]
    ds_read_b64_tr_b16 v[36:37], v10 offset:20480
    ds_read_b64_tr_b16 v[38:39], v10 offset:25600
    v_mfma_f32_16x16x32_bf16 v[196:199], v[76:79], v[168:171], v[196:199]
    ds_read_b64_tr_b16 v[40:41], v9 offset:20544
    ds_read_b64_tr_b16 v[42:43], v9 offset:25664
    v_mfma_f32_16x16x32_bf16 v[236:239], v[76:79], v[172:175], v[236:239]
    ds_read_b64_tr_b16 v[44:45], v10 offset:20544
    ds_read_b64_tr_b16 v[46:47], v10 offset:25664
    v_mfma_f32_16x16x32_bf16 v[200:203], v[80:83], v[168:171], v[200:203]
    ds_read_b64_tr_b16 v[48:49], v9 offset:20608
    ds_read_b64_tr_b16 v[50:51], v9 offset:25728
    v_mfma_f32_16x16x32_bf16 v[240:243], v[80:83], v[172:175], v[240:243]
    ds_read_b64_tr_b16 v[52:53], v10 offset:20608
    ds_read_b64_tr_b16 v[54:55], v10 offset:25728
    v_mfma_f32_16x16x32_bf16 v[204:207], v[84:87], v[168:171], v[204:207]
    ds_read_b64_tr_b16 v[56:57], v9 offset:20672
    v_mfma_f32_16x16x32_bf16 v[244:247], v[84:87], v[172:175], v[244:247]
    ds_read_b64_tr_b16 v[58:59], v9 offset:25792
    v_mfma_f32_16x16x32_bf16 v[208:211], v[88:91], v[168:171], v[208:211]
    ds_read_b64_tr_b16 v[60:61], v10 offset:20672
    v_mfma_f32_16x16x32_bf16 v[248:251], v[88:91], v[172:175], v[248:251]
    ds_read_b64_tr_b16 v[62:63], v10 offset:25792
    v_mfma_f32_16x16x32_bf16 v[212:215], v[92:95], v[168:171], v[212:215]
    ds_read_b64_tr_b16 v[64:65], v9 offset:20736
    v_mfma_f32_16x16x32_bf16 v[252:255], v[92:95], v[172:175], v[252:255]
    ds_read_b64_tr_b16 v[66:67], v9 offset:25856
    v_mfma_f32_16x16x32_bf16 v[216:219], v[96:99], v[168:171], v[216:219]
    ds_read_b64_tr_b16 v[68:69], v10 offset:20736
    v_mfma_f32_16x16x32_bf16 v[112:115], v[96:99], v[172:175], v[112:115]
    ds_read_b64_tr_b16 v[70:71], v10 offset:25856
    v_mfma_f32_16x16x32_bf16 v[220:223], v[100:103], v[168:171], v[220:223]
    v_mfma_f32_16x16x32_bf16 v[116:119], v[100:103], v[172:175], v[116:119]
    v_mfma_f32_16x16x32_bf16 v[224:227], v[104:107], v[168:171], v[224:227]
    v_max3_u32 v16, v16, v168, v169
    v_mfma_f32_16x16x32_bf16 v[120:123], v[104:107], v[172:175], v[120:123]
    v_max3_u32 v17, v17, v170, v171
    v_mfma_f32_16x16x32_bf16 v[228:231], v[108:111], v[168:171], v[228:231]
    v_max3_u32 v16, v16, v172, v173
    v_mfma_f32_16x16x32_bf16 v[124:127], v[108:111], v[172:175], v[124:127]
    v_max3_u32 v17, v17, v174, v175
    s_add_u32 s3, s26, 69632
    buffer_load_dwordx4 v[168:171], v20, s[36:39], s3 offen offset:1024 sc1
    s_add_u32 s3, s27, 69632
    buffer_load_dwordx4 v[172:175], v20, s[36:39], s3 offen offset:1024 sc1
    s_waitcnt vmcnt(19)
    s_waitcnt lgkmcnt(0)
    v_mfma_f32_16x16x32_bf16 v[192:195], v[32:35], v[176:179], v[192:195]
    ds_read_b64_tr_b16 v[72:73], v9 offset:30720
    ds_read_b64_tr_b16 v[74:75], v9 offset:35840
    v_mfma_f32_16x16x32_bf16 v[232:235], v[32:35], v[180:183], v[232:235]
    ds_read_b64_tr_b16 v[76:77], v10 offset:30720
    ds_read_b64_tr_b16 v[78:79], v10 offset:35840
    v_mfma_f32_16x16x32_bf16 v[196:199], v[36:39], v[176:179], v[196:199]
    ds_read_b64_tr_b16 v[80:81], v9 offset:30784
    ds_read_b64_tr_b16 v[82:83], v9 offset:35904
    v_mfma_f32_16x16x32_bf16 v[236:239], v[36:39], v[180:183], v[236:239]
    ds_read_b64_tr_b16 v[84:85], v10 offset:30784
    ds_read_b64_tr_b16 v[86:87], v10 offset:35904
    v_mfma_f32_16x16x32_bf16 v[200:203], v[40:43], v[176:179], v[200:203]
    ds_read_b64_tr_b16 v[88:89], v9 offset:30848
    ds_read_b64_tr_b16 v[90:91], v9 offset:35968
    v_mfma_f32_16x16x32_bf16 v[240:243], v[40:43], v[180:183], v[240:243]
    ds_read_b64_tr_b16 v[92:93], v10 offset:30848
    ds_read_b64_tr_b16 v[94:95], v10 offset:35968
    v_mfma_f32_16x16x32_bf16 v[204:207], v[44:47], v[176:179], v[204:207]
    ds_read_b64_tr_b16 v[96:97], v9 offset:30912
    v_mfma_f32_16x16x32_bf16 v[244:247], v[44:47], v[180:183], v[244:247]
    ds_read_b64_tr_b16 v[98:99], v9 offset:36032
    v_mfma_f32_16x16x32_bf16 v[208:211], v[48:51], v[176:179], v[208:211]
    ds_read_b64_tr_b16 v[100:101], v10 offset:30912
    v_mfma_f32_16x16x32_bf16 v[248:251], v[48:51], v[180:183], v[248:251]
    ds_read_b64_tr_b16 v[102:103], v10 offset:36032
    v_mfma_f32_16x16x32_bf16 v[212:215], v[52:55], v[176:179], v[212:215]
    ds_read_b64_tr_b16 v[104:105], v9 offset:30976
    v_mfma_f32_16x16x32_bf16 v[252:255], v[52:55], v[180:183], v[252:255]
    ds_read_b64_tr_b16 v[106:107], v9 offset:36096
    v_mfma_f32_16x16x32_bf16 v[216:219], v[56:59], v[176:179], v[216:219]
    ds_read_b64_tr_b16 v[108:109], v10 offset:30976
    v_mfma_f32_16x16x32_bf16 v[112:115], v[56:59], v[180:183], v[112:115]
    ds_read_b64_tr_b16 v[110:111], v10 offset:36096
    v_mfma_f32_16x16x32_bf16 v[220:223], v[60:63], v[176:179], v[220:223]
    v_mfma_f32_16x16x32_bf16 v[116:119], v[60:63], v[180:183], v[116:119]
    v_mfma_f32_16x16x32_bf16 v[224:227], v[64:67], v[176:179], v[224:227]
    v_max3_u32 v16, v16, v176, v177
    v_mfma_f32_16x16x32_bf16 v[120:123], v[64:67], v[180:183], v[120:123]
    v_max3_u32 v17, v17, v178, v179
    v_mfma_f32_16x16x32_bf16 v[228:231], v[68:71], v[176:179], v[228:231]
    v_max3_u32 v16, v16, v180, v181
    v_mfma_f32_16x16x32_bf16 v[124:127], v[68:71], v[180:183], v[124:127]
    v_max3_u32 v17, v17, v182, v183
    s_add_u32 s3, s26, 69632
    buffer_load_dwordx4 v[176:179], v20, s[36:39], s3 offen offset:2048 sc1
    s_add_u32 s3, s27, 69632
    buffer_load_dwordx4 v[180:183], v20, s[36:39], s3 offen offset:2048 sc1
    s_waitcnt vmcnt(19)
    s_waitcnt lgkmcnt(0)
    v_add_u32 v9, 4294885376, v9
    v_add_u32 v10, 4294885376, v10
    v_mfma_f32_16x16x32_bf16 v[192:195], v[72:75], v[184:187], v[192:195]
    ds_read_b64_tr_b16 v[32:33], v9 offset:0
    ds_read_b64_tr_b16 v[34:35], v9 offset:5120
    v_mfma_f32_16x16x32_bf16 v[232:235], v[72:75], v[188:191], v[232:235]
    ds_read_b64_tr_b16 v[36:37], v10 offset:0
    ds_read_b64_tr_b16 v[38:39], v10 offset:5120
    v_mfma_f32_16x16x32_bf16 v[196:199], v[76:79], v[184:187], v[196:199]
    ds_read_b64_tr_b16 v[40:41], v9 offset:64
    ds_read_b64_tr_b16 v[42:43], v9 offset:5184
    v_mfma_f32_16x16x32_bf16 v[236:239], v[76:79], v[188:191], v[236:239]
    ds_read_b64_tr_b16 v[44:45], v10 offset:64
    ds_read_b64_tr_b16 v[46:47], v10 offset:5184
    v_mfma_f32_16x16x32_bf16 v[200:203], v[80:83], v[184:187], v[200:203]
    ds_read_b64_tr_b16 v[48:49], v9 offset:128
    ds_read_b64_tr_b16 v[50:51], v9 offset:5248
    v_mfma_f32_16x16x32_bf16 v[240:243], v[80:83], v[188:191], v[240:243]
    ds_read_b64_tr_b16 v[52:53], v10 offset:128
    ds_read_b64_tr_b16 v[54:55], v10 offset:5248
    v_mfma_f32_16x16x32_bf16 v[204:207], v[84:87], v[184:187], v[204:207]
    ds_read_b64_tr_b16 v[56:57], v9 offset:192
    v_mfma_f32_16x16x32_bf16 v[244:247], v[84:87], v[188:191], v[244:247]
    ds_read_b64_tr_b16 v[58:59], v9 offset:5312
    v_mfma_f32_16x16x32_bf16 v[208:211], v[88:91], v[184:187], v[208:211]
    ds_read_b64_tr_b16 v[60:61], v10 offset:192
    v_mfma_f32_16x16x32_bf16 v[248:251], v[88:91], v[188:191], v[248:251]
    ds_read_b64_tr_b16 v[62:63], v10 offset:5312
    v_mfma_f32_16x16x32_bf16 v[212:215], v[92:95], v[184:187], v[212:215]
    ds_read_b64_tr_b16 v[64:65], v9 offset:256
    v_mfma_f32_16x16x32_bf16 v[252:255], v[92:95], v[188:191], v[252:255]
    ds_read_b64_tr_b16 v[66:67], v9 offset:5376
    v_mfma_f32_16x16x32_bf16 v[216:219], v[96:99], v[184:187], v[216:219]
    ds_read_b64_tr_b16 v[68:69], v10 offset:256
    v_mfma_f32_16x16x32_bf16 v[112:115], v[96:99], v[188:191], v[112:115]
    ds_read_b64_tr_b16 v[70:71], v10 offset:5376
    v_mfma_f32_16x16x32_bf16 v[220:223], v[100:103], v[184:187], v[220:223]
    v_mfma_f32_16x16x32_bf16 v[116:119], v[100:103], v[188:191], v[116:119]
    v_mfma_f32_16x16x32_bf16 v[224:227], v[104:107], v[184:187], v[224:227]
    v_max3_u32 v16, v16, v184, v185
    v_mfma_f32_16x16x32_bf16 v[120:123], v[104:107], v[188:191], v[120:123]
    v_max3_u32 v17, v17, v186, v187
    v_mfma_f32_16x16x32_bf16 v[228:231], v[108:111], v[184:187], v[228:231]
    v_max3_u32 v16, v16, v188, v189
    v_mfma_f32_16x16x32_bf16 v[124:127], v[108:111], v[188:191], v[124:127]
    v_max3_u32 v17, v17, v190, v191
    s_add_u32 s3, s26, 69632
    buffer_load_dwordx4 v[184:187], v20, s[36:39], s3 offen offset:3072 sc1
    s_add_u32 s3, s27, 69632
    buffer_load_dwordx4 v[188:191], v20, s[36:39], s3 offen offset:3072 sc1
    s_waitcnt vmcnt(14)
    s_waitcnt lgkmcnt(0)
    v_mfma_f32_16x16x32_bf16 v[192:195], v[32:35], v[128:131], v[192:195]
    ds_read_b64_tr_b16 v[72:73], v9 offset:10240
    ds_read_b64_tr_b16 v[74:75], v9 offset:15360
    v_mfma_f32_16x16x32_bf16 v[232:235], v[32:35], v[132:135], v[232:235]
    ds_read_b64_tr_b16 v[76:77], v10 offset:10240
    ds_read_b64_tr_b16 v[78:79], v10 offset:15360
    v_mfma_f32_16x16x32_bf16 v[196:199], v[36:39], v[128:131], v[196:199]
    ds_read_b64_tr_b16 v[80:81], v9 offset:10304
    ds_read_b64_tr_b16 v[82:83], v9 offset:15424
    v_mfma_f32_16x16x32_bf16 v[236:239], v[36:39], v[132:135], v[236:239]
    ds_read_b64_tr_b16 v[84:85], v10 offset:10304
    ds_read_b64_tr_b16 v[86:87], v10 offset:15424
    v_mfma_f32_16x16x32_bf16 v[200:203], v[40:43], v[128:131], v[200:203]
    ds_read_b64_tr_b16 v[88:89], v9 offset:10368
    ds_read_b64_tr_b16 v[90:91], v9 offset:15488
    v_mfma_f32_16x16x32_bf16 v[240:243], v[40:43], v[132:135], v[240:243]
    ds_read_b64_tr_b16 v[92:93], v10 offset:10368
    ds_read_b64_tr_b16 v[94:95], v10 offset:15488
    v_mfma_f32_16x16x32_bf16 v[204:207], v[44:47], v[128:131], v[204:207]
    ds_read_b64_tr_b16 v[96:97], v9 offset:10432
    v_mfma_f32_16x16x32_bf16 v[244:247], v[44:47], v[132:135], v[244:247]
    ds_read_b64_tr_b16 v[98:99], v9 offset:15552
    v_mfma_f32_16x16x32_bf16 v[208:211], v[48:51], v[128:131], v[208:211]
    ds_read_b64_tr_b16 v[100:101], v10 offset:10432
    v_mfma_f32_16x16x32_bf16 v[248:251], v[48:51], v[132:135], v[248:251]
    ds_read_b64_tr_b16 v[102:103], v10 offset:15552
    v_mfma_f32_16x16x32_bf16 v[212:215], v[52:55], v[128:131], v[212:215]
    ds_read_b64_tr_b16 v[104:105], v9 offset:10496
    v_mfma_f32_16x16x32_bf16 v[252:255], v[52:55], v[132:135], v[252:255]
    ds_read_b64_tr_b16 v[106:107], v9 offset:15616
    v_mfma_f32_16x16x32_bf16 v[216:219], v[56:59], v[128:131], v[216:219]
    ds_read_b64_tr_b16 v[108:109], v10 offset:10496
    v_mfma_f32_16x16x32_bf16 v[112:115], v[56:59], v[132:135], v[112:115]
    ds_read_b64_tr_b16 v[110:111], v10 offset:15616
    v_mfma_f32_16x16x32_bf16 v[220:223], v[60:63], v[128:131], v[220:223]
    v_mfma_f32_16x16x32_bf16 v[116:119], v[60:63], v[132:135], v[116:119]
    v_mfma_f32_16x16x32_bf16 v[224:227], v[64:67], v[128:131], v[224:227]
    v_max3_u32 v16, v16, v128, v129
    v_mfma_f32_16x16x32_bf16 v[120:123], v[64:67], v[132:135], v[120:123]
    v_max3_u32 v17, v17, v130, v131
    v_mfma_f32_16x16x32_bf16 v[228:231], v[68:71], v[128:131], v[228:231]
    v_max3_u32 v16, v16, v132, v133
    v_mfma_f32_16x16x32_bf16 v[124:127], v[68:71], v[132:135], v[124:127]
    v_max3_u32 v17, v17, v134, v135
    s_waitcnt vmcnt(12)
    s_waitcnt lgkmcnt(0)
    v_mfma_f32_16x16x32_bf16 v[192:195], v[72:75], v[136:139], v[192:195]
    ds_read_b64_tr_b16 v[32:33], v9 offset:20480
    ds_read_b64_tr_b16 v[34:35], v9 offset:25600
    v_mfma_f32_16x16x32_bf16 v[232:235], v[72:75], v[140:143], v[232:235]
    ds_read_b64_tr_b16 v[36:37], v10 offset:20480
    ds_read_b64_tr_b16 v[38:39], v10 offset:25600
    v_mfma_f32_16x16x32_bf16 v[196:199], v[76:79], v[136:139], v[196:199]
    ds_read_b64_tr_b16 v[40:41], v9 offset:20544
    ds_read_b64_tr_b16 v[42:43], v9 offset:25664
    v_mfma_f32_16x16x32_bf16 v[236:239], v[76:79], v[140:143], v[236:239]
    ds_read_b64_tr_b16 v[44:45], v10 offset:20544
    ds_read_b64_tr_b16 v[46:47], v10 offset:25664
    v_mfma_f32_16x16x32_bf16 v[200:203], v[80:83], v[136:139], v[200:203]
    ds_read_b64_tr_b16 v[48:49], v9 offset:20608
    ds_read_b64_tr_b16 v[50:51], v9 offset:25728
    v_mfma_f32_16x16x32_bf16 v[240:243], v[80:83], v[140:143], v[240:243]
    ds_read_b64_tr_b16 v[52:53], v10 offset:20608
    ds_read_b64_tr_b16 v[54:55], v10 offset:25728
    v_mfma_f32_16x16x32_bf16 v[204:207], v[84:87], v[136:139], v[204:207]
    ds_read_b64_tr_b16 v[56:57], v9 offset:20672
    v_mfma_f32_16x16x32_bf16 v[244:247], v[84:87], v[140:143], v[244:247]
    ds_read_b64_tr_b16 v[58:59], v9 offset:25792
    v_mfma_f32_16x16x32_bf16 v[208:211], v[88:91], v[136:139], v[208:211]
    ds_read_b64_tr_b16 v[60:61], v10 offset:20672
    v_mfma_f32_16x16x32_bf16 v[248:251], v[88:91], v[140:143], v[248:251]
    ds_read_b64_tr_b16 v[62:63], v10 offset:25792
    v_mfma_f32_16x16x32_bf16 v[212:215], v[92:95], v[136:139], v[212:215]
    ds_read_b64_tr_b16 v[64:65], v9 offset:20736
    v_mfma_f32_16x16x32_bf16 v[252:255], v[92:95], v[140:143], v[252:255]
    ds_read_b64_tr_b16 v[66:67], v9 offset:25856
    v_mfma_f32_16x16x32_bf16 v[216:219], v[96:99], v[136:139], v[216:219]
    ds_read_b64_tr_b16 v[68:69], v10 offset:20736
    v_mfma_f32_16x16x32_bf16 v[112:115], v[96:99], v[140:143], v[112:115]
    ds_read_b64_tr_b16 v[70:71], v10 offset:25856
    v_mfma_f32_16x16x32_bf16 v[220:223], v[100:103], v[136:139], v[220:223]
    v_mfma_f32_16x16x32_bf16 v[116:119], v[100:103], v[140:143], v[116:119]
    v_mfma_f32_16x16x32_bf16 v[224:227], v[104:107], v[136:139], v[224:227]
    v_max3_u32 v16, v16, v136, v137
    v_mfma_f32_16x16x32_bf16 v[120:123], v[104:107], v[140:143], v[120:123]
    v_max3_u32 v17, v17, v138, v139
    v_mfma_f32_16x16x32_bf16 v[228:231], v[108:111], v[136:139], v[228:231]
    v_max3_u32 v16, v16, v140, v141
    v_mfma_f32_16x16x32_bf16 v[124:127], v[108:111], v[140:143], v[124:127]
    v_max3_u32 v17, v17, v142, v143
    s_waitcnt vmcnt(10)
    s_waitcnt lgkmcnt(0)
    v_mfma_f32_16x16x32_bf16 v[192:195], v[32:35], v[144:147], v[192:195]
    ds_read_b64_tr_b16 v[72:73], v9 offset:30720
    ds_read_b64_tr_b16 v[74:75], v9 offset:35840
    v_mfma_f32_16x16x32_bf16 v[232:235], v[32:35], v[148:151], v[232:235]
    ds_read_b64_tr_b16 v[76:77], v10 offset:30720
    ds_read_b64_tr_b16 v[78:79], v10 offset:35840
    v_mfma_f32_16x16x32_bf16 v[196:199], v[36:39], v[144:147], v[196:199]
    ds_read_b64_tr_b16 v[80:81], v9 offset:30784
    ds_read_b64_tr_b16 v[82:83], v9 offset:35904
    v_mfma_f32_16x16x32_bf16 v[236:239], v[36:39], v[148:151], v[236:239]
    ds_read_b64_tr_b16 v[84:85], v10 offset:30784
    ds_read_b64_tr_b16 v[86:87], v10 offset:35904
    v_mfma_f32_16x16x32_bf16 v[200:203], v[40:43], v[144:147], v[200:203]
    ds_read_b64_tr_b16 v[88:89], v9 offset:30848
    ds_read_b64_tr_b16 v[90:91], v9 offset:35968
    v_mfma_f32_16x16x32_bf16 v[240:243], v[40:43], v[148:151], v[240:243]
    ds_read_b64_tr_b16 v[92:93], v10 offset:30848
    ds_read_b64_tr_b16 v[94:95], v10 offset:35968
    v_mfma_f32_16x16x32_bf16 v[204:207], v[44:47], v[144:147], v[204:207]
    ds_read_b64_tr_b16 v[96:97], v9 offset:30912
    v_mfma_f32_16x16x32_bf16 v[244:247], v[44:47], v[148:151], v[244:247]
    ds_read_b64_tr_b16 v[98:99], v9 offset:36032
    v_mfma_f32_16x16x32_bf16 v[208:211], v[48:51], v[144:147], v[208:211]
    ds_read_b64_tr_b16 v[100:101], v10 offset:30912
    v_mfma_f32_16x16x32_bf16 v[248:251], v[48:51], v[148:151], v[248:251]
    ds_read_b64_tr_b16 v[102:103], v10 offset:36032
    v_mfma_f32_16x16x32_bf16 v[212:215], v[52:55], v[144:147], v[212:215]
    ds_read_b64_tr_b16 v[104:105], v9 offset:30976
    v_mfma_f32_16x16x32_bf16 v[252:255], v[52:55], v[148:151], v[252:255]
    ds_read_b64_tr_b16 v[106:107], v9 offset:36096
    v_mfma_f32_16x16x32_bf16 v[216:219], v[56:59], v[144:147], v[216:219]
    ds_read_b64_tr_b16 v[108:109], v10 offset:30976
    v_mfma_f32_16x16x32_bf16 v[112:115], v[56:59], v[148:151], v[112:115]
    ds_read_b64_tr_b16 v[110:111], v10 offset:36096
    v_mfma_f32_16x16x32_bf16 v[220:223], v[60:63], v[144:147], v[220:223]
    v_mfma_f32_16x16x32_bf16 v[116:119], v[60:63], v[148:151], v[116:119]
    v_mfma_f32_16x16x32_bf16 v[224:227], v[64:67], v[144:147], v[224:227]
    v_max3_u32 v16, v16, v144, v145
    v_mfma_f32_16x16x32_bf16 v[120:123], v[64:67], v[148:151], v[120:123]
    v_max3_u32 v17, v17, v146, v147
    v_mfma_f32_16x16x32_bf16 v[228:231], v[68:71], v[144:147], v[228:231]
    v_max3_u32 v16, v16, v148, v149
    v_mfma_f32_16x16x32_bf16 v[124:127], v[68:71], v[148:151], v[124:127]
    v_max3_u32 v17, v17, v150, v151
    s_waitcnt vmcnt(8)
    s_waitcnt lgkmcnt(0)
    v_add_u32 v9, 40960, v9
    v_add_u32 v10, 40960, v10
    v_mfma_f32_16x16x32_bf16 v[192:195], v[72:75], v[152:155], v[192:195]
    ds_read_b64_tr_b16 v[32:33], v9 offset:0
    ds_read_b64_tr_b16 v[34:35], v9 offset:5120
    v_mfma_f32_16x16x32_bf16 v[232:235], v[72:75], v[156:159], v[232:235]
    ds_read_b64_tr_b16 v[36:37], v10 offset:0
    ds_read_b64_tr_b16 v[38:39], v10 offset:5120
    v_mfma_f32_16x16x32_bf16 v[196:199], v[76:79], v[152:155], v[196:199]
    ds_read_b64_tr_b16 v[40:41], v9 offset:64
    ds_read_b64_tr_b16 v[42:43], v9 offset:5184
    v_mfma_f32_16x16x32_bf16 v[236:239], v[76:79], v[156:159], v[236:239]
    ds_read_b64_tr_b16 v[44:45], v10 offset:64
    ds_read_b64_tr_b16 v[46:47], v10 offset:5184
    v_mfma_f32_16x16x32_bf16 v[200:203], v[80:83], v[152:155], v[200:203]
    ds_read_b64_tr_b16 v[48:49], v9 offset:128
    ds_read_b64_tr_b16 v[50:51], v9 offset:5248
    v_mfma_f32_16x16x32_bf16 v[240:243], v[80:83], v[156:159], v[240:243]
    ds_read_b64_tr_b16 v[52:53], v10 offset:128
    ds_read_b64_tr_b16 v[54:55], v10 offset:5248
    v_mfma_f32_16x16x32_bf16 v[204:207], v[84:87], v[152:155], v[204:207]
    ds_read_b64_tr_b16 v[56:57], v9 offset:192
    v_mfma_f32_16x16x32_bf16 v[244:247], v[84:87], v[156:159], v[244:247]
    ds_read_b64_tr_b16 v[58:59], v9 offset:5312
    v_mfma_f32_16x16x32_bf16 v[208:211], v[88:91], v[152:155], v[208:211]
    ds_read_b64_tr_b16 v[60:61], v10 offset:192
    v_mfma_f32_16x16x32_bf16 v[248:251], v[88:91], v[156:159], v[248:251]
    ds_read_b64_tr_b16 v[62:63], v10 offset:5312
    v_mfma_f32_16x16x32_bf16 v[212:215], v[92:95], v[152:155], v[212:215]
    ds_read_b64_tr_b16 v[64:65], v9 offset:256
    v_mfma_f32_16x16x32_bf16 v[252:255], v[92:95], v[156:159], v[252:255]
    ds_read_b64_tr_b16 v[66:67], v9 offset:5376
    v_mfma_f32_16x16x32_bf16 v[216:219], v[96:99], v[152:155], v[216:219]
    ds_read_b64_tr_b16 v[68:69], v10 offset:256
    v_mfma_f32_16x16x32_bf16 v[112:115], v[96:99], v[156:159], v[112:115]
    ds_read_b64_tr_b16 v[70:71], v10 offset:5376
    v_mfma_f32_16x16x32_bf16 v[220:223], v[100:103], v[152:155], v[220:223]
    v_mfma_f32_16x16x32_bf16 v[116:119], v[100:103], v[156:159], v[116:119]
    v_mfma_f32_16x16x32_bf16 v[224:227], v[104:107], v[152:155], v[224:227]
    v_max3_u32 v16, v16, v152, v153
    v_mfma_f32_16x16x32_bf16 v[120:123], v[104:107], v[156:159], v[120:123]
    v_max3_u32 v17, v17, v154, v155
    v_mfma_f32_16x16x32_bf16 v[228:231], v[108:111], v[152:155], v[228:231]
    v_max3_u32 v16, v16, v156, v157
    v_mfma_f32_16x16x32_bf16 v[124:127], v[108:111], v[156:159], v[124:127]
    v_max3_u32 v17, v17, v158, v159
    s_waitcnt vmcnt(6)
    s_waitcnt lgkmcnt(0)
    v_mfma_f32_16x16x32_bf16 v[192:195], v[32:35], v[160:163], v[192:195]
    ds_read_b64_tr_b16 v[72:73], v9 offset:10240
    ds_read_b64_tr_b16 v[74:75], v9 offset:15360
    v_mfma_f32_16x16x32_bf16 v[232:235], v[32:35], v[164:167], v[232:235]
    ds_read_b64_tr_b16 v[76:77], v10 offset:10240
    ds_read_b64_tr_b16 v[78:79], v10 offset:15360
    v_mfma_f32_16x16x32_bf16 v[196:199], v[36:39], v[160:163], v[196:199]
    ds_read_b64_tr_b16 v[80:81], v9 offset:10304
    ds_read_b64_tr_b16 v[82:83], v9 offset:15424
    v_mfma_f32_16x16x32_bf16 v[236:239], v[36:39], v[164:167], v[236:239]
    ds_read_b64_tr_b16 v[84:85], v10 offset:10304
    ds_read_b64_tr_b16 v[86:87], v10 offset:15424
    v_mfma_f32_16x16x32_bf16 v[200:203], v[40:43], v[160:163], v[200:203]
    ds_read_b64_tr_b16 v[88:89], v9 offset:10368
    ds_read_b64_tr_b16 v[90:91], v9 offset:15488
    v_mfma_f32_16x16x32_bf16 v[240:243], v[40:43], v[164:167], v[240:243]
    ds_read_b64_tr_b16 v[92:93], v10 offset:10368
    ds_read_b64_tr_b16 v[94:95], v10 offset:15488
    v_mfma_f32_16x16x32_bf16 v[204:207], v[44:47], v[160:163], v[204:207]
    ds_read_b64_tr_b16 v[96:97], v9 offset:10432
    v_mfma_f32_16x16x32_bf16 v[244:247], v[44:47], v[164:167], v[244:247]
    ds_read_b64_tr_b16 v[98:99], v9 offset:15552
    v_mfma_f32_16x16x32_bf16 v[208:211], v[48:51], v[160:163], v[208:211]
    ds_read_b64_tr_b16 v[100:101], v10 offset:10432
    v_mfma_f32_16x16x32_bf16 v[248:251], v[48:51], v[164:167], v[248:251]
    ds_read_b64_tr_b16 v[102:103], v10 offset:15552
    v_mfma_f32_16x16x32_bf16 v[212:215], v[52:55], v[160:163], v[212:215]
    ds_read_b64_tr_b16 v[104:105], v9 offset:10496
    v_mfma_f32_16x16x32_bf16 v[252:255], v[52:55], v[164:167], v[252:255]
    ds_read_b64_tr_b16 v[106:107], v9 offset:15616
    v_mfma_f32_16x16x32_bf16 v[216:219], v[56:59], v[160:163], v[216:219]
    ds_read_b64_tr_b16 v[108:109], v10 offset:10496
    v_mfma_f32_16x16x32_bf16 v[112:115], v[56:59], v[164:167], v[112:115]
    ds_read_b64_tr_b16 v[110:111], v10 offset:15616
    v_mfma_f32_16x16x32_bf16 v[220:223], v[60:63], v[160:163], v[220:223]
    v_mfma_f32_16x16x32_bf16 v[116:119], v[60:63], v[164:167], v[116:119]
    v_mfma_f32_16x16x32_bf16 v[224:227], v[64:67], v[160:163], v[224:227]
    v_max3_u32 v16, v16, v160, v161
    v_mfma_f32_16x16x32_bf16 v[120:123], v[64:67], v[164:167], v[120:123]
    v_max3_u32 v17, v17, v162, v163
    v_mfma_f32_16x16x32_bf16 v[228:231], v[68:71], v[160:163], v[228:231]
    v_max3_u32 v16, v16, v164, v165
    v_mfma_f32_16x16x32_bf16 v[124:127], v[68:71], v[164:167], v[124:127]
    v_max3_u32 v17, v17, v166, v167
    s_waitcnt vmcnt(4)
    s_waitcnt lgkmcnt(0)
    v_mfma_f32_16x16x32_bf16 v[192:195], v[72:75], v[168:171], v[192:195]
    ds_read_b64_tr_b16 v[32:33], v9 offset:20480
    ds_read_b64_tr_b16 v[34:35], v9 offset:25600
    v_mfma_f32_16x16x32_bf16 v[232:235], v[72:75], v[172:175], v[232:235]
    ds_read_b64_tr_b16 v[36:37], v10 offset:20480
    ds_read_b64_tr_b16 v[38:39], v10 offset:25600
    v_mfma_f32_16x16x32_bf16 v[196:199], v[76:79], v[168:171], v[196:199]
    ds_read_b64_tr_b16 v[40:41], v9 offset:20544
    ds_read_b64_tr_b16 v[42:43], v9 offset:25664
    v_mfma_f32_16x16x32_bf16 v[236:239], v[76:79], v[172:175], v[236:239]
    ds_read_b64_tr_b16 v[44:45], v10 offset:20544
    ds_read_b64_tr_b16 v[46:47], v10 offset:25664
    v_mfma_f32_16x16x32_bf16 v[200:203], v[80:83], v[168:171], v[200:203]
    ds_read_b64_tr_b16 v[48:49], v9 offset:20608
    ds_read_b64_tr_b16 v[50:51], v9 offset:25728
    v_mfma_f32_16x16x32_bf16 v[240:243], v[80:83], v[172:175], v[240:243]
    ds_read_b64_tr_b16 v[52:53], v10 offset:20608
    ds_read_b64_tr_b16 v[54:55], v10 offset:25728
    v_mfma_f32_16x16x32_bf16 v[204:207], v[84:87], v[168:171], v[204:207]
    ds_read_b64_tr_b16 v[56:57], v9 offset:20672
    v_mfma_f32_16x16x32_bf16 v[244:247], v[84:87], v[172:175], v[244:247]
    ds_read_b64_tr_b16 v[58:59], v9 offset:25792
    v_mfma_f32_16x16x32_bf16 v[208:211], v[88:91], v[168:171], v[208:211]
    ds_read_b64_tr_b16 v[60:61], v10 offset:20672
    v_mfma_f32_16x16x32_bf16 v[248:251], v[88:91], v[172:175], v[248:251]
    ds_read_b64_tr_b16 v[62:63], v10 offset:25792
    v_mfma_f32_16x16x32_bf16 v[212:215], v[92:95], v[168:171], v[212:215]
    ds_read_b64_tr_b16 v[64:65], v9 offset:20736
    v_mfma_f32_16x16x32_bf16 v[252:255], v[92:95], v[172:175], v[252:255]
    ds_read_b64_tr_b16 v[66:67], v9 offset:25856
    v_mfma_f32_16x16x32_bf16 v[216:219], v[96:99], v[168:171], v[216:219]
    ds_read_b64_tr_b16 v[68:69], v10 offset:20736
    v_mfma_f32_16x16x32_bf16 v[112:115], v[96:99], v[172:175], v[112:115]
    ds_read_b64_tr_b16 v[70:71], v10 offset:25856
    v_mfma_f32_16x16x32_bf16 v[220:223], v[100:103], v[168:171], v[220:223]
    v_mfma_f32_16x16x32_bf16 v[116:119], v[100:103], v[172:175], v[116:119]
    v_mfma_f32_16x16x32_bf16 v[224:227], v[104:107], v[168:171], v[224:227]
    v_max3_u32 v16, v16, v168, v169
    v_mfma_f32_16x16x32_bf16 v[120:123], v[104:107], v[172:175], v[120:123]
    v_max3_u32 v17, v17, v170, v171
    v_mfma_f32_16x16x32_bf16 v[228:231], v[108:111], v[168:171], v[228:231]
    v_max3_u32 v16, v16, v172, v173
    v_mfma_f32_16x16x32_bf16 v[124:127], v[108:111], v[172:175], v[124:127]
    v_max3_u32 v17, v17, v174, v175
    s_waitcnt vmcnt(2)
    s_waitcnt lgkmcnt(0)
    v_mfma_f32_16x16x32_bf16 v[192:195], v[32:35], v[176:179], v[192:195]
    ds_read_b64_tr_b16 v[72:73], v9 offset:30720
    ds_read_b64_tr_b16 v[74:75], v9 offset:35840
    v_mfma_f32_16x16x32_bf16 v[232:235], v[32:35], v[180:183], v[232:235]
    ds_read_b64_tr_b16 v[76:77], v10 offset:30720
    ds_read_b64_tr_b16 v[78:79], v10 offset:35840
    v_mfma_f32_16x16x32_bf16 v[196:199], v[36:39], v[176:179], v[196:199]
    ds_read_b64_tr_b16 v[80:81], v9 offset:30784
    ds_read_b64_tr_b16 v[82:83], v9 offset:35904
    v_mfma_f32_16x16x32_bf16 v[236:239], v[36:39], v[180:183], v[236:239]
    ds_read_b64_tr_b16 v[84:85], v10 offset:30784
    ds_read_b64_tr_b16 v[86:87], v10 offset:35904
    v_mfma_f32_16x16x32_bf16 v[200:203], v[40:43], v[176:179], v[200:203]
    ds_read_b64_tr_b16 v[88:89], v9 offset:30848
    ds_read_b64_tr_b16 v[90:91], v9 offset:35968
    v_mfma_f32_16x16x32_bf16 v[240:243], v[40:43], v[180:183], v[240:243]
    ds_read_b64_tr_b16 v[92:93], v10 offset:30848
    ds_read_b64_tr_b16 v[94:95], v10 offset:35968
    v_mfma_f32_16x16x32_bf16 v[204:207], v[44:47], v[176:179], v[204:207]
    ds_read_b64_tr_b16 v[96:97], v9 offset:30912
    v_mfma_f32_16x16x32_bf16 v[244:247], v[44:47], v[180:183], v[244:247]
    ds_read_b64_tr_b16 v[98:99], v9 offset:36032
    v_mfma_f32_16x16x32_bf16 v[208:211], v[48:51], v[176:179], v[208:211]
    ds_read_b64_tr_b16 v[100:101], v10 offset:30912
    v_mfma_f32_16x16x32_bf16 v[248:251], v[48:51], v[180:183], v[248:251]
    ds_read_b64_tr_b16 v[102:103], v10 offset:36032
    v_mfma_f32_16x16x32_bf16 v[212:215], v[52:55], v[176:179], v[212:215]
    ds_read_b64_tr_b16 v[104:105], v9 offset:30976
    v_mfma_f32_16x16x32_bf16 v[252:255], v[52:55], v[180:183], v[252:255]
    ds_read_b64_tr_b16 v[106:107], v9 offset:36096
    v_mfma_f32_16x16x32_bf16 v[216:219], v[56:59], v[176:179], v[216:219]
    ds_read_b64_tr_b16 v[108:109], v10 offset:30976
    v_mfma_f32_16x16x32_bf16 v[112:115], v[56:59], v[180:183], v[112:115]
    ds_read_b64_tr_b16 v[110:111], v10 offset:36096
    v_mfma_f32_16x16x32_bf16 v[220:223], v[60:63], v[176:179], v[220:223]
    v_mfma_f32_16x16x32_bf16 v[116:119], v[60:63], v[180:183], v[116:119]
    v_mfma_f32_16x16x32_bf16 v[224:227], v[64:67], v[176:179], v[224:227]
    v_max3_u32 v16, v16, v176, v177
    v_mfma_f32_16x16x32_bf16 v[120:123], v[64:67], v[180:183], v[120:123]
    v_max3_u32 v17, v17, v178, v179
    v_mfma_f32_16x16x32_bf16 v[228:231], v[68:71], v[176:179], v[228:231]
    v_max3_u32 v16, v16, v180, v181
    v_mfma_f32_16x16x32_bf16 v[124:127], v[68:71], v[180:183], v[124:127]
    v_max3_u32 v17, v17, v182, v183
    s_waitcnt vmcnt(0)
    s_waitcnt lgkmcnt(0)
    s_load_dwordx8 s[88:95], s[0:1], 56
    s_load_dwordx2 s[96:97], s[0:1], 104
    s_load_dwordx2 s[100:101], s[0:1], 0
    v_and_b32 v2, 15, v0
    v_mul_u32_u24 v2, 64, v2
    v_lshrrev_b32 v1, 4, v0
    v_lshl_add_u32 v2, v1, 4, v2
    s_add_u32 s56, s32, 20480
    v_add_u32 v3, 2048, v2
    v_mfma_f32_16x16x32_bf16 v[192:195], v[72:75], v[184:187], v[192:195]
    v_mfma_f32_16x16x32_bf16 v[232:235], v[72:75], v[188:191], v[232:235]
    v_mfma_f32_16x16x32_bf16 v[196:199], v[76:79], v[184:187], v[196:199]
    v_mfma_f32_16x16x32_bf16 v[236:239], v[76:79], v[188:191], v[236:239]
    v_mfma_f32_16x16x32_bf16 v[200:203], v[80:83], v[184:187], v[200:203]
    v_mfma_f32_16x16x32_bf16 v[240:243], v[80:83], v[188:191], v[240:243]
    v_mfma_f32_16x16x32_bf16 v[204:207], v[84:87], v[184:187], v[204:207]
    v_mfma_f32_16x16x32_bf16 v[244:247], v[84:87], v[188:191], v[244:247]
    v_mfma_f32_16x16x32_bf16 v[208:211], v[88:91], v[184:187], v[208:211]
    v_mfma_f32_16x16x32_bf16 v[248:251], v[88:91], v[188:191], v[248:251]
    v_mfma_f32_16x16x32_bf16 v[212:215], v[92:95], v[184:187], v[212:215]
    v_mfma_f32_16x16x32_bf16 v[252:255], v[92:95], v[188:191], v[252:255]
    v_mfma_f32_16x16x32_bf16 v[216:219], v[96:99], v[184:187], v[216:219]
    v_mfma_f32_16x16x32_bf16 v[112:115], v[96:99], v[188:191], v[112:115]
    v_mfma_f32_16x16x32_bf16 v[220:223], v[100:103], v[184:187], v[220:223]
    v_mfma_f32_16x16x32_bf16 v[116:119], v[100:103], v[188:191], v[116:119]
    v_mfma_f32_16x16x32_bf16 v[224:227], v[104:107], v[184:187], v[224:227]
    v_max3_u32 v16, v16, v184, v185
    v_mfma_f32_16x16x32_bf16 v[120:123], v[104:107], v[188:191], v[120:123]
    v_max3_u32 v17, v17, v186, v187
    v_mfma_f32_16x16x32_bf16 v[228:231], v[108:111], v[184:187], v[228:231]
    v_max3_u32 v16, v16, v188, v189
    v_mfma_f32_16x16x32_bf16 v[124:127], v[108:111], v[188:191], v[124:127]
    v_max3_u32 v17, v17, v190, v191
    v_max_u32 v16, v16, v17
    v_cmp_eq_u32 vcc, -1, v16
    s_nop 0
    s_cmp_eq_u64 vcc, 0
    s_cbranch_scc0 k1_rd
k1_rdb:
    v_bfe_u32 v1, v0, 4, 1
    v_cmp_eq_u32 vcc, 1, v1
    v_cvt_pk_bf16_f32 v32, v192, v193
    v_cvt_pk_bf16_f32 v33, v194, v195
    v_cvt_pk_bf16_f32 v34, v196, v197
    v_cvt_pk_bf16_f32 v35, v198, v199
    v_cndmask_b32 v36, v32, v34, vcc
    v_cndmask_b32 v37, v33, v35, vcc
    v_cndmask_b32 v38, v34, v32, vcc
    v_cndmask_b32 v39, v35, v33, vcc
    buffer_store_dwordx4 v[36:39], v2, s[36:39], s32 offen offset:0 sc1
    v_cvt_pk_bf16_f32 v40, v200, v201
    v_cvt_pk_bf16_f32 v41, v202, v203
    v_cvt_pk_bf16_f32 v42, v204, v205
    v_cvt_pk_bf16_f32 v43, v206, v207
    v_cndmask_b32 v44, v40, v42, vcc
    v_cndmask_b32 v45, v41, v43, vcc
    v_cndmask_b32 v46, v42, v40, vcc
    v_cndmask_b32 v47, v43, v41, vcc
    buffer_store_dwordx4 v[44:47], v2, s[36:39], s32 offen offset:1024 sc1
    v_cvt_pk_bf16_f32 v48, v208, v209
    v_cvt_pk_bf16_f32 v49, v210, v211
    v_cvt_pk_bf16_f32 v50, v212, v213
    v_cvt_pk_bf16_f32 v51, v214, v215
    v_cndmask_b32 v52, v48, v50, vcc
    v_cndmask_b32 v53, v49, v51, vcc
    v_cndmask_b32 v54, v50, v48, vcc
    v_cndmask_b32 v55, v51, v49, vcc
    buffer_store_dwordx4 v[52:55], v3, s[36:39], s32 offen offset:0 sc1
    v_cvt_pk_bf16_f32 v56, v216, v217
    v_cvt_pk_bf16_f32 v57, v218, v219
    v_cvt_pk_bf16_f32 v58, v220, v221
    v_cvt_pk_bf16_f32 v59, v222, v223
    v_cndmask_b32 v60, v56, v58, vcc
    v_cndmask_b32 v61, v57, v59, vcc
    v_cndmask_b32 v62, v58, v56, vcc
    v_cndmask_b32 v63, v59, v57, vcc
    buffer_store_dwordx4 v[60:63], v3, s[36:39], s32 offen offset:1024 sc1
    v_cvt_pk_bf16_f32 v32, v224, v225
    v_cvt_pk_bf16_f32 v33, v226, v227
    v_cvt_pk_bf16_f32 v34, v228, v229
    v_cvt_pk_bf16_f32 v35, v230, v231
    v_cndmask_b32 v36, v32, v34, vcc
    v_cndmask_b32 v37, v33, v35, vcc
    v_cndmask_b32 v38, v34, v32, vcc
    v_cndmask_b32 v39, v35, v33, vcc
    buffer_store_dwordx4 v[36:39], v3, s[36:39], s32 offen offset:2048 sc1
    v_cvt_pk_bf16_f32 v40, v232, v233
    v_cvt_pk_bf16_f32 v41, v234, v235
    v_cvt_pk_bf16_f32 v42, v236, v237
    v_cvt_pk_bf16_f32 v43, v238, v239
    v_cndmask_b32 v44, v40, v42, vcc
    v_cndmask_b32 v45, v41, v43, vcc
    v_cndmask_b32 v46, v42, v40, vcc
    v_cndmask_b32 v47, v43, v41, vcc
    buffer_store_dwordx4 v[44:47], v2, s[36:39], s56 offen offset:0 sc1
    v_cvt_pk_bf16_f32 v48, v240, v241
    v_cvt_pk_bf16_f32 v49, v242, v243
    v_cvt_pk_bf16_f32 v50, v244, v245
    v_cvt_pk_bf16_f32 v51, v246, v247
    v_cndmask_b32 v52, v48, v50, vcc
    v_cndmask_b32 v53, v49, v51, vcc
    v_cndmask_b32 v54, v50, v48, vcc
    v_cndmask_b32 v55, v51, v49, vcc
    buffer_store_dwordx4 v[52:55], v2, s[36:39], s56 offen offset:1024 sc1
    v_cvt_pk_bf16_f32 v56, v248, v249
    v_cvt_pk_bf16_f32 v57, v250, v251
    v_cvt_pk_bf16_f32 v58, v252, v253
    v_cvt_pk_bf16_f32 v59, v254, v255
    v_cndmask_b32 v60, v56, v58, vcc
    v_cndmask_b32 v61, v57, v59, vcc
    v_cndmask_b32 v62, v58, v56, vcc
    v_cndmask_b32 v63, v59, v57, vcc
    buffer_store_dwordx4 v[60:63], v3, s[36:39], s56 offen offset:0 sc1
    v_cvt_pk_bf16_f32 v32, v112, v113
    v_cvt_pk_bf16_f32 v33, v114, v115
    v_cvt_pk_bf16_f32 v34, v116, v117
    v_cvt_pk_bf16_f32 v35, v118, v119
    v_cndmask_b32 v36, v32, v34, vcc
    v_cndmask_b32 v37, v33, v35, vcc
    v_cndmask_b32 v38, v34, v32, vcc
    v_cndmask_b32 v39, v35, v33, vcc
    buffer_store_dwordx4 v[36:39], v3, s[36:39], s56 offen offset:1024 sc1
    v_cvt_pk_bf16_f32 v40, v120, v121
    v_cvt_pk_bf16_f32 v41, v122, v123
    v_cvt_pk_bf16_f32 v42, v124, v125
    v_cvt_pk_bf16_f32 v43, v126, v127
    v_cndmask_b32 v44, v40, v42, vcc
    v_cndmask_b32 v45, v41, v43, vcc
    v_cndmask_b32 v46, v42, v40, vcc
    v_cndmask_b32 v47, v43, v41, vcc
    buffer_store_dwordx4 v[44:47], v3, s[36:39], s56 offen offset:2048 sc1
    s_barrier
k1_fin:
    s_xor_b32 s3, s4, 1
    s_lshl_b32 s3, s3, 8
    s_add_u32 s3, s3, s2
    s_lshl_b32 s3, s3, 2
    s_add_u32 s57, s3, s5
    s_mul_i32 s6, s57, 1280
    s_lshl_b32 s7, s57, 2
    s_add_u32 s7, s7, 83984384
    s_lshr_b32 s20, s57, 5
    s_lshl_b32 s20, s20, 7
    s_add_u32 s20, s20, 83976192
    s_bfe_u32 s3, s2, 0x20003
    s_lshl_b32 s3, s3, 2
    s_add_u32 s58, s25, s3
    s_add_u32 s58, s58, 8192
    s_mov_b32 s59, 83888640
    buffer_load_dwordx4 v[72:75], v20, s[36:39], s59 offen offset:0 sc1
    buffer_load_dword v76, v21, s[36:39], s59 offen offset:1024 sc1
    buffer_load_dwordx4 v[80:83], v20, s[36:39], s59 offen offset:1280 sc1
    buffer_load_dword v84, v21, s[36:39], s59 offen offset:2304 sc1
    buffer_load_dwordx4 v[88:91], v20, s[36:39], s59 offen offset:2560 sc1
    buffer_load_dword v92, v21, s[36:39], s59 offen offset:3584 sc1
    s_mov_b32 s59, 83892480
    buffer_load_dwordx4 v[96:99], v20, s[36:39], s59 offen offset:0 sc1
    buffer_load_dword v100, v21, s[36:39], s59 offen offset:1024 sc1
    v_mov_b32 v1, 1073741824
    v_cmp_gt_u32 vcc, 32, v0
    v_lshrrev_b32 v13, 2, v0
    s_mov_b32 s3, 2621440
    v_mul_lo_u32 v13, v13, s3
    v_and_b32 v14, 3, v0
    v_mul_u32_u24 v14, 5120, v14
    v_add_u32 v13, v13, v14
    v_add_u32 v13, 4096, v13
    v_cndmask_b32 v3, v1, v13, vcc
    v_and_b32 v14, 3, v0
    v_cmp_eq_u32 vcc, 0, v14
    s_nop 1
    v_cndmask_b32 v15, v1, v21, vcc
    s_waitcnt lgkmcnt(0)
    s_mov_b32 s8, s100
    s_mov_b32 s9, s101
    s_mov_b32 s10, 2621440
    s_mov_b32 s11, 0x00020000
    s_mov_b32 s12, s88
    s_mov_b32 s13, s89
    s_mov_b32 s14, 1280
    s_mov_b32 s15, 0x00020000
    s_mov_b32 s16, s96
    s_mov_b32 s17, s97
    s_mov_b32 s18, 2621440
    s_mov_b32 s19, 0x00020000
    buffer_load_dwordx4 v[64:67], v20, s[8:11], s6 offen offset:0
    buffer_load_dword v68, v21, s[8:11], s6 offen offset:1024
    buffer_load_dwordx4 v[104:107], v20, s[12:15], 0 offen offset:0
    buffer_load_dword v108, v21, s[12:15], 0 offen offset:1024
    s_mov_b32 s60, 0x3f80
    s_mov_b32 s61, 0x3f800000
    s_lshr_b32 s63, s57, 4
    s_mul_i32 s63, s63, 20480
    s_and_b32 s3, s57, 15
    s_lshl_b32 s3, s3, 6
    s_add_u32 s63, s63, s3
    s_add_u32 s63, s63, 54525952
    v_lshrrev_b32 v13, 2, v0
    v_and_b32 v14, 3, v0
    v_lshlrev_b32 v14, 4, v14
    v_lshl_add_u32 v13, v13, 10, v14
    v_lshrrev_b32 v14, 4, v0
    v_and_b32 v8, 15, v0
    v_lshlrev_b32 v8, 2, v8
    v_lshl_add_u32 v14, v14, 10, v8
    v_add_u32 v14, 16384, v14
    v_min_u32 v8, v4, v5
    v_min3_u32 v8, v8, v6, v7
    v_cmp_eq_u32 vcc, 0, v8
    s_nop 0
    s_cmp_eq_u64 vcc, 0
    s_cbranch_scc1 k1_fok45
    s_mov_b32 s62, 83976192
    s_mov_b32 s21, 0
k1_tl46:
    buffer_load_dwordx4 v[4:7], v20, s[36:39], s62 offen sc1
    s_waitcnt vmcnt(0)
    v_min_u32 v8, v4, v5
    v_min3_u32 v8, v8, v6, v7
    v_cmp_eq_u32 vcc, 0, v8
    s_nop 0
    s_cmp_eq_u64 vcc, 0
    s_cbranch_scc1 k1_tok47
    s_add_u32 s21, s21, 1
    s_cmp_ge_u32 s21, 0x8000
    s_cbranch_scc1 k1_tok47
    s_sleep 4
    s_branch k1_tl46
k1_tok47:
k1_fok45:
    s_mov_b32 s21, 0
k1_tl48:
    buffer_load_dword v29, v3, s[36:39], s63 offen sc1
    s_waitcnt vmcnt(0)
    v_cmp_eq_u32 vcc, -1, v29
    s_nop 0
    s_bcnt1_i32_b64 s3, vcc
    s_cmp_le_u32 s3, 12
    s_cbranch_scc1 k1_tok49
    s_add_u32 s21, s21, 1
    s_cmp_ge_u32 s21, 0x8000
    s_cbranch_scc1 k1_tok49
    s_branch k1_tl48
k1_tok49:
    v_lshlrev_b32 v192, 16, v64
    v_and_b32 v193, 0xffff0000, v64
    v_lshlrev_b32 v194, 16, v65
    v_and_b32 v195, 0xffff0000, v65
    v_lshlrev_b32 v196, 16, v66
    v_and_b32 v197, 0xffff0000, v66
    v_lshlrev_b32 v198, 16, v67
    v_and_b32 v199, 0xffff0000, v67
    v_lshlrev_b32 v200, 16, v68
    v_and_b32 v201, 0xffff0000, v68
    v_lshlrev_b32 v208, 16, v72
    v_and_b32 v209, 0xffff0000, v72
    v_lshlrev_b32 v210, 16, v73
    v_and_b32 v211, 0xffff0000, v73
    v_lshlrev_b32 v212, 16, v74
    v_and_b32 v213, 0xffff0000, v74
    v_lshlrev_b32 v214, 16, v75
    v_and_b32 v215, 0xffff0000, v75
    v_lshlrev_b32 v216, 16, v76
    v_and_b32 v217, 0xffff0000, v76
    s_mov_b32 s21, 0
k1_rl50:
    s_mov_b32 s62, s63
    buffer_load_dwordx4 v[112:115], v13, s[36:39], s62 offen sc1
    buffer_load_dword v116, v14, s[36:39], s62 offen sc1
    s_add_u32 s62, s62, 2621440
    buffer_load_dwordx4 v[120:123], v13, s[36:39], s62 offen sc1
    buffer_load_dword v124, v14, s[36:39], s62 offen sc1
    s_add_u32 s62, s62, 2621440
    buffer_load_dwordx4 v[128:131], v13, s[36:39], s62 offen sc1
    buffer_load_dword v132, v14, s[36:39], s62 offen sc1
    s_add_u32 s62, s62, 2621440
    buffer_load_dwordx4 v[136:139], v13, s[36:39], s62 offen sc1
    buffer_load_dword v140, v14, s[36:39], s62 offen sc1
    s_add_u32 s62, s62, 2621440
    buffer_load_dwordx4 v[144:147], v13, s[36:39], s62 offen sc1
    buffer_load_dword v148, v14, s[36:39], s62 offen sc1
    s_add_u32 s62, s62, 2621440
    buffer_load_dwordx4 v[152:155], v13, s[36:39], s62 offen sc1
    buffer_load_dword v156, v14, s[36:39], s62 offen sc1
    s_add_u32 s62, s62, 2621440
    buffer_load_dwordx4 v[160:163], v13, s[36:39], s62 offen sc1
    buffer_load_dword v164, v14, s[36:39], s62 offen sc1
    s_add_u32 s62, s62, 2621440
    buffer_load_dwordx4 v[168:171], v13, s[36:39], s62 offen sc1
    buffer_load_dword v172, v14, s[36:39], s62 offen sc1
    s_waitcnt vmcnt(14)
    v_dot2_f32_bf16 v176, v112, s60, 0
    v_dot2_f32_bf16 v177, v112, s61, 0
    v_dot2_f32_bf16 v178, v113, s60, 0
    v_dot2_f32_bf16 v179, v113, s61, 0
    v_dot2_f32_bf16 v180, v114, s60, 0
    v_dot2_f32_bf16 v181, v114, s61, 0
    v_dot2_f32_bf16 v182, v115, s60, 0
    v_dot2_f32_bf16 v183, v115, s61, 0
    v_dot2_f32_bf16 v184, v116, s60, 0
    v_dot2_f32_bf16 v185, v116, s61, 0
    s_waitcnt vmcnt(12)
    v_dot2_f32_bf16 v176, v120, s60, v176
    v_dot2_f32_bf16 v177, v120, s61, v177
    v_dot2_f32_bf16 v178, v121, s60, v178
    v_dot2_f32_bf16 v179, v121, s61, v179
    v_dot2_f32_bf16 v180, v122, s60, v180
    v_dot2_f32_bf16 v181, v122, s61, v181
    v_dot2_f32_bf16 v182, v123, s60, v182
    v_dot2_f32_bf16 v183, v123, s61, v183
    v_dot2_f32_bf16 v184, v124, s60, v184
    v_dot2_f32_bf16 v185, v124, s61, v185
    s_waitcnt vmcnt(10)
    v_dot2_f32_bf16 v176, v128, s60, v176
    v_dot2_f32_bf16 v177, v128, s61, v177
    v_dot2_f32_bf16 v178, v129, s60, v178
    v_dot2_f32_bf16 v179, v129, s61, v179
    v_dot2_f32_bf16 v180, v130, s60, v180
    v_dot2_f32_bf16 v181, v130, s61, v181
    v_dot2_f32_bf16 v182, v131, s60, v182
    v_dot2_f32_bf16 v183, v131, s61, v183
    v_dot2_f32_bf16 v184, v132, s60, v184
    v_dot2_f32_bf16 v185, v132, s61, v185
    s_waitcnt vmcnt(8)
    v_dot2_f32_bf16 v176, v136, s60, v176
    v_dot2_f32_bf16 v177, v136, s61, v177
    v_dot2_f32_bf16 v178, v137, s60, v178
    v_dot2_f32_bf16 v179, v137, s61, v179
    v_dot2_f32_bf16 v180, v138, s60, v180
    v_dot2_f32_bf16 v181, v138, s61, v181
    v_dot2_f32_bf16 v182, v139, s60, v182
    v_dot2_f32_bf16 v183, v139, s61, v183
    v_dot2_f32_bf16 v184, v140, s60, v184
    v_dot2_f32_bf16 v185, v140, s61, v185
    s_waitcnt vmcnt(6)
    v_dot2_f32_bf16 v176, v144, s60, v176
    v_dot2_f32_bf16 v177, v144, s61, v177
    v_dot2_f32_bf16 v178, v145, s60, v178
    v_dot2_f32_bf16 v179, v145, s61, v179
    v_dot2_f32_bf16 v180, v146, s60, v180
    v_dot2_f32_bf16 v181, v146, s61, v181
    v_dot2_f32_bf16 v182, v147, s60, v182
    v_dot2_f32_bf16 v183, v147, s61, v183
    v_dot2_f32_bf16 v184, v148, s60, v184
    v_dot2_f32_bf16 v185, v148, s61, v185
    s_waitcnt vmcnt(4)
    v_dot2_f32_bf16 v176, v152, s60, v176
    v_dot2_f32_bf16 v177, v152, s61, v177
    v_dot2_f32_bf16 v178, v153, s60, v178
    v_dot2_f32_bf16 v179, v153, s61, v179
    v_dot2_f32_bf16 v180, v154, s60, v180
    v_dot2_f32_bf16 v181, v154, s61, v181
    v_dot2_f32_bf16 v182, v155, s60, v182
    v_dot2_f32_bf16 v183, v155, s61, v183
    v_dot2_f32_bf16 v184, v156, s60, v184
    v_dot2_f32_bf16 v185, v156, s61, v185
    s_waitcnt vmcnt(2)
    v_dot2_f32_bf16 v176, v160, s60, v176
    v_dot2_f32_bf16 v177, v160, s61, v177
    v_dot2_f32_bf16 v178, v161, s60, v178
    v_dot2_f32_bf16 v179, v161, s61, v179
    v_dot2_f32_bf16 v180, v162, s60, v180
    v_dot2_f32_bf16 v181, v162, s61, v181
    v_dot2_f32_bf16 v182, v163, s60, v182
    v_dot2_f32_bf16 v183, v163, s61, v183
    v_dot2_f32_bf16 v184, v164, s60, v184
    v_dot2_f32_bf16 v185, v164, s61, v185
    s_waitcnt vmcnt(0)
    v_dot2_f32_bf16 v176, v168, s60, v176
    v_dot2_f32_bf16 v177, v168, s61, v177
    v_dot2_f32_bf16 v178, v169, s60, v178
    v_dot2_f32_bf16 v179, v169, s61, v179
    v_dot2_f32_bf16 v180, v170, s60, v180
    v_dot2_f32_bf16 v181, v170, s61, v181
    v_dot2_f32_bf16 v182, v171, s60, v182
    v_dot2_f32_bf16 v183, v171, s61, v183
    v_dot2_f32_bf16 v184, v172, s60, v184
    v_dot2_f32_bf16 v185, v172, s61, v185
    v_add_f32 v224, v176, v178
    v_add_f32 v225, v180, v182
    v_add_f32 v224, v224, v184
    v_cmp_u_f32 vcc, v224, v225
    s_nop 0
    s_cmp_eq_u64 vcc, 0
    s_cbranch_scc1 k1_rok51
    s_add_u32 s21, s21, 1
    s_cmp_lt_u32 s21, 0x8000
    s_cbranch_scc1 k1_rl50
k1_rok51:
    v_cvt_pk_bf16_f32 v224, v176, v177
    v_cvt_pk_bf16_f32 v225, v178, v179
    v_cvt_pk_bf16_f32 v226, v180, v181
    v_cvt_pk_bf16_f32 v227, v182, v183
    v_cvt_pk_bf16_f32 v228, v184, v185
    v_lshlrev_b32 v176, 16, v224
    v_and_b32 v177, 0xffff0000, v224
    v_lshlrev_b32 v178, 16, v225
    v_and_b32 v179, 0xffff0000, v225
    v_lshlrev_b32 v180, 16, v226
    v_and_b32 v181, 0xffff0000, v226
    v_lshlrev_b32 v182, 16, v227
    v_and_b32 v183, 0xffff0000, v227
    v_lshlrev_b32 v184, 16, v228
    v_and_b32 v185, 0xffff0000, v228
    v_mul_f32 v176, v176, v208
    v_mul_f32 v177, v177, v209
    v_mul_f32 v178, v178, v210
    v_mul_f32 v179, v179, v211
    v_mul_f32 v180, v180, v212
    v_mul_f32 v181, v181, v213
    v_mul_f32 v182, v182, v214
    v_mul_f32 v183, v183, v215
    v_mul_f32 v184, v184, v216
    v_mul_f32 v185, v185, v217
    v_cvt_pk_bf16_f32 v224, v176, v177
    v_cvt_pk_bf16_f32 v225, v178, v179
    v_cvt_pk_bf16_f32 v226, v180, v181
    v_cvt_pk_bf16_f32 v227, v182, v183
    v_cvt_pk_bf16_f32 v228, v184, v185
    v_lshlrev_b32 v176, 16, v224
    v_and_b32 v177, 0xffff0000, v224
    v_lshlrev_b32 v178, 16, v225
    v_and_b32 v179, 0xffff0000, v225
    v_lshlrev_b32 v180, 16, v226
    v_and_b32 v181, 0xffff0000, v226
    v_lshlrev_b32 v182, 16, v227
    v_and_b32 v183, 0xffff0000, v227
    v_lshlrev_b32 v184, 16, v228
    v_and_b32 v185, 0xffff0000, v228
    v_add_f32 v192, v192, v176
    v_add_f32 v193, v193, v177
    v_add_f32 v194, v194, v178
    v_add_f32 v195, v195, v179
    v_add_f32 v196, v196, v180
    v_add_f32 v197, v197, v181
    v_add_f32 v198, v198, v182
    v_add_f32 v199, v199, v183
    v_add_f32 v200, v200, v184
    v_add_f32 v201, v201, v185
    v_cvt_pk_bf16_f32 v112, v192, v193
    v_cvt_pk_bf16_f32 v113, v194, v195
    v_cvt_pk_bf16_f32 v114, v196, v197
    v_cvt_pk_bf16_f32 v115, v198, v199
    v_cvt_pk_bf16_f32 v116, v200, v201
    v_lshlrev_b32 v192, 16, v112
    v_and_b32 v193, 0xffff0000, v112
    v_lshlrev_b32 v194, 16, v113
    v_and_b32 v195, 0xffff0000, v113
    v_lshlrev_b32 v196, 16, v114
    v_and_b32 v197, 0xffff0000, v114
    v_lshlrev_b32 v198, 16, v115
    v_and_b32 v199, 0xffff0000, v115
    v_lshlrev_b32 v200, 16, v116
    v_and_b32 v201, 0xffff0000, v116
    s_add_u32 s3, s6, 88080384
    buffer_store_dwordx4 v[112:115], v20, s[36:39], s3 offen sc1
    v_mov_b32_dpp v117, v116 quad_perm:[1,1,1,1] row_mask:0xf bank_mask:0xf
    v_mov_b32_dpp v118, v116 quad_perm:[2,2,2,2] row_mask:0xf bank_mask:0xf
    v_mov_b32_dpp v119, v116 quad_perm:[3,3,3,3] row_mask:0xf bank_mask:0xf
    buffer_store_dwordx4 v[116:119], v15, s[36:39], s3 offen offset:1024 sc1
    v_add_f32 v232, v192, v193
    v_add_f32 v233, v194, v195
    v_add_f32 v232, v232, v196
    v_add_f32 v233, v233, v197
    v_add_f32 v232, v232, v198
    v_add_f32 v233, v233, v199
    v_add_f32 v232, v232, v200
    v_add_f32 v233, v233, v201
    v_add_f32 v232, v232, v233
    s_nop 1
    v_add_f32_dpp v232, v232, v232 row_ror:1 row_mask:0xf bank_mask:0xf
    v_lshlrev_b32 v128, 16, v88
    v_and_b32 v129, 0xffff0000, v88
    v_add_f32_dpp v232, v232, v232 row_ror:2 row_mask:0xf bank_mask:0xf
    v_lshlrev_b32 v144, 16, v80
    v_and_b32 v145, 0xffff0000, v80
    v_add_f32_dpp v232, v232, v232 row_ror:4 row_mask:0xf bank_mask:0xf
    v_lshlrev_b32 v130, 16, v89
    v_and_b32 v131, 0xffff0000, v89
    v_add_f32_dpp v232, v232, v232 row_ror:8 row_mask:0xf bank_mask:0xf
    v_lshlrev_b32 v146, 16, v81
    v_and_b32 v147, 0xffff0000, v81
    v_mov_b32 v224, v232
    v_lshlrev_b32 v132, 16, v90
    v_and_b32 v133, 0xffff0000, v90
    v_permlane16_swap_b32 v232, v224
    v_lshlrev_b32 v148, 16, v82
    v_and_b32 v149, 0xffff0000, v82
    v_add_f32 v232, v232, v224
    v_lshlrev_b32 v134, 16, v91
    v_and_b32 v135, 0xffff0000, v91
    v_mov_b32 v224, v232
    v_lshlrev_b32 v150, 16, v83
    v_and_b32 v151, 0xffff0000, v83
    v_permlane32_swap_b32 v232, v224
    v_lshlrev_b32 v136, 16, v92
    v_and_b32 v137, 0xffff0000, v92
    v_add_f32 v232, v232, v224
    v_lshlrev_b32 v152, 16, v84
    v_and_b32 v153, 0xffff0000, v84
    v_mul_f32 v232, 0x3acccccd, v232
    v_sub_f32 v208, v192, v232
    v_sub_f32 v209, v193, v232
    v_sub_f32 v210, v194, v232
    v_sub_f32 v211, v195, v232
    v_sub_f32 v212, v196, v232
    v_sub_f32 v213, v197, v232
    v_sub_f32 v214, v198, v232
    v_sub_f32 v215, v199, v232
    v_sub_f32 v216, v200, v232
    v_sub_f32 v217, v201, v232
    v_mul_f32 v233, v208, v208
    v_mul_f32 v234, v209, v209
    v_fmac_f32 v233, v210, v210
    v_fmac_f32 v234, v211, v211
    v_fmac_f32 v233, v212, v212
    v_fmac_f32 v234, v213, v213
    v_fmac_f32 v233, v214, v214
    v_fmac_f32 v234, v215, v215
    v_fmac_f32 v233, v216, v216
    v_fmac_f32 v234, v217, v217
    v_add_f32 v233, v233, v234
    s_nop 1
    v_add_f32_dpp v233, v233, v233 row_ror:1 row_mask:0xf bank_mask:0xf
    v_cvt_pk_bf16_f32 v232, v232, v232
    v_lshlrev_b32 v232, 16, v232
    v_add_f32_dpp v233, v233, v233 row_ror:2 row_mask:0xf bank_mask:0xf
    v_sub_f32 v208, v192, v232
    v_sub_f32 v209, v193, v232
    v_add_f32_dpp v233, v233, v233 row_ror:4 row_mask:0xf bank_mask:0xf
    v_sub_f32 v210, v194, v232
    v_sub_f32 v211, v195, v232
    v_add_f32_dpp v233, v233, v233 row_ror:8 row_mask:0xf bank_mask:0xf
    v_sub_f32 v212, v196, v232
    v_sub_f32 v213, v197, v232
    v_mov_b32 v224, v233
    v_sub_f32 v214, v198, v232
    v_sub_f32 v215, v199, v232
    v_permlane16_swap_b32 v233, v224
    v_sub_f32 v216, v200, v232
    v_sub_f32 v217, v201, v232
    v_add_f32 v233, v233, v224
    v_cvt_pk_bf16_f32 v225, v208, v209
    v_cvt_pk_bf16_f32 v226, v210, v211
    v_mov_b32 v224, v233
    v_cvt_pk_bf16_f32 v227, v212, v213
    v_cvt_pk_bf16_f32 v228, v214, v215
    v_permlane32_swap_b32 v233, v224
    v_cvt_pk_bf16_f32 v229, v216, v217
    v_add_f32 v233, v233, v224
    v_mul_f32 v233, 0x3acccccd, v233
    v_cvt_pk_bf16_f32 v233, v233, v233
    v_lshlrev_b32 v208, 16, v225
    v_and_b32 v209, 0xffff0000, v225
    v_lshlrev_b32 v233, 16, v233
    v_lshlrev_b32 v210, 16, v226
    v_and_b32 v211, 0xffff0000, v226
    v_add_f32 v233, 0x3727c5ac, v233
    v_lshlrev_b32 v212, 16, v227
    v_and_b32 v213, 0xffff0000, v227
    v_cvt_pk_bf16_f32 v233, v233, v233
    v_lshlrev_b32 v214, 16, v228
    v_and_b32 v215, 0xffff0000, v228
    v_lshlrev_b32 v233, 16, v233
    v_lshlrev_b32 v216, 16, v229
    v_and_b32 v217, 0xffff0000, v229
    v_sqrt_f32 v233, v233
    v_lshlrev_b32 v160, 16, v96
    v_and_b32 v161, 0xffff0000, v96
    v_cvt_pk_bf16_f32 v233, v233, v233
    v_lshlrev_b32 v176, 16, v104
    v_and_b32 v177, 0xffff0000, v104
    v_lshlrev_b32 v233, 16, v233
    v_lshlrev_b32 v162, 16, v97
    v_and_b32 v163, 0xffff0000, v97
    v_rcp_f32 v233, v233
    v_lshlrev_b32 v178, 16, v105
    v_and_b32 v179, 0xffff0000, v105
    v_lshlrev_b32 v164, 16, v98
    v_and_b32 v165, 0xffff0000, v98
    v_lshlrev_b32 v180, 16, v106
    v_and_b32 v181, 0xffff0000, v106
    v_lshlrev_b32 v166, 16, v99
    v_and_b32 v167, 0xffff0000, v99
    v_lshlrev_b32 v182, 16, v107
    v_and_b32 v183, 0xffff0000, v107
    v_lshlrev_b32 v168, 16, v100
    v_and_b32 v169, 0xffff0000, v100
    v_lshlrev_b32 v184, 16, v108
    v_and_b32 v185, 0xffff0000, v108
    v_mul_f32 v208, v208, v233
    v_mul_f32 v209, v209, v233
    v_mul_f32 v210, v210, v233
    v_mul_f32 v211, v211, v233
    v_mul_f32 v212, v212, v233
    v_mul_f32 v213, v213, v233
    v_mul_f32 v214, v214, v233
    v_mul_f32 v215, v215, v233
    v_mul_f32 v216, v216, v233
    v_mul_f32 v217, v217, v233
    v_cvt_pk_bf16_f32 v224, v208, v209
    v_cvt_pk_bf16_f32 v225, v210, v211
    v_cvt_pk_bf16_f32 v226, v212, v213
    v_cvt_pk_bf16_f32 v227, v214, v215
    v_cvt_pk_bf16_f32 v228, v216, v217
    v_lshlrev_b32 v208, 16, v224
    v_and_b32 v209, 0xffff0000, v224
    v_lshlrev_b32 v210, 16, v225
    v_and_b32 v211, 0xffff0000, v225
    v_lshlrev_b32 v212, 16, v226
    v_and_b32 v213, 0xffff0000, v226
    v_lshlrev_b32 v214, 16, v227
    v_and_b32 v215, 0xffff0000, v227
    v_lshlrev_b32 v216, 16, v228
    v_and_b32 v217, 0xffff0000, v228
    v_mul_f32 v208, v208, v128
    v_mul_f32 v209, v209, v129
    v_mul_f32 v210, v210, v130
    v_mul_f32 v211, v211, v131
    v_mul_f32 v212, v212, v132
    v_mul_f32 v213, v213, v133
    v_mul_f32 v214, v214, v134
    v_mul_f32 v215, v215, v135
    v_mul_f32 v216, v216, v136
    v_mul_f32 v217, v217, v137
    v_cvt_pk_bf16_f32 v224, v208, v209
    v_cvt_pk_bf16_f32 v225, v210, v211
    v_cvt_pk_bf16_f32 v226, v212, v213
    v_cvt_pk_bf16_f32 v227, v214, v215
    v_cvt_pk_bf16_f32 v228, v216, v217
    v_lshlrev_b32 v208, 16, v224
    v_and_b32 v209, 0xffff0000, v224
    v_lshlrev_b32 v210, 16, v225
    v_and_b32 v211, 0xffff0000, v225
    v_lshlrev_b32 v212, 16, v226
    v_and_b32 v213, 0xffff0000, v226
    v_lshlrev_b32 v214, 16, v227
    v_and_b32 v215, 0xffff0000, v227
    v_lshlrev_b32 v216, 16, v228
    v_and_b32 v217, 0xffff0000, v228
    v_add_f32 v208, v208, v144
    v_add_f32 v209, v209, v145
    v_add_f32 v210, v210, v146
    v_add_f32 v211, v211, v147
    v_add_f32 v212, v212, v148
    v_add_f32 v213, v213, v149
    v_add_f32 v214, v214, v150
    v_add_f32 v215, v215, v151
    v_add_f32 v216, v216, v152
    v_add_f32 v217, v217, v153
    v_cvt_pk_bf16_f32 v120, v208, v209
    v_cvt_pk_bf16_f32 v121, v210, v211
    v_cvt_pk_bf16_f32 v122, v212, v213
    v_cvt_pk_bf16_f32 v123, v214, v215
    v_cvt_pk_bf16_f32 v124, v216, v217
    v_lshlrev_b32 v208, 16, v120
    v_and_b32 v209, 0xffff0000, v120
    v_lshlrev_b32 v210, 16, v121
    v_and_b32 v211, 0xffff0000, v121
    v_lshlrev_b32 v212, 16, v122
    v_and_b32 v213, 0xffff0000, v122
    v_lshlrev_b32 v214, 16, v123
    v_and_b32 v215, 0xffff0000, v123
    v_lshlrev_b32 v216, 16, v124
    v_and_b32 v217, 0xffff0000, v124
    s_add_u32 s3, s6, 84934656
    buffer_store_dwordx4 v[120:123], v20, s[36:39], s3 offen sc1
    v_mov_b32_dpp v125, v124 quad_perm:[1,1,1,1] row_mask:0xf bank_mask:0xf
    v_mov_b32_dpp v126, v124 quad_perm:[2,2,2,2] row_mask:0xf bank_mask:0xf
    v_mov_b32_dpp v127, v124 quad_perm:[3,3,3,3] row_mask:0xf bank_mask:0xf
    buffer_store_dwordx4 v[124:127], v15, s[36:39], s3 offen offset:1024 sc1
    v_mul_f32 v232, v208, v176
    v_mul_f32 v233, v209, v177
    v_fmac_f32 v232, v210, v178
    v_fmac_f32 v233, v211, v179
    v_fmac_f32 v232, v212, v180
    v_fmac_f32 v233, v213, v181
    v_fmac_f32 v232, v214, v182
    v_fmac_f32 v233, v215, v183
    v_fmac_f32 v232, v216, v184
    v_fmac_f32 v233, v217, v185
    v_add_f32 v232, v232, v233
    s_nop 1
    v_add_f32_dpp v232, v232, v232 row_ror:1 row_mask:0xf bank_mask:0xf
    s_nop 1
    v_add_f32_dpp v232, v232, v232 row_ror:2 row_mask:0xf bank_mask:0xf
    s_nop 1
    v_add_f32_dpp v232, v232, v232 row_ror:4 row_mask:0xf bank_mask:0xf
    s_nop 1
    v_add_f32_dpp v232, v232, v232 row_ror:8 row_mask:0xf bank_mask:0xf
    v_mov_b32 v224, v232
    s_nop 1
    v_permlane16_swap_b32 v232, v224
    v_add_f32 v232, v232, v224
    v_mov_b32 v224, v232
    s_nop 1
    v_permlane32_swap_b32 v232, v224
    v_add_f32 v232, v232, v224
    v_cvt_pk_bf16_f32 v232, v232, v232
    s_lshl_b32 s3, s57, 1
    v_ashrrev_i32 v233, 31, v232
    v_or_b32 v233, 0x80000000, v233
    v_xor_b32 v232, v232, v233
    v_and_b32 v232, 0xffff0000, v232
    s_sub_u32 s3, 36862, s3
    v_or_b32 v232, s3, v232
    buffer_store_dword v232, v11, s[36:39], s7 offen sc1
    v_mul_f32 v160, v208, v160
    v_mul_f32 v161, v209, v161
    v_mul_f32 v162, v210, v162
    v_mul_f32 v163, v211, v163
    v_mul_f32 v164, v212, v164
    v_mul_f32 v165, v213, v165
    v_mul_f32 v166, v214, v166
    v_mul_f32 v167, v215, v167
    v_mul_f32 v168, v216, v168
    v_mul_f32 v169, v217, v169
    v_cvt_pk_bf16_f32 v236, v160, v161
    v_cvt_pk_bf16_f32 v237, v162, v163
    v_cvt_pk_bf16_f32 v238, v164, v165
    v_cvt_pk_bf16_f32 v239, v166, v167
    v_cvt_pk_bf16_f32 v240, v168, v169
    v_lshlrev_b32 v160, 16, v236
    v_and_b32 v161, 0xffff0000, v236
    v_lshlrev_b32 v162, 16, v237
    v_and_b32 v163, 0xffff0000, v237
    v_lshlrev_b32 v164, 16, v238
    v_and_b32 v165, 0xffff0000, v238
    v_lshlrev_b32 v166, 16, v239
    v_and_b32 v167, 0xffff0000, v239
    v_lshlrev_b32 v168, 16, v240
    v_and_b32 v169, 0xffff0000, v240
    v_add_f32 v160, v160, v192
    v_add_f32 v161, v161, v193
    v_add_f32 v162, v162, v194
    v_add_f32 v163, v163, v195
    v_add_f32 v164, v164, v196
    v_add_f32 v165, v165, v197
    v_add_f32 v166, v166, v198
    v_add_f32 v167, v167, v199
    v_add_f32 v168, v168, v200
    v_add_f32 v169, v169, v201
    v_cvt_pk_bf16_f32 v128, v160, v161
    v_cvt_pk_bf16_f32 v129, v162, v163
    v_cvt_pk_bf16_f32 v130, v164, v165
    v_cvt_pk_bf16_f32 v131, v166, v167
    v_cvt_pk_bf16_f32 v132, v168, v169
    buffer_store_dwordx4 v[128:131], v20, s[16:19], s6 offen sc1
    s_nop 0
    v_mov_b32_dpp v133, v132 quad_perm:[1,1,1,1] row_mask:0xf bank_mask:0xf
    v_mov_b32_dpp v134, v132 quad_perm:[2,2,2,2] row_mask:0xf bank_mask:0xf
    v_mov_b32_dpp v135, v132 quad_perm:[3,3,3,3] row_mask:0xf bank_mask:0xf
    buffer_store_dwordx4 v[132:135], v15, s[16:19], s6 offen offset:1024 sc1
    v_or_b32 v233, 1, v232
    s_waitcnt vmcnt(0)
    buffer_store_dword v233, v11, s[36:39], s7 offen sc1
    s_cmp_eq_u32 s4, 0
    s_cbranch_scc1 k1_done
    s_lshr_b32 s56, s2, 3
    s_and_b32 s57, s2, 7
    s_cmp_ge_u32 s56, 19
    s_cbranch_scc1 k1_done
    v_lshrrev_b32 v8, 4, v0
    v_bfe_u32 v3, v0, 2, 2
    v_lshl_add_u32 v2, v8, 3, v3
    v_and_b32 v3, 3, v0
    v_lshlrev_b32 v3, 3, v3
    v_lshl_add_u32 v6, v2, 5, v3
    s_mul_i32 s58, s5, 14336
    s_add_u32 s58, s58, 81920
    v_add_u32 v6, s58, v6
    v_lshrrev_b32 v5, 1, v0
    v_and_b32 v9, 1, v0
    v_lshlrev_b32 v9, 4, v9
    v_and_b32 v10, 7, v0
    s_lshl_b32 s59, s5, 11
    s_add_u32 s59, s59, 140288
    v_add_u32 v12, s59, v20
    v_add_u32 v13, 140288, v20
    s_cmp_ge_u32 s56, 14
    s_cbranch_scc1 k1_mo2
    s_mul_i32 s57, s57, 14
    s_add_u32 s23, s57, s56
    s_cmp_ge_u32 s23, 108
    s_cbranch_scc1 k1_done
    s_lshl_b32 s61, s23, 5
    s_mov_b32 s48, s90
    s_mov_b32 s49, s91
    s_mov_b32 s50, 2211840
    s_mov_b32 s51, 0x00020000
    s_mov_b32 s52, s92
    s_mov_b32 s53, s93
    s_mov_b32 s54, 2211840
    s_mov_b32 s55, 0x00020000
    v_mul_u32_u24 v4, 3456, v5
    v_add_u32 v4, v4, v9
    s_mul_i32 s60, s5, 552960
    s_add_u32 s60, s60, s61
    s_add_u32 m0, s58, 0
    s_add_u32 s3, s60, 0
    buffer_load_dwordx4 v4, s[48:51], s3 offen lds
    s_add_u32 m0, s58, 1024
    s_add_u32 s3, s60, 110592
    buffer_load_dwordx4 v4, s[48:51], s3 offen lds
    s_add_u32 m0, s58, 2048
    s_add_u32 s3, s60, 221184
    buffer_load_dwordx4 v4, s[48:51], s3 offen lds
    s_add_u32 m0, s58, 3072
    s_add_u32 s3, s60, 331776
    buffer_load_dwordx4 v4, s[48:51], s3 offen lds
    s_add_u32 m0, s58, 4096
    s_add_u32 s3, s60, 442368
    buffer_load_dwordx4 v4, s[48:51], s3 offen lds
    s_add_u32 m0, s58, 5120
    s_add_u32 s3, s60, 0
    buffer_load_dwordx4 v4, s[52:55], s3 offen lds
    s_add_u32 m0, s58, 6144
    s_add_u32 s3, s60, 110592
    buffer_load_dwordx4 v4, s[52:55], s3 offen lds
    s_add_u32 m0, s58, 7168
    s_add_u32 s3, s60, 221184
    buffer_load_dwordx4 v4, s[52:55], s3 offen lds
    s_add_u32 m0, s58, 8192
    s_add_u32 s3, s60, 331776
    buffer_load_dwordx4 v4, s[52:55], s3 offen lds
    s_add_u32 m0, s58, 9216
    s_add_u32 s3, s60, 442368
    buffer_load_dwordx4 v4, s[52:55], s3 offen lds
    s_lshl_b32 s62, s5, 10
    s_add_u32 s62, s62, 83984384
    s_add_u32 s63, s62, 4096
    s_waitcnt vmcnt(0)
    ds_read_b64_tr_b16 v[64:65], v6 offset:0
    ds_read_b64_tr_b16 v[66:67], v6 offset:128
    ds_read_b64_tr_b16 v[68:69], v6 offset:1024
    ds_read_b64_tr_b16 v[70:71], v6 offset:1152
    ds_read_b64_tr_b16 v[72:73], v6 offset:2048
    ds_read_b64_tr_b16 v[74:75], v6 offset:2176
    ds_read_b64_tr_b16 v[76:77], v6 offset:3072
    ds_read_b64_tr_b16 v[78:79], v6 offset:3200
    ds_read_b64_tr_b16 v[80:81], v6 offset:4096
    ds_read_b64_tr_b16 v[82:83], v6 offset:4224
    ds_read_b64_tr_b16 v[84:85], v6 offset:5120
    ds_read_b64_tr_b16 v[86:87], v6 offset:5248
    ds_read_b64_tr_b16 v[88:89], v6 offset:6144
    ds_read_b64_tr_b16 v[90:91], v6 offset:6272
    ds_read_b64_tr_b16 v[92:93], v6 offset:7168
    ds_read_b64_tr_b16 v[94:95], v6 offset:7296
    ds_read_b64_tr_b16 v[96:97], v6 offset:8192
    ds_read_b64_tr_b16 v[98:99], v6 offset:8320
    ds_read_b64_tr_b16 v[100:101], v6 offset:9216
    ds_read_b64_tr_b16 v[102:103], v6 offset:9344
    s_mov_b32 s21, 0
k1_ks52:
    buffer_load_dwordx4 v[32:35], v20, s[36:39], s62 offen sc1
    buffer_load_dwordx4 v[36:39], v20, s[36:39], s63 offen sc1
    s_waitcnt vmcnt(0)
k1_kin54:
    v_min3_u32 v40, v32, v33, v34
    v_min3_u32 v41, v35, v36, v37
    v_min3_u32 v40, v40, v38, v39
    v_min_u32 v40, v40, v41
    v_and_b32 v41, v32, v33
    v_cmp_eq_u32 vcc, 0, v40
    v_and_b32 v42, v34, v35
    v_and_b32 v43, v36, v37
    s_cmp_eq_u64 vcc, 0
    s_cbranch_scc1 k1_kok53
    v_and_b32 v40, v38, v39
    v_and_b32 v41, v41, v42
    v_and_b32 v40, v40, v43
    v_and_b32 v40, v40, v41
    v_and_b32 v40, 1, v40
    v_cmpx_eq_u32 vcc, 0, v40
    s_add_u32 s21, s21, 1
    s_cmp_ge_u32 s21, 0x8000
    s_cbranch_scc1 k1_kok53
    s_sleep 1
    s_branch k1_ks52
k1_kok53:
    s_mov_b64 exec, -1
    v_max_u32 v40, v32, v33
    v_min_u32 v33, v32, v33
    v_max_u32 v32, v34, v35
    v_min_u32 v35, v34, v35
    v_max_u32 v34, v36, v37
    v_min_u32 v37, v36, v37
    v_max_u32 v36, v38, v39
    v_min_u32 v39, v38, v39
    v_max_u32 v38, v40, v32
    v_min_u32 v32, v40, v32
    v_max_u32 v40, v33, v35
    v_min_u32 v35, v33, v35
    v_max_u32 v33, v34, v36
    v_min_u32 v36, v34, v36
    v_max_u32 v34, v37, v39
    v_min_u32 v39, v37, v39
    v_max_u32 v37, v40, v32
    v_min_u32 v32, v40, v32
    v_max_u32 v40, v34, v36
    v_min_u32 v36, v34, v36
    v_max_u32 v34, v38, v33
    v_min_u32 v33, v38, v33
    v_max_u32 v38, v35, v39
    v_min_u32 v39, v35, v39
    v_max_u32 v35, v37, v40
    v_min_u32 v40, v37, v40
    v_max_u32 v37, v32, v36
    v_min_u32 v36, v32, v36
    v_max_u32 v32, v35, v33
    v_min_u32 v33, v35, v33
    v_max_u32 v35, v38, v36
    v_min_u32 v36, v38, v36
    v_max_u32 v38, v37, v33
    v_min_u32 v33, v37, v33
    v_max_u32 v37, v35, v40
    v_min_u32 v40, v35, v40
    v_max_u32 v35, v37, v33
    v_min_u32 v33, v37, v33
    v_mov_b32 v44, 0
    v_max_u32_dpp v42, v34, v34 row_ror:1 row_mask:0xf bank_mask:0xf
    s_nop 1
    v_max_u32_dpp v42, v42, v42 row_ror:2 row_mask:0xf bank_mask:0xf
    s_nop 1
    v_max_u32_dpp v42, v42, v42 row_ror:4 row_mask:0xf bank_mask:0xf
    s_nop 1
    v_max_u32_dpp v42, v42, v42 row_ror:8 row_mask:0xf bank_mask:0xf
    v_mov_b32 v43, v42
    s_nop 1
    v_permlane16_swap_b32 v42, v43
    v_max_u32 v42, v42, v43
    v_mov_b32 v43, v42
    s_nop 1
    v_permlane32_swap_b32 v42, v43
    v_max_u32 v42, v42, v43
    v_cmp_eq_u32 vcc, v42, v34
    s_nop 1
    v_cndmask_b32 v34, v34, v32, vcc
    v_cndmask_b32 v32, v32, v38, vcc
    v_cndmask_b32 v38, v38, v35, vcc
    v_cndmask_b32 v35, v35, v33, vcc
    v_cndmask_b32 v33, v33, v40, vcc
    v_cndmask_b32 v40, v40, v36, vcc
    v_cndmask_b32 v36, v36, v39, vcc
    v_cmp_eq_u32 s[64:65], 0, v10
    s_nop 1
    v_cndmask_b32 v44, v44, v42, s[64:65]
    v_max_u32_dpp v42, v34, v34 row_ror:1 row_mask:0xf bank_mask:0xf
    s_nop 1
    v_max_u32_dpp v42, v42, v42 row_ror:2 row_mask:0xf bank_mask:0xf
    s_nop 1
    v_max_u32_dpp v42, v42, v42 row_ror:4 row_mask:0xf bank_mask:0xf
    s_nop 1
    v_max_u32_dpp v42, v42, v42 row_ror:8 row_mask:0xf bank_mask:0xf
    v_mov_b32 v43, v42
    s_nop 1
    v_permlane16_swap_b32 v42, v43
    v_max_u32 v42, v42, v43
    v_mov_b32 v43, v42
    s_nop 1
    v_permlane32_swap_b32 v42, v43
    v_max_u32 v42, v42, v43
    v_cmp_eq_u32 vcc, v42, v34
    s_nop 1
    v_cndmask_b32 v34, v34, v32, vcc
    v_cndmask_b32 v32, v32, v38, vcc
    v_cndmask_b32 v38, v38, v35, vcc
    v_cndmask_b32 v35, v35, v33, vcc
    v_cndmask_b32 v33, v33, v40, vcc
    v_cndmask_b32 v40, v40, v36, vcc
    v_cmp_eq_u32 s[64:65], 1, v10
    s_nop 1
    v_cndmask_b32 v44, v44, v42, s[64:65]
    v_max_u32_dpp v42, v34, v34 row_ror:1 row_mask:0xf bank_mask:0xf
    s_nop 1
    v_max_u32_dpp v42, v42, v42 row_ror:2 row_mask:0xf bank_mask:0xf
    s_nop 1
    v_max_u32_dpp v42, v42, v42 row_ror:4 row_mask:0xf bank_mask:0xf
    s_nop 1
    v_max_u32_dpp v42, v42, v42 row_ror:8 row_mask:0xf bank_mask:0xf
    v_mov_b32 v43, v42
    s_nop 1
    v_permlane16_swap_b32 v42, v43
    v_max_u32 v42, v42, v43
    v_mov_b32 v43, v42
    s_nop 1
    v_permlane32_swap_b32 v42, v43
    v_max_u32 v42, v42, v43
    v_cmp_eq_u32 vcc, v42, v34
    s_nop 1
    v_cndmask_b32 v34, v34, v32, vcc
    v_cndmask_b32 v32, v32, v38, vcc
    v_cndmask_b32 v38, v38, v35, vcc
    v_cndmask_b32 v35, v35, v33, vcc
    v_cndmask_b32 v33, v33, v40, vcc
    v_cmp_eq_u32 s[64:65], 2, v10
    s_nop 1
    v_cndmask_b32 v44, v44, v42, s[64:65]
    v_max_u32_dpp v42, v34, v34 row_ror:1 row_mask:0xf bank_mask:0xf
    s_nop 1
    v_max_u32_dpp v42, v42, v42 row_ror:2 row_mask:0xf bank_mask:0xf
    s_nop 1
    v_max_u32_dpp v42, v42, v42 row_ror:4 row_mask:0xf bank_mask:0xf
    s_nop 1
    v_max_u32_dpp v42, v42, v42 row_ror:8 row_mask:0xf bank_mask:0xf
    v_mov_b32 v43, v42
    s_nop 1
    v_permlane16_swap_b32 v42, v43
    v_max_u32 v42, v42, v43
    v_mov_b32 v43, v42
    s_nop 1
    v_permlane32_swap_b32 v42, v43
    v_max_u32 v42, v42, v43
    v_cmp_eq_u32 vcc, v42, v34
    s_nop 1
    v_cndmask_b32 v34, v34, v32, vcc
    v_cndmask_b32 v32, v32, v38, vcc
    v_cndmask_b32 v38, v38, v35, vcc
    v_cndmask_b32 v35, v35, v33, vcc
    v_cmp_eq_u32 s[64:65], 3, v10
    s_nop 1
    v_cndmask_b32 v44, v44, v42, s[64:65]
    v_max_u32_dpp v42, v34, v34 row_ror:1 row_mask:0xf bank_mask:0xf
    s_nop 1
    v_max_u32_dpp v42, v42, v42 row_ror:2 row_mask:0xf bank_mask:0xf
    s_nop 1
    v_max_u32_dpp v42, v42, v42 row_ror:4 row_mask:0xf bank_mask:0xf
    s_nop 1
    v_max_u32_dpp v42, v42, v42 row_ror:8 row_mask:0xf bank_mask:0xf
    v_mov_b32 v43, v42
    s_nop 1
    v_permlane16_swap_b32 v42, v43
    v_max_u32 v42, v42, v43
    v_mov_b32 v43, v42
    s_nop 1
    v_permlane32_swap_b32 v42, v43
    v_max_u32 v42, v42, v43
    v_cmp_eq_u32 vcc, v42, v34
    s_nop 1
    v_cndmask_b32 v34, v34, v32, vcc
    v_cndmask_b32 v32, v32, v38, vcc
    v_cndmask_b32 v38, v38, v35, vcc
    v_cmp_eq_u32 s[64:65], 4, v10
    s_nop 1
    v_cndmask_b32 v44, v44, v42, s[64:65]
    v_max_u32_dpp v42, v34, v34 row_ror:1 row_mask:0xf bank_mask:0xf
    s_nop 1
    v_max_u32_dpp v42, v42, v42 row_ror:2 row_mask:0xf bank_mask:0xf
    s_nop 1
    v_max_u32_dpp v42, v42, v42 row_ror:4 row_mask:0xf bank_mask:0xf
    s_nop 1
    v_max_u32_dpp v42, v42, v42 row_ror:8 row_mask:0xf bank_mask:0xf
    v_mov_b32 v43, v42
    s_nop 1
    v_permlane16_swap_b32 v42, v43
    v_max_u32 v42, v42, v43
    v_mov_b32 v43, v42
    s_nop 1
    v_permlane32_swap_b32 v42, v43
    v_max_u32 v42, v42, v43
    v_cmp_eq_u32 vcc, v42, v34
    s_nop 1
    v_cndmask_b32 v34, v34, v32, vcc
    v_cndmask_b32 v32, v32, v38, vcc
    v_cmp_eq_u32 s[64:65], 5, v10
    s_nop 1
    v_cndmask_b32 v44, v44, v42, s[64:65]
    v_max_u32_dpp v42, v34, v34 row_ror:1 row_mask:0xf bank_mask:0xf
    s_nop 1
    v_max_u32_dpp v42, v42, v42 row_ror:2 row_mask:0xf bank_mask:0xf
    s_nop 1
    v_max_u32_dpp v42, v42, v42 row_ror:4 row_mask:0xf bank_mask:0xf
    s_nop 1
    v_max_u32_dpp v42, v42, v42 row_ror:8 row_mask:0xf bank_mask:0xf
    v_mov_b32 v43, v42
    s_nop 1
    v_permlane16_swap_b32 v42, v43
    v_max_u32 v42, v42, v43
    v_mov_b32 v43, v42
    s_nop 1
    v_permlane32_swap_b32 v42, v43
    v_max_u32 v42, v42, v43
    v_cmp_eq_u32 vcc, v42, v34
    s_nop 1
    v_cndmask_b32 v34, v34, v32, vcc
    v_cmp_eq_u32 s[64:65], 6, v10
    s_nop 1
    v_cndmask_b32 v44, v44, v42, s[64:65]
    v_max_u32_dpp v42, v34, v34 row_ror:1 row_mask:0xf bank_mask:0xf
    s_nop 1
    v_max_u32_dpp v42, v42, v42 row_ror:2 row_mask:0xf bank_mask:0xf
    s_nop 1
    v_max_u32_dpp v42, v42, v42 row_ror:4 row_mask:0xf bank_mask:0xf
    s_nop 1
    v_max_u32_dpp v42, v42, v42 row_ror:8 row_mask:0xf bank_mask:0xf
    v_mov_b32 v43, v42
    s_nop 1
    v_permlane16_swap_b32 v42, v43
    v_max_u32 v42, v42, v43
    v_mov_b32 v43, v42
    s_nop 1
    v_permlane32_swap_b32 v42, v43
    v_max_u32 v42, v42, v43
    v_cmp_eq_u32 s[64:65], 7, v10
    s_nop 1
    v_cndmask_b32 v44, v44, v42, s[64:65]
    s_lshl_b32 s3, s5, 5
    s_add_u32 s3, s3, 139264
    v_lshlrev_b32 v11, 2, v10
    v_add_u32 v42, s3, v11
    ds_write_b32 v42, v44
    v_and_b32 v43, 124, v21
    v_add_u32 v43, 139264, v43
    v_mov_b32 v42, 139264
    v_add_u32 v11, 139520, v11
    s_waitcnt lgkmcnt(0)
    s_barrier
    ds_read_b32 v45, v43
    ds_read_b128 v[192:195], v42 offset:0
    ds_read_b128 v[196:199], v42 offset:16
    ds_read_b128 v[200:203], v42 offset:32
    ds_read_b128 v[204:207], v42 offset:48
    ds_read_b128 v[208:211], v42 offset:64
    ds_read_b128 v[212:215], v42 offset:80
    ds_read_b128 v[216:219], v42 offset:96
    ds_read_b128 v[220:223], v42 offset:112
    v_mov_b32 v46, 0
    v_mov_b32 v47, 0
    s_waitcnt lgkmcnt(7)
    v_cmp_gt_u32 vcc, v192, v45
    v_cmp_gt_u32 s[64:65], v193, v45
    s_nop 0
    v_addc_co_u32 v46, vcc, 0, v46, vcc
    v_addc_co_u32 v47, s[64:65], 0, v47, s[64:65]
    v_cmp_gt_u32 vcc, v194, v45
    v_cmp_gt_u32 s[64:65], v195, v45
    s_nop 0
    v_addc_co_u32 v46, vcc, 0, v46, vcc
    v_addc_co_u32 v47, s[64:65], 0, v47, s[64:65]
    s_waitcnt lgkmcnt(6)
    v_cmp_gt_u32 vcc, v196, v45
    v_cmp_gt_u32 s[64:65], v197, v45
    s_nop 0
    v_addc_co_u32 v46, vcc, 0, v46, vcc
    v_addc_co_u32 v47, s[64:65], 0, v47, s[64:65]
    v_cmp_gt_u32 vcc, v198, v45
    v_cmp_gt_u32 s[64:65], v199, v45
    s_nop 0
    v_addc_co_u32 v46, vcc, 0, v46, vcc
    v_addc_co_u32 v47, s[64:65], 0, v47, s[64:65]
    s_waitcnt lgkmcnt(5)
    v_cmp_gt_u32 vcc, v200, v45
    v_cmp_gt_u32 s[64:65], v201, v45
    s_nop 0
    v_addc_co_u32 v46, vcc, 0, v46, vcc
    v_addc_co_u32 v47, s[64:65], 0, v47, s[64:65]
    v_cmp_gt_u32 vcc, v202, v45
    v_cmp_gt_u32 s[64:65], v203, v45
    s_nop 0
    v_addc_co_u32 v46, vcc, 0, v46, vcc
    v_addc_co_u32 v47, s[64:65], 0, v47, s[64:65]
    s_waitcnt lgkmcnt(4)
    v_cmp_gt_u32 vcc, v204, v45
    v_cmp_gt_u32 s[64:65], v205, v45
    s_nop 0
    v_addc_co_u32 v46, vcc, 0, v46, vcc
    v_addc_co_u32 v47, s[64:65], 0, v47, s[64:65]
    v_cmp_gt_u32 vcc, v206, v45
    v_cmp_gt_u32 s[64:65], v207, v45
    s_nop 0
    v_addc_co_u32 v46, vcc, 0, v46, vcc
    v_addc_co_u32 v47, s[64:65], 0, v47, s[64:65]
    s_waitcnt lgkmcnt(3)
    v_cmp_gt_u32 vcc, v208, v45
    v_cmp_gt_u32 s[64:65], v209, v45
    s_nop 0
    v_addc_co_u32 v46, vcc, 0, v46, vcc
    v_addc_co_u32 v47, s[64:65], 0, v47, s[64:65]
    v_cmp_gt_u32 vcc, v210, v45
    v_cmp_gt_u32 s[64:65], v211, v45
    s_nop 0
    v_addc_co_u32 v46, vcc, 0, v46, vcc
    v_addc_co_u32 v47, s[64:65], 0, v47, s[64:65]
    s_waitcnt lgkmcnt(2)
    v_cmp_gt_u32 vcc, v212, v45
    v_cmp_gt_u32 s[64:65], v213, v45
    s_nop 0
    v_addc_co_u32 v46, vcc, 0, v46, vcc
    v_addc_co_u32 v47, s[64:65], 0, v47, s[64:65]
    v_cmp_gt_u32 vcc, v214, v45
    v_cmp_gt_u32 s[64:65], v215, v45
    s_nop 0
    v_addc_co_u32 v46, vcc, 0, v46, vcc
    v_addc_co_u32 v47, s[64:65], 0, v47, s[64:65]
    s_waitcnt lgkmcnt(1)
    v_cmp_gt_u32 vcc, v216, v45
    v_cmp_gt_u32 s[64:65], v217, v45
    s_nop 0
    v_addc_co_u32 v46, vcc, 0, v46, vcc
    v_addc_co_u32 v47, s[64:65], 0, v47, s[64:65]
    v_cmp_gt_u32 vcc, v218, v45
    v_cmp_gt_u32 s[64:65], v219, v45
    s_nop 0
    v_addc_co_u32 v46, vcc, 0, v46, vcc
    v_addc_co_u32 v47, s[64:65], 0, v47, s[64:65]
    s_waitcnt lgkmcnt(0)
    v_cmp_gt_u32 vcc, v220, v45
    v_cmp_gt_u32 s[64:65], v221, v45
    s_nop 0
    v_addc_co_u32 v46, vcc, 0, v46, vcc
    v_addc_co_u32 v47, s[64:65], 0, v47, s[64:65]
    v_cmp_gt_u32 vcc, v222, v45
    v_cmp_gt_u32 s[64:65], v223, v45
    s_nop 0
    v_addc_co_u32 v46, vcc, 0, v46, vcc
    v_addc_co_u32 v47, s[64:65], 0, v47, s[64:65]
    v_add_u32 v46, v46, v47
    v_min_u32 v46, 8, v46
    v_lshl_add_u32 v46, v46, 2, v42
    ds_write_b32 v46, v45 offset:256
    s_waitcnt lgkmcnt(0)
    ds_read_b32 v7, v11
    s_mul_i32 s3, s5, 320
    s_add_u32 s3, s3, 84934656
    s_waitcnt lgkmcnt(0)
    v_bfe_u32 v3, v7, 1, 11
    v_sub_u32 v3, 2047, v3
    v_and_b32 v2, 1, v7
    v_cmp_eq_u32 vcc, 0, v2
    s_nop 0
    s_cmp_eq_u64 vcc, 0
    s_cbranch_scc1 k1_dn55
    v_lshlrev_b32 v1, 2, v3
    s_mov_b32 s62, 83984384
    s_mov_b32 s21, 0
k1_tl56:
    buffer_load_dword v7, v1, s[36:39], s62 offen sc1
    s_waitcnt vmcnt(0)
    v_and_b32 v2, 1, v7
    v_cmp_eq_u32 vcc, 0, v2
    s_nop 0
    s_cmp_eq_u64 vcc, 0
    s_cbranch_scc1 k1_tok57
    s_add_u32 s21, s21, 1
    s_cmp_ge_u32 s21, 0x8000
    s_cbranch_scc1 k1_tok57
    s_sleep 1
    s_branch k1_tl56
k1_tok57:
k1_dn55:
    v_mul_u32_u24 v3, 1280, v3
    v_lshl_add_u32 v3, v8, 4, v3
    buffer_load_dwordx4 v[128:131], v3, s[36:39], s3 offen offset:0 sc1
    buffer_load_dwordx4 v[132:135], v3, s[36:39], s3 offen offset:64 sc1
    buffer_load_dwordx4 v[136:139], v3, s[36:39], s3 offen offset:128 sc1
    buffer_load_dwordx4 v[140:143], v3, s[36:39], s3 offen offset:192 sc1
    buffer_load_dwordx4 v[144:147], v3, s[36:39], s3 offen offset:256 sc1
    s_or_b32 s3, s23, s5
    s_cmp_eq_u32 s3, 0
    s_cselect_b32 s3, 84020224, 1073741824
    v_mov_b32 v1, 1073741824
    v_cmp_gt_u32 vcc, 8, v0
    s_nop 1
    v_cndmask_b32 v1, v1, v21, vcc
    buffer_store_dword v7, v1, s[36:39], s3 offen sc1
    v_and_b32 v2, 15, v0
    v_mul_u32_u24 v3, 3456, v2
    v_lshl_add_u32 v3, v8, 3, v3
    v_mov_b32 v1, 1073741824
    v_cmp_gt_u32 vcc, 8, v2
    s_nop 1
    v_cndmask_b32 v14, v1, v3, vcc
    s_add_u32 s61, s61, 83992576
    s_waitcnt vmcnt(5)
    v_mfma_f32_16x16x32_bf16 v[224:227], v[64:67], v[128:131], 0
    v_mfma_f32_16x16x32_bf16 v[228:231], v[84:87], v[128:131], 0
    s_waitcnt vmcnt(4)
    v_mfma_f32_16x16x32_bf16 v[224:227], v[68:71], v[132:135], v[224:227]
    v_mfma_f32_16x16x32_bf16 v[228:231], v[88:91], v[132:135], v[228:231]
    s_waitcnt vmcnt(3)
    v_mfma_f32_16x16x32_bf16 v[224:227], v[72:75], v[136:139], v[224:227]
    v_mfma_f32_16x16x32_bf16 v[228:231], v[92:95], v[136:139], v[228:231]
    s_waitcnt vmcnt(2)
    v_mfma_f32_16x16x32_bf16 v[224:227], v[76:79], v[140:143], v[224:227]
    v_mfma_f32_16x16x32_bf16 v[228:231], v[96:99], v[140:143], v[228:231]
    s_waitcnt vmcnt(1)
    v_mfma_f32_16x16x32_bf16 v[224:227], v[80:83], v[144:147], v[224:227]
    v_mfma_f32_16x16x32_bf16 v[228:231], v[100:103], v[144:147], v[228:231]
    s_nop 6
    ds_write_b128 v12, v[224:227]
    ds_write_b128 v12, v[228:231] offset:1024
    s_waitcnt lgkmcnt(0)
    s_barrier
    s_cmp_lg_u32 s5, 0
    s_cbranch_scc1 k1_done
    ds_read_b128 v[32:35], v13 offset:2048
    ds_read_b128 v[36:39], v13 offset:3072
    ds_read_b128 v[40:43], v13 offset:4096
    ds_read_b128 v[44:47], v13 offset:5120
    ds_read_b128 v[48:51], v13 offset:6144
    ds_read_b128 v[52:55], v13 offset:7168
    s_mov_b32 s3, 0xbfb8aa3b
    s_waitcnt lgkmcnt(4)
    v_add_f32 v224, v224, v32
    v_add_f32 v225, v225, v33
    v_add_f32 v226, v226, v34
    v_add_f32 v227, v227, v35
    v_add_f32 v228, v228, v36
    v_add_f32 v229, v229, v37
    v_add_f32 v230, v230, v38
    v_add_f32 v231, v231, v39
    s_waitcnt lgkmcnt(2)
    v_add_f32 v224, v224, v40
    v_add_f32 v225, v225, v41
    v_add_f32 v226, v226, v42
    v_add_f32 v227, v227, v43
    v_add_f32 v228, v228, v44
    v_add_f32 v229, v229, v45
    v_add_f32 v230, v230, v46
    v_add_f32 v231, v231, v47
    s_waitcnt lgkmcnt(0)
    v_add_f32 v224, v224, v48
    v_add_f32 v225, v225, v49
    v_add_f32 v226, v226, v50
    v_add_f32 v227, v227, v51
    v_add_f32 v228, v228, v52
    v_add_f32 v229, v229, v53
    v_add_f32 v230, v230, v54
    v_add_f32 v231, v231, v55
    v_cvt_pk_bf16_f32 v16, v224, v225
    v_cvt_pk_bf16_f32 v17, v226, v227
    v_cvt_pk_bf16_f32 v18, v228, v229
    v_cvt_pk_bf16_f32 v19, v230, v231
    v_lshlrev_b32 v224, 16, v16
    v_and_b32 v225, 0xffff0000, v16
    v_lshlrev_b32 v226, 16, v17
    v_and_b32 v227, 0xffff0000, v17
    v_lshlrev_b32 v228, 16, v18
    v_and_b32 v229, 0xffff0000, v18
    v_lshlrev_b32 v230, 16, v19
    v_and_b32 v231, 0xffff0000, v19
    v_mul_f32 v16, s3, v224
    v_mul_f32 v17, s3, v225
    v_mul_f32 v18, s3, v226
    v_mul_f32 v19, s3, v227
    v_exp_f32 v16, v16
    v_exp_f32 v17, v17
    v_exp_f32 v18, v18
    v_exp_f32 v19, v19
    v_add_f32 v16, 1.0, v16
    v_add_f32 v17, 1.0, v17
    v_add_f32 v18, 1.0, v18
    v_add_f32 v19, 1.0, v19
    v_rcp_f32 v16, v16
    v_rcp_f32 v17, v17
    v_rcp_f32 v18, v18
    v_rcp_f32 v19, v19
    v_mul_f32 v224, v224, v16
    v_mul_f32 v225, v225, v17
    v_mul_f32 v226, v226, v18
    v_mul_f32 v227, v227, v19
    v_cvt_pk_bf16_f32 v16, v224, v225
    v_cvt_pk_bf16_f32 v17, v226, v227
    v_lshlrev_b32 v224, 16, v16
    v_and_b32 v225, 0xffff0000, v16
    v_lshlrev_b32 v226, 16, v17
    v_and_b32 v227, 0xffff0000, v17
    v_mul_f32 v224, v224, v228
    v_mul_f32 v225, v225, v229
    v_mul_f32 v226, v226, v230
    v_mul_f32 v227, v227, v231
    v_cvt_pk_bf16_f32 v16, v224, v225
    v_cvt_pk_bf16_f32 v17, v226, v227
    buffer_store_dwordx2 v[16:17], v14, s[36:39], s61 offen sc1
    s_branch k1_done
k1_mo2:
    s_mul_i32 s57, s57, 5
    s_add_u32 s23, s57, s56
    s_sub_u32 s23, s23, 14
    s_lshl_b32 s61, s23, 5
    s_cmp_eq_u32 s5, 3
    s_cselect_b32 s62, 81920, 0
    s_cselect_b32 s63, 128, 0
    s_mov_b32 s48, s94
    s_mov_b32 s49, s95
    s_mov_b32 s50, 2211840
    s_mov_b32 s51, 0x00020000
    v_mul_u32_u24 v4, 1280, v5
    v_add_u32 v4, v4, v9
    s_mul_i32 s60, s5, 573440
    s_add_u32 s60, s60, s61
    s_add_u32 m0, s58, 0
    s_add_u32 s3, s60, 0
    buffer_load_dwordx4 v4, s[48:51], s3 offen lds
    s_add_u32 m0, s58, 1024
    s_add_u32 s3, s60, 40960
    buffer_load_dwordx4 v4, s[48:51], s3 offen lds
    s_add_u32 m0, s58, 2048
    s_add_u32 s3, s60, 81920
    buffer_load_dwordx4 v4, s[48:51], s3 offen lds
    s_add_u32 m0, s58, 3072
    s_add_u32 s3, s60, 122880
    buffer_load_dwordx4 v4, s[48:51], s3 offen lds
    s_add_u32 m0, s58, 4096
    s_add_u32 s3, s60, 163840
    buffer_load_dwordx4 v4, s[48:51], s3 offen lds
    s_add_u32 m0, s58, 5120
    s_add_u32 s3, s60, 204800
    buffer_load_dwordx4 v4, s[48:51], s3 offen lds
    s_add_u32 m0, s58, 6144
    s_add_u32 s3, s60, 245760
    buffer_load_dwordx4 v4, s[48:51], s3 offen lds
    s_add_u32 m0, s58, 7168
    s_add_u32 s3, s60, 286720
    buffer_load_dwordx4 v4, s[48:51], s3 offen lds
    s_add_u32 m0, s58, 8192
    s_add_u32 s3, s60, 327680
    buffer_load_dwordx4 v4, s[48:51], s3 offen lds
    s_add_u32 m0, s58, 9216
    s_add_u32 s3, s60, 368640
    buffer_load_dwordx4 v4, s[48:51], s3 offen lds
    s_add_u32 m0, s58, 10240
    s_add_u32 s3, s60, 409600
    buffer_load_dwordx4 v4, s[48:51], s3 offen lds
    s_add_u32 m0, s58, 11264
    s_add_u32 s3, s60, 450560
    buffer_load_dwordx4 v4, s[48:51], s3 offen lds
    s_add_u32 m0, s58, 12288
    s_sub_u32 s60, s60, s62
    s_add_u32 s3, s60, 491520
    buffer_load_dwordx4 v4, s[48:51], s3 offen lds
    s_add_u32 m0, s58, 13312
    s_add_u32 s3, s60, 532480
    buffer_load_dwordx4 v4, s[48:51], s3 offen lds
    v_lshlrev_b32 v11, 3, v8
    s_add_u32 s3, s61, 83892480
    buffer_load_dwordx2 v[28:29], v11, s[36:39], s3 offen sc1
    v_mul_u32_u24 v3, 3456, v10
    v_lshl_add_u32 v3, v8, 4, v3
    v_lshlrev_b32 v2, 2, v10
    s_mul_i32 s60, s5, 896
    s_add_u32 s60, s60, 83992576
    s_sub_u32 s63, s60, s63
    s_mov_b32 s62, 84020224
    s_waitcnt vmcnt(0)
    ds_read_b64_tr_b16 v[64:65], v6 offset:0
    ds_read_b64_tr_b16 v[66:67], v6 offset:128
    ds_read_b64_tr_b16 v[68:69], v6 offset:1024
    ds_read_b64_tr_b16 v[70:71], v6 offset:1152
    ds_read_b64_tr_b16 v[72:73], v6 offset:2048
    ds_read_b64_tr_b16 v[74:75], v6 offset:2176
    ds_read_b64_tr_b16 v[76:77], v6 offset:3072
    ds_read_b64_tr_b16 v[78:79], v6 offset:3200
    ds_read_b64_tr_b16 v[80:81], v6 offset:4096
    ds_read_b64_tr_b16 v[82:83], v6 offset:4224
    ds_read_b64_tr_b16 v[84:85], v6 offset:5120
    ds_read_b64_tr_b16 v[86:87], v6 offset:5248
    ds_read_b64_tr_b16 v[88:89], v6 offset:6144
    ds_read_b64_tr_b16 v[90:91], v6 offset:6272
    ds_read_b64_tr_b16 v[92:93], v6 offset:7168
    ds_read_b64_tr_b16 v[94:95], v6 offset:7296
    ds_read_b64_tr_b16 v[96:97], v6 offset:8192
    ds_read_b64_tr_b16 v[98:99], v6 offset:8320
    ds_read_b64_tr_b16 v[100:101], v6 offset:9216
    ds_read_b64_tr_b16 v[102:103], v6 offset:9344
    ds_read_b64_tr_b16 v[104:105], v6 offset:10240
    ds_read_b64_tr_b16 v[106:107], v6 offset:10368
    ds_read_b64_tr_b16 v[108:109], v6 offset:11264
    ds_read_b64_tr_b16 v[110:111], v6 offset:11392
    ds_read_b64_tr_b16 v[112:113], v6 offset:12288
    ds_read_b64_tr_b16 v[114:115], v6 offset:12416
    ds_read_b64_tr_b16 v[116:117], v6 offset:13312
    ds_read_b64_tr_b16 v[118:119], v6 offset:13440
    s_mov_b32 s21, 0
k1_tl58:
    buffer_load_dword v7, v2, s[36:39], s62 offen sc1
    s_waitcnt vmcnt(0)
    v_cmp_eq_u32 vcc, -1, v7
    s_nop 0
    s_cmp_eq_u64 vcc, 0
    s_cbranch_scc1 k1_tok59
    s_add_u32 s21, s21, 1
    s_cmp_ge_u32 s21, 0x8000
    s_cbranch_scc1 k1_tok59
    s_sleep 4
    s_branch k1_tl58
k1_tok59:
    v_bfe_u32 v14, v7, 1, 11
    v_sub_u32 v14, 2047, v14
    v_mul_u32_u24 v14, 1280, v14
    v_add_u32 v14, v14, v11
    s_add_u32 s3, s61, 84934656
    buffer_load_dwordx2 v[24:25], v14, s[36:39], s3 offen sc1
    s_add_u32 s3, s61, 88080384
    buffer_load_dwordx2 v[26:27], v14, s[36:39], s3 offen sc1
    v_and_b32 v15, 0xffff0000, v7
    v_ashrrev_i32 v16, 31, v15
    v_not_b32 v16, v16
    v_or_b32 v16, 0x80000000, v16
    v_xor_b32 v15, v15, v16
    v_and_b32 v15, 0xffff0000, v15
    v_mul_f32 v15, 0xbfb8aa3b, v15
    v_exp_f32 v15, v15
    s_nop 0
    v_add_f32 v15, 1.0, v15
    v_rcp_f32 v15, v15
    s_nop 0
    v_cvt_pk_bf16_f32 v15, v15, v15
    v_lshlrev_b32 v15, 16, v15
    v_and_b32 v2, 15, v0
    v_mov_b32 v1, 1073741824
    v_cmp_gt_u32 vcc, 8, v2
    s_nop 1
    v_cndmask_b32 v14, v1, v14, vcc
    s_mov_b32 s21, 0
k1_tl60:
    buffer_load_dwordx4 v[128:131], v3, s[36:39], s60 offen offset:0 sc1
    buffer_load_dwordx4 v[132:135], v3, s[36:39], s60 offen offset:64 sc1
    buffer_load_dwordx4 v[136:139], v3, s[36:39], s60 offen offset:128 sc1
    buffer_load_dwordx4 v[140:143], v3, s[36:39], s60 offen offset:192 sc1
    buffer_load_dwordx4 v[144:147], v3, s[36:39], s60 offen offset:256 sc1
    buffer_load_dwordx4 v[148:151], v3, s[36:39], s60 offen offset:320 sc1
    buffer_load_dwordx4 v[152:155], v3, s[36:39], s60 offen offset:384 sc1
    buffer_load_dwordx4 v[156:159], v3, s[36:39], s60 offen offset:448 sc1
    buffer_load_dwordx4 v[160:163], v3, s[36:39], s60 offen offset:512 sc1
    buffer_load_dwordx4 v[164:167], v3, s[36:39], s60 offen offset:576 sc1
    buffer_load_dwordx4 v[168:171], v3, s[36:39], s60 offen offset:640 sc1
    buffer_load_dwordx4 v[172:175], v3, s[36:39], s60 offen offset:704 sc1
    buffer_load_dwordx4 v[176:179], v3, s[36:39], s63 offen offset:768 sc1
    buffer_load_dwordx4 v[180:183], v3, s[36:39], s63 offen offset:832 sc1
    s_waitcnt vmcnt(0)
    v_max_u32 v32, v128, v129
    v_max_u32 v33, v130, v131
    v_max_u32 v34, v132, v133
    v_max_u32 v35, v134, v135
    v_max3_u32 v32, v32, v136, v137
    v_max3_u32 v33, v33, v138, v139
    v_max3_u32 v34, v34, v140, v141
    v_max3_u32 v35, v35, v142, v143
    v_max3_u32 v32, v32, v144, v145
    v_max3_u32 v33, v33, v146, v147
    v_max3_u32 v34, v34, v148, v149
    v_max3_u32 v35, v35, v150, v151
    v_max3_u32 v32, v32, v152, v153
    v_max3_u32 v33, v33, v154, v155
    v_max3_u32 v34, v34, v156, v157
    v_max3_u32 v35, v35, v158, v159
    v_max3_u32 v32, v32, v160, v161
    v_max3_u32 v33, v33, v162, v163
    v_max3_u32 v34, v34, v164, v165
    v_max3_u32 v35, v35, v166, v167
    v_max3_u32 v32, v32, v168, v169
    v_max3_u32 v33, v33, v170, v171
    v_max3_u32 v34, v34, v172, v173
    v_max3_u32 v35, v35, v174, v175
    v_max3_u32 v32, v32, v176, v177
    v_max3_u32 v33, v33, v178, v179
    v_max3_u32 v34, v34, v180, v181
    v_max3_u32 v35, v35, v182, v183
    v_max3_u32 v32, v32, v33, v34
    v_max_u32 v32, v32, v35
    v_cmp_eq_u32 vcc, -1, v32
    s_nop 0
    s_cmp_eq_u64 vcc, 0
    s_cbranch_scc1 k1_tok61
    s_add_u32 s21, s21, 1
    s_cmp_ge_u32 s21, 0x8000
    s_cbranch_scc1 k1_tok61
    s_sleep 1
    s_branch k1_tl60
k1_tok61:
    s_waitcnt lgkmcnt(0)
    v_mfma_f32_16x16x32_bf16 v[224:227], v[64:67], v[128:131], 0
    v_mfma_f32_16x16x32_bf16 v[228:231], v[68:71], v[132:135], 0
    v_mfma_f32_16x16x32_bf16 v[224:227], v[72:75], v[136:139], v[224:227]
    v_mfma_f32_16x16x32_bf16 v[228:231], v[76:79], v[140:143], v[228:231]
    v_mfma_f32_16x16x32_bf16 v[224:227], v[80:83], v[144:147], v[224:227]
    v_mfma_f32_16x16x32_bf16 v[228:231], v[84:87], v[148:151], v[228:231]
    v_mfma_f32_16x16x32_bf16 v[224:227], v[88:91], v[152:155], v[224:227]
    v_mfma_f32_16x16x32_bf16 v[228:231], v[92:95], v[156:159], v[228:231]
    v_mfma_f32_16x16x32_bf16 v[224:227], v[96:99], v[160:163], v[224:227]
    v_mfma_f32_16x16x32_bf16 v[228:231], v[100:103], v[164:167], v[228:231]
    v_mfma_f32_16x16x32_bf16 v[224:227], v[104:107], v[168:171], v[224:227]
    v_mfma_f32_16x16x32_bf16 v[228:231], v[108:111], v[172:175], v[228:231]
    s_cmp_eq_u32 s5, 3
    s_cbranch_scc1 k1_m2s62
    v_mfma_f32_16x16x32_bf16 v[224:227], v[112:115], v[176:179], v[224:227]
    v_mfma_f32_16x16x32_bf16 v[228:231], v[116:119], v[180:183], v[228:231]
k1_m2s62:
    s_nop 7
    v_add_f32 v224, v224, v228
    v_add_f32 v225, v225, v229
    v_add_f32 v226, v226, v230
    v_add_f32 v227, v227, v231
    ds_write_b128 v12, v[224:227]
    s_waitcnt lgkmcnt(0)
    s_barrier
    s_cmp_lg_u32 s5, 0
    s_cbranch_scc1 k1_done
    ds_read_b128 v[32:35], v13 offset:2048
    ds_read_b128 v[36:39], v13 offset:4096
    ds_read_b128 v[40:43], v13 offset:6144
    v_lshlrev_b32 v48, 16, v24
    v_and_b32 v49, 0xffff0000, v24
    v_lshlrev_b32 v50, 16, v25
    v_and_b32 v51, 0xffff0000, v25
    v_lshlrev_b32 v52, 16, v26
    v_and_b32 v53, 0xffff0000, v26
    v_lshlrev_b32 v54, 16, v27
    v_and_b32 v55, 0xffff0000, v27
    v_lshlrev_b32 v56, 16, v28
    v_and_b32 v57, 0xffff0000, v28
    v_lshlrev_b32 v58, 16, v29
    v_and_b32 v59, 0xffff0000, v29
    s_waitcnt lgkmcnt(2)
    v_add_f32 v224, v224, v32
    v_add_f32 v225, v225, v33
    v_add_f32 v226, v226, v34
    v_add_f32 v227, v227, v35
    s_waitcnt lgkmcnt(1)
    v_add_f32 v224, v224, v36
    v_add_f32 v225, v225, v37
    v_add_f32 v226, v226, v38
    v_add_f32 v227, v227, v39
    s_waitcnt lgkmcnt(0)
    v_add_f32 v224, v224, v40
    v_add_f32 v225, v225, v41
    v_add_f32 v226, v226, v42
    v_add_f32 v227, v227, v43
    v_cvt_pk_bf16_f32 v16, v224, v225
    v_cvt_pk_bf16_f32 v17, v226, v227
    v_lshlrev_b32 v224, 16, v16
    v_and_b32 v225, 0xffff0000, v16
    v_lshlrev_b32 v226, 16, v17
    v_and_b32 v227, 0xffff0000, v17
    v_mul_f32 v224, v224, v15
    v_mul_f32 v225, v225, v15
    v_mul_f32 v226, v226, v15
    v_mul_f32 v227, v227, v15
    v_cvt_pk_bf16_f32 v16, v224, v225
    v_cvt_pk_bf16_f32 v17, v226, v227
    v_lshlrev_b32 v224, 16, v16
    v_and_b32 v225, 0xffff0000, v16
    v_lshlrev_b32 v226, 16, v17
    v_and_b32 v227, 0xffff0000, v17
    v_add_f32 v224, v224, v48
    v_add_f32 v225, v225, v49
    v_add_f32 v226, v226, v50
    v_add_f32 v227, v227, v51
    v_cvt_pk_bf16_f32 v16, v224, v225
    v_cvt_pk_bf16_f32 v17, v226, v227
    v_lshlrev_b32 v224, 16, v16
    v_and_b32 v225, 0xffff0000, v16
    v_lshlrev_b32 v226, 16, v17
    v_and_b32 v227, 0xffff0000, v17
    v_mul_f32 v224, v224, v56
    v_mul_f32 v225, v225, v57
    v_mul_f32 v226, v226, v58
    v_mul_f32 v227, v227, v59
    v_cvt_pk_bf16_f32 v16, v224, v225
    v_cvt_pk_bf16_f32 v17, v226, v227
    v_lshlrev_b32 v224, 16, v16
    v_and_b32 v225, 0xffff0000, v16
    v_lshlrev_b32 v226, 16, v17
    v_and_b32 v227, 0xffff0000, v17
    v_add_f32 v224, v224, v52
    v_add_f32 v225, v225, v53
    v_add_f32 v226, v226, v54
    v_add_f32 v227, v227, v55
    v_cvt_pk_bf16_f32 v16, v224, v225
    v_cvt_pk_bf16_f32 v17, v226, v227
    buffer_store_dwordx2 v[16:17], v14, s[16:19], s61 offen sc1
k1_done:
    s_endpgm
k1_spin1:
    s_mov_b32 s11, 0
k1_lp63:
    s_sleep 4
    buffer_load_dword v29, v22, s[44:47], 0 offen offset:0 sc1
    s_waitcnt vmcnt(0)
    s_add_u32 s11, s11, 1
    s_cmp_ge_u32 s11, 0x4000
    s_cbranch_scc1 k1_back2
    v_readfirstlane_b32 s3, v29
    s_nop 0
    s_cmp_ge_u32 s3, 80
    s_cbranch_scc0 k1_lp63
    s_branch k1_back2
k1_spin3:
    s_mov_b32 s11, 0
k1_lp64:
    s_sleep 4
    buffer_load_dword v29, v22, s[44:47], 0 offen offset:128 sc1
    s_waitcnt vmcnt(0)
    s_add_u32 s11, s11, 1
    s_cmp_ge_u32 s11, 0x4000
    s_cbranch_scc1 k1_back4
    v_readfirstlane_b32 s3, v29
    s_nop 0
    s_cmp_ge_u32 s3, 160
    s_cbranch_scc0 k1_lp64
    s_branch k1_back4
k1_spin5:
    s_mov_b32 s11, 0
k1_lp65:
    s_sleep 4
    buffer_load_dword v29, v23, s[36:39], s18 offen sc1
    s_waitcnt vmcnt(0)
    s_add_u32 s11, s11, 1
    s_cmp_ge_u32 s11, 0x4000
    s_cbranch_scc1 k1_back6
    v_cmp_le_u32 vcc, 1, v29
    s_nop 0
    s_mov_b32 s3, vcc_lo
    s_and_b32 s3, s3, 65535
    s_cmp_eq_u32 s3, 65535
    s_cbranch_scc0 k1_lp65
    s_branch k1_back6
k1_spin7:
    s_mov_b32 s11, 0
k1_lp66:
    s_sleep 4
    buffer_load_dword v29, v31, s[36:39], s18 offen sc1
    s_waitcnt vmcnt(0)
    s_add_u32 s11, s11, 1
    s_cmp_ge_u32 s11, 0x4000
    s_cbranch_scc1 k1_back8
    v_cmp_le_u32 vcc, 1, v29
    s_nop 0
    s_mov_b32 s3, vcc_lo
    s_and_b32 s3, s3, 255
    s_cmp_eq_u32 s3, 255
    s_cbranch_scc0 k1_lp66
    s_branch k1_back8
k1_spin9:
    s_mov_b32 s11, 0
k1_lp67:
    s_sleep 4
    buffer_load_dword v29, v22, s[44:47], 0 offen offset:0 sc1
    s_waitcnt vmcnt(0)
    s_add_u32 s11, s11, 1
    s_cmp_ge_u32 s11, 0x4000
    s_cbranch_scc1 k1_back10
    v_readfirstlane_b32 s3, v29
    s_nop 0
    s_cmp_ge_u32 s3, 80
    s_cbranch_scc0 k1_lp67
    s_branch k1_back10
k1_spin11:
    s_mov_b32 s11, 0
k1_lp68:
    s_sleep 4
    buffer_load_dword v29, v22, s[44:47], 0 offen offset:128 sc1
    s_waitcnt vmcnt(0)
    s_add_u32 s11, s11, 1
    s_cmp_ge_u32 s11, 0x4000
    s_cbranch_scc1 k1_back12
    v_readfirstlane_b32 s3, v29
    s_nop 0
    s_cmp_ge_u32 s3, 160
    s_cbranch_scc0 k1_lp68
    s_branch k1_back12
k1_spin13:
    s_mov_b32 s11, 0
k1_lp69:
    s_sleep 4
    buffer_load_dword v29, v23, s[36:39], s18 offen sc1
    s_waitcnt vmcnt(0)
    s_add_u32 s11, s11, 1
    s_cmp_ge_u32 s11, 0x4000
    s_cbranch_scc1 k1_back14
    v_cmp_le_u32 vcc, 1, v29
    s_nop 0
    s_mov_b32 s3, vcc_lo
    s_and_b32 s3, s3, 65535
    s_cmp_eq_u32 s3, 65535
    s_cbranch_scc0 k1_lp69
    s_branch k1_back14
k1_spin15:
    s_mov_b32 s11, 0
k1_lp70:
    s_sleep 4
    buffer_load_dword v29, v31, s[36:39], s18 offen sc1
    s_waitcnt vmcnt(0)
    s_add_u32 s11, s11, 1
    s_cmp_ge_u32 s11, 0x4000
    s_cbranch_scc1 k1_back16
    v_cmp_le_u32 vcc, 1, v29
    s_nop 0
    s_mov_b32 s3, vcc_lo
    s_and_b32 s3, s3, 255
    s_cmp_eq_u32 s3, 255
    s_cbranch_scc0 k1_lp70
    s_branch k1_back16
k1_spin17:
    s_mov_b32 s11, 0
k1_lp71:
    s_sleep 4
    buffer_load_dword v29, v31, s[36:39], s18 offen sc1
    s_waitcnt vmcnt(0)
    s_add_u32 s11, s11, 1
    s_cmp_ge_u32 s11, 0x4000
    s_cbranch_scc1 k1_back18
    v_cmp_le_u32 vcc, 2, v29
    s_nop 0
    s_mov_b32 s3, vcc_lo
    s_and_b32 s3, s3, 255
    s_cmp_eq_u32 s3, 255
    s_cbranch_scc0 k1_lp71
    s_branch k1_back18
k1_spin43:
    s_mov_b32 s11, 0
k1_lp72:
    s_sleep 4
    buffer_load_dword v29, v12, s[36:39], s25 offen sc1
    s_waitcnt vmcnt(0)
    s_add_u32 s11, s11, 1
    s_cmp_ge_u32 s11, 0x4000
    s_cbranch_scc1 k1_back44
    v_cmp_le_u32 vcc, 1, v29
    s_nop 0
    s_mov_b32 s3, vcc_lo
    s_and_b32 s3, s3, 15
    s_cmp_eq_u32 s3, 15
    s_cbranch_scc0 k1_lp72
    s_branch k1_back44
k1_fsp:
    s_mov_b32 s62, 83976192
    s_mov_b32 s21, 0
k1_tl73:
    buffer_load_dwordx4 v[4:7], v20, s[36:39], s62 offen sc1
    s_waitcnt vmcnt(0)
    v_min_u32 v16, v4, v5
    v_min3_u32 v16, v16, v6, v7
    v_cmp_eq_u32 vcc, 0, v16
    s_nop 0
    s_cmp_eq_u64 vcc, 0
    s_cbranch_scc1 k1_tok74
    s_add_u32 s21, s21, 1
    s_cmp_ge_u32 s21, 0x8000
    s_cbranch_scc1 k1_tok74
    s_sleep 4
    s_branch k1_tl73
k1_tok74:
    s_branch k1_fbk
k1_hslo:
    s_mov_b32 s21, 0
k1_tl75:
    buffer_load_dword v29, v15, s[36:39], s26 offen sc1
    s_waitcnt vmcnt(0)
    v_cmp_eq_u32 vcc, -1, v29
    s_nop 0
    s_and_b32 s3, vcc_lo, 65535
    s_cmp_eq_u32 s3, 0
    s_cbranch_scc1 k1_tok76
    s_add_u32 s21, s21, 1
    s_cmp_ge_u32 s21, 0x8000
    s_cbranch_scc1 k1_tok76
    s_sleep 4
    s_branch k1_tl75
k1_tok76:
    s_branch k1_hblo
k1_hshi:
    s_mov_b32 s21, 0
k1_tl77:
    buffer_load_dword v29, v15, s[36:39], s26 offen sc1
    s_waitcnt vmcnt(0)
    v_cmp_eq_u32 vcc, -1, v29
    s_nop 0
    s_and_b32 s3, vcc_lo, 4294901760
    s_cmp_eq_u32 s3, 0
    s_cbranch_scc1 k1_tok78
    s_add_u32 s21, s21, 1
    s_cmp_ge_u32 s21, 0x8000
    s_cbranch_scc1 k1_tok78
    s_sleep 4
    s_branch k1_tl77
k1_tok78:
    s_branch k1_hbhi
k1_rd:
    s_add_u32 s16, s16, 1
    s_cmp_ge_u32 s16, 0x400
    s_cbranch_scc1 k1_rdb
    v_add_u32 v9, 81920, v9
    v_add_u32 v10, 81920, v10
    ds_read_b64_tr_b16 v[32:33], v9 offset:0
    ds_read_b64_tr_b16 v[34:35], v9 offset:5120
    ds_read_b64_tr_b16 v[36:37], v10 offset:0
    ds_read_b64_tr_b16 v[38:39], v10 offset:5120
    ds_read_b64_tr_b16 v[40:41], v9 offset:64
    ds_read_b64_tr_b16 v[42:43], v9 offset:5184
    ds_read_b64_tr_b16 v[44:45], v10 offset:64
    ds_read_b64_tr_b16 v[46:47], v10 offset:5184
    ds_read_b64_tr_b16 v[48:49], v9 offset:128
    ds_read_b64_tr_b16 v[50:51], v9 offset:5248
    ds_read_b64_tr_b16 v[52:53], v10 offset:128
    ds_read_b64_tr_b16 v[54:55], v10 offset:5248
    ds_read_b64_tr_b16 v[56:57], v9 offset:192
    ds_read_b64_tr_b16 v[58:59], v9 offset:5312
    ds_read_b64_tr_b16 v[60:61], v10 offset:192
    ds_read_b64_tr_b16 v[62:63], v10 offset:5312
    ds_read_b64_tr_b16 v[64:65], v9 offset:256
    ds_read_b64_tr_b16 v[66:67], v9 offset:5376
    ds_read_b64_tr_b16 v[68:69], v10 offset:256
    ds_read_b64_tr_b16 v[70:71], v10 offset:5376
    buffer_load_dword v29, v15, s[36:39], s26 offen sc1
    s_branch k1_redo
k1_end:
    s_endpgm
.section .rodata,"a"
.p2align 6
.amdhsa_kernel k1_kernel
  .amdhsa_next_free_vgpr 256
  .amdhsa_next_free_sgpr 102
  .amdhsa_accum_offset 256
  .amdhsa_group_segment_fixed_size 0
  .amdhsa_kernarg_size 128
  .amdhsa_user_sgpr_count 2
  .amdhsa_user_sgpr_kernarg_segment_ptr 1
  .amdhsa_system_sgpr_workgroup_id_x 1
.end_amdhsa_kernel
```
